```python
import torch

def _softmax(x, axis=-1):
    return torch.softmax(x, dim=axis)

def _gelu(x):
    return torch.nn.functional.gelu(x, approximate='tanh')

def _silu(x):
    return torch.nn.functional.silu(x)

def _sigmoid(x):
    return torch.sigmoid(x)

def _layernorm(x, axis=-1, eps=1e-05):
    m = x.mean(dim=axis, keepdim=True)
    v = x.var(dim=axis, keepdim=True, unbiased=False)
    return (x - m) / torch.sqrt(v + eps)

def _scatter_add(tgt, idx, src, axis=0):
    return tgt.clone().index_add_(axis, idx, src)

def _segment_sum(src, seg, n):
    out = torch.zeros((n,) + src.shape[1:], dtype=src.dtype)
    return out.index_add_(0, seg, src)

def _pad(x, pw):
    flat = tuple((v for pair in reversed(pw) for v in pair))
    return torch.nn.functional.pad(x, flat)
kernel_name = 'adaLN_cond__memory_aug_recurrent_mem_tr__glu_gated_bilinear__prompt'

def setup_inputs():

    _w = lambda a: (lambda t: t.to(torch.bfloat16) if t.is_floating_point() else t)(torch.as_tensor(a))

    def _A_setup():
        B, S, Dm = (1, 2048, 640)
        H, Dh = (32, 192)
        M, seg = (8, 32)
        seg = min(seg, S)
        S = S // seg * seg
        return {'x': _w((lambda *s: torch.randn(*s, dtype=torch.bfloat16) * 0.05)(B, S, Dm)), 'mem0': _w((lambda *s: torch.randn(*s, dtype=torch.bfloat16) * 0.8)(B, M, Dm)), 'Wq': _w((lambda *s: torch.randn(*s, dtype=torch.bfloat16) * 0.8)(Dm, H, Dh) * Dm ** (-0.5)), 'Wk': _w((lambda *s: torch.randn(*s, dtype=torch.bfloat16) * 0.8)(Dm, H, Dh) * Dm ** (-0.5)), 'Wv': _w((lambda *s: torch.randn(*s, dtype=torch.bfloat16) * 0.8)(Dm, H, Dh) * Dm ** (-0.5)), 'Wo': _w((lambda *s: torch.randn(*s, dtype=torch.bfloat16) * 0.8)(H, Dh, Dm) * (H * Dh) ** (-0.5)), 'seg_len': seg}
    _A_in = _A_setup()

    def _B_setup():
        B, S, D, F = (1, 2048, 640, 1536)
        return {'x': _w((lambda *s: torch.randn(*s, dtype=torch.bfloat16) * 0.05)(B, S, D)), 'w_gate': _w((lambda *s: torch.randn(*s, dtype=torch.bfloat16) * 0.4)(D, F) * D ** (-0.5)), 'w_up': _w((lambda *s: torch.randn(*s, dtype=torch.bfloat16) * 0.4)(D, F) * D ** (-0.5)), 'w_down': _w((lambda *s: torch.randn(*s, dtype=torch.bfloat16) * 0.4)(F, D) * F ** (-0.5))}
    _B_in = _B_setup()
    return {'A_x': _A_in['x'], 'A_mem0': _A_in['mem0'], 'A_Wq': _A_in['Wq'], 'A_Wk': _A_in['Wk'], 'A_Wv': _A_in['Wv'], 'A_Wo': _A_in['Wo'], 'A_seg_len': _A_in['seg_len'], 'B_x': _B_in['x'], 'B_w_gate': _B_in['w_gate'], 'B_w_up': _B_in['w_up'], 'B_w_down': _B_in['w_down'], 'c': _w((lambda *s: torch.randn(*s, dtype=torch.bfloat16) * 0.1)(1, 640) * 8.0), 'w_mod': _w((lambda *s: torch.randn(*s, dtype=torch.bfloat16) * 0.1)(640, 6 * 640) * 640 ** (-0.5) * 8.0)}

def reference(A_x, A_mem0, A_Wq, A_Wk, A_Wv, A_Wo, A_seg_len, B_x, B_w_gate, B_w_up, B_w_down, c, w_mod):

    def _A_ref(x, mem0, Wq, Wk, Wv, Wo, seg_len):
        B, S, Dm = x.shape
        H, Dh = (Wq.shape[1], Wq.shape[2])
        M = mem0.shape[1]
        scale = Dh ** (-0.5)
        n_seg = S // seg_len
        L = M + seg_len
        idx = torch.arange(L)
        mask = (idx[:, None] < M) | (idx[:, None] >= idx[None, :])
        mem = mem0
        outs = []
        for s in range(n_seg):
            xs = x[:, s * seg_len:(s + 1) * seg_len, :].clone()
            h = torch.concatenate([mem, xs], axis=1)
            q = torch.einsum('btd,dhe->bhte', h, Wq)
            k = torch.einsum('btd,dhe->bhte', h, Wk)
            v = torch.einsum('btd,dhe->bhte', h, Wv)
            scores = torch.einsum('bhqe,bhke->bhqk', q, k) * scale
            scores = torch.where(mask[None, None], scores, -1000000000.0)
            p = _softmax(scores, axis=-1)
            o = torch.einsum('bhqk,bhke->bhqe', p, v)
            o = torch.einsum('bhte,hed->btd', o, Wo)
            mem = o[:, :M, :].clone()
            outs.append(o[:, M:, :])
        return torch.concatenate(outs, axis=1)

    def _B_ref(x, w_gate, w_up, w_down):
        g = torch.einsum('bsd,df->bsf', x, w_gate)
        u = torch.einsum('bsd,df->bsf', x, w_up)
        h = g * u
        return torch.einsum('bsf,fd->bsd', h, w_down)
    x = A_x
    mod = (_silu(c) @ w_mod).reshape(c.shape[0], 6, 1, -1)
    sa, ca, ga, sb, cb, gb = (mod[:, 0].clone(), mod[:, 1].clone(), mod[:, 2].clone(), mod[:, 3].clone(), mod[:, 4].clone(), mod[:, 5].clone())
    h = _layernorm(x, axis=-1) * (1 + ca) + sa
    x = x + ga * _A_ref(h, A_mem0, A_Wq, A_Wk, A_Wv, A_Wo, A_seg_len)
    h = _layernorm(x, axis=-1) * (1 + cb) + sb
    x = x + gb * _B_ref(h, B_w_gate, B_w_up, B_w_down)
    return x
```

```asm
; @launch kernel=main_kernel grid=(256,1,1) block=(256,1,1) lds=163840
.amdgcn_target "amdgcn-amd-amdhsa--gfx950"

.macro M32 d, a, b, c
v_mfma_f32_32x32x16_bf16 v[\d:\d+15], \a, \b, \c
.endm
.macro MA d, a, b
v_mfma_f32_32x32x16_bf16 v[\d:\d+15], a[\a:\a+3], a[\b:\b+3], v[\d:\d+15]
.endm
.macro MB d, a, b
v_mfma_f32_32x32x16_bf16 v[\d:\d+15], v[\a:\a+3], a[\b:\b+3], v[\d:\d+15]
.endm
.macro MV d, a, b
v_mfma_f32_32x32x16_bf16 v[\d:\d+15], v[\a:\a+3], v[\b:\b+3], v[\d:\d+15]
.endm
.macro TR f, v, o
ds_read_b64_tr_b16 a[\f:\f+1], v\v offset:\o
.endm
.macro CV d, a, b
v_cvt_pk_bf16_f32 v\d, v\a, v\b
.endm
.macro WL n
s_waitcnt lgkmcnt(\n)
.endm
.macro WV n
s_waitcnt vmcnt(\n)
.endm
.macro DM v, r, s
buffer_load_dwordx4 v\v, s[\r:\r+3], s\s offen lds
.endm
.macro DMC v, r, s
buffer_load_dwordx4 v\v, s[\r:\r+3], s\s offen sc1 lds
.endm
.macro LA a, v, r, s, o
buffer_load_dwordx4 a[\a:\a+3], v\v, s[\r:\r+3], s\s offen offset:\o
.endm
.macro SH d, s
v_lshlrev_b32 v\d, 16, v\s
.endm
.macro HH d, s
v_and_b32 v\d, 0xffff0000, v\s
.endm
.macro SM d, a, b, i
v_smfmac_f32_16x16x64_bf16 v[\d:\d+3], v[\a:\a+3], \b, v\i
.endm
.text
.globl main_kernel
.p2align 8
.type main_kernel,@function
main_kernel:
s_load_dwordx2 s[4:5], s[0:1], 120
s_cmp_ge_u32 s2, 256
s_cbranch_scc1 R_exit
v_lshrrev_b32 v1, 6, v0
WL 0
s_mov_b32 s8, s4
s_and_b32 s9, s5, 0xffff
s_mov_b32 s10, 0x10000000
s_mov_b32 s11, 0x20000
v_readfirstlane_b32 s16, v1
s_load_dwordx2 s[6:7], s[0:1], 112
s_getreg_b32 s50, hwreg(HW_REG_XCC_ID)
s_and_b32 s50, s50, 7
WL 0
s_mov_b32 s12, s6
s_and_b32 s13, s7, 0xffff
s_mov_b32 s14, 0x100
s_mov_b32 s15, 0x20000
s_cmp_eq_u32 s2, 0
s_cbranch_scc0 bc_1
v_lshlrev_b32 v2, 4, v0
v_mov_b32 v4, 0
v_mov_b32 v5, 0
v_mov_b32 v6, 0
v_mov_b32 v7, 0
buffer_store_dwordx4 v[4:7], v2, s[8:11], 0 offen sc1
WV 0
s_barrier
v_mov_b32 v2, 1
v_mov_b32 v3, 108
s_mov_b64 exec, 1
buffer_store_dword v2, v3, s[12:15], 0 offen sc1
WV 0
s_mov_b64 exec, -1
bc_1:
s_mov_b32 s3, -1
s_cmp_eq_u32 s16, 0
s_cbranch_scc0 R_role_wait
s_mov_b64 exec, 1
s_lshl_b32 s52, s50, 2
v_mov_b32 v2, 1
v_mov_b32 v3, s52
buffer_atomic_add v2, v3, s[12:15], 0 offen sc0
WV 0
v_readfirstlane_b32 s51, v2
s_nop 3
s_mov_b32 s81, s51
s_cmp_lt_u32 s50, 4
s_cbranch_scc0 R_role_free
s_cmp_lt_u32 s51, 8
s_cbranch_scc0 R_role_c
s_lshl_b32 s52, s50, 3
s_add_u32 s52, s52, s51
s_branch R_role_try
R_role_c:
s_cmp_lt_u32 s51, 28
s_cbranch_scc0 R_role_free
s_mul_i32 s52, s50, 20
s_add_u32 s52, s52, s51
s_add_u32 s52, s52, 24
R_role_try:
s_lshr_b32 s53, s52, 5
s_lshl_b32 s53, s53, 2
s_add_u32 s53, s53, 64
s_and_b32 s54, s52, 31
s_lshl_b32 s54, 1, s54
v_mov_b32 v2, s54
v_mov_b32 v3, s53
buffer_atomic_or v2, v3, s[12:15], 0 offen sc0
WV 0
v_readfirstlane_b32 s51, v2
s_nop 3
s_and_b32 s51, s51, s54
s_cmp_eq_u32 s51, 0
s_cselect_b32 s3, s52, s3
s_cmp_lt_i32 s3, 0
s_cbranch_scc0 R_role_pub
R_role_free:
s_mov_b32 s22, 0
v_mov_b32 v3, 0
R_role_spin:
buffer_load_dwordx4 v[4:7], v3, s[12:15], 0 offen sc1
buffer_load_dwordx4 v[8:11], v3, s[12:15], 0 offen offset:16 sc1
WV 0
v_min_u32 v2, v4, v5
v_min3_u32 v2, v2, v6, v7
v_add3_u32 v4, v4, v5, v6
v_add3_u32 v8, v8, v9, v10
v_add3_u32 v4, v4, v7, v8
v_add_u32 v4, v4, v11
s_nop 0
v_readfirstlane_b32 s51, v2
v_readfirstlane_b32 s52, v4
s_nop 3
s_cmp_ge_u32 s51, 28
s_cbranch_scc1 R_role_pub
s_cmp_ge_u32 s52, 256
s_cbranch_scc1 R_role_scan
s_sleep 4
s_add_u32 s22, s22, 1
s_cmp_lt_u32 s22, 0x4000
s_cbranch_scc1 R_role_spin
R_role_scan:
R_scan0:
v_mov_b32 v2, 0
v_mov_b32 v3, 64
buffer_atomic_add v2, v3, s[12:15], 0 offen sc0
WV 0
v_readfirstlane_b32 s51, v2
s_nop 3
s_not_b32 s51, s51
s_and_b32 s51, s51, 0xffffffff
s_cmp_eq_u32 s51, 0
s_cbranch_scc1 R_scan0_n
s_ff1_i32_b32 s55, s51
s_add_u32 s55, s55, 0
v_mov_b32 v2, 1
v_mov_b32 v3, 96
buffer_atomic_add v2, v3, s[12:15], 0 offen sc0
WV 0
v_readfirstlane_b32 s51, v2
s_nop 3
s_mov_b32 s52, s55
s_lshr_b32 s53, s52, 5
s_lshl_b32 s53, s53, 2
s_add_u32 s53, s53, 64
s_and_b32 s54, s52, 31
s_lshl_b32 s54, 1, s54
v_mov_b32 v2, s54
v_mov_b32 v3, s53
buffer_atomic_or v2, v3, s[12:15], 0 offen sc0
WV 0
v_readfirstlane_b32 s51, v2
s_nop 3
s_and_b32 s51, s51, s54
s_cmp_eq_u32 s51, 0
s_cselect_b32 s3, s52, s3
s_cmp_lt_i32 s3, 0
s_cbranch_scc0 R_role_pub
s_branch R_scan0
R_scan0_n:
R_scan1:
v_mov_b32 v2, 0
v_mov_b32 v3, 68
buffer_atomic_add v2, v3, s[12:15], 0 offen sc0
WV 0
v_readfirstlane_b32 s51, v2
s_nop 3
s_not_b32 s51, s51
s_and_b32 s51, s51, 0xffffffff
s_cmp_eq_u32 s51, 0
s_cbranch_scc1 R_scan1_n
s_ff1_i32_b32 s55, s51
s_add_u32 s55, s55, 32
v_mov_b32 v2, 1
v_mov_b32 v3, 96
buffer_atomic_add v2, v3, s[12:15], 0 offen sc0
WV 0
v_readfirstlane_b32 s51, v2
s_nop 3
s_mov_b32 s52, s55
s_lshr_b32 s53, s52, 5
s_lshl_b32 s53, s53, 2
s_add_u32 s53, s53, 64
s_and_b32 s54, s52, 31
s_lshl_b32 s54, 1, s54
v_mov_b32 v2, s54
v_mov_b32 v3, s53
buffer_atomic_or v2, v3, s[12:15], 0 offen sc0
WV 0
v_readfirstlane_b32 s51, v2
s_nop 3
s_and_b32 s51, s51, s54
s_cmp_eq_u32 s51, 0
s_cselect_b32 s3, s52, s3
s_cmp_lt_i32 s3, 0
s_cbranch_scc0 R_role_pub
s_branch R_scan1
R_scan1_n:
R_scan2:
v_mov_b32 v2, 0
v_mov_b32 v3, 72
buffer_atomic_add v2, v3, s[12:15], 0 offen sc0
WV 0
v_readfirstlane_b32 s51, v2
s_nop 3
s_not_b32 s51, s51
s_and_b32 s51, s51, 0xffffffff
s_cmp_eq_u32 s51, 0
s_cbranch_scc1 R_scan2_n
s_ff1_i32_b32 s55, s51
s_add_u32 s55, s55, 64
v_mov_b32 v2, 1
v_mov_b32 v3, 96
buffer_atomic_add v2, v3, s[12:15], 0 offen sc0
WV 0
v_readfirstlane_b32 s51, v2
s_nop 3
s_mov_b32 s52, s55
s_lshr_b32 s53, s52, 5
s_lshl_b32 s53, s53, 2
s_add_u32 s53, s53, 64
s_and_b32 s54, s52, 31
s_lshl_b32 s54, 1, s54
v_mov_b32 v2, s54
v_mov_b32 v3, s53
buffer_atomic_or v2, v3, s[12:15], 0 offen sc0
WV 0
v_readfirstlane_b32 s51, v2
s_nop 3
s_and_b32 s51, s51, s54
s_cmp_eq_u32 s51, 0
s_cselect_b32 s3, s52, s3
s_cmp_lt_i32 s3, 0
s_cbranch_scc0 R_role_pub
s_branch R_scan2
R_scan2_n:
R_scan3:
v_mov_b32 v2, 0
v_mov_b32 v3, 76
buffer_atomic_add v2, v3, s[12:15], 0 offen sc0
WV 0
v_readfirstlane_b32 s51, v2
s_nop 3
s_not_b32 s51, s51
s_and_b32 s51, s51, 0xffff
s_cmp_eq_u32 s51, 0
s_cbranch_scc1 R_scan3_n
s_ff1_i32_b32 s55, s51
s_add_u32 s55, s55, 96
v_mov_b32 v2, 1
v_mov_b32 v3, 96
buffer_atomic_add v2, v3, s[12:15], 0 offen sc0
WV 0
v_readfirstlane_b32 s51, v2
s_nop 3
s_mov_b32 s52, s55
s_lshr_b32 s53, s52, 5
s_lshl_b32 s53, s53, 2
s_add_u32 s53, s53, 64
s_and_b32 s54, s52, 31
s_lshl_b32 s54, 1, s54
v_mov_b32 v2, s54
v_mov_b32 v3, s53
buffer_atomic_or v2, v3, s[12:15], 0 offen sc0
WV 0
v_readfirstlane_b32 s51, v2
s_nop 3
s_and_b32 s51, s51, s54
s_cmp_eq_u32 s51, 0
s_cselect_b32 s3, s52, s3
s_cmp_lt_i32 s3, 0
s_cbranch_scc0 R_role_pub
s_branch R_scan3
R_scan3_n:
R_role_pub:
v_mov_b32 v2, s3
v_mov_b32 v3, 0
ds_write_b32 v3, v2
v_mov_b32 v2, s81
ds_write_b32 v3, v2 offset:4
WL 0
s_mov_b64 exec, -1
R_role_wait:
s_barrier
v_mov_b32 v3, 0
ds_read_b32 v2, v3
ds_read_b32 v4, v3 offset:4
WL 0
v_readfirstlane_b32 s3, v2
v_readfirstlane_b32 s81, v4
s_nop 3
s_barrier
s_cmp_lt_u32 s3, 112
s_cbranch_scc0 W_role
s_mov_b32 s17, 0
s_cmp_lt_u32 s3, 32
s_cbranch_scc0 C_role
S_role:
s_cmp_eq_u32 s16, 0
s_cbranch_scc0 dw_3
s_mov_b32 s22, 0
v_mov_b32 v22, 108
dw_2:
buffer_load_dword v23, v22, s[12:15], 0 offen sc1
s_add_u32 s22, s22, 1
s_cmp_gt_u32 s22, 1048576
s_cbranch_scc1 dw_3
WV 0
v_readfirstlane_b32 s23, v23
s_nop 3
s_cmp_ge_u32 s23, 1
s_cbranch_scc1 dw_3
s_sleep 2
s_branch dw_2
dw_3:
s_barrier
s_mul_i32 s90, s16, 6144
s_mul_i32 s91, s16, 5120
v_and_b32 v22, 63, v0
v_lshlrev_b32 v1, 4, v22
v_lshrrev_b32 v23, 5, v22
v_lshlrev_b32 v23, 2, v23
v_and_b32 v24, 15, v22
v_lshrrev_b32 v25, 2, v24
v_add_u32 v23, v23, v25
v_lshrrev_b32 v25, 4, v22
v_and_b32 v25, 1, v25
v_lshlrev_b32 v25, 5, v25
v_and_b32 v26, 3, v24
v_lshlrev_b32 v26, 3, v26
v_add_u32 v25, v25, v26
v_mul_u32_u24 v26, 384, v23
v_add_u32 v26, v26, v25
v_lshrrev_b32 v27, 1, v23
v_and_b32 v27, 1, v27
v_lshlrev_b32 v27, 6, v27
v_add_u32 v2, v26, v27
v_sub_u32 v3, v26, v27
v_mul_u32_u24 v26, 320, v23
v_add_u32 v4, v26, v25
s_mov_b32 s85, 0
B_loopS:
s_barrier
s_cmp_eq_u32 s16, 0
s_cbranch_scc0 dt_4
s_mov_b64 exec, 1
v_mov_b32 v22, 1
v_mov_b32 v23, 128
buffer_atomic_add v22, v23, s[8:11], 0 offen sc0
WV 0
v_mov_b32 v23, 163836
ds_write_b32 v23, v22
WL 0
s_mov_b64 exec, -1
dt_4:
s_barrier
v_mov_b32 v23, 163836
ds_read_b32 v22, v23
WL 0
v_readfirstlane_b32 s84, v22
s_nop 3
s_cmp_ge_u32 s84, 320
s_cbranch_scc1 B_endS
s_and_b32 s41, s84, 31
s_lshr_b32 s40, s84, 5
s_cmp_ge_u32 s40, 5
s_cselect_b32 s83, 1, 0
s_mul_i32 s23, s83, 5
s_sub_u32 s40, s40, s23
s_load_dwordx2 s[6:7], s[0:1], 32
s_load_dwordx2 s[56:57], s[0:1], 40
v_and_b32 v22, 63, v0
s_mul_i32 s23, s16, 320
s_add_u32 s23, s23, 0
v_add_u32 v23, s23, v22
v_mul_u32_u24 v24, 3277, v23
v_lshrrev_b32 v24, 16, v24
v_mul_u32_u24 v25, 20, v24
v_sub_u32 v25, v23, v25
v_lshlrev_b32 v25, 4, v25
v_mul_u32_u24 v24, 1280, v24
v_add_u32 v16, v24, v25
s_mul_i32 s23, s16, 320
s_add_u32 s23, s23, 64
v_add_u32 v23, s23, v22
v_mul_u32_u24 v24, 3277, v23
v_lshrrev_b32 v24, 16, v24
v_mul_u32_u24 v25, 20, v24
v_sub_u32 v25, v23, v25
v_lshlrev_b32 v25, 4, v25
v_mul_u32_u24 v24, 1280, v24
v_add_u32 v17, v24, v25
s_mul_i32 s23, s16, 320
s_add_u32 s23, s23, 128
v_add_u32 v23, s23, v22
v_mul_u32_u24 v24, 3277, v23
v_lshrrev_b32 v24, 16, v24
v_mul_u32_u24 v25, 20, v24
v_sub_u32 v25, v23, v25
v_lshlrev_b32 v25, 4, v25
v_mul_u32_u24 v24, 1280, v24
v_add_u32 v18, v24, v25
s_mul_i32 s23, s16, 320
s_add_u32 s23, s23, 192
v_add_u32 v23, s23, v22
v_mul_u32_u24 v24, 3277, v23
v_lshrrev_b32 v24, 16, v24
v_mul_u32_u24 v25, 20, v24
v_sub_u32 v25, v23, v25
v_lshlrev_b32 v25, 4, v25
v_mul_u32_u24 v24, 1280, v24
v_add_u32 v19, v24, v25
s_mul_i32 s23, s16, 320
s_add_u32 s23, s23, 256
v_add_u32 v23, s23, v22
v_mul_u32_u24 v24, 3277, v23
v_lshrrev_b32 v24, 16, v24
v_mul_u32_u24 v25, 20, v24
v_sub_u32 v25, v23, v25
v_lshlrev_b32 v25, 4, v25
v_mul_u32_u24 v24, 1280, v24
v_add_u32 v20, v24, v25
WL 0
s_mov_b32 s36, s6
s_and_b32 s37, s7, 0xffff
s_mov_b32 s38, 0x780000
s_mov_b32 s39, 0x20000
s_mov_b32 s28, s56
s_and_b32 s29, s57, 0xffff
s_mov_b32 s30, 0x780000
s_mov_b32 s31, 0x20000
s_mul_i32 s46, s41, 245760
s_mul_i32 s23, s83, 640
s_add_u32 s46, s46, s23
v_and_b32 v22, 63, v0
v_and_b32 v23, 31, v22
v_mul_u32_u24 v23, 12288, v23
v_lshrrev_b32 v24, 5, v22
v_lshlrev_b32 v24, 4, v24
v_add_u32 v23, v23, v24
s_lshl_b32 s43, s40, 2
s_add_u32 s43, s43, s16
s_mul_i32 s44, s43, 393216
s_mul_i32 s23, s41, 384
s_add_u32 s44, s44, s23
buffer_load_dwordx4 v[128:131], v23, s[36:39], s44 offen offset:0
buffer_load_dwordx4 v[132:135], v23, s[36:39], s44 offen offset:32
buffer_load_dwordx4 v[136:139], v23, s[36:39], s44 offen offset:64
buffer_load_dwordx4 v[140:143], v23, s[36:39], s44 offen offset:96
buffer_load_dwordx4 v[144:147], v23, s[36:39], s44 offen offset:128
buffer_load_dwordx4 v[148:151], v23, s[36:39], s44 offen offset:160
buffer_load_dwordx4 v[152:155], v23, s[36:39], s44 offen offset:192
buffer_load_dwordx4 v[156:159], v23, s[36:39], s44 offen offset:224
buffer_load_dwordx4 v[160:163], v23, s[36:39], s44 offen offset:256
buffer_load_dwordx4 v[164:167], v23, s[36:39], s44 offen offset:288
buffer_load_dwordx4 v[168:171], v23, s[36:39], s44 offen offset:320
buffer_load_dwordx4 v[172:175], v23, s[36:39], s44 offen offset:352
v_and_b32 v25, 31, v22
v_lshrrev_b32 v26, 3, v25
s_mov_b32 s23, 327680
v_mul_lo_u32 v26, v26, s23
v_lshrrev_b32 v27, 5, v22
v_lshlrev_b32 v27, 4, v27
v_and_b32 v25, 7, v25
v_add_u32 v25, v25, v27
s_lshr_b32 s23, s41, 2
s_and_b32 s23, s23, 1
s_lshl_b32 s23, s23, 3
v_add_u32 v25, s23, v25
v_lshlrev_b32 v25, 4, v25
v_add_u32 v21, v25, v26
s_lshr_b32 s47, s41, 3
s_mul_i32 s47, s47, 81920
s_and_b32 s23, s41, 3
s_mul_i32 s23, s23, 20480
s_add_u32 s47, s47, s23
s_lshl_b32 s23, s43, 10
s_add_u32 s47, s47, s23
s_add_u32 s47, s47, 47185920
s_mul_i32 s23, s83, 13107200
s_add_u32 s47, s47, s23
s_mul_i32 s23, s16, 5120
s_add_u32 m0, s23, 0
s_nop 0
DM 16,28,46
s_add_u32 m0, s23, 1024
s_nop 0
DM 17,28,46
s_add_u32 m0, s23, 2048
s_nop 0
DM 18,28,46
s_add_u32 m0, s23, 3072
s_nop 0
DM 19,28,46
s_add_u32 m0, s23, 4096
s_nop 0
DM 20,28,46
s_add_u32 s46, s46, 81920
s_mul_i32 s23, s16, 5120
s_add_u32 m0, s23, 20480
s_nop 0
DM 16,28,46
s_add_u32 m0, s23, 21504
s_nop 0
DM 17,28,46
s_add_u32 m0, s23, 22528
s_nop 0
DM 18,28,46
s_add_u32 m0, s23, 23552
s_nop 0
DM 19,28,46
s_add_u32 m0, s23, 24576
s_nop 0
DM 20,28,46
s_add_u32 s46, s46, 81920
s_mul_i32 s23, s16, 5120
s_add_u32 m0, s23, 40960
s_nop 0
DM 16,28,46
s_add_u32 m0, s23, 41984
s_nop 0
DM 17,28,46
s_add_u32 m0, s23, 43008
s_nop 0
DM 18,28,46
s_add_u32 m0, s23, 44032
s_nop 0
DM 19,28,46
s_add_u32 m0, s23, 45056
s_nop 0
DM 20,28,46
s_add_u32 s46, s46, -163520
WV 15
v_permlane32_swap_b32 v128, v130
v_permlane32_swap_b32 v129, v131
v_permlane32_swap_b32 v132, v134
v_permlane32_swap_b32 v133, v135
v_permlane32_swap_b32 v136, v138
v_permlane32_swap_b32 v137, v139
v_permlane32_swap_b32 v140, v142
v_permlane32_swap_b32 v141, v143
v_permlane32_swap_b32 v144, v146
v_permlane32_swap_b32 v145, v147
v_permlane32_swap_b32 v148, v150
v_permlane32_swap_b32 v149, v151
v_permlane32_swap_b32 v152, v154
v_permlane32_swap_b32 v153, v155
v_permlane32_swap_b32 v156, v158
v_permlane32_swap_b32 v157, v159
v_permlane32_swap_b32 v160, v162
v_permlane32_swap_b32 v161, v163
v_permlane32_swap_b32 v164, v166
v_permlane32_swap_b32 v165, v167
v_permlane32_swap_b32 v168, v170
v_permlane32_swap_b32 v169, v171
v_permlane32_swap_b32 v172, v174
v_permlane32_swap_b32 v173, v175
s_nop 1
WV 10
s_barrier
v_add_u32 v6, 0, v4
TR 0,6,0
TR 2,6,2560
TR 4,6,64
TR 6,6,2624
TR 8,6,128
TR 10,6,2688
TR 12,6,192
TR 14,6,2752
TR 16,6,256
TR 18,6,2816
WL 8
v_mfma_f32_32x32x16_bf16 v[32:47], v[128:131], a[0:3], 0
TR 24,6,5120
TR 26,6,7680
WL 8
v_mfma_f32_32x32x16_bf16 v[48:63], v[128:131], a[4:7], 0
TR 28,6,5184
TR 30,6,7744
WL 8
v_mfma_f32_32x32x16_bf16 v[64:79], v[128:131], a[8:11], 0
TR 32,6,5248
TR 34,6,7808
WL 8
v_mfma_f32_32x32x16_bf16 v[80:95], v[128:131], a[12:15], 0
TR 36,6,5312
TR 38,6,7872
WL 8
v_mfma_f32_32x32x16_bf16 v[96:111], v[128:131], a[16:19], 0
TR 40,6,5376
TR 42,6,7936
WL 8
MB 32,132,24
TR 0,6,10240
TR 2,6,12800
WL 8
MB 48,132,28
TR 4,6,10304
TR 6,6,12864
WL 8
MB 64,132,32
TR 8,6,10368
TR 10,6,12928
WL 8
MB 80,132,36
TR 12,6,10432
TR 14,6,12992
WL 8
MB 96,132,40
TR 16,6,10496
TR 18,6,13056
WV 5
s_barrier
v_add_u32 v8, 20480, v4
WL 8
MB 32,136,0
TR 24,6,15360
TR 26,6,17920
WL 8
MB 48,136,4
TR 28,6,15424
TR 30,6,17984
s_add_u32 m0, s91, 61440
s_nop 0
DM 16,28,46
WL 8
MB 64,136,8
TR 32,6,15488
TR 34,6,18048
WL 8
MB 80,136,12
TR 36,6,15552
TR 38,6,18112
WL 8
MB 96,136,16
TR 40,6,15616
TR 42,6,18176
s_add_u32 m0, s91, 62464
s_nop 0
DM 17,28,46
WL 8
MB 32,140,24
TR 0,8,0
TR 2,8,2560
WL 8
MB 48,140,28
TR 4,8,64
TR 6,8,2624
s_add_u32 m0, s91, 63488
s_nop 0
DM 18,28,46
WL 8
MB 64,140,32
TR 8,8,128
TR 10,8,2688
WL 8
MB 80,140,36
TR 12,8,192
TR 14,8,2752
WL 8
MB 96,140,40
TR 16,8,256
TR 18,8,2816
s_add_u32 m0, s91, 64512
s_nop 0
DM 19,28,46
WL 8
MB 32,144,0
TR 24,8,5120
TR 26,8,7680
WL 8
MB 48,144,4
TR 28,8,5184
TR 30,8,7744
s_add_u32 m0, s91, 65536
s_nop 0
DM 20,28,46
s_add_u32 s46, s46, 81920
WL 8
MB 64,144,8
TR 32,8,5248
TR 34,8,7808
WL 8
MB 80,144,12
TR 36,8,5312
TR 38,8,7872
WL 8
MB 96,144,16
TR 40,8,5376
TR 42,8,7936
WL 8
MB 32,148,24
TR 0,8,10240
TR 2,8,12800
WL 8
MB 48,148,28
TR 4,8,10304
TR 6,8,12864
WL 8
MB 64,148,32
TR 8,8,10368
TR 10,8,12928
WL 8
MB 80,148,36
TR 12,8,10432
TR 14,8,12992
WL 8
MB 96,148,40
TR 16,8,10496
TR 18,8,13056
WV 5
s_barrier
v_add_u32 v6, 40960, v4
WL 8
MB 32,152,0
TR 24,8,15360
TR 26,8,17920
WL 8
MB 48,152,4
TR 28,8,15424
TR 30,8,17984
s_add_u32 m0, s91, 0
s_nop 0
DM 16,28,46
WL 8
MB 64,152,8
TR 32,8,15488
TR 34,8,18048
WL 8
MB 80,152,12
TR 36,8,15552
TR 38,8,18112
WL 8
MB 96,152,16
TR 40,8,15616
TR 42,8,18176
s_add_u32 m0, s91, 1024
s_nop 0
DM 17,28,46
WL 8
MB 32,156,24
TR 0,6,0
TR 2,6,2560
WL 8
MB 48,156,28
TR 4,6,64
TR 6,6,2624
s_add_u32 m0, s91, 2048
s_nop 0
DM 18,28,46
WL 8
MB 64,156,32
TR 8,6,128
TR 10,6,2688
WL 8
MB 80,156,36
TR 12,6,192
TR 14,6,2752
WL 8
MB 96,156,40
TR 16,6,256
TR 18,6,2816
s_add_u32 m0, s91, 3072
s_nop 0
DM 19,28,46
WL 8
MB 32,160,0
TR 24,6,5120
TR 26,6,7680
WL 8
MB 48,160,4
TR 28,6,5184
TR 30,6,7744
s_add_u32 m0, s91, 4096
s_nop 0
DM 20,28,46
s_add_u32 s46, s46, 81920
WL 8
MB 64,160,8
TR 32,6,5248
TR 34,6,7808
WL 8
MB 80,160,12
TR 36,6,5312
TR 38,6,7872
WL 8
MB 96,160,16
TR 40,6,5376
TR 42,6,7936
WL 8
MB 32,164,24
TR 0,6,10240
TR 2,6,12800
WL 8
MB 48,164,28
TR 4,6,10304
TR 6,6,12864
WL 8
MB 64,164,32
TR 8,6,10368
TR 10,6,12928
WL 8
MB 80,164,36
TR 12,6,10432
TR 14,6,12992
WL 8
MB 96,164,40
TR 16,6,10496
TR 18,6,13056
WV 5
s_barrier
v_add_u32 v8, 61440, v4
WL 8
MB 32,168,0
TR 24,6,15360
TR 26,6,17920
WL 8
MB 48,168,4
TR 28,6,15424
TR 30,6,17984
s_add_u32 m0, s91, 20480
s_nop 0
DM 16,28,46
WL 8
MB 64,168,8
TR 32,6,15488
TR 34,6,18048
WL 8
MB 80,168,12
TR 36,6,15552
TR 38,6,18112
WL 8
MB 96,168,16
TR 40,6,15616
TR 42,6,18176
s_add_u32 m0, s91, 21504
s_nop 0
DM 17,28,46
WL 8
MB 32,172,24
TR 0,8,0
TR 2,8,2560
WL 8
MB 48,172,28
TR 4,8,64
TR 6,8,2624
s_add_u32 m0, s91, 22528
s_nop 0
DM 18,28,46
WL 8
MB 64,172,32
TR 8,8,128
TR 10,8,2688
WL 8
MB 80,172,36
TR 12,8,192
TR 14,8,2752
WL 8
MB 96,172,40
TR 16,8,256
TR 18,8,2816
s_add_u32 m0, s91, 23552
s_nop 0
DM 19,28,46
s_nop 7
s_nop 7
CV 112,32,33
CV 113,36,37
CV 114,34,35
CV 115,38,39
CV 116,40,41
CV 117,44,45
CV 118,42,43
CV 119,46,47
s_add_u32 s48, s47, 0
buffer_store_dwordx4 v[112:115], v21, s[8:11], s48 offen sc1
buffer_store_dwordx4 v[116:119], v21, s[8:11], s48 offen offset:512 sc1
CV 120,48,49
CV 121,52,53
CV 122,50,51
CV 123,54,55
CV 124,56,57
CV 125,60,61
CV 126,58,59
CV 127,62,63
s_add_u32 s48, s47, 1310720
buffer_store_dwordx4 v[120:123], v21, s[8:11], s48 offen sc1
buffer_store_dwordx4 v[124:127], v21, s[8:11], s48 offen offset:512 sc1
CV 112,64,65
CV 113,68,69
CV 114,66,67
CV 115,70,71
CV 116,72,73
CV 117,76,77
CV 118,74,75
CV 119,78,79
s_add_u32 s48, s47, 2621440
buffer_store_dwordx4 v[112:115], v21, s[8:11], s48 offen sc1
buffer_store_dwordx4 v[116:119], v21, s[8:11], s48 offen offset:512 sc1
CV 120,80,81
CV 121,84,85
CV 122,82,83
CV 123,86,87
CV 124,88,89
CV 125,92,93
CV 126,90,91
CV 127,94,95
s_add_u32 s48, s47, 3932160
buffer_store_dwordx4 v[120:123], v21, s[8:11], s48 offen sc1
buffer_store_dwordx4 v[124:127], v21, s[8:11], s48 offen offset:512 sc1
CV 112,96,97
CV 113,100,101
CV 114,98,99
CV 115,102,103
CV 116,104,105
CV 117,108,109
CV 118,106,107
CV 119,110,111
s_add_u32 s48, s47, 5242880
buffer_store_dwordx4 v[112:115], v21, s[8:11], s48 offen sc1
buffer_store_dwordx4 v[116:119], v21, s[8:11], s48 offen offset:512 sc1
WL 8
v_mfma_f32_32x32x16_bf16 v[32:47], v[128:131], a[0:3], 0
TR 24,8,5120
TR 26,8,7680
WL 8
v_mfma_f32_32x32x16_bf16 v[48:63], v[128:131], a[4:7], 0
TR 28,8,5184
TR 30,8,7744
s_add_u32 m0, s91, 24576
s_nop 0
DM 20,28,46
s_add_u32 s46, s46, -163520
WL 8
v_mfma_f32_32x32x16_bf16 v[64:79], v[128:131], a[8:11], 0
TR 32,8,5248
TR 34,8,7808
WL 8
v_mfma_f32_32x32x16_bf16 v[80:95], v[128:131], a[12:15], 0
TR 36,8,5312
TR 38,8,7872
WL 8
v_mfma_f32_32x32x16_bf16 v[96:111], v[128:131], a[16:19], 0
TR 40,8,5376
TR 42,8,7936
WL 8
MB 32,132,24
TR 0,8,10240
TR 2,8,12800
WL 8
MB 48,132,28
TR 4,8,10304
TR 6,8,12864
WL 8
MB 64,132,32
TR 8,8,10368
TR 10,8,12928
WL 8
MB 80,132,36
TR 12,8,10432
TR 14,8,12992
WL 8
MB 96,132,40
TR 16,8,10496
TR 18,8,13056
WV 15
s_barrier
v_add_u32 v6, 0, v4
WL 8
MB 32,136,0
TR 24,8,15360
TR 26,8,17920
WL 8
MB 48,136,4
TR 28,8,15424
TR 30,8,17984
WL 8
MB 64,136,8
TR 32,8,15488
TR 34,8,18048
WL 8
MB 80,136,12
TR 36,8,15552
TR 38,8,18112
WL 8
MB 96,136,16
TR 40,8,15616
TR 42,8,18176
WL 8
MB 32,140,24
TR 0,6,0
TR 2,6,2560
WL 8
MB 48,140,28
TR 4,6,64
TR 6,6,2624
WL 8
MB 64,140,32
TR 8,6,128
TR 10,6,2688
WL 8
MB 80,140,36
TR 12,6,192
TR 14,6,2752
WL 8
MB 96,140,40
TR 16,6,256
TR 18,6,2816
WL 8
MB 32,144,0
TR 24,6,5120
TR 26,6,7680
WL 8
MB 48,144,4
TR 28,6,5184
TR 30,6,7744
WL 8
MB 64,144,8
TR 32,6,5248
TR 34,6,7808
WL 8
MB 80,144,12
TR 36,6,5312
TR 38,6,7872
WL 8
MB 96,144,16
TR 40,6,5376
TR 42,6,7936
WL 8
MB 32,148,24
TR 0,6,10240
TR 2,6,12800
WL 8
MB 48,148,28
TR 4,6,10304
TR 6,6,12864
WL 8
MB 64,148,32
TR 8,6,10368
TR 10,6,12928
WL 8
MB 80,148,36
TR 12,6,10432
TR 14,6,12992
WL 8
MB 96,148,40
TR 16,6,10496
TR 18,6,13056
WV 0
s_barrier
v_add_u32 v8, 20480, v4
WL 8
MB 32,152,0
TR 24,6,15360
TR 26,6,17920
WL 8
MB 48,152,4
TR 28,6,15424
TR 30,6,17984
WL 8
MB 64,152,8
TR 32,6,15488
TR 34,6,18048
WL 8
MB 80,152,12
TR 36,6,15552
TR 38,6,18112
WL 8
MB 96,152,16
TR 40,6,15616
TR 42,6,18176
WL 8
MB 32,156,24
TR 0,8,0
TR 2,8,2560
WL 8
MB 48,156,28
TR 4,8,64
TR 6,8,2624
WL 8
MB 64,156,32
TR 8,8,128
TR 10,8,2688
WL 8
MB 80,156,36
TR 12,8,192
TR 14,8,2752
WL 8
MB 96,156,40
TR 16,8,256
TR 18,8,2816
WL 8
MB 32,160,0
TR 24,8,5120
TR 26,8,7680
WL 8
MB 48,160,4
TR 28,8,5184
TR 30,8,7744
WL 8
MB 64,160,8
TR 32,8,5248
TR 34,8,7808
WL 8
MB 80,160,12
TR 36,8,5312
TR 38,8,7872
WL 8
MB 96,160,16
TR 40,8,5376
TR 42,8,7936
WL 8
MB 32,164,24
TR 0,8,10240
TR 2,8,12800
WL 8
MB 48,164,28
TR 4,8,10304
TR 6,8,12864
WL 8
MB 64,164,32
TR 8,8,10368
TR 10,8,12928
WL 8
MB 80,164,36
TR 12,8,10432
TR 14,8,12992
WL 8
MB 96,164,40
TR 16,8,10496
TR 18,8,13056
WL 8
MB 32,168,0
TR 24,8,15360
TR 26,8,17920
WL 8
MB 48,168,4
TR 28,8,15424
TR 30,8,17984
WL 8
MB 64,168,8
TR 32,8,15488
TR 34,8,18048
WL 8
MB 80,168,12
TR 36,8,15552
TR 38,8,18112
WL 8
MB 96,168,16
TR 40,8,15616
TR 42,8,18176
WL 8
MB 32,172,24
WL 6
MB 48,172,28
WL 4
MB 64,172,32
WL 2
MB 80,172,36
WL 0
MB 96,172,40
s_nop 7
s_nop 7
CV 112,32,33
CV 113,36,37
CV 114,34,35
CV 115,38,39
CV 116,40,41
CV 117,44,45
CV 118,42,43
CV 119,46,47
s_add_u32 s48, s47, 6553600
buffer_store_dwordx4 v[112:115], v21, s[8:11], s48 offen sc1
buffer_store_dwordx4 v[116:119], v21, s[8:11], s48 offen offset:512 sc1
CV 120,48,49
CV 121,52,53
CV 122,50,51
CV 123,54,55
CV 124,56,57
CV 125,60,61
CV 126,58,59
CV 127,62,63
s_add_u32 s48, s47, 7864320
buffer_store_dwordx4 v[120:123], v21, s[8:11], s48 offen sc1
buffer_store_dwordx4 v[124:127], v21, s[8:11], s48 offen offset:512 sc1
CV 112,64,65
CV 113,68,69
CV 114,66,67
CV 115,70,71
CV 116,72,73
CV 117,76,77
CV 118,74,75
CV 119,78,79
s_add_u32 s48, s47, 9175040
buffer_store_dwordx4 v[112:115], v21, s[8:11], s48 offen sc1
buffer_store_dwordx4 v[116:119], v21, s[8:11], s48 offen offset:512 sc1
CV 120,80,81
CV 121,84,85
CV 122,82,83
CV 123,86,87
CV 124,88,89
CV 125,92,93
CV 126,90,91
CV 127,94,95
s_add_u32 s48, s47, 10485760
buffer_store_dwordx4 v[120:123], v21, s[8:11], s48 offen sc1
buffer_store_dwordx4 v[124:127], v21, s[8:11], s48 offen offset:512 sc1
CV 112,96,97
CV 113,100,101
CV 114,98,99
CV 115,102,103
CV 116,104,105
CV 117,108,109
CV 118,106,107
CV 119,110,111
s_add_u32 s48, s47, 11796480
buffer_store_dwordx4 v[112:115], v21, s[8:11], s48 offen sc1
buffer_store_dwordx4 v[116:119], v21, s[8:11], s48 offen offset:512 sc1
WV 0
s_barrier
s_cmp_eq_u32 s16, 0
s_cbranch_scc0 da_5
s_mov_b64 exec, 1
v_mov_b32 v22, 1
v_mov_b32 v23, 512
buffer_atomic_add v22, v23, s[8:11], 0 offen
s_mov_b64 exec, -1
da_5:
s_add_u32 s85, s85, 1
s_cmp_lt_u32 s85, 1
s_cbranch_scc1 B_loopS
B_endS:
s_load_dwordx2 s[6:7], s[0:1], 16
s_load_dwordx2 s[40:41], s[0:1], 24
v_and_b32 v22, 63, v0
s_mul_i32 s23, s16, 384
s_add_u32 s23, s23, 0
v_add_u32 v23, s23, v22
v_mul_u32_u24 v24, 2731, v23
v_lshrrev_b32 v24, 16, v24
v_mul_u32_u24 v25, 24, v24
v_sub_u32 v25, v23, v25
v_lshrrev_b32 v26, 1, v24
v_and_b32 v26, 1, v26
v_lshlrev_b32 v26, 2, v26
v_xor_b32 v25, v25, v26
v_lshlrev_b32 v25, 4, v25
v_mul_u32_u24 v24, 12288, v24
v_add_u32 v2, v24, v25
s_mul_i32 s23, s16, 384
s_add_u32 s23, s23, 64
v_add_u32 v23, s23, v22
v_mul_u32_u24 v24, 2731, v23
v_lshrrev_b32 v24, 16, v24
v_mul_u32_u24 v25, 24, v24
v_sub_u32 v25, v23, v25
v_lshrrev_b32 v26, 1, v24
v_and_b32 v26, 1, v26
v_lshlrev_b32 v26, 2, v26
v_xor_b32 v25, v25, v26
v_lshlrev_b32 v25, 4, v25
v_mul_u32_u24 v24, 12288, v24
v_add_u32 v3, v24, v25
s_mul_i32 s23, s16, 384
s_add_u32 s23, s23, 128
v_add_u32 v23, s23, v22
v_mul_u32_u24 v24, 2731, v23
v_lshrrev_b32 v24, 16, v24
v_mul_u32_u24 v25, 24, v24
v_sub_u32 v25, v23, v25
v_lshrrev_b32 v26, 1, v24
v_and_b32 v26, 1, v26
v_lshlrev_b32 v26, 2, v26
v_xor_b32 v25, v25, v26
v_lshlrev_b32 v25, 4, v25
v_mul_u32_u24 v24, 12288, v24
v_add_u32 v4, v24, v25
s_mul_i32 s23, s16, 384
s_add_u32 s23, s23, 192
v_add_u32 v23, s23, v22
v_mul_u32_u24 v24, 2731, v23
v_lshrrev_b32 v24, 16, v24
v_mul_u32_u24 v25, 24, v24
v_sub_u32 v25, v23, v25
v_lshrrev_b32 v26, 1, v24
v_and_b32 v26, 1, v26
v_lshlrev_b32 v26, 2, v26
v_xor_b32 v25, v25, v26
v_lshlrev_b32 v25, 4, v25
v_mul_u32_u24 v24, 12288, v24
v_add_u32 v5, v24, v25
s_mul_i32 s23, s16, 384
s_add_u32 s23, s23, 256
v_add_u32 v23, s23, v22
v_mul_u32_u24 v24, 2731, v23
v_lshrrev_b32 v24, 16, v24
v_mul_u32_u24 v25, 24, v24
v_sub_u32 v25, v23, v25
v_lshrrev_b32 v26, 1, v24
v_and_b32 v26, 1, v26
v_lshlrev_b32 v26, 2, v26
v_xor_b32 v25, v25, v26
v_lshlrev_b32 v25, 4, v25
v_mul_u32_u24 v24, 12288, v24
v_add_u32 v6, v24, v25
s_mul_i32 s23, s16, 384
s_add_u32 s23, s23, 320
v_add_u32 v23, s23, v22
v_mul_u32_u24 v24, 2731, v23
v_lshrrev_b32 v24, 16, v24
v_mul_u32_u24 v25, 24, v24
v_sub_u32 v25, v23, v25
v_lshrrev_b32 v26, 1, v24
v_and_b32 v26, 1, v26
v_lshlrev_b32 v26, 2, v26
v_xor_b32 v25, v25, v26
v_lshlrev_b32 v25, 4, v25
v_mul_u32_u24 v24, 12288, v24
v_add_u32 v7, v24, v25
v_lshrrev_b32 v23, 4, v22
v_and_b32 v24, 15, v22
v_lshrrev_b32 v25, 1, v23
v_lshlrev_b32 v25, 4, v25
v_and_b32 v26, 1, v23
v_lshlrev_b32 v26, 2, v26
v_add_u32 v25, v25, v26
v_lshrrev_b32 v26, 2, v24
v_and_b32 v27, 1, v26
v_lshrrev_b32 v26, 1, v26
v_lshlrev_b32 v26, 3, v26
v_add3_u32 v25, v25, v26, v27
v_and_b32 v24, 3, v24
v_lshlrev_b32 v24, 2, v24
s_mul_i32 s23, s16, 48
v_add_u32 v24, s23, v24
v_add_u32 v28, 0, v25
v_add_u32 v29, 0, v24
v_lshrrev_b32 v30, 1, v28
v_and_b32 v30, 1, v30
v_lshrrev_b32 v31, 5, v29
v_xor_b32 v30, v30, v31
v_lshlrev_b32 v30, 6, v30
v_and_b32 v29, 31, v29
v_lshlrev_b32 v29, 1, v29
v_mul_u32_u24 v28, 384, v28
v_add3_u32 v112, v28, v29, v30
v_add_u32 v28, 2, v25
v_add_u32 v29, 0, v24
v_lshrrev_b32 v30, 1, v28
v_and_b32 v30, 1, v30
v_lshrrev_b32 v31, 5, v29
v_xor_b32 v30, v30, v31
v_lshlrev_b32 v30, 6, v30
v_and_b32 v29, 31, v29
v_lshlrev_b32 v29, 1, v29
v_mul_u32_u24 v28, 384, v28
v_add3_u32 v113, v28, v29, v30
v_add_u32 v28, 32, v25
v_add_u32 v29, 0, v24
v_lshrrev_b32 v30, 1, v28
v_and_b32 v30, 1, v30
v_lshrrev_b32 v31, 5, v29
v_xor_b32 v30, v30, v31
v_lshlrev_b32 v30, 6, v30
v_and_b32 v29, 31, v29
v_lshlrev_b32 v29, 1, v29
v_mul_u32_u24 v28, 384, v28
v_add3_u32 v114, v28, v29, v30
v_add_u32 v28, 34, v25
v_add_u32 v29, 0, v24
v_lshrrev_b32 v30, 1, v28
v_and_b32 v30, 1, v30
v_lshrrev_b32 v31, 5, v29
v_xor_b32 v30, v30, v31
v_lshlrev_b32 v30, 6, v30
v_and_b32 v29, 31, v29
v_lshlrev_b32 v29, 1, v29
v_mul_u32_u24 v28, 384, v28
v_add3_u32 v115, v28, v29, v30
v_add_u32 v28, 0, v25
v_add_u32 v29, 16, v24
v_lshrrev_b32 v30, 1, v28
v_and_b32 v30, 1, v30
v_lshrrev_b32 v31, 5, v29
v_xor_b32 v30, v30, v31
v_lshlrev_b32 v30, 6, v30
v_and_b32 v29, 31, v29
v_lshlrev_b32 v29, 1, v29
v_mul_u32_u24 v28, 384, v28
v_add3_u32 v116, v28, v29, v30
v_add_u32 v28, 2, v25
v_add_u32 v29, 16, v24
v_lshrrev_b32 v30, 1, v28
v_and_b32 v30, 1, v30
v_lshrrev_b32 v31, 5, v29
v_xor_b32 v30, v30, v31
v_lshlrev_b32 v30, 6, v30
v_and_b32 v29, 31, v29
v_lshlrev_b32 v29, 1, v29
v_mul_u32_u24 v28, 384, v28
v_add3_u32 v117, v28, v29, v30
v_add_u32 v28, 32, v25
v_add_u32 v29, 16, v24
v_lshrrev_b32 v30, 1, v28
v_and_b32 v30, 1, v30
v_lshrrev_b32 v31, 5, v29
v_xor_b32 v30, v30, v31
v_lshlrev_b32 v30, 6, v30
v_and_b32 v29, 31, v29
v_lshlrev_b32 v29, 1, v29
v_mul_u32_u24 v28, 384, v28
v_add3_u32 v118, v28, v29, v30
v_add_u32 v28, 34, v25
v_add_u32 v29, 16, v24
v_lshrrev_b32 v30, 1, v28
v_and_b32 v30, 1, v30
v_lshrrev_b32 v31, 5, v29
v_xor_b32 v30, v30, v31
v_lshlrev_b32 v30, 6, v30
v_and_b32 v29, 31, v29
v_lshlrev_b32 v29, 1, v29
v_mul_u32_u24 v28, 384, v28
v_add3_u32 v119, v28, v29, v30
v_add_u32 v28, 0, v25
v_add_u32 v29, 32, v24
v_lshrrev_b32 v30, 1, v28
v_and_b32 v30, 1, v30
v_lshrrev_b32 v31, 5, v29
v_xor_b32 v30, v30, v31
v_lshlrev_b32 v30, 6, v30
v_and_b32 v29, 31, v29
v_lshlrev_b32 v29, 1, v29
v_mul_u32_u24 v28, 384, v28
v_add3_u32 v120, v28, v29, v30
v_add_u32 v28, 2, v25
v_add_u32 v29, 32, v24
v_lshrrev_b32 v30, 1, v28
v_and_b32 v30, 1, v30
v_lshrrev_b32 v31, 5, v29
v_xor_b32 v30, v30, v31
v_lshlrev_b32 v30, 6, v30
v_and_b32 v29, 31, v29
v_lshlrev_b32 v29, 1, v29
v_mul_u32_u24 v28, 384, v28
v_add3_u32 v121, v28, v29, v30
v_add_u32 v28, 32, v25
v_add_u32 v29, 32, v24
v_lshrrev_b32 v30, 1, v28
v_and_b32 v30, 1, v30
v_lshrrev_b32 v31, 5, v29
v_xor_b32 v30, v30, v31
v_lshlrev_b32 v30, 6, v30
v_and_b32 v29, 31, v29
v_lshlrev_b32 v29, 1, v29
v_mul_u32_u24 v28, 384, v28
v_add3_u32 v122, v28, v29, v30
v_add_u32 v28, 34, v25
v_add_u32 v29, 32, v24
v_lshrrev_b32 v30, 1, v28
v_and_b32 v30, 1, v30
v_lshrrev_b32 v31, 5, v29
v_xor_b32 v30, v30, v31
v_lshlrev_b32 v30, 6, v30
v_and_b32 v29, 31, v29
v_lshlrev_b32 v29, 1, v29
v_mul_u32_u24 v28, 384, v28
v_add3_u32 v123, v28, v29, v30
WL 0
s_mov_b32 s28, s6
s_and_b32 s29, s7, 0xffff
s_mov_b32 s30, 0x780000
s_mov_b32 s31, 0x20000
s_mov_b32 s44, s40
s_and_b32 s45, s41, 0xffff
s_mov_b32 s46, 0x780000
s_mov_b32 s47, 0x20000
s_mul_i32 s42, s3, 384
s_mov_b32 s43, s42
s_mul_i32 s52, s16, 6144
s_add_u32 m0, s52, 0
s_nop 0
DM 2,28,42
s_add_u32 m0, s52, 1024
s_nop 0
DM 3,28,42
s_add_u32 m0, s52, 2048
s_nop 0
DM 4,28,42
s_add_u32 m0, s52, 3072
s_nop 0
DM 5,28,42
s_add_u32 m0, s52, 4096
s_nop 0
DM 6,28,42
s_add_u32 m0, s52, 5120
s_nop 0
DM 7,28,42
s_add_u32 s42, s42, 786432
s_add_u32 m0, s52, 24576
s_nop 0
DM 2,44,43
s_add_u32 m0, s52, 25600
s_nop 0
DM 3,44,43
s_add_u32 m0, s52, 26624
s_nop 0
DM 4,44,43
s_add_u32 m0, s52, 27648
s_nop 0
DM 5,44,43
s_add_u32 m0, s52, 28672
s_nop 0
DM 6,44,43
s_add_u32 m0, s52, 29696
s_nop 0
DM 7,44,43
s_add_u32 s43, s43, 786432
s_add_u32 m0, s52, 49152
s_nop 0
DM 2,28,42
s_add_u32 m0, s52, 50176
s_nop 0
DM 3,28,42
s_add_u32 m0, s52, 51200
s_nop 0
DM 4,28,42
s_add_u32 m0, s52, 52224
s_nop 0
DM 5,28,42
s_add_u32 m0, s52, 53248
s_nop 0
DM 6,28,42
s_add_u32 m0, s52, 54272
s_nop 0
DM 7,28,42
s_add_u32 s42, s42, 786432
s_add_u32 m0, s52, 73728
s_nop 0
DM 2,44,43
s_add_u32 m0, s52, 74752
s_nop 0
DM 3,44,43
s_add_u32 m0, s52, 75776
s_nop 0
DM 4,44,43
s_add_u32 m0, s52, 76800
s_nop 0
DM 5,44,43
s_add_u32 m0, s52, 77824
s_nop 0
DM 6,44,43
s_add_u32 m0, s52, 78848
s_nop 0
DM 7,44,43
s_add_u32 s43, s43, 786432
s_add_u32 m0, s52, 98304
s_nop 0
DM 2,28,42
s_add_u32 m0, s52, 99328
s_nop 0
DM 3,28,42
s_add_u32 m0, s52, 100352
s_nop 0
DM 4,28,42
s_add_u32 m0, s52, 101376
s_nop 0
DM 5,28,42
s_add_u32 m0, s52, 102400
s_nop 0
DM 6,28,42
s_add_u32 m0, s52, 103424
s_nop 0
DM 7,28,42
s_add_u32 s42, s42, 786432
WV 24
s_barrier
s_add_u32 m0, s52, 122880
s_nop 0
DM 2,44,43
s_add_u32 m0, s52, 123904
s_nop 0
DM 3,44,43
s_add_u32 m0, s52, 124928
s_nop 0
DM 4,44,43
s_add_u32 m0, s52, 125952
s_nop 0
DM 5,44,43
s_add_u32 m0, s52, 126976
s_nop 0
DM 6,44,43
s_add_u32 m0, s52, 128000
s_nop 0
DM 7,44,43
s_add_u32 s43, s43, 786432
TR 0,112,0
TR 2,113,0
TR 4,114,0
TR 6,115,0
TR 128,116,0
TR 130,117,0
TR 132,118,0
TR 134,119,0
ds_read_b64_tr_b16 v[128:129], v120 offset:0
ds_read_b64_tr_b16 v[130:131], v121 offset:0
ds_read_b64_tr_b16 v[132:133], v122 offset:0
ds_read_b64_tr_b16 v[134:135], v123 offset:0
WL 0
WV 24
s_barrier
s_add_u32 m0, s52, 0
s_nop 0
DM 2,28,42
s_add_u32 m0, s52, 1024
s_nop 0
DM 3,28,42
s_add_u32 m0, s52, 2048
s_nop 0
DM 4,28,42
s_add_u32 m0, s52, 3072
s_nop 0
DM 5,28,42
s_add_u32 m0, s52, 4096
s_nop 0
DM 6,28,42
s_add_u32 m0, s52, 5120
s_nop 0
DM 7,28,42
s_add_u32 s42, s42, 786432
TR 64,112,24576
TR 66,113,24576
TR 68,114,24576
TR 70,115,24576
TR 192,116,24576
TR 194,117,24576
TR 196,118,24576
TR 198,119,24576
ds_read_b64_tr_b16 v[192:193], v120 offset:24576
ds_read_b64_tr_b16 v[194:195], v121 offset:24576
ds_read_b64_tr_b16 v[196:197], v122 offset:24576
ds_read_b64_tr_b16 v[198:199], v123 offset:24576
WL 0
WV 24
s_barrier
s_add_u32 m0, s52, 24576
s_nop 0
DM 2,44,43
s_add_u32 m0, s52, 25600
s_nop 0
DM 3,44,43
s_add_u32 m0, s52, 26624
s_nop 0
DM 4,44,43
s_add_u32 m0, s52, 27648
s_nop 0
DM 5,44,43
s_add_u32 m0, s52, 28672
s_nop 0
DM 6,44,43
s_add_u32 m0, s52, 29696
s_nop 0
DM 7,44,43
s_add_u32 s43, s43, 786432
TR 8,112,49152
TR 10,113,49152
TR 12,114,49152
TR 14,115,49152
TR 136,116,49152
TR 138,117,49152
TR 140,118,49152
TR 142,119,49152
ds_read_b64_tr_b16 v[136:137], v120 offset:49152
ds_read_b64_tr_b16 v[138:139], v121 offset:49152
ds_read_b64_tr_b16 v[140:141], v122 offset:49152
ds_read_b64_tr_b16 v[142:143], v123 offset:49152
WL 0
WV 24
s_barrier
s_add_u32 m0, s52, 49152
s_nop 0
DM 2,28,42
s_add_u32 m0, s52, 50176
s_nop 0
DM 3,28,42
s_add_u32 m0, s52, 51200
s_nop 0
DM 4,28,42
s_add_u32 m0, s52, 52224
s_nop 0
DM 5,28,42
s_add_u32 m0, s52, 53248
s_nop 0
DM 6,28,42
s_add_u32 m0, s52, 54272
s_nop 0
DM 7,28,42
s_add_u32 s42, s42, 786432
v_add_u32 v1, 73728, v112
ds_read_b64_tr_b16 a[72:73], v1
v_add_u32 v1, 73728, v113
ds_read_b64_tr_b16 a[74:75], v1
v_add_u32 v1, 73728, v114
ds_read_b64_tr_b16 a[76:77], v1
v_add_u32 v1, 73728, v115
ds_read_b64_tr_b16 a[78:79], v1
v_add_u32 v1, 73728, v116
ds_read_b64_tr_b16 a[200:201], v1
v_add_u32 v1, 73728, v117
ds_read_b64_tr_b16 a[202:203], v1
v_add_u32 v1, 73728, v118
ds_read_b64_tr_b16 a[204:205], v1
v_add_u32 v1, 73728, v119
ds_read_b64_tr_b16 a[206:207], v1
v_add_u32 v1, 73728, v120
ds_read_b64_tr_b16 v[200:201], v1
v_add_u32 v1, 73728, v121
ds_read_b64_tr_b16 v[202:203], v1
v_add_u32 v1, 73728, v122
ds_read_b64_tr_b16 v[204:205], v1
v_add_u32 v1, 73728, v123
ds_read_b64_tr_b16 v[206:207], v1
WL 0
WV 24
s_barrier
s_add_u32 m0, s52, 73728
s_nop 0
DM 2,44,43
s_add_u32 m0, s52, 74752
s_nop 0
DM 3,44,43
s_add_u32 m0, s52, 75776
s_nop 0
DM 4,44,43
s_add_u32 m0, s52, 76800
s_nop 0
DM 5,44,43
s_add_u32 m0, s52, 77824
s_nop 0
DM 6,44,43
s_add_u32 m0, s52, 78848
s_nop 0
DM 7,44,43
s_add_u32 s43, s43, 786432
v_add_u32 v1, 98304, v112
ds_read_b64_tr_b16 v[16:17], v1
v_add_u32 v1, 98304, v113
ds_read_b64_tr_b16 v[18:19], v1
v_add_u32 v1, 98304, v114
ds_read_b64_tr_b16 v[20:21], v1
v_add_u32 v1, 98304, v115
ds_read_b64_tr_b16 v[22:23], v1
v_add_u32 v1, 98304, v116
ds_read_b64_tr_b16 v[48:49], v1
v_add_u32 v1, 98304, v117
ds_read_b64_tr_b16 v[50:51], v1
v_add_u32 v1, 98304, v118
ds_read_b64_tr_b16 v[52:53], v1
v_add_u32 v1, 98304, v119
ds_read_b64_tr_b16 v[54:55], v1
v_add_u32 v1, 98304, v120
ds_read_b64_tr_b16 v[80:81], v1
v_add_u32 v1, 98304, v121
ds_read_b64_tr_b16 v[82:83], v1
v_add_u32 v1, 98304, v122
ds_read_b64_tr_b16 v[84:85], v1
v_add_u32 v1, 98304, v123
ds_read_b64_tr_b16 v[86:87], v1
WL 0
WV 24
s_barrier
s_add_u32 m0, s52, 98304
s_nop 0
DM 2,28,42
s_add_u32 m0, s52, 99328
s_nop 0
DM 3,28,42
s_add_u32 m0, s52, 100352
s_nop 0
DM 4,28,42
s_add_u32 m0, s52, 101376
s_nop 0
DM 5,28,42
s_add_u32 m0, s52, 102400
s_nop 0
DM 6,28,42
s_add_u32 m0, s52, 103424
s_nop 0
DM 7,28,42
s_add_u32 s42, s42, 786432
v_add_u32 v1, 122880, v112
ds_read_b64_tr_b16 a[80:81], v1
v_add_u32 v1, 122880, v113
ds_read_b64_tr_b16 a[82:83], v1
v_add_u32 v1, 122880, v114
ds_read_b64_tr_b16 a[84:85], v1
v_add_u32 v1, 122880, v115
ds_read_b64_tr_b16 a[86:87], v1
v_add_u32 v1, 122880, v116
ds_read_b64_tr_b16 a[208:209], v1
v_add_u32 v1, 122880, v117
ds_read_b64_tr_b16 a[210:211], v1
v_add_u32 v1, 122880, v118
ds_read_b64_tr_b16 a[212:213], v1
v_add_u32 v1, 122880, v119
ds_read_b64_tr_b16 a[214:215], v1
v_add_u32 v1, 122880, v120
ds_read_b64_tr_b16 v[208:209], v1
v_add_u32 v1, 122880, v121
ds_read_b64_tr_b16 v[210:211], v1
v_add_u32 v1, 122880, v122
ds_read_b64_tr_b16 v[212:213], v1
v_add_u32 v1, 122880, v123
ds_read_b64_tr_b16 v[214:215], v1
WL 0
WV 24
s_barrier
s_add_u32 m0, s52, 122880
s_nop 0
DM 2,44,43
s_add_u32 m0, s52, 123904
s_nop 0
DM 3,44,43
s_add_u32 m0, s52, 124928
s_nop 0
DM 4,44,43
s_add_u32 m0, s52, 125952
s_nop 0
DM 5,44,43
s_add_u32 m0, s52, 126976
s_nop 0
DM 6,44,43
s_add_u32 m0, s52, 128000
s_nop 0
DM 7,44,43
s_add_u32 s43, s43, 786432
TR 16,112,0
TR 18,113,0
TR 20,114,0
TR 22,115,0
TR 144,116,0
TR 146,117,0
TR 148,118,0
TR 150,119,0
ds_read_b64_tr_b16 v[144:145], v120 offset:0
ds_read_b64_tr_b16 v[146:147], v121 offset:0
ds_read_b64_tr_b16 v[148:149], v122 offset:0
ds_read_b64_tr_b16 v[150:151], v123 offset:0
WL 0
WV 24
s_barrier
s_add_u32 m0, s52, 0
s_nop 0
DM 2,28,42
s_add_u32 m0, s52, 1024
s_nop 0
DM 3,28,42
s_add_u32 m0, s52, 2048
s_nop 0
DM 4,28,42
s_add_u32 m0, s52, 3072
s_nop 0
DM 5,28,42
s_add_u32 m0, s52, 4096
s_nop 0
DM 6,28,42
s_add_u32 m0, s52, 5120
s_nop 0
DM 7,28,42
s_add_u32 s42, s42, 786432
TR 88,112,24576
TR 90,113,24576
TR 92,114,24576
TR 94,115,24576
TR 216,116,24576
TR 218,117,24576
TR 220,118,24576
TR 222,119,24576
ds_read_b64_tr_b16 v[216:217], v120 offset:24576
ds_read_b64_tr_b16 v[218:219], v121 offset:24576
ds_read_b64_tr_b16 v[220:221], v122 offset:24576
ds_read_b64_tr_b16 v[222:223], v123 offset:24576
WL 0
WV 24
s_barrier
s_add_u32 m0, s52, 24576
s_nop 0
DM 2,44,43
s_add_u32 m0, s52, 25600
s_nop 0
DM 3,44,43
s_add_u32 m0, s52, 26624
s_nop 0
DM 4,44,43
s_add_u32 m0, s52, 27648
s_nop 0
DM 5,44,43
s_add_u32 m0, s52, 28672
s_nop 0
DM 6,44,43
s_add_u32 m0, s52, 29696
s_nop 0
DM 7,44,43
s_add_u32 s43, s43, 786432
TR 24,112,49152
TR 26,113,49152
TR 28,114,49152
TR 30,115,49152
TR 152,116,49152
TR 154,117,49152
TR 156,118,49152
TR 158,119,49152
ds_read_b64_tr_b16 v[152:153], v120 offset:49152
ds_read_b64_tr_b16 v[154:155], v121 offset:49152
ds_read_b64_tr_b16 v[156:157], v122 offset:49152
ds_read_b64_tr_b16 v[158:159], v123 offset:49152
WL 0
WV 24
s_barrier
s_add_u32 m0, s52, 49152
s_nop 0
DM 2,28,42
s_add_u32 m0, s52, 50176
s_nop 0
DM 3,28,42
s_add_u32 m0, s52, 51200
s_nop 0
DM 4,28,42
s_add_u32 m0, s52, 52224
s_nop 0
DM 5,28,42
s_add_u32 m0, s52, 53248
s_nop 0
DM 6,28,42
s_add_u32 m0, s52, 54272
s_nop 0
DM 7,28,42
s_add_u32 s42, s42, 786432
v_add_u32 v1, 73728, v112
ds_read_b64_tr_b16 v[24:25], v1
v_add_u32 v1, 73728, v113
ds_read_b64_tr_b16 v[26:27], v1
v_add_u32 v1, 73728, v114
ds_read_b64_tr_b16 v[28:29], v1
v_add_u32 v1, 73728, v115
ds_read_b64_tr_b16 v[30:31], v1
v_add_u32 v1, 73728, v116
ds_read_b64_tr_b16 v[56:57], v1
v_add_u32 v1, 73728, v117
ds_read_b64_tr_b16 v[58:59], v1
v_add_u32 v1, 73728, v118
ds_read_b64_tr_b16 v[60:61], v1
v_add_u32 v1, 73728, v119
ds_read_b64_tr_b16 v[62:63], v1
v_add_u32 v1, 73728, v120
ds_read_b64_tr_b16 v[88:89], v1
v_add_u32 v1, 73728, v121
ds_read_b64_tr_b16 v[90:91], v1
v_add_u32 v1, 73728, v122
ds_read_b64_tr_b16 v[92:93], v1
v_add_u32 v1, 73728, v123
ds_read_b64_tr_b16 v[94:95], v1
WL 0
WV 24
s_barrier
s_add_u32 m0, s52, 73728
s_nop 0
DM 2,44,43
s_add_u32 m0, s52, 74752
s_nop 0
DM 3,44,43
s_add_u32 m0, s52, 75776
s_nop 0
DM 4,44,43
s_add_u32 m0, s52, 76800
s_nop 0
DM 5,44,43
s_add_u32 m0, s52, 77824
s_nop 0
DM 6,44,43
s_add_u32 m0, s52, 78848
s_nop 0
DM 7,44,43
s_add_u32 s43, s43, 786432
v_add_u32 v1, 98304, v112
ds_read_b64_tr_b16 a[32:33], v1
v_add_u32 v1, 98304, v113
ds_read_b64_tr_b16 a[34:35], v1
v_add_u32 v1, 98304, v114
ds_read_b64_tr_b16 a[36:37], v1
v_add_u32 v1, 98304, v115
ds_read_b64_tr_b16 a[38:39], v1
v_add_u32 v1, 98304, v116
ds_read_b64_tr_b16 a[160:161], v1
v_add_u32 v1, 98304, v117
ds_read_b64_tr_b16 a[162:163], v1
v_add_u32 v1, 98304, v118
ds_read_b64_tr_b16 a[164:165], v1
v_add_u32 v1, 98304, v119
ds_read_b64_tr_b16 a[166:167], v1
v_add_u32 v1, 98304, v120
ds_read_b64_tr_b16 v[160:161], v1
v_add_u32 v1, 98304, v121
ds_read_b64_tr_b16 v[162:163], v1
v_add_u32 v1, 98304, v122
ds_read_b64_tr_b16 v[164:165], v1
v_add_u32 v1, 98304, v123
ds_read_b64_tr_b16 v[166:167], v1
WL 0
WV 24
s_barrier
s_add_u32 m0, s52, 98304
s_nop 0
DM 2,28,42
s_add_u32 m0, s52, 99328
s_nop 0
DM 3,28,42
s_add_u32 m0, s52, 100352
s_nop 0
DM 4,28,42
s_add_u32 m0, s52, 101376
s_nop 0
DM 5,28,42
s_add_u32 m0, s52, 102400
s_nop 0
DM 6,28,42
s_add_u32 m0, s52, 103424
s_nop 0
DM 7,28,42
s_add_u32 s42, s42, 786432
v_add_u32 v1, 122880, v112
ds_read_b64_tr_b16 a[96:97], v1
v_add_u32 v1, 122880, v113
ds_read_b64_tr_b16 a[98:99], v1
v_add_u32 v1, 122880, v114
ds_read_b64_tr_b16 a[100:101], v1
v_add_u32 v1, 122880, v115
ds_read_b64_tr_b16 a[102:103], v1
v_add_u32 v1, 122880, v116
ds_read_b64_tr_b16 a[224:225], v1
v_add_u32 v1, 122880, v117
ds_read_b64_tr_b16 a[226:227], v1
v_add_u32 v1, 122880, v118
ds_read_b64_tr_b16 a[228:229], v1
v_add_u32 v1, 122880, v119
ds_read_b64_tr_b16 a[230:231], v1
v_add_u32 v1, 122880, v120
ds_read_b64_tr_b16 v[224:225], v1
v_add_u32 v1, 122880, v121
ds_read_b64_tr_b16 v[226:227], v1
v_add_u32 v1, 122880, v122
ds_read_b64_tr_b16 v[228:229], v1
v_add_u32 v1, 122880, v123
ds_read_b64_tr_b16 v[230:231], v1
WL 0
WV 24
s_barrier
s_add_u32 m0, s52, 122880
s_nop 0
DM 2,44,43
s_add_u32 m0, s52, 123904
s_nop 0
DM 3,44,43
s_add_u32 m0, s52, 124928
s_nop 0
DM 4,44,43
s_add_u32 m0, s52, 125952
s_nop 0
DM 5,44,43
s_add_u32 m0, s52, 126976
s_nop 0
DM 6,44,43
s_add_u32 m0, s52, 128000
s_nop 0
DM 7,44,43
s_add_u32 s43, s43, 786432
ds_read_b64_tr_b16 v[32:33], v112 offset:0
ds_read_b64_tr_b16 v[34:35], v113 offset:0
ds_read_b64_tr_b16 v[36:37], v114 offset:0
ds_read_b64_tr_b16 v[38:39], v115 offset:0
ds_read_b64_tr_b16 v[64:65], v116 offset:0
ds_read_b64_tr_b16 v[66:67], v117 offset:0
ds_read_b64_tr_b16 v[68:69], v118 offset:0
ds_read_b64_tr_b16 v[70:71], v119 offset:0
ds_read_b64_tr_b16 v[96:97], v120 offset:0
ds_read_b64_tr_b16 v[98:99], v121 offset:0
ds_read_b64_tr_b16 v[100:101], v122 offset:0
ds_read_b64_tr_b16 v[102:103], v123 offset:0
WL 0
WV 24
s_barrier
s_add_u32 m0, s52, 0
s_nop 0
DM 2,28,42
s_add_u32 m0, s52, 1024
s_nop 0
DM 3,28,42
s_add_u32 m0, s52, 2048
s_nop 0
DM 4,28,42
s_add_u32 m0, s52, 3072
s_nop 0
DM 5,28,42
s_add_u32 m0, s52, 4096
s_nop 0
DM 6,28,42
s_add_u32 m0, s52, 5120
s_nop 0
DM 7,28,42
s_add_u32 s42, s42, 786432
TR 104,112,24576
TR 106,113,24576
TR 108,114,24576
TR 110,115,24576
TR 232,116,24576
TR 234,117,24576
TR 236,118,24576
TR 238,119,24576
ds_read_b64_tr_b16 v[232:233], v120 offset:24576
ds_read_b64_tr_b16 v[234:235], v121 offset:24576
ds_read_b64_tr_b16 v[236:237], v122 offset:24576
ds_read_b64_tr_b16 v[238:239], v123 offset:24576
WL 0
WV 24
s_barrier
s_add_u32 m0, s52, 24576
s_nop 0
DM 2,44,43
s_add_u32 m0, s52, 25600
s_nop 0
DM 3,44,43
s_add_u32 m0, s52, 26624
s_nop 0
DM 4,44,43
s_add_u32 m0, s52, 27648
s_nop 0
DM 5,44,43
s_add_u32 m0, s52, 28672
s_nop 0
DM 6,44,43
s_add_u32 m0, s52, 29696
s_nop 0
DM 7,44,43
s_add_u32 s43, s43, 786432
TR 40,112,49152
TR 42,113,49152
TR 44,114,49152
TR 46,115,49152
TR 168,116,49152
TR 170,117,49152
TR 172,118,49152
TR 174,119,49152
ds_read_b64_tr_b16 v[168:169], v120 offset:49152
ds_read_b64_tr_b16 v[170:171], v121 offset:49152
ds_read_b64_tr_b16 v[172:173], v122 offset:49152
ds_read_b64_tr_b16 v[174:175], v123 offset:49152
WL 0
WV 24
s_barrier
v_add_u32 v1, 73728, v112
ds_read_b64_tr_b16 a[112:113], v1
v_add_u32 v1, 73728, v113
ds_read_b64_tr_b16 a[114:115], v1
v_add_u32 v1, 73728, v114
ds_read_b64_tr_b16 a[116:117], v1
v_add_u32 v1, 73728, v115
ds_read_b64_tr_b16 a[118:119], v1
v_add_u32 v1, 73728, v116
ds_read_b64_tr_b16 a[240:241], v1
v_add_u32 v1, 73728, v117
ds_read_b64_tr_b16 a[242:243], v1
v_add_u32 v1, 73728, v118
ds_read_b64_tr_b16 a[244:245], v1
v_add_u32 v1, 73728, v119
ds_read_b64_tr_b16 a[246:247], v1
v_add_u32 v1, 73728, v120
ds_read_b64_tr_b16 v[240:241], v1
v_add_u32 v1, 73728, v121
ds_read_b64_tr_b16 v[242:243], v1
v_add_u32 v1, 73728, v122
ds_read_b64_tr_b16 v[244:245], v1
v_add_u32 v1, 73728, v123
ds_read_b64_tr_b16 v[246:247], v1
WL 0
WV 18
s_barrier
v_add_u32 v1, 98304, v112
ds_read_b64_tr_b16 a[48:49], v1
v_add_u32 v1, 98304, v113
ds_read_b64_tr_b16 a[50:51], v1
v_add_u32 v1, 98304, v114
ds_read_b64_tr_b16 a[52:53], v1
v_add_u32 v1, 98304, v115
ds_read_b64_tr_b16 a[54:55], v1
v_add_u32 v1, 98304, v116
ds_read_b64_tr_b16 a[176:177], v1
v_add_u32 v1, 98304, v117
ds_read_b64_tr_b16 a[178:179], v1
v_add_u32 v1, 98304, v118
ds_read_b64_tr_b16 a[180:181], v1
v_add_u32 v1, 98304, v119
ds_read_b64_tr_b16 a[182:183], v1
v_add_u32 v1, 98304, v120
ds_read_b64_tr_b16 v[176:177], v1
v_add_u32 v1, 98304, v121
ds_read_b64_tr_b16 v[178:179], v1
v_add_u32 v1, 98304, v122
ds_read_b64_tr_b16 v[180:181], v1
v_add_u32 v1, 98304, v123
ds_read_b64_tr_b16 v[182:183], v1
WL 0
WV 12
s_barrier
v_add_u32 v1, 122880, v112
ds_read_b64_tr_b16 v[40:41], v1
v_add_u32 v1, 122880, v113
ds_read_b64_tr_b16 v[42:43], v1
v_add_u32 v1, 122880, v114
ds_read_b64_tr_b16 v[44:45], v1
v_add_u32 v1, 122880, v115
ds_read_b64_tr_b16 v[46:47], v1
v_add_u32 v1, 122880, v116
ds_read_b64_tr_b16 v[72:73], v1
v_add_u32 v1, 122880, v117
ds_read_b64_tr_b16 v[74:75], v1
v_add_u32 v1, 122880, v118
ds_read_b64_tr_b16 v[76:77], v1
v_add_u32 v1, 122880, v119
ds_read_b64_tr_b16 v[78:79], v1
v_add_u32 v1, 122880, v120
ds_read_b64_tr_b16 v[104:105], v1
v_add_u32 v1, 122880, v121
ds_read_b64_tr_b16 v[106:107], v1
v_add_u32 v1, 122880, v122
ds_read_b64_tr_b16 v[108:109], v1
v_add_u32 v1, 122880, v123
ds_read_b64_tr_b16 v[110:111], v1
WL 0
WV 6
s_barrier
TR 56,112,0
TR 58,113,0
TR 60,114,0
TR 62,115,0
TR 184,116,0
TR 186,117,0
TR 188,118,0
TR 190,119,0
ds_read_b64_tr_b16 v[184:185], v120 offset:0
ds_read_b64_tr_b16 v[186:187], v121 offset:0
ds_read_b64_tr_b16 v[188:189], v122 offset:0
ds_read_b64_tr_b16 v[190:191], v123 offset:0
WL 0
WV 0
s_barrier
TR 120,112,24576
TR 122,113,24576
TR 124,114,24576
TR 126,115,24576
TR 248,116,24576
TR 250,117,24576
TR 252,118,24576
TR 254,119,24576
ds_read_b64_tr_b16 v[248:249], v120 offset:24576
ds_read_b64_tr_b16 v[250:251], v121 offset:24576
ds_read_b64_tr_b16 v[252:253], v122 offset:24576
ds_read_b64_tr_b16 v[254:255], v123 offset:24576
WL 0
s_barrier
v_and_b32 v1, 63, v0
v_lshlrev_b32 v1, 4, v1
s_mul_i32 s23, s16, 24576
v_add_u32 v1, s23, v1
ds_write_b128 v1, v[16:19] offset:0
ds_write_b128 v1, v[20:23] offset:1024
ds_write_b128 v1, v[24:27] offset:2048
ds_write_b128 v1, v[28:31] offset:3072
ds_write_b128 v1, v[32:35] offset:4096
ds_write_b128 v1, v[36:39] offset:5120
ds_write_b128 v1, v[40:43] offset:6144
ds_write_b128 v1, v[44:47] offset:7168
WL 0
ds_write_b128 v1, v[48:51] offset:8192
ds_write_b128 v1, v[52:55] offset:9216
ds_write_b128 v1, v[56:59] offset:10240
ds_write_b128 v1, v[60:63] offset:11264
ds_write_b128 v1, v[64:67] offset:12288
ds_write_b128 v1, v[68:71] offset:13312
ds_write_b128 v1, v[72:75] offset:14336
ds_write_b128 v1, v[76:79] offset:15360
WL 0
ds_write_b128 v1, v[80:83] offset:16384
ds_write_b128 v1, v[84:87] offset:17408
ds_write_b128 v1, v[88:91] offset:18432
ds_write_b128 v1, v[92:95] offset:19456
ds_write_b128 v1, v[96:99] offset:20480
ds_write_b128 v1, v[100:103] offset:21504
ds_write_b128 v1, v[104:107] offset:22528
ds_write_b128 v1, v[108:111] offset:23552
WL 0
s_barrier
v_and_b32 v16, 63, v0
v_lshlrev_b32 v1, 4, v16
v_mov_b32 v2, v1
s_lshl_b32 s23, s16, 11
s_add_u32 s23, s23, 2048
s_add_u32 s24, s23, 147456
v_add_u32 v5, s24, v1
s_cmp_ge_u32 s23, 8192
s_cselect_b32 s24, 8192, 0
s_add_u32 s23, s23, s24
v_add_u32 v3, s23, v1
v_add_u32 v7, 147456, v1
s_mul_i32 s23, s16, 24576
v_add_u32 v8, s23, v1
v_and_b32 v17, 15, v16
v_lshrrev_b32 v18, 4, v16
v_and_b32 v19, 7, v16
s_mul_i32 s23, s16, 3
s_lshr_b32 s24, s23, 1
s_lshl_b32 s24, s24, 10
s_and_b32 s25, s23, 1
s_lshl_b32 s25, s25, 3
s_add_u32 s24, s24, s25
s_add_u32 s24, s24, 157696
v_add_u32 v9, s24, v1
s_and_b32 s25, s16, 1
s_cmp_eq_u32 s25, 0
s_cselect_b32 s40, 8, 1016
s_mov_b32 s41, 1024
v_lshlrev_b32 v20, 4, v18
v_add_u32 v20, v20, v19
v_lshlrev_b32 v20, 4, v20
v_add_u32 v11, 157824, v20
v_add_u32 v10, 157696, v20
s_cmp_eq_u32 s16, 0
s_cbranch_scc1 S_notq_6
s_sub_u32 s23, s16, 2
s_mul_i32 s23, s23, 6144
s_add_u32 s23, s23, 110592
v_add_u32 v10, s23, v1
S_notq_6:
v_add_u32 v12, 98304, v1
s_mov_b32 s36, 24576
v_and_b32 v20, 8, v16
v_cmp_eq_u32 vcc, 0, v20
v_mov_b32 v15, 0xeeee
v_mov_b32 v21, 0x4444
s_nop 0
v_cndmask_b32 v15, v15, v21, vcc
v_lshlrev_b32 v20, 2, v18
v_and_b32 v20, 7, v20
v_sub_u32 v21, v17, v20
v_subrev_u32 v22, 8, v21
v_cmp_eq_u32 vcc, 0, v21
v_mov_b32 v23, 0
v_mov_b32 v24, 0x3f80
v_cndmask_b32 v25, v23, v24, vcc
v_cmp_eq_u32 vcc, 1, v21
v_mov_b32 v24, 0x3f800000
s_nop 0
v_cndmask_b32 v26, v23, v24, vcc
v_or_b32 v116, v25, v26
v_cmp_eq_u32 vcc, 2, v21
v_mov_b32 v23, 0
v_mov_b32 v24, 0x3f80
v_cndmask_b32 v25, v23, v24, vcc
v_cmp_eq_u32 vcc, 3, v21
v_mov_b32 v24, 0x3f800000
s_nop 0
v_cndmask_b32 v26, v23, v24, vcc
v_or_b32 v117, v25, v26
v_cmp_eq_u32 vcc, 0, v22
v_mov_b32 v23, 0
v_mov_b32 v24, 0x3f80
v_cndmask_b32 v25, v23, v24, vcc
v_cmp_eq_u32 vcc, 1, v22
v_mov_b32 v24, 0x3f800000
s_nop 0
v_cndmask_b32 v26, v23, v24, vcc
v_or_b32 v118, v25, v26
v_cmp_eq_u32 vcc, 2, v22
v_mov_b32 v23, 0
v_mov_b32 v24, 0x3f80
v_cndmask_b32 v25, v23, v24, vcc
v_cmp_eq_u32 vcc, 3, v22
v_mov_b32 v24, 0x3f800000
s_nop 0
v_cndmask_b32 v26, v23, v24, vcc
v_or_b32 v119, v25, v26
v_mov_b32 v127, 0xff800000
v_cmp_gt_u32 vcc, 32, v16
s_nop 3
s_mov_b64 s[42:43], vcc
v_and_b32 v20, 8, v16
v_cmp_eq_u32 vcc, 0, v20
s_nop 3
s_and_b64 s[44:45], vcc, s[42:43]
s_cmp_eq_u32 s16, 0
s_cselect_b64 s[42:43], s[44:45], s[42:43]
v_mov_b32 v23, 0
s_nop 1
v_cndmask_b32 v120, v127, v23, s[42:43]
v_cndmask_b32 v121, v127, v23, s[42:43]
v_cndmask_b32 v122, v127, v23, s[42:43]
v_cndmask_b32 v123, v127, v23, s[42:43]
s_mov_b32 s26, 0xff00ff00
s_mov_b32 s27, 0xff00ff00
v_lshlrev_b32 v20, 2, v18
v_add_u32 v21, 0, v20
v_cmp_le_u32 vcc, v21, v17
s_nop 3
s_mov_b64 s[44:45], vcc
s_cmp_eq_u32 s16, 2
s_cselect_b64 s[48:49], s[44:45], -1
s_cselect_b64 s[56:57], 0, s[44:45]
v_add_u32 v21, 1, v20
v_cmp_le_u32 vcc, v21, v17
s_nop 3
s_mov_b64 s[44:45], vcc
s_cmp_eq_u32 s16, 2
s_cselect_b64 s[50:51], s[44:45], -1
s_cselect_b64 s[58:59], 0, s[44:45]
v_add_u32 v21, 2, v20
v_cmp_le_u32 vcc, v21, v17
s_nop 3
s_mov_b64 s[44:45], vcc
s_cmp_eq_u32 s16, 2
s_cselect_b64 s[52:53], s[44:45], -1
s_cselect_b64 s[60:61], 0, s[44:45]
v_add_u32 v21, 3, v20
v_cmp_le_u32 vcc, v21, v17
s_nop 3
s_mov_b64 s[44:45], vcc
s_cmp_eq_u32 s16, 2
s_cselect_b64 s[54:55], s[44:45], -1
s_cselect_b64 s[62:63], 0, s[44:45]
s_mul_i32 s23, s3, 640
v_lshrrev_b32 v20, 3, v16
v_and_b32 v20, 1, v20
v_lshlrev_b32 v20, 1, v20
v_lshrrev_b32 v21, 1, v18
v_add3_u32 v20, v20, v21, 1
v_lshlrev_b32 v20, 7, v20
v_lshlrev_b32 v21, 4, v19
v_add_u32 v20, v20, v21
v_and_b32 v21, 1, v18
v_lshlrev_b32 v21, 3, v21
v_add3_u32 v13, v20, v21, s23
v_lshrrev_b32 v22, 13, v13
v_lshlrev_b32 v22, 14, v22
v_and_b32 v13, 0x1fff, v13
v_add_u32 v13, v13, v22
v_lshlrev_b32 v20, 4, v19
v_lshlrev_b32 v21, 3, v18
v_add3_u32 v14, v20, v21, s23
v_lshrrev_b32 v22, 13, v14
v_lshlrev_b32 v22, 14, v22
v_and_b32 v14, 0x1fff, v14
v_add_u32 v14, v14, v22
v_cmp_gt_u32 vcc, 32, v16
s_nop 3
s_mov_b64 s[44:45], vcc
v_and_b32 v20, 8, v16
v_cmp_eq_u32 vcc, 0, v20
s_nop 3
s_and_b64 s[44:45], vcc, s[44:45]
v_mov_b32 v22, 0x80000000
s_nop 0
v_cndmask_b32 v14, v22, v14, s[44:45]
s_cmp_lt_u32 s16, 2
s_cbranch_scc1 S_tokoff_7
s_sub_u32 s23, s16, 2
s_lshl_b32 s23, s23, 4
v_add_u32 v20, s23, v17
v_lshrrev_b32 v21, 1, v18
v_lshlrev_b32 v21, 5, v21
v_add_u32 v21, v21, v20
v_lshlrev_b32 v21, 4, v21
v_and_b32 v22, 1, v18
v_lshlrev_b32 v22, 3, v22
v_add_u32 v13, v21, v22
v_lshlrev_b32 v21, 4, v20
v_lshlrev_b32 v22, 3, v18
v_add_u32 v21, v21, v22
v_add_u32 v14, 2048, v21
v_cmp_gt_u32 vcc, 32, v16
v_mov_b32 v22, 0x80000000
s_nop 0
v_cndmask_b32 v14, v22, v14, vcc
S_tokoff_7:
s_mul_i32 s20, s3, 12288
s_add_u32 s21, s20, 98566144
s_add_u32 s20, s20, 73400320
s_mul_i32 s37, s3, 2560
s_add_u32 s37, s37, 26214400
s_mov_b32 s38, 98304
s_cmp_eq_u32 s16, 0
s_cbranch_scc0 dw_9
s_mov_b32 s22, 0
v_mov_b32 v124, 384
dw_8:
buffer_load_dword v125, v124, s[8:11], 0 offen sc1
s_add_u32 s22, s22, 1
s_cmp_gt_u32 s22, 1048576
s_cbranch_scc1 dw_9
WV 0
v_readfirstlane_b32 s23, v125
s_nop 3
s_cmp_ge_u32 s23, 37
s_cbranch_scc1 dw_9
s_sleep 4
s_branch dw_8
dw_9:
s_barrier
s_lshl_b32 s65, s3, 7
s_add_u32 s65, s65, 131072
s_cmp_eq_u32 s16, 1
s_cbranch_scc0 S_nodma0_10
s_mov_b32 s22, 0
v_mov_b32 v124, 0
pf_11:
buffer_load_dword v125, v124, s[8:11], s65 offen sc1
s_add_u32 s22, s22, 1
s_cmp_gt_u32 s22, 4194304
s_cbranch_scc1 R_fail
WV 0
v_readfirstlane_b32 s23, v125
s_nop 3
s_cmp_ge_u32 s23, 1
s_cbranch_scc1 pf_12
s_sleep 4
s_branch pf_11
pf_12:
s_add_u32 m0, s38, 0
s_add_u32 s23, s20, 0
buffer_load_dwordx4 v1, s[8:11], s23 offen offset:0 sc1 lds
buffer_load_dwordx4 v1, s[8:11], s23 offen offset:1024 sc1 lds
buffer_load_dwordx4 v1, s[8:11], s23 offen offset:2048 sc1 lds
buffer_load_dwordx4 v1, s[8:11], s23 offen offset:3072 sc1 lds
s_add_u32 m0, s38, 4096
s_add_u32 s23, s20, 4096
buffer_load_dwordx4 v1, s[8:11], s23 offen offset:0 sc1 lds
buffer_load_dwordx4 v1, s[8:11], s23 offen offset:1024 sc1 lds
buffer_load_dwordx4 v1, s[8:11], s23 offen offset:2048 sc1 lds
buffer_load_dwordx4 v1, s[8:11], s23 offen offset:3072 sc1 lds
s_add_u32 m0, s38, 8192
s_add_u32 s23, s20, 8192
buffer_load_dwordx4 v1, s[8:11], s23 offen offset:0 sc1 lds
buffer_load_dwordx4 v1, s[8:11], s23 offen offset:1024 sc1 lds
buffer_load_dwordx4 v1, s[8:11], s23 offen offset:2048 sc1 lds
buffer_load_dwordx4 v1, s[8:11], s23 offen offset:3072 sc1 lds
s_add_u32 m0, s38, 12288
s_add_u32 s23, s21, 0
buffer_load_dwordx4 v1, s[8:11], s23 offen offset:0 sc1 lds
buffer_load_dwordx4 v1, s[8:11], s23 offen offset:1024 sc1 lds
buffer_load_dwordx4 v1, s[8:11], s23 offen offset:2048 sc1 lds
buffer_load_dwordx4 v1, s[8:11], s23 offen offset:3072 sc1 lds
s_add_u32 m0, s38, 16384
s_add_u32 s23, s21, 4096
buffer_load_dwordx4 v1, s[8:11], s23 offen offset:0 sc1 lds
buffer_load_dwordx4 v1, s[8:11], s23 offen offset:1024 sc1 lds
buffer_load_dwordx4 v1, s[8:11], s23 offen offset:2048 sc1 lds
buffer_load_dwordx4 v1, s[8:11], s23 offen offset:3072 sc1 lds
s_add_u32 m0, s38, 20480
s_add_u32 s23, s21, 8192
buffer_load_dwordx4 v1, s[8:11], s23 offen offset:0 sc1 lds
buffer_load_dwordx4 v1, s[8:11], s23 offen offset:1024 sc1 lds
buffer_load_dwordx4 v1, s[8:11], s23 offen offset:2048 sc1 lds
buffer_load_dwordx4 v1, s[8:11], s23 offen offset:3072 sc1 lds
S_nodma0_10:
s_add_u32 s20, s20, 393216
s_add_u32 s21, s21, 393216
s_add_u32 s38, s38, s36
v_mov_b32 v72, 0
v_mov_b32 v73, 0
v_mov_b32 v74, 0
v_mov_b32 v75, 0
v_mov_b32 v76, 0
v_mov_b32 v77, 0
v_mov_b32 v78, 0
v_mov_b32 v79, 0
v_mov_b32 v80, 0
v_mov_b32 v81, 0
v_mov_b32 v82, 0
v_mov_b32 v83, 0
v_mov_b32 v84, 0
v_mov_b32 v85, 0
v_mov_b32 v86, 0
v_mov_b32 v87, 0
v_mov_b32 v88, 0
v_mov_b32 v89, 0
v_mov_b32 v90, 0
v_mov_b32 v91, 0
v_mov_b32 v92, 0
v_mov_b32 v93, 0
v_mov_b32 v94, 0
v_mov_b32 v95, 0
v_mov_b32 v104, 0
s_mov_b32 s24, 0x3dd53b95
WV 0
s_barrier
s_lshr_b32 s77, s3, 3
s_lshl_b32 s77, s77, 8
s_add_u32 s77, s77, 223232
s_add_u32 s78, s77, 128
s_and_b32 s23, s3, 7
s_lshl_b32 s23, s23, 2
s_add_u32 s77, s77, s23
v_and_b32 v0, 63, v0
v_min_u32 v0, 19, v0
v_lshlrev_b32 v0, 2, v0
s_mov_b32 s25, s24
s_mov_b32 s82, 224768
s_lshr_b32 s83, s3, 3
s_lshl_b32 s83, s83, 7
s_and_b32 s23, s3, 7
s_lshl_b32 s23, s23, 2
s_add_u32 s83, s83, s23
s_add_u32 s83, s83, 229376
s_mov_b32 s76, 0
s_mov_b32 s22, 0
v_mov_b32 v16, 0
pl_13:
buffer_load_dwordx4 v[18:21], v16, s[12:15], 0 offen sc1
buffer_load_dword v17, v16, s[12:15], 0 offen offset:96 sc1
WV 0
v_min_u32 v18, v18, v19
v_min3_u32 v18, v18, v20, v21
s_nop 0
v_readfirstlane_b32 s23, v18
v_readfirstlane_b32 s79, v17
s_add_u32 s22, s22, 1
s_cmp_gt_u32 s22, 0x400
s_cbranch_scc1 pl_14
s_cmp_ge_u32 s23, 28
s_cbranch_scc0 pl_13
s_cmp_eq_u32 s79, 0
s_cselect_b32 s76, 1, 0
pl_14:
s_mov_b32 s87, 4
s_mov_b32 s88, 0
v_mov_b32 v16, 224
s_mov_b32 s22, 0
par_15:
buffer_load_dwordx4 v[18:21], v16, s[12:15], 0 offen sc1
s_add_u32 s22, s22, 1
s_cmp_gt_u32 s22, 4194304
s_cbranch_scc1 R_fail
WV 0
v_and_b32 v17, v18, v19
v_and_b32 v17, v17, v20
s_nop 0
v_readfirstlane_b32 s79, v17
v_readfirstlane_b32 s44, v18
v_readfirstlane_b32 s45, v19
v_readfirstlane_b32 s46, v20
s_nop 3
s_bitcmp1_b32 s79, 16
s_cbranch_scc0 par_15
s_and_b32 s44, s44, 8192
s_and_b32 s45, s45, 8192
s_and_b32 s46, s46, 8192
s_sub_u32 s18, 0, s4
s_and_b32 s18, s18, 0x1fffff
s_add_u32 s18, s18, 2097152
s_add_u32 s19, s18, 2097152
s_add_u32 s19, s19, s45
s_add_u32 s18, s18, s44
s_sub_u32 s33, s46, s45
S_loop:
s_cmp_eq_u32 s76, 0
s_cbranch_scc1 db_17
s_mov_b32 s22, 0
db_16:
buffer_load_dword v30, v0, s[8:11], s78 offen sc1
s_add_u32 s22, s22, 1
s_cmp_gt_u32 s22, 256
s_cbranch_scc1 db_17
WV 0
v_cmp_gt_u32 vcc, s17, v30
s_cbranch_vccnz db_16
s_sleep 4
db_17:
s_mov_b32 s22, 0
S_poll:
buffer_load_dwordx4 v[16:19], v2, s[8:11], s18 offen sc1
buffer_load_dwordx4 v[20:23], v2, s[8:11], s18 offen offset:1024 sc1
buffer_load_dwordx4 v[24:27], v3, s[8:11], s18 offen sc1
buffer_load_dwordx4 v[28:31], v3, s[8:11], s18 offen offset:1024 sc1
s_add_u32 s22, s22, 1
s_cmp_gt_u32 s22, 4194304
s_cbranch_scc1 R_fail
WV 2
v_max3_u32 v32, v16, v17, v18
v_max3_u32 v33, v19, v20, v21
v_max3_u32 v32, v22, v23, v32
WV 1
ds_write_b128 v5, v[24:27]
v_max3_u32 v33, v24, v25, v33
v_max3_u32 v32, v26, v27, v32
WV 0
ds_write_b128 v5, v[28:31] offset:1024
v_max3_u32 v33, v28, v29, v33
v_max3_u32 v32, v30, v31, v32
v_max_u32 v32, v32, v33
v_cmp_eq_u32 vcc, -1, v32
s_cbranch_vccnz S_poll
SM 72,16,a[0:7],15
SM 76,16,a[64:71],15
SM 80,16,a[128:135],15
SM 84,16,a[192:199],15
SM 88,16,v[128:135],15
SM 92,16,v[192:199],15
WL 0
s_barrier
ds_read_b128 v[24:27], v7 offset:2048
ds_read_b128 v[56:59], v8 offset:0
ds_read_b128 v[60:63], v8 offset:1024
ds_read_b128 v[28:31], v7 offset:3072
ds_read_b128 v[32:35], v7 offset:4096
SM 72,20,a[8:15],15
ds_read_b128 v[36:39], v7 offset:5120
SM 76,20,a[72:79],15
ds_read_b128 v[40:43], v7 offset:6144
SM 80,20,a[136:143],15
ds_read_b128 v[44:47], v7 offset:7168
SM 84,20,a[200:207],15
ds_read_b128 v[48:51], v7 offset:8192
SM 88,20,v[136:143],15
ds_read_b128 v[52:55], v7 offset:9216
SM 92,20,v[200:207],15
WL 9
WL 7
SM 72,24,v[56:63],15
ds_read_b128 v[64:67], v8 offset:2048
SM 76,24,a[80:87],15
ds_read_b128 v[68:71], v8 offset:3072
WL 7
SM 72,28,a[16:23],15
ds_read_b128 v[56:59], v8 offset:4096
SM 76,28,a[88:95],15
ds_read_b128 v[60:63], v8 offset:5120
SM 72,32,a[24:31],15
WL 2
SM 76,32,v[64:71],15
SM 72,36,a[32:39],15
ds_read_b128 v[64:67], v8 offset:6144
SM 76,36,a[96:103],15
ds_read_b128 v[68:71], v8 offset:7168
WL 2
SM 72,40,v[56:63],15
SM 76,40,a[104:111],15
ds_read_b128 v[56:59], v8 offset:8192
SM 72,44,a[40:47],15
ds_read_b128 v[60:63], v8 offset:9216
SM 76,44,a[112:119],15
ds_read_b128 v[16:19], v12 offset:0
SM 72,48,a[48:55],15
ds_read_b128 v[20:23], v12 offset:6144
WL 4
SM 76,48,v[64:71],15
SM 72,52,a[56:63],15
SM 76,52,a[120:127],15
WL 2
SM 80,24,v[56:63],15
ds_read_b128 v[64:67], v8 offset:10240
SM 84,24,a[208:215],15
ds_read_b128 v[68:71], v8 offset:11264
SM 80,28,a[144:151],15
ds_read_b128 v[56:59], v8 offset:12288
SM 84,28,a[216:223],15
ds_read_b128 v[60:63], v8 offset:13312
SM 80,32,a[152:159],15
CV 96,72,73
WL 2
SM 84,32,v[64:71],15
CV 97,74,75
SM 80,36,a[160:167],15
ds_read_b128 v[64:67], v8 offset:14336
CV 98,76,77
SM 84,36,a[224:231],15
ds_read_b128 v[68:71], v8 offset:15360
WL 2
SM 80,40,v[56:63],15
CV 99,78,79
SM 84,40,a[232:239],15
ds_read_b128 v[56:59], v8 offset:16384
SM 80,44,a[168:175],15
ds_read_b128 v[60:63], v8 offset:17408
v_mfma_f32_16x16x32_bf16 v[100:103], v[96:99], v[116:119], 0
SM 84,44,a[240:247],15
SM 80,48,a[176:183],15
WL 2
SM 84,48,v[64:71],15
SM 80,52,a[184:191],15
s_nop 2
CV 124,100,101
SM 84,52,a[248:255],15
CV 125,102,103
ds_write_b64 v9, v[124:125]
WL 1
SM 88,24,v[56:63],15
ds_read_b128 v[64:67], v8 offset:18432
SM 92,24,v[208:215],15
ds_read_b128 v[68:71], v8 offset:19456
v_add_u32 v126, s40, v9
SM 88,28,v[144:151],15
ds_read_b128 v[56:59], v8 offset:20480
ds_read_b128 v[24:27], v12 offset:1024
SM 92,28,v[216:223],15
ds_read_b128 v[60:63], v8 offset:21504
SM 88,32,v[152:159],15
CV 96,80,81
ds_read_b128 v[28:31], v12 offset:7168
WL 4
SM 92,32,v[64:71],15
CV 97,82,83
SM 88,36,v[160:167],15
ds_read_b128 v[64:67], v8 offset:22528
CV 98,84,85
ds_read_b128 v[32:35], v12 offset:2048
SM 92,36,v[224:231],15
ds_read_b128 v[68:71], v8 offset:23552
WL 4
SM 88,40,v[56:63],15
CV 99,86,87
ds_read_b128 v[36:39], v12 offset:8192
SM 92,40,v[232:239],15
SM 88,44,v[168:175],15
v_mfma_f32_16x16x32_bf16 v[100:103], v[96:99], v[116:119], 0
ds_read_b128 v[40:43], v12 offset:3072
SM 92,44,v[240:247],15
ds_read_b128 v[56:59], v12 offset:5120
SM 88,48,v[176:183],15
ds_read_b128 v[44:47], v12 offset:9216
WL 4
SM 92,48,v[64:71],15
ds_read_b128 v[60:63], v12 offset:11264
SM 88,52,v[184:191],15
CV 124,100,101
ds_read_b128 v[48:51], v12 offset:4096
SM 92,52,v[248:255],15
CV 125,102,103
ds_write_b64 v126, v[124:125]
ds_read_b128 v[52:55], v12 offset:10240
s_nop 4
CV 96,88,89
CV 97,90,91
CV 98,92,93
CV 99,94,95
v_add_u32 v126, s41, v9
s_nop 0
v_mfma_f32_16x16x32_bf16 v[100:103], v[96:99], v[116:119], 0
s_nop 7
CV 124,100,101
CV 125,102,103
ds_write_b64 v126, v[124:125]
WL 0
s_barrier
s_cmp_eq_u32 s16, 0
s_cbranch_scc0 S_notw0
ds_read_b128 v[72:75], v10 offset:0
ds_read_b128 v[76:79], v11 offset:0
ds_read_b128 v[80:83], v10 offset:1024
ds_read_b128 v[84:87], v11 offset:1024
ds_read_b128 v[88:91], v10 offset:2048
ds_read_b128 v[92:95], v11 offset:2048
WL 5
v_mfma_f32_16x16x32_bf16 v[108:111], v[16:19], v[72:75], 0
v_mfma_f32_16x16x32_bf16 v[112:115], v[20:23], v[72:75], 0
WL 4
v_mfma_f32_16x16x32_bf16 v[104:107], v[76:79], v[72:75], v[120:123]
ds_read_b128 v[72:75], v10 offset:3072
ds_read_b128 v[76:79], v11 offset:3072
WL 5
v_mfma_f32_16x16x32_bf16 v[108:111], v[24:27], v[80:83], v[108:111]
v_mfma_f32_16x16x32_bf16 v[112:115], v[28:31], v[80:83], v[112:115]
WL 4
v_mfma_f32_16x16x32_bf16 v[104:107], v[84:87], v[80:83], v[104:107]
ds_read_b128 v[80:83], v10 offset:4096
ds_read_b128 v[84:87], v11 offset:4096
WL 5
v_mfma_f32_16x16x32_bf16 v[108:111], v[32:35], v[88:91], v[108:111]
v_mfma_f32_16x16x32_bf16 v[112:115], v[36:39], v[88:91], v[112:115]
WL 4
v_mfma_f32_16x16x32_bf16 v[104:107], v[92:95], v[88:91], v[104:107]
ds_read_b128 v[88:91], v10 offset:5120
ds_read_b128 v[92:95], v11 offset:5120
WL 5
v_mfma_f32_16x16x32_bf16 v[108:111], v[40:43], v[72:75], v[108:111]
v_mfma_f32_16x16x32_bf16 v[112:115], v[44:47], v[72:75], v[112:115]
WL 4
v_mfma_f32_16x16x32_bf16 v[104:107], v[76:79], v[72:75], v[104:107]
WL 3
v_mfma_f32_16x16x32_bf16 v[108:111], v[48:51], v[80:83], v[108:111]
v_mfma_f32_16x16x32_bf16 v[112:115], v[52:55], v[80:83], v[112:115]
WL 2
v_mfma_f32_16x16x32_bf16 v[104:107], v[84:87], v[80:83], v[104:107]
WL 1
v_mfma_f32_16x16x32_bf16 v[108:111], v[56:59], v[88:91], v[108:111]
v_mfma_f32_16x16x32_bf16 v[112:115], v[60:63], v[88:91], v[112:115]
WL 0
v_mfma_f32_16x16x32_bf16 v[104:107], v[92:95], v[88:91], v[104:107]
s_nop 7
v_cndmask_b32 v72, v108, v112, s[26:27]
v_cndmask_b32 v73, v109, v113, s[26:27]
v_cndmask_b32 v74, v110, v114, s[26:27]
v_cndmask_b32 v75, v111, v115, s[26:27]
v_max3_f32 v96, v104, v105, v106
v_max3_f32 v98, v72, v73, v74
v_max3_f32 v96, v96, v107, v75
v_max_f32 v96, v96, v98
v_mul_f32 v96, s24, v96
v_pk_fma_f32 v[80:81], v[72:73], s[24:25], v[96:97] op_sel_hi:[1,1,0] neg_lo:[0,0,1] neg_hi:[0,0,1]
v_pk_fma_f32 v[82:83], v[74:75], s[24:25], v[96:97] op_sel_hi:[1,1,0] neg_lo:[0,0,1] neg_hi:[0,0,1]
v_max_f32_dpp v97, v96, v96 row_ror:8 row_mask:0xf bank_mask:0xf
v_mov_b32 v98, v97
v_pk_fma_f32 v[84:85], v[104:105], s[24:25], v[96:97] op_sel_hi:[1,1,0] neg_lo:[0,0,1] neg_hi:[0,0,1]
v_pk_fma_f32 v[86:87], v[106:107], s[24:25], v[96:97] op_sel_hi:[1,1,0] neg_lo:[0,0,1] neg_hi:[0,0,1]
v_permlane16_swap_b32 v97, v98
v_exp_f32 v80, v80
v_max_f32 v97, v97, v98
v_exp_f32 v81, v81
v_mov_b32 v98, v97
v_exp_f32 v82, v82
v_exp_f32 v83, v83
v_permlane32_swap_b32 v97, v98
v_exp_f32 v84, v84
v_max_f32 v97, v97, v98
v_exp_f32 v85, v85
v_sub_f32 v99, v96, v97
v_exp_f32 v86, v86
v_exp_f32 v87, v87
v_exp_f32 v99, v99
v_pk_add_f32 v[100:101], v[80:81], v[82:83]
v_pk_add_f32 v[102:103], v[84:85], v[86:87]
v_pk_add_f32 v[100:101], v[100:101], v[102:103]
v_add_f32 v100, v100, v101
v_mul_f32 v100, v100, v99
s_nop 1
v_add_f32_dpp v100, v100, v100 row_ror:8 row_mask:0xf bank_mask:0xf
v_mov_b32 v98, v100
s_nop 1
v_permlane16_swap_b32 v100, v98
v_add_f32 v100, v100, v98
v_mov_b32 v98, v100
s_nop 1
v_permlane32_swap_b32 v100, v98
v_add_f32 v100, v100, v98
v_rcp_f32 v100, v100
s_nop 0
v_mul_f32 v99, v99, v100
v_pk_mul_f32 v[80:81], v[80:81], v[98:99] op_sel:[0,1] op_sel_hi:[1,1]
v_pk_mul_f32 v[82:83], v[82:83], v[98:99] op_sel:[0,1] op_sel_hi:[1,1]
CV 72,80,81
CV 73,82,83
buffer_store_dwordx2 v[72:73], v13, s[8:11], s19 offen sc1
v_pk_mul_f32 v[84:85], v[84:85], v[98:99] op_sel:[0,1] op_sel_hi:[1,1]
v_pk_mul_f32 v[86:87], v[86:87], v[98:99] op_sel:[0,1] op_sel_hi:[1,1]
CV 74,84,85
CV 75,86,87
buffer_store_dwordx2 v[74:75], v14, s[8:11], s19 offen sc1
s_branch S_end
S_notw0:
s_cmp_eq_u32 s16, 1
s_cbranch_scc1 S_wave1
s_cmp_eq_u32 s16, 3
s_cbranch_scc0 S_nopt_18
s_mov_b64 exec, 1
buffer_store_dword v15, off, s[8:11], s82 sc1
s_mov_b64 exec, -1
s_mov_b32 s82, s83
s_add_u32 s83, s83, 512
S_nopt_18:
ds_read_b128 v[72:75], v10 offset:0
ds_read_b128 v[76:79], v11 offset:0
ds_read_b128 v[80:83], v10 offset:1024
ds_read_b128 v[84:87], v11 offset:1024
ds_read_b128 v[88:91], v10 offset:2048
ds_read_b128 v[92:95], v11 offset:2048
WL 5
v_mfma_f32_16x16x32_bf16 v[108:111], v[16:19], v[72:75], 0
v_mfma_f32_16x16x32_bf16 v[112:115], v[20:23], v[72:75], 0
WL 4
v_mfma_f32_16x16x32_bf16 v[104:107], v[76:79], v[72:75], v[120:123]
ds_read_b128 v[72:75], v10 offset:3072
ds_read_b128 v[76:79], v11 offset:3072
WL 5
v_mfma_f32_16x16x32_bf16 v[108:111], v[24:27], v[80:83], v[108:111]
v_mfma_f32_16x16x32_bf16 v[112:115], v[28:31], v[80:83], v[112:115]
WL 4
v_mfma_f32_16x16x32_bf16 v[104:107], v[84:87], v[80:83], v[104:107]
ds_read_b128 v[80:83], v10 offset:4096
ds_read_b128 v[84:87], v11 offset:4096
WL 5
v_mfma_f32_16x16x32_bf16 v[108:111], v[32:35], v[88:91], v[108:111]
v_mfma_f32_16x16x32_bf16 v[112:115], v[36:39], v[88:91], v[112:115]
WL 4
v_mfma_f32_16x16x32_bf16 v[104:107], v[92:95], v[88:91], v[104:107]
ds_read_b128 v[88:91], v10 offset:5120
ds_read_b128 v[92:95], v11 offset:5120
WL 5
v_mfma_f32_16x16x32_bf16 v[108:111], v[40:43], v[72:75], v[108:111]
v_mfma_f32_16x16x32_bf16 v[112:115], v[44:47], v[72:75], v[112:115]
WL 4
v_mfma_f32_16x16x32_bf16 v[104:107], v[76:79], v[72:75], v[104:107]
WL 3
v_mfma_f32_16x16x32_bf16 v[108:111], v[48:51], v[80:83], v[108:111]
v_mfma_f32_16x16x32_bf16 v[112:115], v[52:55], v[80:83], v[112:115]
WL 2
v_mfma_f32_16x16x32_bf16 v[104:107], v[84:87], v[80:83], v[104:107]
WL 1
v_mfma_f32_16x16x32_bf16 v[108:111], v[56:59], v[88:91], v[108:111]
v_mfma_f32_16x16x32_bf16 v[112:115], v[60:63], v[88:91], v[112:115]
WL 0
v_mfma_f32_16x16x32_bf16 v[104:107], v[92:95], v[88:91], v[104:107]
s_nop 7
v_cndmask_b32 v108, v127, v108, s[48:49]
v_cndmask_b32 v112, v127, v112, s[56:57]
v_cndmask_b32 v109, v127, v109, s[50:51]
v_cndmask_b32 v113, v127, v113, s[58:59]
v_cndmask_b32 v110, v127, v110, s[52:53]
v_cndmask_b32 v114, v127, v114, s[60:61]
v_cndmask_b32 v111, v127, v111, s[54:55]
v_cndmask_b32 v115, v127, v115, s[62:63]
v_max3_f32 v96, v104, v105, v106
v_max3_f32 v97, v108, v109, v110
v_max3_f32 v96, v96, v107, v111
v_max3_f32 v97, v97, v112, v113
v_max3_f32 v96, v96, v114, v115
v_max_f32 v96, v96, v97
v_mov_b32 v97, v96
s_nop 1
v_permlane16_swap_b32 v96, v97
v_max_f32 v96, v96, v97
v_mov_b32 v97, v96
s_nop 1
v_permlane32_swap_b32 v96, v97
v_max_f32 v96, v96, v97
v_mul_f32 v96, s24, v96
v_fma_f32 v72, v104, s24, -v96
v_fma_f32 v73, v105, s24, -v96
v_fma_f32 v74, v106, s24, -v96
v_fma_f32 v75, v107, s24, -v96
v_fma_f32 v76, v108, s24, -v96
v_fma_f32 v77, v109, s24, -v96
v_fma_f32 v78, v110, s24, -v96
v_fma_f32 v79, v111, s24, -v96
v_fma_f32 v80, v112, s24, -v96
v_fma_f32 v81, v113, s24, -v96
v_fma_f32 v82, v114, s24, -v96
v_fma_f32 v83, v115, s24, -v96
v_exp_f32 v72, v72
v_exp_f32 v73, v73
v_exp_f32 v74, v74
v_exp_f32 v75, v75
v_exp_f32 v76, v76
v_exp_f32 v77, v77
v_exp_f32 v78, v78
v_exp_f32 v79, v79
v_exp_f32 v80, v80
v_exp_f32 v81, v81
v_exp_f32 v82, v82
v_exp_f32 v83, v83
v_add_f32 v98, v72, v73
v_add_f32 v98, v98, v74
v_add_f32 v98, v98, v75
v_add_f32 v98, v98, v76
v_add_f32 v98, v98, v77
v_add_f32 v98, v98, v78
v_add_f32 v98, v98, v79
v_add_f32 v98, v98, v80
v_add_f32 v98, v98, v81
v_add_f32 v98, v98, v82
v_add_f32 v98, v98, v83
v_mov_b32 v97, v98
s_nop 1
v_permlane16_swap_b32 v98, v97
v_add_f32 v98, v98, v97
v_mov_b32 v97, v98
s_nop 1
v_permlane32_swap_b32 v98, v97
v_add_f32 v98, v98, v97
v_rcp_f32 v98, v98
s_nop 0
v_mul_f32 v72, v72, v98
v_mul_f32 v73, v73, v98
v_mul_f32 v74, v74, v98
v_mul_f32 v75, v75, v98
v_mul_f32 v76, v76, v98
v_mul_f32 v77, v77, v98
v_mul_f32 v78, v78, v98
v_mul_f32 v79, v79, v98
v_mul_f32 v80, v80, v98
v_mul_f32 v81, v81, v98
v_mul_f32 v82, v82, v98
v_mul_f32 v83, v83, v98
CV 84,72,73
CV 85,74,75
CV 86,76,77
CV 87,78,79
CV 88,80,81
CV 89,82,83
buffer_store_dwordx2 v[84:85], v14, s[8:11], s37 offen sc1
buffer_store_dwordx2 v[86:87], v13, s[8:11], s37 offen sc1
buffer_store_dwordx2 v[88:89], v13, s[8:11], s37 offen offset:1024 sc1
s_branch S_end
S_wave1:
s_add_u32 s79, s17, 1
s_mov_b64 exec, 1
v_mov_b32 v124, s79
buffer_store_dword v124, off, s[8:11], s77
s_mov_b64 exec, -1
s_cmp_ge_u32 s17, 63
s_cbranch_scc1 S_end
s_add_u32 s23, s17, 1
s_and_b32 s23, s23, 3
s_cmp_eq_u32 s23, 0
s_cbranch_scc0 S_noflag_19
s_add_u32 s65, s65, 4096
v_readfirstlane_b32 s23, v104
s_nop 3
s_cmp_ge_u32 s23, 1
s_cbranch_scc1 S_noflag_19
s_mov_b32 s22, 0
v_mov_b32 v124, 0
pf_20:
buffer_load_dword v125, v124, s[8:11], s65 offen sc1
s_add_u32 s22, s22, 1
s_cmp_gt_u32 s22, 4194304
s_cbranch_scc1 R_fail
WV 0
v_readfirstlane_b32 s23, v125
s_nop 3
s_cmp_ge_u32 s23, 1
s_cbranch_scc0 pf_20
S_noflag_19:
s_add_u32 m0, s38, 0
s_add_u32 s23, s20, 0
buffer_load_dwordx4 v1, s[8:11], s23 offen offset:0 sc1 lds
buffer_load_dwordx4 v1, s[8:11], s23 offen offset:1024 sc1 lds
buffer_load_dwordx4 v1, s[8:11], s23 offen offset:2048 sc1 lds
buffer_load_dwordx4 v1, s[8:11], s23 offen offset:3072 sc1 lds
s_add_u32 m0, s38, 4096
s_add_u32 s23, s20, 4096
buffer_load_dwordx4 v1, s[8:11], s23 offen offset:0 sc1 lds
buffer_load_dwordx4 v1, s[8:11], s23 offen offset:1024 sc1 lds
buffer_load_dwordx4 v1, s[8:11], s23 offen offset:2048 sc1 lds
buffer_load_dwordx4 v1, s[8:11], s23 offen offset:3072 sc1 lds
s_add_u32 m0, s38, 8192
s_add_u32 s23, s20, 8192
buffer_load_dwordx4 v1, s[8:11], s23 offen offset:0 sc1 lds
buffer_load_dwordx4 v1, s[8:11], s23 offen offset:1024 sc1 lds
buffer_load_dwordx4 v1, s[8:11], s23 offen offset:2048 sc1 lds
buffer_load_dwordx4 v1, s[8:11], s23 offen offset:3072 sc1 lds
s_add_u32 m0, s38, 12288
s_add_u32 s23, s21, 0
buffer_load_dwordx4 v1, s[8:11], s23 offen offset:0 sc1 lds
buffer_load_dwordx4 v1, s[8:11], s23 offen offset:1024 sc1 lds
buffer_load_dwordx4 v1, s[8:11], s23 offen offset:2048 sc1 lds
buffer_load_dwordx4 v1, s[8:11], s23 offen offset:3072 sc1 lds
s_add_u32 m0, s38, 16384
s_add_u32 s23, s21, 4096
buffer_load_dwordx4 v1, s[8:11], s23 offen offset:0 sc1 lds
buffer_load_dwordx4 v1, s[8:11], s23 offen offset:1024 sc1 lds
buffer_load_dwordx4 v1, s[8:11], s23 offen offset:2048 sc1 lds
buffer_load_dwordx4 v1, s[8:11], s23 offen offset:3072 sc1 lds
s_add_u32 m0, s38, 20480
s_add_u32 s23, s21, 8192
buffer_load_dwordx4 v1, s[8:11], s23 offen offset:0 sc1 lds
buffer_load_dwordx4 v1, s[8:11], s23 offen offset:1024 sc1 lds
buffer_load_dwordx4 v1, s[8:11], s23 offen offset:2048 sc1 lds
buffer_load_dwordx4 v1, s[8:11], s23 offen offset:3072 sc1 lds
s_add_u32 s23, s17, 2
s_and_b32 s23, s23, 3
s_cmp_eq_u32 s23, 0
s_cbranch_scc0 S_nosample_21
s_add_u32 s23, s65, 4096
buffer_load_dword v104, off, s[8:11], s23 sc1
S_nosample_21:
S_end:
s_nop 1
v_mov_b32 v72, 0
v_mov_b32 v73, 0
v_mov_b32 v74, 0
v_mov_b32 v75, 0
v_mov_b32 v76, 0
v_mov_b32 v77, 0
v_mov_b32 v78, 0
v_mov_b32 v79, 0
v_mov_b32 v80, 0
v_mov_b32 v81, 0
v_mov_b32 v82, 0
v_mov_b32 v83, 0
v_mov_b32 v84, 0
v_mov_b32 v85, 0
v_mov_b32 v86, 0
v_mov_b32 v87, 0
v_mov_b32 v88, 0
v_mov_b32 v89, 0
v_mov_b32 v90, 0
v_mov_b32 v91, 0
v_mov_b32 v92, 0
v_mov_b32 v93, 0
v_mov_b32 v94, 0
v_mov_b32 v95, 0
v_add_u32 v12, s36, v12
s_cmp_eq_u32 s16, 0
s_cselect_b32 s23, 0, s36
v_add_u32 v10, s23, v10
s_sub_u32 s38, s38, s36
s_sub_u32 s36, 0, s36
s_add_u32 s20, s20, 393216
s_add_u32 s21, s21, 393216
s_add_u32 s37, s37, 81920
s_add_u32 s18, s18, 32768
s_add_u32 s19, s19, 65536
s_add_u32 s17, s17, 1
s_cmp_eq_u32 s17, 32
s_cselect_b32 s23, s33, 0
s_add_u32 s19, s19, s23
s_cmp_lt_u32 s17, 64
s_cbranch_scc1 S_loop
WV 0
s_barrier
s_cmp_eq_u32 s16, 3
s_cbranch_scc0 R_done
s_mov_b64 exec, 1
buffer_store_dword v15, off, s[8:11], s82 sc1
s_mov_b64 exec, -1
s_branch R_done
C_role:
s_sub_u32 s3, s3, 32
s_cmp_eq_u32 s3, 0
s_cbranch_scc0 cal_22
s_cmp_lt_u32 s16, 3
s_cbranch_scc0 cal_22
s_sub_u32 s24, 0, s4
s_and_b32 s24, s24, 0x1fffff
s_add_u32 s24, s24, 2097152
s_lshl_b32 s25, s16, 21
s_add_u32 s24, s24, s25
s_add_u32 s24, s24, 118784
s_mov_b64 exec, 1
v_mov_b32 v2, 0
v_mov_b32 v3, 8192
s_mov_b32 s40, -1
s_mov_b32 s41, -1
v_mov_b32 v4, 0
s_memtime s[42:43]
WL 0
buffer_atomic_add v4, v2, s[8:11], s24 offen sc0
WV 0
s_memtime s[48:49]
WL 0
s_sub_u32 s48, s48, s42
v_mov_b32 v4, 0
s_memtime s[42:43]
WL 0
buffer_atomic_add v4, v3, s[8:11], s24 offen sc0
WV 0
s_memtime s[48:49]
WL 0
s_sub_u32 s48, s48, s42
v_mov_b32 v4, 0
s_memtime s[42:43]
WL 0
buffer_atomic_add v4, v2, s[8:11], s24 offen sc0
WV 0
s_memtime s[48:49]
WL 0
s_sub_u32 s48, s48, s42
s_min_u32 s40, s40, s48
v_mov_b32 v4, 0
s_memtime s[42:43]
WL 0
buffer_atomic_add v4, v3, s[8:11], s24 offen sc0
WV 0
s_memtime s[48:49]
WL 0
s_sub_u32 s48, s48, s42
s_min_u32 s41, s41, s48
v_mov_b32 v4, 0
s_memtime s[42:43]
WL 0
buffer_atomic_add v4, v2, s[8:11], s24 offen sc0
WV 0
s_memtime s[48:49]
WL 0
s_sub_u32 s48, s48, s42
s_min_u32 s40, s40, s48
v_mov_b32 v4, 0
s_memtime s[42:43]
WL 0
buffer_atomic_add v4, v3, s[8:11], s24 offen sc0
WV 0
s_memtime s[48:49]
WL 0
s_sub_u32 s48, s48, s42
s_min_u32 s41, s41, s48
v_mov_b32 v4, 0
s_memtime s[42:43]
WL 0
buffer_atomic_add v4, v2, s[8:11], s24 offen sc0
WV 0
s_memtime s[48:49]
WL 0
s_sub_u32 s48, s48, s42
s_min_u32 s40, s40, s48
v_mov_b32 v4, 0
s_memtime s[42:43]
WL 0
buffer_atomic_add v4, v3, s[8:11], s24 offen sc0
WV 0
s_memtime s[48:49]
WL 0
s_sub_u32 s48, s48, s42
s_min_u32 s41, s41, s48
v_mov_b32 v4, 0
s_memtime s[42:43]
WL 0
buffer_atomic_add v4, v2, s[8:11], s24 offen sc0
WV 0
s_memtime s[48:49]
WL 0
s_sub_u32 s48, s48, s42
s_min_u32 s40, s40, s48
v_mov_b32 v4, 0
s_memtime s[42:43]
WL 0
buffer_atomic_add v4, v3, s[8:11], s24 offen sc0
WV 0
s_memtime s[48:49]
WL 0
s_sub_u32 s48, s48, s42
s_min_u32 s41, s41, s48
s_cmp_lt_u32 s41, s40
s_cselect_b32 s46, 8192, 0
s_or_b32 s46, s46, 0x10000
v_mov_b32 v4, s46
s_lshl_b32 s25, s16, 2
s_add_u32 s25, s25, 224
v_mov_b32 v5, s25
buffer_store_dword v4, v5, s[12:15], 0 offen sc1
WV 0
s_mov_b64 exec, -1
cal_22:
s_cmp_eq_u32 s16, 0
s_cbranch_scc0 dw_24
s_mov_b32 s22, 0
v_mov_b32 v22, 108
dw_23:
buffer_load_dword v23, v22, s[12:15], 0 offen sc1
s_add_u32 s22, s22, 1
s_cmp_gt_u32 s22, 1048576
s_cbranch_scc1 dw_24
WV 0
v_readfirstlane_b32 s23, v23
s_nop 3
s_cmp_ge_u32 s23, 1
s_cbranch_scc1 dw_24
s_sleep 2
s_branch dw_23
dw_24:
s_barrier
s_mul_i32 s90, s16, 6144
s_mul_i32 s91, s16, 5120
v_and_b32 v22, 63, v0
v_lshlrev_b32 v1, 4, v22
v_lshrrev_b32 v23, 5, v22
v_lshlrev_b32 v23, 2, v23
v_and_b32 v24, 15, v22
v_lshrrev_b32 v25, 2, v24
v_add_u32 v23, v23, v25
v_lshrrev_b32 v25, 4, v22
v_and_b32 v25, 1, v25
v_lshlrev_b32 v25, 5, v25
v_and_b32 v26, 3, v24
v_lshlrev_b32 v26, 3, v26
v_add_u32 v25, v25, v26
v_mul_u32_u24 v26, 384, v23
v_add_u32 v26, v26, v25
v_lshrrev_b32 v27, 1, v23
v_and_b32 v27, 1, v27
v_lshlrev_b32 v27, 6, v27
v_add_u32 v2, v26, v27
v_sub_u32 v3, v26, v27
v_mul_u32_u24 v26, 320, v23
v_add_u32 v4, v26, v25
s_mov_b32 s85, 0
B_loopC:
s_barrier
s_cmp_eq_u32 s16, 0
s_cbranch_scc0 dt_25
s_mov_b64 exec, 1
v_mov_b32 v22, 1
v_mov_b32 v23, 128
buffer_atomic_add v22, v23, s[8:11], 0 offen sc0
WV 0
v_mov_b32 v23, 163836
ds_write_b32 v23, v22
WL 0
s_mov_b64 exec, -1
dt_25:
s_barrier
v_mov_b32 v23, 163836
ds_read_b32 v22, v23
WL 0
v_readfirstlane_b32 s84, v22
s_nop 3
s_cmp_ge_u32 s84, 320
s_cbranch_scc1 B_endC
s_and_b32 s41, s84, 31
s_lshr_b32 s40, s84, 5
s_cmp_ge_u32 s40, 5
s_cselect_b32 s83, 1, 0
s_mul_i32 s23, s83, 5
s_sub_u32 s40, s40, s23
s_load_dwordx2 s[6:7], s[0:1], 32
s_load_dwordx2 s[56:57], s[0:1], 40
v_and_b32 v22, 63, v0
s_mul_i32 s23, s16, 320
s_add_u32 s23, s23, 0
v_add_u32 v23, s23, v22
v_mul_u32_u24 v24, 3277, v23
v_lshrrev_b32 v24, 16, v24
v_mul_u32_u24 v25, 20, v24
v_sub_u32 v25, v23, v25
v_lshlrev_b32 v25, 4, v25
v_mul_u32_u24 v24, 1280, v24
v_add_u32 v16, v24, v25
s_mul_i32 s23, s16, 320
s_add_u32 s23, s23, 64
v_add_u32 v23, s23, v22
v_mul_u32_u24 v24, 3277, v23
v_lshrrev_b32 v24, 16, v24
v_mul_u32_u24 v25, 20, v24
v_sub_u32 v25, v23, v25
v_lshlrev_b32 v25, 4, v25
v_mul_u32_u24 v24, 1280, v24
v_add_u32 v17, v24, v25
s_mul_i32 s23, s16, 320
s_add_u32 s23, s23, 128
v_add_u32 v23, s23, v22
v_mul_u32_u24 v24, 3277, v23
v_lshrrev_b32 v24, 16, v24
v_mul_u32_u24 v25, 20, v24
v_sub_u32 v25, v23, v25
v_lshlrev_b32 v25, 4, v25
v_mul_u32_u24 v24, 1280, v24
v_add_u32 v18, v24, v25
s_mul_i32 s23, s16, 320
s_add_u32 s23, s23, 192
v_add_u32 v23, s23, v22
v_mul_u32_u24 v24, 3277, v23
v_lshrrev_b32 v24, 16, v24
v_mul_u32_u24 v25, 20, v24
v_sub_u32 v25, v23, v25
v_lshlrev_b32 v25, 4, v25
v_mul_u32_u24 v24, 1280, v24
v_add_u32 v19, v24, v25
s_mul_i32 s23, s16, 320
s_add_u32 s23, s23, 256
v_add_u32 v23, s23, v22
v_mul_u32_u24 v24, 3277, v23
v_lshrrev_b32 v24, 16, v24
v_mul_u32_u24 v25, 20, v24
v_sub_u32 v25, v23, v25
v_lshlrev_b32 v25, 4, v25
v_mul_u32_u24 v24, 1280, v24
v_add_u32 v20, v24, v25
WL 0
s_mov_b32 s36, s6
s_and_b32 s37, s7, 0xffff
s_mov_b32 s38, 0x780000
s_mov_b32 s39, 0x20000
s_mov_b32 s28, s56
s_and_b32 s29, s57, 0xffff
s_mov_b32 s30, 0x780000
s_mov_b32 s31, 0x20000
s_mul_i32 s46, s41, 245760
s_mul_i32 s23, s83, 640
s_add_u32 s46, s46, s23
v_and_b32 v22, 63, v0
v_and_b32 v23, 31, v22
v_mul_u32_u24 v23, 12288, v23
v_lshrrev_b32 v24, 5, v22
v_lshlrev_b32 v24, 4, v24
v_add_u32 v23, v23, v24
s_lshl_b32 s43, s40, 2
s_add_u32 s43, s43, s16
s_mul_i32 s44, s43, 393216
s_mul_i32 s23, s41, 384
s_add_u32 s44, s44, s23
buffer_load_dwordx4 v[128:131], v23, s[36:39], s44 offen offset:0
buffer_load_dwordx4 v[132:135], v23, s[36:39], s44 offen offset:32
buffer_load_dwordx4 v[136:139], v23, s[36:39], s44 offen offset:64
buffer_load_dwordx4 v[140:143], v23, s[36:39], s44 offen offset:96
buffer_load_dwordx4 v[144:147], v23, s[36:39], s44 offen offset:128
buffer_load_dwordx4 v[148:151], v23, s[36:39], s44 offen offset:160
buffer_load_dwordx4 v[152:155], v23, s[36:39], s44 offen offset:192
buffer_load_dwordx4 v[156:159], v23, s[36:39], s44 offen offset:224
buffer_load_dwordx4 v[160:163], v23, s[36:39], s44 offen offset:256
buffer_load_dwordx4 v[164:167], v23, s[36:39], s44 offen offset:288
buffer_load_dwordx4 v[168:171], v23, s[36:39], s44 offen offset:320
buffer_load_dwordx4 v[172:175], v23, s[36:39], s44 offen offset:352
v_and_b32 v25, 31, v22
v_lshrrev_b32 v26, 3, v25
s_mov_b32 s23, 327680
v_mul_lo_u32 v26, v26, s23
v_lshrrev_b32 v27, 5, v22
v_lshlrev_b32 v27, 4, v27
v_and_b32 v25, 7, v25
v_add_u32 v25, v25, v27
s_lshr_b32 s23, s41, 2
s_and_b32 s23, s23, 1
s_lshl_b32 s23, s23, 3
v_add_u32 v25, s23, v25
v_lshlrev_b32 v25, 4, v25
v_add_u32 v21, v25, v26
s_lshr_b32 s47, s41, 3
s_mul_i32 s47, s47, 81920
s_and_b32 s23, s41, 3
s_mul_i32 s23, s23, 20480
s_add_u32 s47, s47, s23
s_lshl_b32 s23, s43, 10
s_add_u32 s47, s47, s23
s_add_u32 s47, s47, 47185920
s_mul_i32 s23, s83, 13107200
s_add_u32 s47, s47, s23
s_mul_i32 s23, s16, 5120
s_add_u32 m0, s23, 0
s_nop 0
DM 16,28,46
s_add_u32 m0, s23, 1024
s_nop 0
DM 17,28,46
s_add_u32 m0, s23, 2048
s_nop 0
DM 18,28,46
s_add_u32 m0, s23, 3072
s_nop 0
DM 19,28,46
s_add_u32 m0, s23, 4096
s_nop 0
DM 20,28,46
s_add_u32 s46, s46, 81920
s_mul_i32 s23, s16, 5120
s_add_u32 m0, s23, 20480
s_nop 0
DM 16,28,46
s_add_u32 m0, s23, 21504
s_nop 0
DM 17,28,46
s_add_u32 m0, s23, 22528
s_nop 0
DM 18,28,46
s_add_u32 m0, s23, 23552
s_nop 0
DM 19,28,46
s_add_u32 m0, s23, 24576
s_nop 0
DM 20,28,46
s_add_u32 s46, s46, 81920
s_mul_i32 s23, s16, 5120
s_add_u32 m0, s23, 40960
s_nop 0
DM 16,28,46
s_add_u32 m0, s23, 41984
s_nop 0
DM 17,28,46
s_add_u32 m0, s23, 43008
s_nop 0
DM 18,28,46
s_add_u32 m0, s23, 44032
s_nop 0
DM 19,28,46
s_add_u32 m0, s23, 45056
s_nop 0
DM 20,28,46
s_add_u32 s46, s46, -163520
WV 15
v_permlane32_swap_b32 v128, v130
v_permlane32_swap_b32 v129, v131
v_permlane32_swap_b32 v132, v134
v_permlane32_swap_b32 v133, v135
v_permlane32_swap_b32 v136, v138
v_permlane32_swap_b32 v137, v139
v_permlane32_swap_b32 v140, v142
v_permlane32_swap_b32 v141, v143
v_permlane32_swap_b32 v144, v146
v_permlane32_swap_b32 v145, v147
v_permlane32_swap_b32 v148, v150
v_permlane32_swap_b32 v149, v151
v_permlane32_swap_b32 v152, v154
v_permlane32_swap_b32 v153, v155
v_permlane32_swap_b32 v156, v158
v_permlane32_swap_b32 v157, v159
v_permlane32_swap_b32 v160, v162
v_permlane32_swap_b32 v161, v163
v_permlane32_swap_b32 v164, v166
v_permlane32_swap_b32 v165, v167
v_permlane32_swap_b32 v168, v170
v_permlane32_swap_b32 v169, v171
v_permlane32_swap_b32 v172, v174
v_permlane32_swap_b32 v173, v175
s_nop 1
WV 10
s_barrier
v_add_u32 v6, 0, v4
TR 0,6,0
TR 2,6,2560
TR 4,6,64
TR 6,6,2624
TR 8,6,128
TR 10,6,2688
TR 12,6,192
TR 14,6,2752
TR 16,6,256
TR 18,6,2816
WL 8
v_mfma_f32_32x32x16_bf16 v[32:47], v[128:131], a[0:3], 0
TR 24,6,5120
TR 26,6,7680
WL 8
v_mfma_f32_32x32x16_bf16 v[48:63], v[128:131], a[4:7], 0
TR 28,6,5184
TR 30,6,7744
WL 8
v_mfma_f32_32x32x16_bf16 v[64:79], v[128:131], a[8:11], 0
TR 32,6,5248
TR 34,6,7808
WL 8
v_mfma_f32_32x32x16_bf16 v[80:95], v[128:131], a[12:15], 0
TR 36,6,5312
TR 38,6,7872
WL 8
v_mfma_f32_32x32x16_bf16 v[96:111], v[128:131], a[16:19], 0
TR 40,6,5376
TR 42,6,7936
WL 8
MB 32,132,24
TR 0,6,10240
TR 2,6,12800
WL 8
MB 48,132,28
TR 4,6,10304
TR 6,6,12864
WL 8
MB 64,132,32
TR 8,6,10368
TR 10,6,12928
WL 8
MB 80,132,36
TR 12,6,10432
TR 14,6,12992
WL 8
MB 96,132,40
TR 16,6,10496
TR 18,6,13056
WV 5
s_barrier
v_add_u32 v8, 20480, v4
WL 8
MB 32,136,0
TR 24,6,15360
TR 26,6,17920
WL 8
MB 48,136,4
TR 28,6,15424
TR 30,6,17984
s_add_u32 m0, s91, 61440
s_nop 0
DM 16,28,46
WL 8
MB 64,136,8
TR 32,6,15488
TR 34,6,18048
WL 8
MB 80,136,12
TR 36,6,15552
TR 38,6,18112
WL 8
MB 96,136,16
TR 40,6,15616
TR 42,6,18176
s_add_u32 m0, s91, 62464
s_nop 0
DM 17,28,46
WL 8
MB 32,140,24
TR 0,8,0
TR 2,8,2560
WL 8
MB 48,140,28
TR 4,8,64
TR 6,8,2624
s_add_u32 m0, s91, 63488
s_nop 0
DM 18,28,46
WL 8
MB 64,140,32
TR 8,8,128
TR 10,8,2688
WL 8
MB 80,140,36
TR 12,8,192
TR 14,8,2752
WL 8
MB 96,140,40
TR 16,8,256
TR 18,8,2816
s_add_u32 m0, s91, 64512
s_nop 0
DM 19,28,46
WL 8
MB 32,144,0
TR 24,8,5120
TR 26,8,7680
WL 8
MB 48,144,4
TR 28,8,5184
TR 30,8,7744
s_add_u32 m0, s91, 65536
s_nop 0
DM 20,28,46
s_add_u32 s46, s46, 81920
WL 8
MB 64,144,8
TR 32,8,5248
TR 34,8,7808
WL 8
MB 80,144,12
TR 36,8,5312
TR 38,8,7872
WL 8
MB 96,144,16
TR 40,8,5376
TR 42,8,7936
WL 8
MB 32,148,24
TR 0,8,10240
TR 2,8,12800
WL 8
MB 48,148,28
TR 4,8,10304
TR 6,8,12864
WL 8
MB 64,148,32
TR 8,8,10368
TR 10,8,12928
WL 8
MB 80,148,36
TR 12,8,10432
TR 14,8,12992
WL 8
MB 96,148,40
TR 16,8,10496
TR 18,8,13056
WV 5
s_barrier
v_add_u32 v6, 40960, v4
WL 8
MB 32,152,0
TR 24,8,15360
TR 26,8,17920
WL 8
MB 48,152,4
TR 28,8,15424
TR 30,8,17984
s_add_u32 m0, s91, 0
s_nop 0
DM 16,28,46
WL 8
MB 64,152,8
TR 32,8,15488
TR 34,8,18048
WL 8
MB 80,152,12
TR 36,8,15552
TR 38,8,18112
WL 8
MB 96,152,16
TR 40,8,15616
TR 42,8,18176
s_add_u32 m0, s91, 1024
s_nop 0
DM 17,28,46
WL 8
MB 32,156,24
TR 0,6,0
TR 2,6,2560
WL 8
MB 48,156,28
TR 4,6,64
TR 6,6,2624
s_add_u32 m0, s91, 2048
s_nop 0
DM 18,28,46
WL 8
MB 64,156,32
TR 8,6,128
TR 10,6,2688
WL 8
MB 80,156,36
TR 12,6,192
TR 14,6,2752
WL 8
MB 96,156,40
TR 16,6,256
TR 18,6,2816
s_add_u32 m0, s91, 3072
s_nop 0
DM 19,28,46
WL 8
MB 32,160,0
TR 24,6,5120
TR 26,6,7680
WL 8
MB 48,160,4
TR 28,6,5184
TR 30,6,7744
s_add_u32 m0, s91, 4096
s_nop 0
DM 20,28,46
s_add_u32 s46, s46, 81920
WL 8
MB 64,160,8
TR 32,6,5248
TR 34,6,7808
WL 8
MB 80,160,12
TR 36,6,5312
TR 38,6,7872
WL 8
MB 96,160,16
TR 40,6,5376
TR 42,6,7936
WL 8
MB 32,164,24
TR 0,6,10240
TR 2,6,12800
WL 8
MB 48,164,28
TR 4,6,10304
TR 6,6,12864
WL 8
MB 64,164,32
TR 8,6,10368
TR 10,6,12928
WL 8
MB 80,164,36
TR 12,6,10432
TR 14,6,12992
WL 8
MB 96,164,40
TR 16,6,10496
TR 18,6,13056
WV 5
s_barrier
v_add_u32 v8, 61440, v4
WL 8
MB 32,168,0
TR 24,6,15360
TR 26,6,17920
WL 8
MB 48,168,4
TR 28,6,15424
TR 30,6,17984
s_add_u32 m0, s91, 20480
s_nop 0
DM 16,28,46
WL 8
MB 64,168,8
TR 32,6,15488
TR 34,6,18048
WL 8
MB 80,168,12
TR 36,6,15552
TR 38,6,18112
WL 8
MB 96,168,16
TR 40,6,15616
TR 42,6,18176
s_add_u32 m0, s91, 21504
s_nop 0
DM 17,28,46
WL 8
MB 32,172,24
TR 0,8,0
TR 2,8,2560
WL 8
MB 48,172,28
TR 4,8,64
TR 6,8,2624
s_add_u32 m0, s91, 22528
s_nop 0
DM 18,28,46
WL 8
MB 64,172,32
TR 8,8,128
TR 10,8,2688
WL 8
MB 80,172,36
TR 12,8,192
TR 14,8,2752
WL 8
MB 96,172,40
TR 16,8,256
TR 18,8,2816
s_add_u32 m0, s91, 23552
s_nop 0
DM 19,28,46
s_nop 7
s_nop 7
CV 112,32,33
CV 113,36,37
CV 114,34,35
CV 115,38,39
CV 116,40,41
CV 117,44,45
CV 118,42,43
CV 119,46,47
s_add_u32 s48, s47, 0
buffer_store_dwordx4 v[112:115], v21, s[8:11], s48 offen sc1
buffer_store_dwordx4 v[116:119], v21, s[8:11], s48 offen offset:512 sc1
CV 120,48,49
CV 121,52,53
CV 122,50,51
CV 123,54,55
CV 124,56,57
CV 125,60,61
CV 126,58,59
CV 127,62,63
s_add_u32 s48, s47, 1310720
buffer_store_dwordx4 v[120:123], v21, s[8:11], s48 offen sc1
buffer_store_dwordx4 v[124:127], v21, s[8:11], s48 offen offset:512 sc1
CV 112,64,65
CV 113,68,69
CV 114,66,67
CV 115,70,71
CV 116,72,73
CV 117,76,77
CV 118,74,75
CV 119,78,79
s_add_u32 s48, s47, 2621440
buffer_store_dwordx4 v[112:115], v21, s[8:11], s48 offen sc1
buffer_store_dwordx4 v[116:119], v21, s[8:11], s48 offen offset:512 sc1
CV 120,80,81
CV 121,84,85
CV 122,82,83
CV 123,86,87
CV 124,88,89
CV 125,92,93
CV 126,90,91
CV 127,94,95
s_add_u32 s48, s47, 3932160
buffer_store_dwordx4 v[120:123], v21, s[8:11], s48 offen sc1
buffer_store_dwordx4 v[124:127], v21, s[8:11], s48 offen offset:512 sc1
CV 112,96,97
CV 113,100,101
CV 114,98,99
CV 115,102,103
CV 116,104,105
CV 117,108,109
CV 118,106,107
CV 119,110,111
s_add_u32 s48, s47, 5242880
buffer_store_dwordx4 v[112:115], v21, s[8:11], s48 offen sc1
buffer_store_dwordx4 v[116:119], v21, s[8:11], s48 offen offset:512 sc1
WL 8
v_mfma_f32_32x32x16_bf16 v[32:47], v[128:131], a[0:3], 0
TR 24,8,5120
TR 26,8,7680
WL 8
v_mfma_f32_32x32x16_bf16 v[48:63], v[128:131], a[4:7], 0
TR 28,8,5184
TR 30,8,7744
s_add_u32 m0, s91, 24576
s_nop 0
DM 20,28,46
s_add_u32 s46, s46, -163520
WL 8
v_mfma_f32_32x32x16_bf16 v[64:79], v[128:131], a[8:11], 0
TR 32,8,5248
TR 34,8,7808
WL 8
v_mfma_f32_32x32x16_bf16 v[80:95], v[128:131], a[12:15], 0
TR 36,8,5312
TR 38,8,7872
WL 8
v_mfma_f32_32x32x16_bf16 v[96:111], v[128:131], a[16:19], 0
TR 40,8,5376
TR 42,8,7936
WL 8
MB 32,132,24
TR 0,8,10240
TR 2,8,12800
WL 8
MB 48,132,28
TR 4,8,10304
TR 6,8,12864
WL 8
MB 64,132,32
TR 8,8,10368
TR 10,8,12928
WL 8
MB 80,132,36
TR 12,8,10432
TR 14,8,12992
WL 8
MB 96,132,40
TR 16,8,10496
TR 18,8,13056
WV 15
s_barrier
v_add_u32 v6, 0, v4
WL 8
MB 32,136,0
TR 24,8,15360
TR 26,8,17920
WL 8
MB 48,136,4
TR 28,8,15424
TR 30,8,17984
WL 8
MB 64,136,8
TR 32,8,15488
TR 34,8,18048
WL 8
MB 80,136,12
TR 36,8,15552
TR 38,8,18112
WL 8
MB 96,136,16
TR 40,8,15616
TR 42,8,18176
WL 8
MB 32,140,24
TR 0,6,0
TR 2,6,2560
WL 8
MB 48,140,28
TR 4,6,64
TR 6,6,2624
WL 8
MB 64,140,32
TR 8,6,128
TR 10,6,2688
WL 8
MB 80,140,36
TR 12,6,192
TR 14,6,2752
WL 8
MB 96,140,40
TR 16,6,256
TR 18,6,2816
WL 8
MB 32,144,0
TR 24,6,5120
TR 26,6,7680
WL 8
MB 48,144,4
TR 28,6,5184
TR 30,6,7744
WL 8
MB 64,144,8
TR 32,6,5248
TR 34,6,7808
WL 8
MB 80,144,12
TR 36,6,5312
TR 38,6,7872
WL 8
MB 96,144,16
TR 40,6,5376
TR 42,6,7936
WL 8
MB 32,148,24
TR 0,6,10240
TR 2,6,12800
WL 8
MB 48,148,28
TR 4,6,10304
TR 6,6,12864
WL 8
MB 64,148,32
TR 8,6,10368
TR 10,6,12928
WL 8
MB 80,148,36
TR 12,6,10432
TR 14,6,12992
WL 8
MB 96,148,40
TR 16,6,10496
TR 18,6,13056
WV 0
s_barrier
v_add_u32 v8, 20480, v4
WL 8
MB 32,152,0
TR 24,6,15360
TR 26,6,17920
WL 8
MB 48,152,4
TR 28,6,15424
TR 30,6,17984
WL 8
MB 64,152,8
TR 32,6,15488
TR 34,6,18048
WL 8
MB 80,152,12
TR 36,6,15552
TR 38,6,18112
WL 8
MB 96,152,16
TR 40,6,15616
TR 42,6,18176
WL 8
MB 32,156,24
TR 0,8,0
TR 2,8,2560
WL 8
MB 48,156,28
TR 4,8,64
TR 6,8,2624
WL 8
MB 64,156,32
TR 8,8,128
TR 10,8,2688
WL 8
MB 80,156,36
TR 12,8,192
TR 14,8,2752
WL 8
MB 96,156,40
TR 16,8,256
TR 18,8,2816
WL 8
MB 32,160,0
TR 24,8,5120
TR 26,8,7680
WL 8
MB 48,160,4
TR 28,8,5184
TR 30,8,7744
WL 8
MB 64,160,8
TR 32,8,5248
TR 34,8,7808
WL 8
MB 80,160,12
TR 36,8,5312
TR 38,8,7872
WL 8
MB 96,160,16
TR 40,8,5376
TR 42,8,7936
WL 8
MB 32,164,24
TR 0,8,10240
TR 2,8,12800
WL 8
MB 48,164,28
TR 4,8,10304
TR 6,8,12864
WL 8
MB 64,164,32
TR 8,8,10368
TR 10,8,12928
WL 8
MB 80,164,36
TR 12,8,10432
TR 14,8,12992
WL 8
MB 96,164,40
TR 16,8,10496
TR 18,8,13056
WL 8
MB 32,168,0
TR 24,8,15360
TR 26,8,17920
WL 8
MB 48,168,4
TR 28,8,15424
TR 30,8,17984
WL 8
MB 64,168,8
TR 32,8,15488
TR 34,8,18048
WL 8
MB 80,168,12
TR 36,8,15552
TR 38,8,18112
WL 8
MB 96,168,16
TR 40,8,15616
TR 42,8,18176
WL 8
MB 32,172,24
WL 6
MB 48,172,28
WL 4
MB 64,172,32
WL 2
MB 80,172,36
WL 0
MB 96,172,40
s_nop 7
s_nop 7
CV 112,32,33
CV 113,36,37
CV 114,34,35
CV 115,38,39
CV 116,40,41
CV 117,44,45
CV 118,42,43
CV 119,46,47
s_add_u32 s48, s47, 6553600
buffer_store_dwordx4 v[112:115], v21, s[8:11], s48 offen sc1
buffer_store_dwordx4 v[116:119], v21, s[8:11], s48 offen offset:512 sc1
CV 120,48,49
CV 121,52,53
CV 122,50,51
CV 123,54,55
CV 124,56,57
CV 125,60,61
CV 126,58,59
CV 127,62,63
s_add_u32 s48, s47, 7864320
buffer_store_dwordx4 v[120:123], v21, s[8:11], s48 offen sc1
buffer_store_dwordx4 v[124:127], v21, s[8:11], s48 offen offset:512 sc1
CV 112,64,65
CV 113,68,69
CV 114,66,67
CV 115,70,71
CV 116,72,73
CV 117,76,77
CV 118,74,75
CV 119,78,79
s_add_u32 s48, s47, 9175040
buffer_store_dwordx4 v[112:115], v21, s[8:11], s48 offen sc1
buffer_store_dwordx4 v[116:119], v21, s[8:11], s48 offen offset:512 sc1
CV 120,80,81
CV 121,84,85
CV 122,82,83
CV 123,86,87
CV 124,88,89
CV 125,92,93
CV 126,90,91
CV 127,94,95
s_add_u32 s48, s47, 10485760
buffer_store_dwordx4 v[120:123], v21, s[8:11], s48 offen sc1
buffer_store_dwordx4 v[124:127], v21, s[8:11], s48 offen offset:512 sc1
CV 112,96,97
CV 113,100,101
CV 114,98,99
CV 115,102,103
CV 116,104,105
CV 117,108,109
CV 118,106,107
CV 119,110,111
s_add_u32 s48, s47, 11796480
buffer_store_dwordx4 v[112:115], v21, s[8:11], s48 offen sc1
buffer_store_dwordx4 v[116:119], v21, s[8:11], s48 offen offset:512 sc1
WV 0
s_barrier
s_cmp_eq_u32 s16, 0
s_cbranch_scc0 da_26
s_mov_b64 exec, 1
v_mov_b32 v22, 1
v_mov_b32 v23, 512
buffer_atomic_add v22, v23, s[8:11], 0 offen
s_mov_b64 exec, -1
da_26:
s_add_u32 s85, s85, 1
s_branch B_loopC
B_endC:
s_cmp_eq_u32 s16, 0
s_cbranch_scc0 dw_28
s_mov_b32 s22, 0
v_mov_b32 v136, 512
dw_27:
buffer_load_dword v137, v136, s[8:11], 0 offen sc1
s_add_u32 s22, s22, 1
s_cmp_gt_u32 s22, 1048576
s_cbranch_scc1 dw_28
WV 0
v_readfirstlane_b32 s23, v137
s_nop 3
s_cmp_ge_u32 s23, 320
s_cbranch_scc1 dw_28
s_sleep 8
s_branch dw_27
dw_28:
s_barrier
v_and_b32 v136, 63, v0
v_lshlrev_b32 v1, 4, v136
v_lshlrev_b32 v2, 4, v0
v_add_u32 v3, 4096, v2
v_add_u32 v4, 16384, v2
v_add_u32 v5, 0, v2
v_add_u32 v6, 8192, v2
v_cmp_gt_u32 vcc, 128, v0
s_nop 1
v_cndmask_b32 v4, v2, v4, vcc
v_cndmask_b32 v6, v5, v6, vcc
v_add_u32 v7, 0, v1
v_lshrrev_b32 v137, 4, v136
v_and_b32 v138, 7, v136
v_lshrrev_b32 v139, 3, v136
v_and_b32 v139, 1, v139
v_cmp_eq_u32 vcc, 0, v139
v_mov_b32 v8, 0xeeee
v_mov_b32 v140, 0x4444
s_nop 0
v_cndmask_b32 v8, v8, v140, vcc
s_lshl_b32 s23, s16, 3
v_add_u32 v140, s23, v139
v_add_u32 v140, 0, v140
v_mul_u32_u24 v140, 640, v140
v_add_u32 v141, 1, v137
v_lshlrev_b32 v141, 7, v141
v_lshlrev_b32 v142, 4, v138
v_add3_u32 v9, v140, v141, v142
v_lshrrev_b32 v140, 13, v9
v_lshlrev_b32 v140, 14, v140
v_and_b32 v9, 0x1fff, v9
v_add_u32 v9, v9, v140
v_add_u32 v140, s23, v139
v_add_u32 v140, 2, v140
v_mul_u32_u24 v140, 640, v140
v_add_u32 v141, 1, v137
v_lshlrev_b32 v141, 7, v141
v_lshlrev_b32 v142, 4, v138
v_add3_u32 v10, v140, v141, v142
v_lshrrev_b32 v140, 13, v10
v_lshlrev_b32 v140, 14, v140
v_and_b32 v10, 0x1fff, v10
v_add_u32 v10, v10, v140
v_add_u32 v140, s23, v139
v_add_u32 v140, 4, v140
v_mul_u32_u24 v140, 640, v140
v_add_u32 v141, 1, v137
v_lshlrev_b32 v141, 7, v141
v_lshlrev_b32 v142, 4, v138
v_add3_u32 v11, v140, v141, v142
v_lshrrev_b32 v140, 13, v11
v_lshlrev_b32 v140, 14, v140
v_and_b32 v11, 0x1fff, v11
v_add_u32 v11, v11, v140
v_add_u32 v140, s23, v139
v_add_u32 v140, 6, v140
v_mul_u32_u24 v140, 640, v140
v_add_u32 v141, 1, v137
v_lshlrev_b32 v141, 7, v141
v_lshlrev_b32 v142, 4, v138
v_add3_u32 v12, v140, v141, v142
v_lshrrev_b32 v140, 13, v12
v_lshlrev_b32 v140, 14, v140
v_and_b32 v12, 0x1fff, v12
v_add_u32 v12, v12, v140
v_lshlrev_b32 v140, 2, v139
v_add3_u32 v140, v140, v137, s23
v_mul_u32_u24 v140, 640, v140
v_lshlrev_b32 v142, 4, v138
v_add_u32 v13, v140, v142
v_lshrrev_b32 v140, 13, v13
v_lshlrev_b32 v140, 14, v140
v_and_b32 v13, 0x1fff, v13
v_add_u32 v13, v13, v140
s_lshl_b32 s23, s16, 10
s_add_u32 s23, s23, 16384
v_add_u32 v14, s23, v1
v_lshlrev_b32 v140, 10, v137
v_lshlrev_b32 v141, 4, v139
v_add_u32 v141, v141, v138
v_lshlrev_b32 v141, 4, v141
v_add_u32 v140, v140, v141
v_add_u32 v15, 16384, v140
v_add_u32 v16, 17024, v140
s_lshl_b32 s23, s3, 7
v_lshlrev_b32 v140, 4, v138
v_lshlrev_b32 v141, 3, v139
v_add_u32 v140, v140, v141
v_lshrrev_b32 v141, 1, v137
v_lshlrev_b32 v141, 2, v141
v_add3_u32 v17, v140, v141, s23
v_lshrrev_b32 v140, 13, v17
v_lshlrev_b32 v140, 14, v140
v_and_b32 v17, 0x1fff, v17
v_add_u32 v17, v17, v140
v_add_u32 v17, 32768, v17
v_and_b32 v140, 1, v137
v_cmp_eq_u32 vcc, 0, v140
v_mov_b32 v141, 0x80000000
s_nop 0
v_cndmask_b32 v17, v141, v17, vcc
s_mul_i32 s23, s3, 327680
s_mul_i32 s24, s16, 81920
s_add_u32 s23, s23, s24
s_add_u32 s23, s23, 47185920
buffer_load_dwordx4 a[0:3], v1, s[8:11], s23 offen sc1
buffer_load_dwordx4 a[4:7], v1, s[8:11], s23 offen offset:1024 sc1
s_add_u32 s23, s23, 2048
buffer_load_dwordx4 a[8:11], v1, s[8:11], s23 offen sc1
buffer_load_dwordx4 a[12:15], v1, s[8:11], s23 offen offset:1024 sc1
s_add_u32 s23, s23, 2048
buffer_load_dwordx4 a[16:19], v1, s[8:11], s23 offen sc1
buffer_load_dwordx4 a[20:23], v1, s[8:11], s23 offen offset:1024 sc1
s_add_u32 s23, s23, 2048
buffer_load_dwordx4 a[24:27], v1, s[8:11], s23 offen sc1
buffer_load_dwordx4 a[28:31], v1, s[8:11], s23 offen offset:1024 sc1
s_add_u32 s23, s23, 2048
buffer_load_dwordx4 a[32:35], v1, s[8:11], s23 offen sc1
buffer_load_dwordx4 a[36:39], v1, s[8:11], s23 offen offset:1024 sc1
s_add_u32 s23, s23, 2048
buffer_load_dwordx4 a[40:43], v1, s[8:11], s23 offen sc1
buffer_load_dwordx4 a[44:47], v1, s[8:11], s23 offen offset:1024 sc1
s_add_u32 s23, s23, 2048
buffer_load_dwordx4 a[48:51], v1, s[8:11], s23 offen sc1
buffer_load_dwordx4 a[52:55], v1, s[8:11], s23 offen offset:1024 sc1
s_add_u32 s23, s23, 2048
buffer_load_dwordx4 a[56:59], v1, s[8:11], s23 offen sc1
buffer_load_dwordx4 a[60:63], v1, s[8:11], s23 offen offset:1024 sc1
s_add_u32 s23, s23, 2048
WV 32
buffer_load_dwordx4 a[64:67], v1, s[8:11], s23 offen sc1
buffer_load_dwordx4 a[68:71], v1, s[8:11], s23 offen offset:1024 sc1
s_add_u32 s23, s23, 2048
buffer_load_dwordx4 a[72:75], v1, s[8:11], s23 offen sc1
buffer_load_dwordx4 a[76:79], v1, s[8:11], s23 offen offset:1024 sc1
s_add_u32 s23, s23, 2048
buffer_load_dwordx4 a[80:83], v1, s[8:11], s23 offen sc1
buffer_load_dwordx4 a[84:87], v1, s[8:11], s23 offen offset:1024 sc1
s_add_u32 s23, s23, 2048
buffer_load_dwordx4 a[88:91], v1, s[8:11], s23 offen sc1
buffer_load_dwordx4 a[92:95], v1, s[8:11], s23 offen offset:1024 sc1
s_add_u32 s23, s23, 2048
buffer_load_dwordx4 a[96:99], v1, s[8:11], s23 offen sc1
buffer_load_dwordx4 a[100:103], v1, s[8:11], s23 offen offset:1024 sc1
s_add_u32 s23, s23, 2048
buffer_load_dwordx4 a[104:107], v1, s[8:11], s23 offen sc1
buffer_load_dwordx4 a[108:111], v1, s[8:11], s23 offen offset:1024 sc1
s_add_u32 s23, s23, 2048
buffer_load_dwordx4 a[112:115], v1, s[8:11], s23 offen sc1
buffer_load_dwordx4 a[116:119], v1, s[8:11], s23 offen offset:1024 sc1
s_add_u32 s23, s23, 2048
buffer_load_dwordx4 a[120:123], v1, s[8:11], s23 offen sc1
buffer_load_dwordx4 a[124:127], v1, s[8:11], s23 offen offset:1024 sc1
s_add_u32 s23, s23, 2048
WV 32
buffer_load_dwordx4 a[128:131], v1, s[8:11], s23 offen sc1
buffer_load_dwordx4 a[132:135], v1, s[8:11], s23 offen offset:1024 sc1
s_add_u32 s23, s23, 2048
buffer_load_dwordx4 a[136:139], v1, s[8:11], s23 offen sc1
buffer_load_dwordx4 a[140:143], v1, s[8:11], s23 offen offset:1024 sc1
s_add_u32 s23, s23, 2048
buffer_load_dwordx4 a[144:147], v1, s[8:11], s23 offen sc1
buffer_load_dwordx4 a[148:151], v1, s[8:11], s23 offen offset:1024 sc1
s_add_u32 s23, s23, 2048
buffer_load_dwordx4 a[152:155], v1, s[8:11], s23 offen sc1
buffer_load_dwordx4 a[156:159], v1, s[8:11], s23 offen offset:1024 sc1
s_add_u32 s23, s23, 2048
buffer_load_dwordx4 a[160:163], v1, s[8:11], s23 offen sc1
buffer_load_dwordx4 a[164:167], v1, s[8:11], s23 offen offset:1024 sc1
s_add_u32 s23, s23, 2048
buffer_load_dwordx4 a[168:171], v1, s[8:11], s23 offen sc1
buffer_load_dwordx4 a[172:175], v1, s[8:11], s23 offen offset:1024 sc1
s_add_u32 s23, s23, 2048
buffer_load_dwordx4 a[176:179], v1, s[8:11], s23 offen sc1
buffer_load_dwordx4 a[180:183], v1, s[8:11], s23 offen offset:1024 sc1
s_add_u32 s23, s23, 2048
buffer_load_dwordx4 a[184:187], v1, s[8:11], s23 offen sc1
buffer_load_dwordx4 a[188:191], v1, s[8:11], s23 offen offset:1024 sc1
s_add_u32 s23, s23, 2048
WV 32
buffer_load_dwordx4 a[192:195], v1, s[8:11], s23 offen sc1
buffer_load_dwordx4 a[196:199], v1, s[8:11], s23 offen offset:1024 sc1
s_add_u32 s23, s23, 2048
buffer_load_dwordx4 a[200:203], v1, s[8:11], s23 offen sc1
buffer_load_dwordx4 a[204:207], v1, s[8:11], s23 offen offset:1024 sc1
s_add_u32 s23, s23, 2048
buffer_load_dwordx4 a[208:211], v1, s[8:11], s23 offen sc1
buffer_load_dwordx4 a[212:215], v1, s[8:11], s23 offen offset:1024 sc1
s_add_u32 s23, s23, 2048
buffer_load_dwordx4 a[216:219], v1, s[8:11], s23 offen sc1
buffer_load_dwordx4 a[220:223], v1, s[8:11], s23 offen offset:1024 sc1
s_add_u32 s23, s23, 2048
buffer_load_dwordx4 a[224:227], v1, s[8:11], s23 offen sc1
buffer_load_dwordx4 a[228:231], v1, s[8:11], s23 offen offset:1024 sc1
s_add_u32 s23, s23, 2048
buffer_load_dwordx4 a[232:235], v1, s[8:11], s23 offen sc1
buffer_load_dwordx4 a[236:239], v1, s[8:11], s23 offen offset:1024 sc1
s_add_u32 s23, s23, 2048
buffer_load_dwordx4 a[240:243], v1, s[8:11], s23 offen sc1
buffer_load_dwordx4 a[244:247], v1, s[8:11], s23 offen offset:1024 sc1
s_add_u32 s23, s23, 2048
buffer_load_dwordx4 a[248:251], v1, s[8:11], s23 offen sc1
buffer_load_dwordx4 a[252:255], v1, s[8:11], s23 offen offset:1024 sc1
s_add_u32 s23, s23, 2048
WV 32
buffer_load_dwordx4 v[192:195], v1, s[8:11], s23 offen sc1
buffer_load_dwordx4 v[196:199], v1, s[8:11], s23 offen offset:1024 sc1
s_add_u32 s23, s23, 2048
buffer_load_dwordx4 v[200:203], v1, s[8:11], s23 offen sc1
buffer_load_dwordx4 v[204:207], v1, s[8:11], s23 offen offset:1024 sc1
s_add_u32 s23, s23, 2048
buffer_load_dwordx4 v[208:211], v1, s[8:11], s23 offen sc1
buffer_load_dwordx4 v[212:215], v1, s[8:11], s23 offen offset:1024 sc1
s_add_u32 s23, s23, 2048
buffer_load_dwordx4 v[216:219], v1, s[8:11], s23 offen sc1
buffer_load_dwordx4 v[220:223], v1, s[8:11], s23 offen offset:1024 sc1
s_add_u32 s23, s23, 2048
buffer_load_dwordx4 v[224:227], v1, s[8:11], s23 offen sc1
buffer_load_dwordx4 v[228:231], v1, s[8:11], s23 offen offset:1024 sc1
s_add_u32 s23, s23, 2048
buffer_load_dwordx4 v[232:235], v1, s[8:11], s23 offen sc1
buffer_load_dwordx4 v[236:239], v1, s[8:11], s23 offen offset:1024 sc1
s_add_u32 s23, s23, 2048
buffer_load_dwordx4 v[240:243], v1, s[8:11], s23 offen sc1
buffer_load_dwordx4 v[244:247], v1, s[8:11], s23 offen offset:1024 sc1
s_add_u32 s23, s23, 2048
buffer_load_dwordx4 v[248:251], v1, s[8:11], s23 offen sc1
buffer_load_dwordx4 v[252:255], v1, s[8:11], s23 offen offset:1024 sc1
s_add_u32 s23, s23, 2048
WV 32
WV 0
s_mul_i32 s20, s3, 16384
s_lshl_b32 s23, s16, 12
s_add_u32 s20, s20, s23
s_add_u32 s20, s20, 144703488
s_mul_i32 s21, s3, 4096
s_lshl_b32 s23, s16, 10
s_add_u32 s21, s21, s23
s_add_u32 s21, s21, 123731968
s_cmp_eq_u32 s16, 0
s_cbranch_scc0 dw_30
s_mov_b32 s22, 0
v_mov_b32 v136, 384
dw_29:
buffer_load_dword v137, v136, s[8:11], 0 offen sc1
s_add_u32 s22, s22, 1
s_cmp_gt_u32 s22, 1048576
s_cbranch_scc1 dw_30
WV 0
v_readfirstlane_b32 s23, v137
s_nop 3
s_cmp_ge_u32 s23, 37
s_cbranch_scc1 dw_30
s_sleep 4
s_branch dw_29
dw_30:
s_barrier
s_mov_b32 s65, 196608
s_mov_b32 s22, 0
v_mov_b32 v136, 0
pf_31:
buffer_load_dword v137, v136, s[8:11], s65 offen sc1
s_add_u32 s22, s22, 1
s_cmp_gt_u32 s22, 4194304
s_cbranch_scc1 R_fail
WV 0
v_readfirstlane_b32 s23, v137
s_nop 3
s_cmp_ge_u32 s23, 32
s_cbranch_scc1 pf_32
s_sleep 4
s_branch pf_31
pf_32:
v_mov_b32 v149, 0
buffer_load_dwordx4 v[80:83], v1, s[8:11], s20 offen offset:0 sc1
buffer_load_dwordx4 v[84:87], v1, s[8:11], s20 offen offset:1024 sc1
buffer_load_dwordx4 v[88:91], v1, s[8:11], s20 offen offset:2048 sc1
buffer_load_dwordx4 v[92:95], v1, s[8:11], s20 offen offset:3072 sc1
s_add_u32 s20, s20, 1310720
WV 0
s_mul_i32 s77, s3, 3277
s_lshr_b32 s77, s77, 16
s_mul_i32 s23, s77, 20
s_sub_u32 s79, s3, s23
s_lshl_b32 s77, s77, 8
s_add_u32 s78, s77, 223232
s_add_u32 s80, s78, 128
s_lshl_b32 s79, s79, 2
s_add_u32 s77, s80, s79
v_and_b32 v18, 63, v0
v_min_u32 v19, 19, v18
v_lshlrev_b32 v19, 2, v19
v_min_u32 v18, 7, v18
v_lshlrev_b32 v18, 2, v18
s_mov_b32 s76, 0
s_mov_b32 s22, 0
v_mov_b32 v136, 0
pl_33:
buffer_load_dwordx4 v[138:141], v136, s[12:15], 0 offen sc1
buffer_load_dword v137, v136, s[12:15], 0 offen offset:96 sc1
WV 0
v_min_u32 v138, v138, v139
v_min3_u32 v138, v138, v140, v141
s_nop 0
v_readfirstlane_b32 s23, v138
v_readfirstlane_b32 s79, v137
s_add_u32 s22, s22, 1
s_cmp_gt_u32 s22, 0x400
s_cbranch_scc1 pl_34
s_cmp_ge_u32 s23, 28
s_cbranch_scc0 pl_33
s_cmp_eq_u32 s79, 0
s_cselect_b32 s76, 1, 0
pl_34:
s_mov_b32 s87, 10
s_mov_b32 s88, 0
v_mov_b32 v136, 224
s_mov_b32 s22, 0
par_35:
buffer_load_dwordx4 v[138:141], v136, s[12:15], 0 offen sc1
s_add_u32 s22, s22, 1
s_cmp_gt_u32 s22, 4194304
s_cbranch_scc1 R_fail
WV 0
v_and_b32 v137, v138, v139
v_and_b32 v137, v137, v140
s_nop 0
v_readfirstlane_b32 s79, v137
v_readfirstlane_b32 s44, v138
v_readfirstlane_b32 s45, v139
v_readfirstlane_b32 s46, v140
s_nop 3
s_bitcmp1_b32 s79, 16
s_cbranch_scc0 par_35
s_and_b32 s44, s44, 8192
s_and_b32 s45, s45, 8192
s_and_b32 s46, s46, 8192
s_sub_u32 s18, 0, s4
s_and_b32 s18, s18, 0x1fffff
s_add_u32 s18, s18, 2097152
s_add_u32 s19, s18, 2097152
s_add_u32 s19, s19, s45
s_add_u32 s18, s18, s44
s_sub_u32 s33, s46, s45
C_loop:
s_cmp_eq_u32 s76, 0
s_cbranch_scc1 db_37
s_mov_b32 s22, 0
db_36:
buffer_load_dword v136, v19, s[8:11], s80 offen sc1
s_add_u32 s22, s22, 1
s_cmp_gt_u32 s22, 256
s_cbranch_scc1 db_37
WV 0
v_cmp_gt_u32 vcc, s17, v136
s_cbranch_vccnz db_36
s_sleep 6
db_37:
s_mov_b32 s22, 0
C_polla:
buffer_load_dwordx4 v[112:115], v2, s[8:11], s18 offen sc1
buffer_load_dwordx4 v[116:119], v3, s[8:11], s18 offen sc1
buffer_load_dwordx4 v[120:123], v4, s[8:11], s18 offen sc1
s_add_u32 s22, s22, 1
s_cmp_gt_u32 s22, 4194304
s_cbranch_scc1 R_fail
WV 2
ds_write_b128 v5, v[112:115]
v_max3_u32 v124, v112, v113, v114
WV 1
ds_write_b128 v5, v[116:119] offset:4096
v_max3_u32 v125, v115, v116, v117
v_max3_u32 v124, v118, v119, v124
WV 0
ds_write_b128 v6, v[120:123]
v_max3_u32 v125, v120, v121, v125
v_max3_u32 v124, v122, v123, v124
v_max_u32 v124, v124, v125
v_cmp_eq_u32 vcc, -1, v124
s_cbranch_vccnz C_polla
WL 0
s_barrier
ds_read_b128 v[20:23], v7 offset:0
ds_read_b128 v[24:27], v7 offset:1024
ds_read_b128 v[28:31], v7 offset:2048
ds_read_b128 v[32:35], v7 offset:3072
ds_read_b128 v[36:39], v7 offset:4096
ds_read_b128 v[40:43], v7 offset:5120
ds_read_b128 v[44:47], v7 offset:6144
ds_read_b128 v[48:51], v7 offset:7168
ds_read_b128 v[52:55], v7 offset:8192
ds_read_b128 v[56:59], v7 offset:9216
s_cmp_ge_u32 s17, 63
s_cbranch_scc1 C_novt_38
s_add_u32 s23, s17, 1
s_and_b32 s23, s23, 3
s_cmp_eq_u32 s23, 0
s_cbranch_scc0 C_noflag_39
s_add_u32 s65, s65, 128
v_readfirstlane_b32 s23, v149
s_nop 3
s_cmp_ge_u32 s23, 32
s_cbranch_scc1 C_noflag_39
s_mov_b32 s22, 0
v_mov_b32 v136, 0
pf_40:
buffer_load_dword v137, v136, s[8:11], s65 offen sc1
s_add_u32 s22, s22, 1
s_cmp_gt_u32 s22, 4194304
s_cbranch_scc1 R_fail
WV 0
v_readfirstlane_b32 s23, v137
s_nop 3
s_cmp_ge_u32 s23, 32
s_cbranch_scc0 pf_40
C_noflag_39:
buffer_load_dwordx4 v[96:99], v1, s[8:11], s20 offen offset:0 sc1
buffer_load_dwordx4 v[100:103], v1, s[8:11], s20 offen offset:1024 sc1
buffer_load_dwordx4 v[104:107], v1, s[8:11], s20 offen offset:2048 sc1
buffer_load_dwordx4 v[108:111], v1, s[8:11], s20 offen offset:3072 sc1
s_add_u32 s20, s20, 1310720
s_add_u32 s23, s17, 2
s_and_b32 s23, s23, 3
s_cmp_eq_u32 s23, 0
s_cbranch_scc0 C_nosample_41
s_add_u32 s23, s65, 128
buffer_load_dword v149, off, s[8:11], s23 sc1
C_nosample_41:
C_novt_38:
v_mov_b32 v60, 0
v_mov_b32 v61, 0
v_mov_b32 v62, 0
v_mov_b32 v63, 0
v_mov_b32 v64, 0
v_mov_b32 v65, 0
v_mov_b32 v66, 0
v_mov_b32 v67, 0
v_mov_b32 v68, 0
v_mov_b32 v69, 0
v_mov_b32 v70, 0
v_mov_b32 v71, 0
v_mov_b32 v72, 0
v_mov_b32 v73, 0
v_mov_b32 v74, 0
v_mov_b32 v75, 0
s_nop 1
WL 9
SM 60,20,a[0:7],8
SM 64,20,a[80:87],8
SM 68,20,a[160:167],8
SM 72,20,a[240:247],8
WL 8
SM 60,24,a[8:15],8
SM 64,24,a[88:95],8
SM 68,24,a[168:175],8
SM 72,24,a[248:255],8
WL 7
SM 60,28,a[16:23],8
SM 64,28,a[96:103],8
SM 68,28,a[176:183],8
SM 72,28,v[192:199],8
WL 6
SM 60,32,a[24:31],8
SM 64,32,a[104:111],8
SM 68,32,a[184:191],8
SM 72,32,v[200:207],8
WL 5
SM 60,36,a[32:39],8
SM 64,36,a[112:119],8
SM 68,36,a[192:199],8
SM 72,36,v[208:215],8
WL 4
SM 60,40,a[40:47],8
SM 64,40,a[120:127],8
SM 68,40,a[200:207],8
SM 72,40,v[216:223],8
WL 3
SM 60,44,a[48:55],8
SM 64,44,a[128:135],8
SM 68,44,a[208:215],8
SM 72,44,v[224:231],8
WL 2
SM 60,48,a[56:63],8
SM 64,48,a[136:143],8
SM 68,48,a[216:223],8
SM 72,48,v[232:239],8
WL 1
SM 60,52,a[64:71],8
SM 64,52,a[144:151],8
SM 68,52,a[224:231],8
SM 72,52,v[240:247],8
WL 0
SM 60,56,a[72:79],8
SM 64,56,a[152:159],8
SM 68,56,a[232:239],8
SM 72,56,v[248:255],8
s_nop 7
v_permlane32_swap_b32 v60, v68
v_permlane32_swap_b32 v64, v72
v_permlane32_swap_b32 v61, v69
v_permlane32_swap_b32 v65, v73
v_permlane32_swap_b32 v62, v70
v_permlane32_swap_b32 v66, v74
v_permlane32_swap_b32 v63, v71
v_permlane32_swap_b32 v67, v75
v_add_f32 v60, v60, v68
v_add_f32 v64, v64, v72
v_add_f32 v61, v61, v69
v_add_f32 v65, v65, v73
v_add_f32 v62, v62, v70
v_add_f32 v66, v66, v74
v_add_f32 v63, v63, v71
v_add_f32 v67, v67, v75
CV 76,60,61
CV 77,62,63
CV 78,64,65
CV 79,66,67
s_nop 1
v_permlane16_swap_b32 v76, v78
v_permlane16_swap_b32 v77, v79
s_cmp_ge_u32 s17, 63
s_cbranch_scc1 C_last
s_add_u32 s79, s17, 1
s_cmp_eq_u32 s76, 0
s_cbranch_scc1 db_43
s_mov_b32 s22, 0
db_42:
buffer_load_dword v136, v18, s[8:11], s78 offen sc1
s_add_u32 s22, s22, 1
s_cmp_gt_u32 s22, 256
s_cbranch_scc1 db_43
WV 0
v_cmp_gt_u32 vcc, s79, v136
s_cbranch_vccnz db_42
s_sleep 10
db_43:
s_mov_b32 s22, 0
v_mov_b32 v138, s79
C_ppa:
buffer_load_dwordx4 v[112:115], v9, s[8:11], s19 offen sc1
buffer_load_dwordx4 v[116:119], v10, s[8:11], s19 offen sc1
buffer_load_dwordx4 v[120:123], v11, s[8:11], s19 offen sc1
buffer_load_dwordx4 v[124:127], v12, s[8:11], s19 offen sc1
buffer_load_dwordx4 v[128:131], v13, s[8:11], s19 offen sc1
s_add_u32 s22, s22, 1
s_cmp_gt_u32 s22, 4194304
s_cbranch_scc1 R_fail
WV 4
v_mfma_f32_16x16x32_bf16 v[132:135], v[80:83], v[112:115], 0
v_max3_u32 v136, v112, v113, v114
v_mov_b32 v137, v115
WV 3
v_mfma_f32_16x16x32_bf16 v[132:135], v[84:87], v[116:119], v[132:135]
v_max3_u32 v136, v116, v117, v136
v_max3_u32 v137, v118, v119, v137
WV 2
v_mfma_f32_16x16x32_bf16 v[132:135], v[88:91], v[120:123], v[132:135]
v_max3_u32 v136, v120, v121, v136
v_max3_u32 v137, v122, v123, v137
WV 1
v_mfma_f32_16x16x32_bf16 v[132:135], v[92:95], v[124:127], v[132:135]
v_max3_u32 v136, v124, v125, v136
v_max3_u32 v137, v126, v127, v137
WV 0
v_mfma_f32_16x16x32_bf16 v[132:135], v[76:79], v[128:131], v[132:135]
v_max3_u32 v136, v128, v129, v136
v_max3_u32 v137, v130, v131, v137
v_max_u32 v136, v136, v137
v_cmp_eq_u32 vcc, -1, v136
s_cbranch_vccnz C_ppa
s_nop 4
ds_write_b128 v14, v[132:135]
s_cmp_eq_u32 s16, 0
s_cbranch_scc0 C_nopub_44
s_mov_b64 exec, 1
buffer_store_dword v138, off, s[8:11], s77
s_mov_b64 exec, -1
WL 0
s_barrier
ds_read_b128 v[140:143], v15
ds_read_b128 v[144:147], v16
WL 0
v_pk_add_f32 v[140:141], v[140:141], v[144:145]
v_pk_add_f32 v[142:143], v[142:143], v[146:147]
s_nop 1
v_permlane32_swap_b32 v140, v142
v_permlane32_swap_b32 v141, v143
v_pk_add_f32 v[140:141], v[140:141], v[142:143]
v_mov_b32 v144, v140
v_mov_b32 v145, v141
s_nop 0
v_permlane16_swap_b32 v140, v144
v_permlane16_swap_b32 v141, v145
v_pk_add_f32 v[140:141], v[140:141], v[144:145]
CV 140,140,141
buffer_store_dword v140, v17, s[8:11], s18 offen sc1
s_branch C_join_45
C_nopub_44:
WL 0
s_barrier
C_join_45:
buffer_store_dwordx4 v[76:79], v1, s[8:11], s21 offen sc1
s_add_u32 s21, s21, 327680
s_add_u32 s18, s18, 32768
s_add_u32 s19, s19, 65536
s_add_u32 s17, s17, 1
s_cmp_eq_u32 s17, 32
s_cselect_b32 s23, s33, 0
s_add_u32 s19, s19, s23
s_cmp_eq_u32 s76, 0
s_cbranch_scc1 db_47
s_mov_b32 s22, 0
db_46:
buffer_load_dword v136, v19, s[8:11], s80 offen sc1
s_add_u32 s22, s22, 1
s_cmp_gt_u32 s22, 256
s_cbranch_scc1 db_47
WV 0
v_cmp_gt_u32 vcc, s17, v136
s_cbranch_vccnz db_46
s_sleep 6
db_47:
s_mov_b32 s22, 0
C_pollb:
buffer_load_dwordx4 v[112:115], v2, s[8:11], s18 offen sc1
buffer_load_dwordx4 v[116:119], v3, s[8:11], s18 offen sc1
buffer_load_dwordx4 v[120:123], v4, s[8:11], s18 offen sc1
s_add_u32 s22, s22, 1
s_cmp_gt_u32 s22, 4194304
s_cbranch_scc1 R_fail
WV 2
ds_write_b128 v5, v[112:115]
v_max3_u32 v124, v112, v113, v114
WV 1
ds_write_b128 v5, v[116:119] offset:4096
v_max3_u32 v125, v115, v116, v117
v_max3_u32 v124, v118, v119, v124
WV 0
ds_write_b128 v6, v[120:123]
v_max3_u32 v125, v120, v121, v125
v_max3_u32 v124, v122, v123, v124
v_max_u32 v124, v124, v125
v_cmp_eq_u32 vcc, -1, v124
s_cbranch_vccnz C_pollb
WL 0
s_barrier
ds_read_b128 v[20:23], v7 offset:0
ds_read_b128 v[24:27], v7 offset:1024
ds_read_b128 v[28:31], v7 offset:2048
ds_read_b128 v[32:35], v7 offset:3072
ds_read_b128 v[36:39], v7 offset:4096
ds_read_b128 v[40:43], v7 offset:5120
ds_read_b128 v[44:47], v7 offset:6144
ds_read_b128 v[48:51], v7 offset:7168
ds_read_b128 v[52:55], v7 offset:8192
ds_read_b128 v[56:59], v7 offset:9216
s_cmp_ge_u32 s17, 63
s_cbranch_scc1 C_novt_48
s_add_u32 s23, s17, 1
s_and_b32 s23, s23, 3
s_cmp_eq_u32 s23, 0
s_cbranch_scc0 C_noflag_49
s_add_u32 s65, s65, 128
v_readfirstlane_b32 s23, v149
s_nop 3
s_cmp_ge_u32 s23, 32
s_cbranch_scc1 C_noflag_49
s_mov_b32 s22, 0
v_mov_b32 v136, 0
pf_50:
buffer_load_dword v137, v136, s[8:11], s65 offen sc1
s_add_u32 s22, s22, 1
s_cmp_gt_u32 s22, 4194304
s_cbranch_scc1 R_fail
WV 0
v_readfirstlane_b32 s23, v137
s_nop 3
s_cmp_ge_u32 s23, 32
s_cbranch_scc0 pf_50
C_noflag_49:
buffer_load_dwordx4 v[80:83], v1, s[8:11], s20 offen offset:0 sc1
buffer_load_dwordx4 v[84:87], v1, s[8:11], s20 offen offset:1024 sc1
buffer_load_dwordx4 v[88:91], v1, s[8:11], s20 offen offset:2048 sc1
buffer_load_dwordx4 v[92:95], v1, s[8:11], s20 offen offset:3072 sc1
s_add_u32 s20, s20, 1310720
s_add_u32 s23, s17, 2
s_and_b32 s23, s23, 3
s_cmp_eq_u32 s23, 0
s_cbranch_scc0 C_nosample_51
s_add_u32 s23, s65, 128
buffer_load_dword v149, off, s[8:11], s23 sc1
C_nosample_51:
C_novt_48:
v_mov_b32 v60, 0
v_mov_b32 v61, 0
v_mov_b32 v62, 0
v_mov_b32 v63, 0
v_mov_b32 v64, 0
v_mov_b32 v65, 0
v_mov_b32 v66, 0
v_mov_b32 v67, 0
v_mov_b32 v68, 0
v_mov_b32 v69, 0
v_mov_b32 v70, 0
v_mov_b32 v71, 0
v_mov_b32 v72, 0
v_mov_b32 v73, 0
v_mov_b32 v74, 0
v_mov_b32 v75, 0
s_nop 1
WL 9
SM 60,20,a[0:7],8
SM 64,20,a[80:87],8
SM 68,20,a[160:167],8
SM 72,20,a[240:247],8
WL 8
SM 60,24,a[8:15],8
SM 64,24,a[88:95],8
SM 68,24,a[168:175],8
SM 72,24,a[248:255],8
WL 7
SM 60,28,a[16:23],8
SM 64,28,a[96:103],8
SM 68,28,a[176:183],8
SM 72,28,v[192:199],8
WL 6
SM 60,32,a[24:31],8
SM 64,32,a[104:111],8
SM 68,32,a[184:191],8
SM 72,32,v[200:207],8
WL 5
SM 60,36,a[32:39],8
SM 64,36,a[112:119],8
SM 68,36,a[192:199],8
SM 72,36,v[208:215],8
WL 4
SM 60,40,a[40:47],8
SM 64,40,a[120:127],8
SM 68,40,a[200:207],8
SM 72,40,v[216:223],8
WL 3
SM 60,44,a[48:55],8
SM 64,44,a[128:135],8
SM 68,44,a[208:215],8
SM 72,44,v[224:231],8
WL 2
SM 60,48,a[56:63],8
SM 64,48,a[136:143],8
SM 68,48,a[216:223],8
SM 72,48,v[232:239],8
WL 1
SM 60,52,a[64:71],8
SM 64,52,a[144:151],8
SM 68,52,a[224:231],8
SM 72,52,v[240:247],8
WL 0
SM 60,56,a[72:79],8
SM 64,56,a[152:159],8
SM 68,56,a[232:239],8
SM 72,56,v[248:255],8
s_nop 7
v_permlane32_swap_b32 v60, v68
v_permlane32_swap_b32 v64, v72
v_permlane32_swap_b32 v61, v69
v_permlane32_swap_b32 v65, v73
v_permlane32_swap_b32 v62, v70
v_permlane32_swap_b32 v66, v74
v_permlane32_swap_b32 v63, v71
v_permlane32_swap_b32 v67, v75
v_add_f32 v60, v60, v68
v_add_f32 v64, v64, v72
v_add_f32 v61, v61, v69
v_add_f32 v65, v65, v73
v_add_f32 v62, v62, v70
v_add_f32 v66, v66, v74
v_add_f32 v63, v63, v71
v_add_f32 v67, v67, v75
CV 76,60,61
CV 77,62,63
CV 78,64,65
CV 79,66,67
s_nop 1
v_permlane16_swap_b32 v76, v78
v_permlane16_swap_b32 v77, v79
s_cmp_ge_u32 s17, 63
s_cbranch_scc1 C_last
s_add_u32 s79, s17, 1
s_cmp_eq_u32 s76, 0
s_cbranch_scc1 db_53
s_mov_b32 s22, 0
db_52:
buffer_load_dword v136, v18, s[8:11], s78 offen sc1
s_add_u32 s22, s22, 1
s_cmp_gt_u32 s22, 256
s_cbranch_scc1 db_53
WV 0
v_cmp_gt_u32 vcc, s79, v136
s_cbranch_vccnz db_52
s_sleep 10
db_53:
s_mov_b32 s22, 0
v_mov_b32 v138, s79
C_ppb:
buffer_load_dwordx4 v[112:115], v9, s[8:11], s19 offen sc1
buffer_load_dwordx4 v[116:119], v10, s[8:11], s19 offen sc1
buffer_load_dwordx4 v[120:123], v11, s[8:11], s19 offen sc1
buffer_load_dwordx4 v[124:127], v12, s[8:11], s19 offen sc1
buffer_load_dwordx4 v[128:131], v13, s[8:11], s19 offen sc1
s_add_u32 s22, s22, 1
s_cmp_gt_u32 s22, 4194304
s_cbranch_scc1 R_fail
WV 4
v_mfma_f32_16x16x32_bf16 v[132:135], v[96:99], v[112:115], 0
v_max3_u32 v136, v112, v113, v114
v_mov_b32 v137, v115
WV 3
v_mfma_f32_16x16x32_bf16 v[132:135], v[100:103], v[116:119], v[132:135]
v_max3_u32 v136, v116, v117, v136
v_max3_u32 v137, v118, v119, v137
WV 2
v_mfma_f32_16x16x32_bf16 v[132:135], v[104:107], v[120:123], v[132:135]
v_max3_u32 v136, v120, v121, v136
v_max3_u32 v137, v122, v123, v137
WV 1
v_mfma_f32_16x16x32_bf16 v[132:135], v[108:111], v[124:127], v[132:135]
v_max3_u32 v136, v124, v125, v136
v_max3_u32 v137, v126, v127, v137
WV 0
v_mfma_f32_16x16x32_bf16 v[132:135], v[76:79], v[128:131], v[132:135]
v_max3_u32 v136, v128, v129, v136
v_max3_u32 v137, v130, v131, v137
v_max_u32 v136, v136, v137
v_cmp_eq_u32 vcc, -1, v136
s_cbranch_vccnz C_ppb
s_nop 4
ds_write_b128 v14, v[132:135]
s_cmp_eq_u32 s16, 0
s_cbranch_scc0 C_nopub_54
s_mov_b64 exec, 1
buffer_store_dword v138, off, s[8:11], s77
s_mov_b64 exec, -1
WL 0
s_barrier
ds_read_b128 v[140:143], v15
ds_read_b128 v[144:147], v16
WL 0
v_pk_add_f32 v[140:141], v[140:141], v[144:145]
v_pk_add_f32 v[142:143], v[142:143], v[146:147]
s_nop 1
v_permlane32_swap_b32 v140, v142
v_permlane32_swap_b32 v141, v143
v_pk_add_f32 v[140:141], v[140:141], v[142:143]
v_mov_b32 v144, v140
v_mov_b32 v145, v141
s_nop 0
v_permlane16_swap_b32 v140, v144
v_permlane16_swap_b32 v141, v145
v_pk_add_f32 v[140:141], v[140:141], v[144:145]
CV 140,140,141
buffer_store_dword v140, v17, s[8:11], s18 offen sc1
s_branch C_join_55
C_nopub_54:
WL 0
s_barrier
C_join_55:
buffer_store_dwordx4 v[76:79], v1, s[8:11], s21 offen sc1
s_add_u32 s21, s21, 327680
s_add_u32 s18, s18, 32768
s_add_u32 s19, s19, 65536
s_add_u32 s17, s17, 1
s_cmp_eq_u32 s17, 32
s_cselect_b32 s23, s33, 0
s_add_u32 s19, s19, s23
s_branch C_loop
C_last:
s_nop 1
buffer_store_dwordx4 v[76:79], v1, s[8:11], s21 offen sc1
WV 0
s_barrier
s_cmp_eq_u32 s16, 1
s_cbranch_scc0 R_done
s_mov_b32 s23, 200704
s_mov_b64 exec, 1
v_mov_b32 v136, 1
v_mov_b32 v137, s3
v_lshlrev_b32 v137, 2, v137
buffer_store_dword v136, v137, s[8:11], s23 offen sc1
s_mov_b64 exec, -1
s_branch R_done
R_fail:
R_done:
R_wexit:
WV 0
s_mov_b64 exec, -1
s_barrier
v_mbcnt_lo_u32_b32 v0, -1, 0
v_mbcnt_hi_u32_b32 v0, -1, v0
s_lshl_b32 s23, s16, 6
v_add_u32 v0, s23, v0
s_mov_b32 s58, 5
s_getpc_b64 s[92:93]
R_pc:
s_add_u32 s92, s92, P_phase-R_pc
s_addc_u32 s93, s93, 0
s_setpc_b64 s[92:93]
R_exit:
s_endpgm
W_role:
s_getreg_b32 s58, hwreg(HW_REG_XCC_ID)
s_and_b32 s58, s58, 7
s_cmp_lt_u32 s58, 4
s_cbranch_scc0 U_boot
s_cmp_eq_u32 s16, 0
s_cbranch_scc0 dw_57
s_mov_b32 s22, 0
v_mov_b32 v22, 108
dw_56:
buffer_load_dword v23, v22, s[12:15], 0 offen sc1
s_add_u32 s22, s22, 1
s_cmp_gt_u32 s22, 1048576
s_cbranch_scc1 dw_57
WV 0
v_readfirstlane_b32 s23, v23
s_nop 3
s_cmp_ge_u32 s23, 1
s_cbranch_scc1 dw_57
s_sleep 2
s_branch dw_56
dw_57:
s_barrier
s_mul_i32 s90, s16, 6144
s_mul_i32 s91, s16, 5120
v_and_b32 v22, 63, v0
v_lshlrev_b32 v1, 4, v22
v_lshrrev_b32 v23, 5, v22
v_lshlrev_b32 v23, 2, v23
v_and_b32 v24, 15, v22
v_lshrrev_b32 v25, 2, v24
v_add_u32 v23, v23, v25
v_lshrrev_b32 v25, 4, v22
v_and_b32 v25, 1, v25
v_lshlrev_b32 v25, 5, v25
v_and_b32 v26, 3, v24
v_lshlrev_b32 v26, 3, v26
v_add_u32 v25, v25, v26
v_mul_u32_u24 v26, 384, v23
v_add_u32 v26, v26, v25
v_lshrrev_b32 v27, 1, v23
v_and_b32 v27, 1, v27
v_lshlrev_b32 v27, 6, v27
v_add_u32 v2, v26, v27
v_sub_u32 v3, v26, v27
v_mul_u32_u24 v26, 320, v23
v_add_u32 v4, v26, v25
s_mov_b32 s85, 0
B_loopW:
s_barrier
s_cmp_eq_u32 s16, 0
s_cbranch_scc0 dt_58
s_mov_b64 exec, 1
v_mov_b32 v22, 1
v_mov_b32 v23, 128
buffer_atomic_add v22, v23, s[8:11], 0 offen sc0
WV 0
v_mov_b32 v23, 163836
ds_write_b32 v23, v22
WL 0
s_mov_b64 exec, -1
dt_58:
s_barrier
v_mov_b32 v23, 163836
ds_read_b32 v22, v23
WL 0
v_readfirstlane_b32 s84, v22
s_nop 3
s_cmp_ge_u32 s84, 320
s_cbranch_scc1 B_endW
s_and_b32 s41, s84, 31
s_lshr_b32 s40, s84, 5
s_cmp_ge_u32 s40, 5
s_cselect_b32 s83, 1, 0
s_mul_i32 s23, s83, 5
s_sub_u32 s40, s40, s23
s_load_dwordx2 s[6:7], s[0:1], 32
s_load_dwordx2 s[56:57], s[0:1], 40
v_and_b32 v22, 63, v0
s_mul_i32 s23, s16, 320
s_add_u32 s23, s23, 0
v_add_u32 v23, s23, v22
v_mul_u32_u24 v24, 3277, v23
v_lshrrev_b32 v24, 16, v24
v_mul_u32_u24 v25, 20, v24
v_sub_u32 v25, v23, v25
v_lshlrev_b32 v25, 4, v25
v_mul_u32_u24 v24, 1280, v24
v_add_u32 v16, v24, v25
s_mul_i32 s23, s16, 320
s_add_u32 s23, s23, 64
v_add_u32 v23, s23, v22
v_mul_u32_u24 v24, 3277, v23
v_lshrrev_b32 v24, 16, v24
v_mul_u32_u24 v25, 20, v24
v_sub_u32 v25, v23, v25
v_lshlrev_b32 v25, 4, v25
v_mul_u32_u24 v24, 1280, v24
v_add_u32 v17, v24, v25
s_mul_i32 s23, s16, 320
s_add_u32 s23, s23, 128
v_add_u32 v23, s23, v22
v_mul_u32_u24 v24, 3277, v23
v_lshrrev_b32 v24, 16, v24
v_mul_u32_u24 v25, 20, v24
v_sub_u32 v25, v23, v25
v_lshlrev_b32 v25, 4, v25
v_mul_u32_u24 v24, 1280, v24
v_add_u32 v18, v24, v25
s_mul_i32 s23, s16, 320
s_add_u32 s23, s23, 192
v_add_u32 v23, s23, v22
v_mul_u32_u24 v24, 3277, v23
v_lshrrev_b32 v24, 16, v24
v_mul_u32_u24 v25, 20, v24
v_sub_u32 v25, v23, v25
v_lshlrev_b32 v25, 4, v25
v_mul_u32_u24 v24, 1280, v24
v_add_u32 v19, v24, v25
s_mul_i32 s23, s16, 320
s_add_u32 s23, s23, 256
v_add_u32 v23, s23, v22
v_mul_u32_u24 v24, 3277, v23
v_lshrrev_b32 v24, 16, v24
v_mul_u32_u24 v25, 20, v24
v_sub_u32 v25, v23, v25
v_lshlrev_b32 v25, 4, v25
v_mul_u32_u24 v24, 1280, v24
v_add_u32 v20, v24, v25
WL 0
s_mov_b32 s36, s6
s_and_b32 s37, s7, 0xffff
s_mov_b32 s38, 0x780000
s_mov_b32 s39, 0x20000
s_mov_b32 s28, s56
s_and_b32 s29, s57, 0xffff
s_mov_b32 s30, 0x780000
s_mov_b32 s31, 0x20000
s_mul_i32 s46, s41, 245760
s_mul_i32 s23, s83, 640
s_add_u32 s46, s46, s23
v_and_b32 v22, 63, v0
v_and_b32 v23, 31, v22
v_mul_u32_u24 v23, 12288, v23
v_lshrrev_b32 v24, 5, v22
v_lshlrev_b32 v24, 4, v24
v_add_u32 v23, v23, v24
s_lshl_b32 s43, s40, 2
s_add_u32 s43, s43, s16
s_mul_i32 s44, s43, 393216
s_mul_i32 s23, s41, 384
s_add_u32 s44, s44, s23
buffer_load_dwordx4 v[128:131], v23, s[36:39], s44 offen offset:0
buffer_load_dwordx4 v[132:135], v23, s[36:39], s44 offen offset:32
buffer_load_dwordx4 v[136:139], v23, s[36:39], s44 offen offset:64
buffer_load_dwordx4 v[140:143], v23, s[36:39], s44 offen offset:96
buffer_load_dwordx4 v[144:147], v23, s[36:39], s44 offen offset:128
buffer_load_dwordx4 v[148:151], v23, s[36:39], s44 offen offset:160
buffer_load_dwordx4 v[152:155], v23, s[36:39], s44 offen offset:192
buffer_load_dwordx4 v[156:159], v23, s[36:39], s44 offen offset:224
buffer_load_dwordx4 v[160:163], v23, s[36:39], s44 offen offset:256
buffer_load_dwordx4 v[164:167], v23, s[36:39], s44 offen offset:288
buffer_load_dwordx4 v[168:171], v23, s[36:39], s44 offen offset:320
buffer_load_dwordx4 v[172:175], v23, s[36:39], s44 offen offset:352
v_and_b32 v25, 31, v22
v_lshrrev_b32 v26, 3, v25
s_mov_b32 s23, 327680
v_mul_lo_u32 v26, v26, s23
v_lshrrev_b32 v27, 5, v22
v_lshlrev_b32 v27, 4, v27
v_and_b32 v25, 7, v25
v_add_u32 v25, v25, v27
s_lshr_b32 s23, s41, 2
s_and_b32 s23, s23, 1
s_lshl_b32 s23, s23, 3
v_add_u32 v25, s23, v25
v_lshlrev_b32 v25, 4, v25
v_add_u32 v21, v25, v26
s_lshr_b32 s47, s41, 3
s_mul_i32 s47, s47, 81920
s_and_b32 s23, s41, 3
s_mul_i32 s23, s23, 20480
s_add_u32 s47, s47, s23
s_lshl_b32 s23, s43, 10
s_add_u32 s47, s47, s23
s_add_u32 s47, s47, 47185920
s_mul_i32 s23, s83, 13107200
s_add_u32 s47, s47, s23
s_mul_i32 s23, s16, 5120
s_add_u32 m0, s23, 0
s_nop 0
DM 16,28,46
s_add_u32 m0, s23, 1024
s_nop 0
DM 17,28,46
s_add_u32 m0, s23, 2048
s_nop 0
DM 18,28,46
s_add_u32 m0, s23, 3072
s_nop 0
DM 19,28,46
s_add_u32 m0, s23, 4096
s_nop 0
DM 20,28,46
s_add_u32 s46, s46, 81920
s_mul_i32 s23, s16, 5120
s_add_u32 m0, s23, 20480
s_nop 0
DM 16,28,46
s_add_u32 m0, s23, 21504
s_nop 0
DM 17,28,46
s_add_u32 m0, s23, 22528
s_nop 0
DM 18,28,46
s_add_u32 m0, s23, 23552
s_nop 0
DM 19,28,46
s_add_u32 m0, s23, 24576
s_nop 0
DM 20,28,46
s_add_u32 s46, s46, 81920
s_mul_i32 s23, s16, 5120
s_add_u32 m0, s23, 40960
s_nop 0
DM 16,28,46
s_add_u32 m0, s23, 41984
s_nop 0
DM 17,28,46
s_add_u32 m0, s23, 43008
s_nop 0
DM 18,28,46
s_add_u32 m0, s23, 44032
s_nop 0
DM 19,28,46
s_add_u32 m0, s23, 45056
s_nop 0
DM 20,28,46
s_add_u32 s46, s46, -163520
WV 15
v_permlane32_swap_b32 v128, v130
v_permlane32_swap_b32 v129, v131
v_permlane32_swap_b32 v132, v134
v_permlane32_swap_b32 v133, v135
v_permlane32_swap_b32 v136, v138
v_permlane32_swap_b32 v137, v139
v_permlane32_swap_b32 v140, v142
v_permlane32_swap_b32 v141, v143
v_permlane32_swap_b32 v144, v146
v_permlane32_swap_b32 v145, v147
v_permlane32_swap_b32 v148, v150
v_permlane32_swap_b32 v149, v151
v_permlane32_swap_b32 v152, v154
v_permlane32_swap_b32 v153, v155
v_permlane32_swap_b32 v156, v158
v_permlane32_swap_b32 v157, v159
v_permlane32_swap_b32 v160, v162
v_permlane32_swap_b32 v161, v163
v_permlane32_swap_b32 v164, v166
v_permlane32_swap_b32 v165, v167
v_permlane32_swap_b32 v168, v170
v_permlane32_swap_b32 v169, v171
v_permlane32_swap_b32 v172, v174
v_permlane32_swap_b32 v173, v175
s_nop 1
WV 10
s_barrier
v_add_u32 v6, 0, v4
TR 0,6,0
TR 2,6,2560
TR 4,6,64
TR 6,6,2624
TR 8,6,128
TR 10,6,2688
TR 12,6,192
TR 14,6,2752
TR 16,6,256
TR 18,6,2816
WL 8
v_mfma_f32_32x32x16_bf16 v[32:47], v[128:131], a[0:3], 0
TR 24,6,5120
TR 26,6,7680
WL 8
v_mfma_f32_32x32x16_bf16 v[48:63], v[128:131], a[4:7], 0
TR 28,6,5184
TR 30,6,7744
WL 8
v_mfma_f32_32x32x16_bf16 v[64:79], v[128:131], a[8:11], 0
TR 32,6,5248
TR 34,6,7808
WL 8
v_mfma_f32_32x32x16_bf16 v[80:95], v[128:131], a[12:15], 0
TR 36,6,5312
TR 38,6,7872
WL 8
v_mfma_f32_32x32x16_bf16 v[96:111], v[128:131], a[16:19], 0
TR 40,6,5376
TR 42,6,7936
WL 8
MB 32,132,24
TR 0,6,10240
TR 2,6,12800
WL 8
MB 48,132,28
TR 4,6,10304
TR 6,6,12864
WL 8
MB 64,132,32
TR 8,6,10368
TR 10,6,12928
WL 8
MB 80,132,36
TR 12,6,10432
TR 14,6,12992
WL 8
MB 96,132,40
TR 16,6,10496
TR 18,6,13056
WV 5
s_barrier
v_add_u32 v8, 20480, v4
WL 8
MB 32,136,0
TR 24,6,15360
TR 26,6,17920
WL 8
MB 48,136,4
TR 28,6,15424
TR 30,6,17984
s_add_u32 m0, s91, 61440
s_nop 0
DM 16,28,46
WL 8
MB 64,136,8
TR 32,6,15488
TR 34,6,18048
WL 8
MB 80,136,12
TR 36,6,15552
TR 38,6,18112
WL 8
MB 96,136,16
TR 40,6,15616
TR 42,6,18176
s_add_u32 m0, s91, 62464
s_nop 0
DM 17,28,46
WL 8
MB 32,140,24
TR 0,8,0
TR 2,8,2560
WL 8
MB 48,140,28
TR 4,8,64
TR 6,8,2624
s_add_u32 m0, s91, 63488
s_nop 0
DM 18,28,46
WL 8
MB 64,140,32
TR 8,8,128
TR 10,8,2688
WL 8
MB 80,140,36
TR 12,8,192
TR 14,8,2752
WL 8
MB 96,140,40
TR 16,8,256
TR 18,8,2816
s_add_u32 m0, s91, 64512
s_nop 0
DM 19,28,46
WL 8
MB 32,144,0
TR 24,8,5120
TR 26,8,7680
WL 8
MB 48,144,4
TR 28,8,5184
TR 30,8,7744
s_add_u32 m0, s91, 65536
s_nop 0
DM 20,28,46
s_add_u32 s46, s46, 81920
WL 8
MB 64,144,8
TR 32,8,5248
TR 34,8,7808
WL 8
MB 80,144,12
TR 36,8,5312
TR 38,8,7872
WL 8
MB 96,144,16
TR 40,8,5376
TR 42,8,7936
WL 8
MB 32,148,24
TR 0,8,10240
TR 2,8,12800
WL 8
MB 48,148,28
TR 4,8,10304
TR 6,8,12864
WL 8
MB 64,148,32
TR 8,8,10368
TR 10,8,12928
WL 8
MB 80,148,36
TR 12,8,10432
TR 14,8,12992
WL 8
MB 96,148,40
TR 16,8,10496
TR 18,8,13056
WV 5
s_barrier
v_add_u32 v6, 40960, v4
WL 8
MB 32,152,0
TR 24,8,15360
TR 26,8,17920
WL 8
MB 48,152,4
TR 28,8,15424
TR 30,8,17984
s_add_u32 m0, s91, 0
s_nop 0
DM 16,28,46
WL 8
MB 64,152,8
TR 32,8,15488
TR 34,8,18048
WL 8
MB 80,152,12
TR 36,8,15552
TR 38,8,18112
WL 8
MB 96,152,16
TR 40,8,15616
TR 42,8,18176
s_add_u32 m0, s91, 1024
s_nop 0
DM 17,28,46
WL 8
MB 32,156,24
TR 0,6,0
TR 2,6,2560
WL 8
MB 48,156,28
TR 4,6,64
TR 6,6,2624
s_add_u32 m0, s91, 2048
s_nop 0
DM 18,28,46
WL 8
MB 64,156,32
TR 8,6,128
TR 10,6,2688
WL 8
MB 80,156,36
TR 12,6,192
TR 14,6,2752
WL 8
MB 96,156,40
TR 16,6,256
TR 18,6,2816
s_add_u32 m0, s91, 3072
s_nop 0
DM 19,28,46
WL 8
MB 32,160,0
TR 24,6,5120
TR 26,6,7680
WL 8
MB 48,160,4
TR 28,6,5184
TR 30,6,7744
s_add_u32 m0, s91, 4096
s_nop 0
DM 20,28,46
s_add_u32 s46, s46, 81920
WL 8
MB 64,160,8
TR 32,6,5248
TR 34,6,7808
WL 8
MB 80,160,12
TR 36,6,5312
TR 38,6,7872
WL 8
MB 96,160,16
TR 40,6,5376
TR 42,6,7936
WL 8
MB 32,164,24
TR 0,6,10240
TR 2,6,12800
WL 8
MB 48,164,28
TR 4,6,10304
TR 6,6,12864
WL 8
MB 64,164,32
TR 8,6,10368
TR 10,6,12928
WL 8
MB 80,164,36
TR 12,6,10432
TR 14,6,12992
WL 8
MB 96,164,40
TR 16,6,10496
TR 18,6,13056
WV 5
s_barrier
v_add_u32 v8, 61440, v4
WL 8
MB 32,168,0
TR 24,6,15360
TR 26,6,17920
WL 8
MB 48,168,4
TR 28,6,15424
TR 30,6,17984
s_add_u32 m0, s91, 20480
s_nop 0
DM 16,28,46
WL 8
MB 64,168,8
TR 32,6,15488
TR 34,6,18048
WL 8
MB 80,168,12
TR 36,6,15552
TR 38,6,18112
WL 8
MB 96,168,16
TR 40,6,15616
TR 42,6,18176
s_add_u32 m0, s91, 21504
s_nop 0
DM 17,28,46
WL 8
MB 32,172,24
TR 0,8,0
TR 2,8,2560
WL 8
MB 48,172,28
TR 4,8,64
TR 6,8,2624
s_add_u32 m0, s91, 22528
s_nop 0
DM 18,28,46
WL 8
MB 64,172,32
TR 8,8,128
TR 10,8,2688
WL 8
MB 80,172,36
TR 12,8,192
TR 14,8,2752
WL 8
MB 96,172,40
TR 16,8,256
TR 18,8,2816
s_add_u32 m0, s91, 23552
s_nop 0
DM 19,28,46
s_nop 7
s_nop 7
CV 112,32,33
CV 113,36,37
CV 114,34,35
CV 115,38,39
CV 116,40,41
CV 117,44,45
CV 118,42,43
CV 119,46,47
s_add_u32 s48, s47, 0
buffer_store_dwordx4 v[112:115], v21, s[8:11], s48 offen sc1
buffer_store_dwordx4 v[116:119], v21, s[8:11], s48 offen offset:512 sc1
CV 120,48,49
CV 121,52,53
CV 122,50,51
CV 123,54,55
CV 124,56,57
CV 125,60,61
CV 126,58,59
CV 127,62,63
s_add_u32 s48, s47, 1310720
buffer_store_dwordx4 v[120:123], v21, s[8:11], s48 offen sc1
buffer_store_dwordx4 v[124:127], v21, s[8:11], s48 offen offset:512 sc1
CV 112,64,65
CV 113,68,69
CV 114,66,67
CV 115,70,71
CV 116,72,73
CV 117,76,77
CV 118,74,75
CV 119,78,79
s_add_u32 s48, s47, 2621440
buffer_store_dwordx4 v[112:115], v21, s[8:11], s48 offen sc1
buffer_store_dwordx4 v[116:119], v21, s[8:11], s48 offen offset:512 sc1
CV 120,80,81
CV 121,84,85
CV 122,82,83
CV 123,86,87
CV 124,88,89
CV 125,92,93
CV 126,90,91
CV 127,94,95
s_add_u32 s48, s47, 3932160
buffer_store_dwordx4 v[120:123], v21, s[8:11], s48 offen sc1
buffer_store_dwordx4 v[124:127], v21, s[8:11], s48 offen offset:512 sc1
CV 112,96,97
CV 113,100,101
CV 114,98,99
CV 115,102,103
CV 116,104,105
CV 117,108,109
CV 118,106,107
CV 119,110,111
s_add_u32 s48, s47, 5242880
buffer_store_dwordx4 v[112:115], v21, s[8:11], s48 offen sc1
buffer_store_dwordx4 v[116:119], v21, s[8:11], s48 offen offset:512 sc1
WL 8
v_mfma_f32_32x32x16_bf16 v[32:47], v[128:131], a[0:3], 0
TR 24,8,5120
TR 26,8,7680
WL 8
v_mfma_f32_32x32x16_bf16 v[48:63], v[128:131], a[4:7], 0
TR 28,8,5184
TR 30,8,7744
s_add_u32 m0, s91, 24576
s_nop 0
DM 20,28,46
s_add_u32 s46, s46, -163520
WL 8
v_mfma_f32_32x32x16_bf16 v[64:79], v[128:131], a[8:11], 0
TR 32,8,5248
TR 34,8,7808
WL 8
v_mfma_f32_32x32x16_bf16 v[80:95], v[128:131], a[12:15], 0
TR 36,8,5312
TR 38,8,7872
WL 8
v_mfma_f32_32x32x16_bf16 v[96:111], v[128:131], a[16:19], 0
TR 40,8,5376
TR 42,8,7936
WL 8
MB 32,132,24
TR 0,8,10240
TR 2,8,12800
WL 8
MB 48,132,28
TR 4,8,10304
TR 6,8,12864
WL 8
MB 64,132,32
TR 8,8,10368
TR 10,8,12928
WL 8
MB 80,132,36
TR 12,8,10432
TR 14,8,12992
WL 8
MB 96,132,40
TR 16,8,10496
TR 18,8,13056
WV 15
s_barrier
v_add_u32 v6, 0, v4
WL 8
MB 32,136,0
TR 24,8,15360
TR 26,8,17920
WL 8
MB 48,136,4
TR 28,8,15424
TR 30,8,17984
WL 8
MB 64,136,8
TR 32,8,15488
TR 34,8,18048
WL 8
MB 80,136,12
TR 36,8,15552
TR 38,8,18112
WL 8
MB 96,136,16
TR 40,8,15616
TR 42,8,18176
WL 8
MB 32,140,24
TR 0,6,0
TR 2,6,2560
WL 8
MB 48,140,28
TR 4,6,64
TR 6,6,2624
WL 8
MB 64,140,32
TR 8,6,128
TR 10,6,2688
WL 8
MB 80,140,36
TR 12,6,192
TR 14,6,2752
WL 8
MB 96,140,40
TR 16,6,256
TR 18,6,2816
WL 8
MB 32,144,0
TR 24,6,5120
TR 26,6,7680
WL 8
MB 48,144,4
TR 28,6,5184
TR 30,6,7744
WL 8
MB 64,144,8
TR 32,6,5248
TR 34,6,7808
WL 8
MB 80,144,12
TR 36,6,5312
TR 38,6,7872
WL 8
MB 96,144,16
TR 40,6,5376
TR 42,6,7936
WL 8
MB 32,148,24
TR 0,6,10240
TR 2,6,12800
WL 8
MB 48,148,28
TR 4,6,10304
TR 6,6,12864
WL 8
MB 64,148,32
TR 8,6,10368
TR 10,6,12928
WL 8
MB 80,148,36
TR 12,6,10432
TR 14,6,12992
WL 8
MB 96,148,40
TR 16,6,10496
TR 18,6,13056
WV 0
s_barrier
v_add_u32 v8, 20480, v4
WL 8
MB 32,152,0
TR 24,6,15360
TR 26,6,17920
WL 8
MB 48,152,4
TR 28,6,15424
TR 30,6,17984
WL 8
MB 64,152,8
TR 32,6,15488
TR 34,6,18048
WL 8
MB 80,152,12
TR 36,6,15552
TR 38,6,18112
WL 8
MB 96,152,16
TR 40,6,15616
TR 42,6,18176
WL 8
MB 32,156,24
TR 0,8,0
TR 2,8,2560
WL 8
MB 48,156,28
TR 4,8,64
TR 6,8,2624
WL 8
MB 64,156,32
TR 8,8,128
TR 10,8,2688
WL 8
MB 80,156,36
TR 12,8,192
TR 14,8,2752
WL 8
MB 96,156,40
TR 16,8,256
TR 18,8,2816
WL 8
MB 32,160,0
TR 24,8,5120
TR 26,8,7680
WL 8
MB 48,160,4
TR 28,8,5184
TR 30,8,7744
WL 8
MB 64,160,8
TR 32,8,5248
TR 34,8,7808
WL 8
MB 80,160,12
TR 36,8,5312
TR 38,8,7872
WL 8
MB 96,160,16
TR 40,8,5376
TR 42,8,7936
WL 8
MB 32,164,24
TR 0,8,10240
TR 2,8,12800
WL 8
MB 48,164,28
TR 4,8,10304
TR 6,8,12864
WL 8
MB 64,164,32
TR 8,8,10368
TR 10,8,12928
WL 8
MB 80,164,36
TR 12,8,10432
TR 14,8,12992
WL 8
MB 96,164,40
TR 16,8,10496
TR 18,8,13056
WL 8
MB 32,168,0
TR 24,8,15360
TR 26,8,17920
WL 8
MB 48,168,4
TR 28,8,15424
TR 30,8,17984
WL 8
MB 64,168,8
TR 32,8,15488
TR 34,8,18048
WL 8
MB 80,168,12
TR 36,8,15552
TR 38,8,18112
WL 8
MB 96,168,16
TR 40,8,15616
TR 42,8,18176
WL 8
MB 32,172,24
WL 6
MB 48,172,28
WL 4
MB 64,172,32
WL 2
MB 80,172,36
WL 0
MB 96,172,40
s_nop 7
s_nop 7
CV 112,32,33
CV 113,36,37
CV 114,34,35
CV 115,38,39
CV 116,40,41
CV 117,44,45
CV 118,42,43
CV 119,46,47
s_add_u32 s48, s47, 6553600
buffer_store_dwordx4 v[112:115], v21, s[8:11], s48 offen sc1
buffer_store_dwordx4 v[116:119], v21, s[8:11], s48 offen offset:512 sc1
CV 120,48,49
CV 121,52,53
CV 122,50,51
CV 123,54,55
CV 124,56,57
CV 125,60,61
CV 126,58,59
CV 127,62,63
s_add_u32 s48, s47, 7864320
buffer_store_dwordx4 v[120:123], v21, s[8:11], s48 offen sc1
buffer_store_dwordx4 v[124:127], v21, s[8:11], s48 offen offset:512 sc1
CV 112,64,65
CV 113,68,69
CV 114,66,67
CV 115,70,71
CV 116,72,73
CV 117,76,77
CV 118,74,75
CV 119,78,79
s_add_u32 s48, s47, 9175040
buffer_store_dwordx4 v[112:115], v21, s[8:11], s48 offen sc1
buffer_store_dwordx4 v[116:119], v21, s[8:11], s48 offen offset:512 sc1
CV 120,80,81
CV 121,84,85
CV 122,82,83
CV 123,86,87
CV 124,88,89
CV 125,92,93
CV 126,90,91
CV 127,94,95
s_add_u32 s48, s47, 10485760
buffer_store_dwordx4 v[120:123], v21, s[8:11], s48 offen sc1
buffer_store_dwordx4 v[124:127], v21, s[8:11], s48 offen offset:512 sc1
CV 112,96,97
CV 113,100,101
CV 114,98,99
CV 115,102,103
CV 116,104,105
CV 117,108,109
CV 118,106,107
CV 119,110,111
s_add_u32 s48, s47, 11796480
buffer_store_dwordx4 v[112:115], v21, s[8:11], s48 offen sc1
buffer_store_dwordx4 v[116:119], v21, s[8:11], s48 offen offset:512 sc1
WV 0
s_barrier
s_cmp_eq_u32 s16, 0
s_cbranch_scc0 da_59
s_mov_b64 exec, 1
v_mov_b32 v22, 1
v_mov_b32 v23, 512
buffer_atomic_add v22, v23, s[8:11], 0 offen
s_mov_b64 exec, -1
da_59:
s_add_u32 s85, s85, 1
s_branch B_loopW
B_endW:
U_more:
s_barrier
s_cmp_eq_u32 s16, 0
s_cbranch_scc0 dt_60
s_mov_b64 exec, 1
v_mov_b32 v22, 1
v_mov_b32 v23, 0
buffer_atomic_add v22, v23, s[8:11], 0 offen sc0
WV 0
v_mov_b32 v23, 163836
ds_write_b32 v23, v22
WL 0
s_mov_b64 exec, -1
dt_60:
s_barrier
v_mov_b32 v23, 163836
ds_read_b32 v22, v23
WL 0
v_readfirstlane_b32 s84, v22
s_nop 3
s_cmp_lt_u32 s84, 97
s_cbranch_scc0 U_ln
s_mov_b32 s82, 0
s_branch U_do
U_boot:
s_cmp_eq_u32 s16, 0
s_cbranch_scc0 dw_62
s_mov_b32 s22, 0
v_mov_b32 v22, 108
dw_61:
buffer_load_dword v23, v22, s[12:15], 0 offen sc1
s_add_u32 s22, s22, 1
s_cmp_gt_u32 s22, 1048576
s_cbranch_scc1 dw_62
WV 0
v_readfirstlane_b32 s23, v23
s_nop 3
s_cmp_ge_u32 s23, 1
s_cbranch_scc1 dw_62
s_sleep 2
s_branch dw_61
dw_62:
s_barrier
s_barrier
s_cmp_eq_u32 s16, 0
s_cbranch_scc0 dt_63
s_mov_b64 exec, 1
v_mov_b32 v22, 1
v_mov_b32 v23, 0
buffer_atomic_add v22, v23, s[8:11], 0 offen sc0
WV 0
v_mov_b32 v23, 163836
ds_write_b32 v23, v22
WL 0
s_mov_b64 exec, -1
dt_63:
s_barrier
v_mov_b32 v23, 163836
ds_read_b32 v22, v23
WL 0
v_readfirstlane_b32 s84, v22
s_nop 3
s_mov_b32 s82, 1
U_do:
s_cmp_lt_u32 s84, 60
s_cbranch_scc0 U_a
s_mov_b32 s40, s84
s_load_dwordx2 s[6:7], s[0:1], 88
s_load_dwordx2 s[18:19], s[0:1], 96
v_and_b32 v2, 63, v0
v_lshrrev_b32 v3, 3, v2
v_and_b32 v4, 7, v2
WL 0
s_mov_b32 s36, s6
s_and_b32 s37, s7, 0xffff
s_mov_b32 s38, 0x500
s_mov_b32 s39, 0x20000
s_mov_b32 s28, s18
s_and_b32 s29, s19, 0xffff
s_mov_b32 s30, 0x4b0000
s_mov_b32 s31, 0x20000
s_mul_i32 s23, s16, 160
v_add_u32 v5, s23, v3
s_mov_b32 s24, 7680
v_mul_lo_u32 v6, v5, s24
v_lshlrev_b32 v7, 4, v4
v_add_u32 v6, v6, v7
s_lshl_b32 s25, s40, 7
v_lshlrev_b32 v5, 1, v5
buffer_load_dwordx4 v[32:35], v6, s[28:31], s25 offen
buffer_load_ushort v112, v5, s[36:39], 0 offen offset:0
s_add_u32 s25, s25, 61440
buffer_load_dwordx4 v[36:39], v6, s[28:31], s25 offen
buffer_load_ushort v113, v5, s[36:39], 0 offen offset:16
s_add_u32 s25, s25, 61440
buffer_load_dwordx4 v[40:43], v6, s[28:31], s25 offen
buffer_load_ushort v114, v5, s[36:39], 0 offen offset:32
s_add_u32 s25, s25, 61440
buffer_load_dwordx4 v[44:47], v6, s[28:31], s25 offen
buffer_load_ushort v115, v5, s[36:39], 0 offen offset:48
s_add_u32 s25, s25, 61440
buffer_load_dwordx4 v[48:51], v6, s[28:31], s25 offen
buffer_load_ushort v116, v5, s[36:39], 0 offen offset:64
s_add_u32 s25, s25, 61440
buffer_load_dwordx4 v[52:55], v6, s[28:31], s25 offen
buffer_load_ushort v117, v5, s[36:39], 0 offen offset:80
s_add_u32 s25, s25, 61440
buffer_load_dwordx4 v[56:59], v6, s[28:31], s25 offen
buffer_load_ushort v118, v5, s[36:39], 0 offen offset:96
s_add_u32 s25, s25, 61440
buffer_load_dwordx4 v[60:63], v6, s[28:31], s25 offen
buffer_load_ushort v119, v5, s[36:39], 0 offen offset:112
s_add_u32 s25, s25, 61440
buffer_load_dwordx4 v[64:67], v6, s[28:31], s25 offen
buffer_load_ushort v120, v5, s[36:39], 0 offen offset:128
s_add_u32 s25, s25, 61440
buffer_load_dwordx4 v[68:71], v6, s[28:31], s25 offen
buffer_load_ushort v121, v5, s[36:39], 0 offen offset:144
s_add_u32 s25, s25, 61440
buffer_load_dwordx4 v[72:75], v6, s[28:31], s25 offen
buffer_load_ushort v122, v5, s[36:39], 0 offen offset:160
s_add_u32 s25, s25, 61440
buffer_load_dwordx4 v[76:79], v6, s[28:31], s25 offen
buffer_load_ushort v123, v5, s[36:39], 0 offen offset:176
s_add_u32 s25, s25, 61440
buffer_load_dwordx4 v[80:83], v6, s[28:31], s25 offen
buffer_load_ushort v124, v5, s[36:39], 0 offen offset:192
s_add_u32 s25, s25, 61440
buffer_load_dwordx4 v[84:87], v6, s[28:31], s25 offen
buffer_load_ushort v125, v5, s[36:39], 0 offen offset:208
s_add_u32 s25, s25, 61440
buffer_load_dwordx4 v[88:91], v6, s[28:31], s25 offen
buffer_load_ushort v126, v5, s[36:39], 0 offen offset:224
s_add_u32 s25, s25, 61440
buffer_load_dwordx4 v[92:95], v6, s[28:31], s25 offen
buffer_load_ushort v127, v5, s[36:39], 0 offen offset:240
s_add_u32 s25, s25, 61440
buffer_load_dwordx4 v[96:99], v6, s[28:31], s25 offen
buffer_load_ushort v128, v5, s[36:39], 0 offen offset:256
s_add_u32 s25, s25, 61440
buffer_load_dwordx4 v[100:103], v6, s[28:31], s25 offen
buffer_load_ushort v129, v5, s[36:39], 0 offen offset:272
s_add_u32 s25, s25, 61440
buffer_load_dwordx4 v[104:107], v6, s[28:31], s25 offen
buffer_load_ushort v130, v5, s[36:39], 0 offen offset:288
s_add_u32 s25, s25, 61440
buffer_load_dwordx4 v[108:111], v6, s[28:31], s25 offen
buffer_load_ushort v131, v5, s[36:39], 0 offen offset:304
s_add_u32 s25, s25, 61440
v_mov_b32 v8, 0
v_mov_b32 v9, 0
v_mov_b32 v10, 0
v_mov_b32 v11, 0
v_mov_b32 v12, 0
v_mov_b32 v13, 0
v_mov_b32 v14, 0
v_mov_b32 v15, 0
s_mov_b32 s26, 0xbfb8aa3b
WV 38
SH 112,112
v_mul_f32 v16, s26, v112
v_exp_f32 v16, v16
s_nop 0
v_add_f32 v16, 1.0, v16
v_rcp_f32 v16, v16
s_nop 0
v_mul_f32 v16, v16, v112
CV 16,16,16
SH 16,16
SH 17,32
HH 18,32
v_fmac_f32 v8, v16, v17
v_fmac_f32 v9, v16, v18
SH 17,33
HH 18,33
v_fmac_f32 v10, v16, v17
v_fmac_f32 v11, v16, v18
SH 17,34
HH 18,34
v_fmac_f32 v12, v16, v17
v_fmac_f32 v13, v16, v18
SH 17,35
HH 18,35
v_fmac_f32 v14, v16, v17
v_fmac_f32 v15, v16, v18
WV 36
SH 113,113
v_mul_f32 v16, s26, v113
v_exp_f32 v16, v16
s_nop 0
v_add_f32 v16, 1.0, v16
v_rcp_f32 v16, v16
s_nop 0
v_mul_f32 v16, v16, v113
CV 16,16,16
SH 16,16
SH 17,36
HH 18,36
v_fmac_f32 v8, v16, v17
v_fmac_f32 v9, v16, v18
SH 17,37
HH 18,37
v_fmac_f32 v10, v16, v17
v_fmac_f32 v11, v16, v18
SH 17,38
HH 18,38
v_fmac_f32 v12, v16, v17
v_fmac_f32 v13, v16, v18
SH 17,39
HH 18,39
v_fmac_f32 v14, v16, v17
v_fmac_f32 v15, v16, v18
WV 34
SH 114,114
v_mul_f32 v16, s26, v114
v_exp_f32 v16, v16
s_nop 0
v_add_f32 v16, 1.0, v16
v_rcp_f32 v16, v16
s_nop 0
v_mul_f32 v16, v16, v114
CV 16,16,16
SH 16,16
SH 17,40
HH 18,40
v_fmac_f32 v8, v16, v17
v_fmac_f32 v9, v16, v18
SH 17,41
HH 18,41
v_fmac_f32 v10, v16, v17
v_fmac_f32 v11, v16, v18
SH 17,42
HH 18,42
v_fmac_f32 v12, v16, v17
v_fmac_f32 v13, v16, v18
SH 17,43
HH 18,43
v_fmac_f32 v14, v16, v17
v_fmac_f32 v15, v16, v18
WV 32
SH 115,115
v_mul_f32 v16, s26, v115
v_exp_f32 v16, v16
s_nop 0
v_add_f32 v16, 1.0, v16
v_rcp_f32 v16, v16
s_nop 0
v_mul_f32 v16, v16, v115
CV 16,16,16
SH 16,16
SH 17,44
HH 18,44
v_fmac_f32 v8, v16, v17
v_fmac_f32 v9, v16, v18
SH 17,45
HH 18,45
v_fmac_f32 v10, v16, v17
v_fmac_f32 v11, v16, v18
SH 17,46
HH 18,46
v_fmac_f32 v12, v16, v17
v_fmac_f32 v13, v16, v18
SH 17,47
HH 18,47
v_fmac_f32 v14, v16, v17
v_fmac_f32 v15, v16, v18
WV 30
SH 116,116
v_mul_f32 v16, s26, v116
v_exp_f32 v16, v16
s_nop 0
v_add_f32 v16, 1.0, v16
v_rcp_f32 v16, v16
s_nop 0
v_mul_f32 v16, v16, v116
CV 16,16,16
SH 16,16
SH 17,48
HH 18,48
v_fmac_f32 v8, v16, v17
v_fmac_f32 v9, v16, v18
SH 17,49
HH 18,49
v_fmac_f32 v10, v16, v17
v_fmac_f32 v11, v16, v18
SH 17,50
HH 18,50
v_fmac_f32 v12, v16, v17
v_fmac_f32 v13, v16, v18
SH 17,51
HH 18,51
v_fmac_f32 v14, v16, v17
v_fmac_f32 v15, v16, v18
WV 28
SH 117,117
v_mul_f32 v16, s26, v117
v_exp_f32 v16, v16
s_nop 0
v_add_f32 v16, 1.0, v16
v_rcp_f32 v16, v16
s_nop 0
v_mul_f32 v16, v16, v117
CV 16,16,16
SH 16,16
SH 17,52
HH 18,52
v_fmac_f32 v8, v16, v17
v_fmac_f32 v9, v16, v18
SH 17,53
HH 18,53
v_fmac_f32 v10, v16, v17
v_fmac_f32 v11, v16, v18
SH 17,54
HH 18,54
v_fmac_f32 v12, v16, v17
v_fmac_f32 v13, v16, v18
SH 17,55
HH 18,55
v_fmac_f32 v14, v16, v17
v_fmac_f32 v15, v16, v18
WV 26
SH 118,118
v_mul_f32 v16, s26, v118
v_exp_f32 v16, v16
s_nop 0
v_add_f32 v16, 1.0, v16
v_rcp_f32 v16, v16
s_nop 0
v_mul_f32 v16, v16, v118
CV 16,16,16
SH 16,16
SH 17,56
HH 18,56
v_fmac_f32 v8, v16, v17
v_fmac_f32 v9, v16, v18
SH 17,57
HH 18,57
v_fmac_f32 v10, v16, v17
v_fmac_f32 v11, v16, v18
SH 17,58
HH 18,58
v_fmac_f32 v12, v16, v17
v_fmac_f32 v13, v16, v18
SH 17,59
HH 18,59
v_fmac_f32 v14, v16, v17
v_fmac_f32 v15, v16, v18
WV 24
SH 119,119
v_mul_f32 v16, s26, v119
v_exp_f32 v16, v16
s_nop 0
v_add_f32 v16, 1.0, v16
v_rcp_f32 v16, v16
s_nop 0
v_mul_f32 v16, v16, v119
CV 16,16,16
SH 16,16
SH 17,60
HH 18,60
v_fmac_f32 v8, v16, v17
v_fmac_f32 v9, v16, v18
SH 17,61
HH 18,61
v_fmac_f32 v10, v16, v17
v_fmac_f32 v11, v16, v18
SH 17,62
HH 18,62
v_fmac_f32 v12, v16, v17
v_fmac_f32 v13, v16, v18
SH 17,63
HH 18,63
v_fmac_f32 v14, v16, v17
v_fmac_f32 v15, v16, v18
WV 22
SH 120,120
v_mul_f32 v16, s26, v120
v_exp_f32 v16, v16
s_nop 0
v_add_f32 v16, 1.0, v16
v_rcp_f32 v16, v16
s_nop 0
v_mul_f32 v16, v16, v120
CV 16,16,16
SH 16,16
SH 17,64
HH 18,64
v_fmac_f32 v8, v16, v17
v_fmac_f32 v9, v16, v18
SH 17,65
HH 18,65
v_fmac_f32 v10, v16, v17
v_fmac_f32 v11, v16, v18
SH 17,66
HH 18,66
v_fmac_f32 v12, v16, v17
v_fmac_f32 v13, v16, v18
SH 17,67
HH 18,67
v_fmac_f32 v14, v16, v17
v_fmac_f32 v15, v16, v18
WV 20
SH 121,121
v_mul_f32 v16, s26, v121
v_exp_f32 v16, v16
s_nop 0
v_add_f32 v16, 1.0, v16
v_rcp_f32 v16, v16
s_nop 0
v_mul_f32 v16, v16, v121
CV 16,16,16
SH 16,16
SH 17,68
HH 18,68
v_fmac_f32 v8, v16, v17
v_fmac_f32 v9, v16, v18
SH 17,69
HH 18,69
v_fmac_f32 v10, v16, v17
v_fmac_f32 v11, v16, v18
SH 17,70
HH 18,70
v_fmac_f32 v12, v16, v17
v_fmac_f32 v13, v16, v18
SH 17,71
HH 18,71
v_fmac_f32 v14, v16, v17
v_fmac_f32 v15, v16, v18
WV 18
SH 122,122
v_mul_f32 v16, s26, v122
v_exp_f32 v16, v16
s_nop 0
v_add_f32 v16, 1.0, v16
v_rcp_f32 v16, v16
s_nop 0
v_mul_f32 v16, v16, v122
CV 16,16,16
SH 16,16
SH 17,72
HH 18,72
v_fmac_f32 v8, v16, v17
v_fmac_f32 v9, v16, v18
SH 17,73
HH 18,73
v_fmac_f32 v10, v16, v17
v_fmac_f32 v11, v16, v18
SH 17,74
HH 18,74
v_fmac_f32 v12, v16, v17
v_fmac_f32 v13, v16, v18
SH 17,75
HH 18,75
v_fmac_f32 v14, v16, v17
v_fmac_f32 v15, v16, v18
WV 16
SH 123,123
v_mul_f32 v16, s26, v123
v_exp_f32 v16, v16
s_nop 0
v_add_f32 v16, 1.0, v16
v_rcp_f32 v16, v16
s_nop 0
v_mul_f32 v16, v16, v123
CV 16,16,16
SH 16,16
SH 17,76
HH 18,76
v_fmac_f32 v8, v16, v17
v_fmac_f32 v9, v16, v18
SH 17,77
HH 18,77
v_fmac_f32 v10, v16, v17
v_fmac_f32 v11, v16, v18
SH 17,78
HH 18,78
v_fmac_f32 v12, v16, v17
v_fmac_f32 v13, v16, v18
SH 17,79
HH 18,79
v_fmac_f32 v14, v16, v17
v_fmac_f32 v15, v16, v18
WV 14
SH 124,124
v_mul_f32 v16, s26, v124
v_exp_f32 v16, v16
s_nop 0
v_add_f32 v16, 1.0, v16
v_rcp_f32 v16, v16
s_nop 0
v_mul_f32 v16, v16, v124
CV 16,16,16
SH 16,16
SH 17,80
HH 18,80
v_fmac_f32 v8, v16, v17
v_fmac_f32 v9, v16, v18
SH 17,81
HH 18,81
v_fmac_f32 v10, v16, v17
v_fmac_f32 v11, v16, v18
SH 17,82
HH 18,82
v_fmac_f32 v12, v16, v17
v_fmac_f32 v13, v16, v18
SH 17,83
HH 18,83
v_fmac_f32 v14, v16, v17
v_fmac_f32 v15, v16, v18
WV 12
SH 125,125
v_mul_f32 v16, s26, v125
v_exp_f32 v16, v16
s_nop 0
v_add_f32 v16, 1.0, v16
v_rcp_f32 v16, v16
s_nop 0
v_mul_f32 v16, v16, v125
CV 16,16,16
SH 16,16
SH 17,84
HH 18,84
v_fmac_f32 v8, v16, v17
v_fmac_f32 v9, v16, v18
SH 17,85
HH 18,85
v_fmac_f32 v10, v16, v17
v_fmac_f32 v11, v16, v18
SH 17,86
HH 18,86
v_fmac_f32 v12, v16, v17
v_fmac_f32 v13, v16, v18
SH 17,87
HH 18,87
v_fmac_f32 v14, v16, v17
v_fmac_f32 v15, v16, v18
WV 10
SH 126,126
v_mul_f32 v16, s26, v126
v_exp_f32 v16, v16
s_nop 0
v_add_f32 v16, 1.0, v16
v_rcp_f32 v16, v16
s_nop 0
v_mul_f32 v16, v16, v126
CV 16,16,16
SH 16,16
SH 17,88
HH 18,88
v_fmac_f32 v8, v16, v17
v_fmac_f32 v9, v16, v18
SH 17,89
HH 18,89
v_fmac_f32 v10, v16, v17
v_fmac_f32 v11, v16, v18
SH 17,90
HH 18,90
v_fmac_f32 v12, v16, v17
v_fmac_f32 v13, v16, v18
SH 17,91
HH 18,91
v_fmac_f32 v14, v16, v17
v_fmac_f32 v15, v16, v18
WV 8
SH 127,127
v_mul_f32 v16, s26, v127
v_exp_f32 v16, v16
s_nop 0
v_add_f32 v16, 1.0, v16
v_rcp_f32 v16, v16
s_nop 0
v_mul_f32 v16, v16, v127
CV 16,16,16
SH 16,16
SH 17,92
HH 18,92
v_fmac_f32 v8, v16, v17
v_fmac_f32 v9, v16, v18
SH 17,93
HH 18,93
v_fmac_f32 v10, v16, v17
v_fmac_f32 v11, v16, v18
SH 17,94
HH 18,94
v_fmac_f32 v12, v16, v17
v_fmac_f32 v13, v16, v18
SH 17,95
HH 18,95
v_fmac_f32 v14, v16, v17
v_fmac_f32 v15, v16, v18
WV 6
SH 128,128
v_mul_f32 v16, s26, v128
v_exp_f32 v16, v16
s_nop 0
v_add_f32 v16, 1.0, v16
v_rcp_f32 v16, v16
s_nop 0
v_mul_f32 v16, v16, v128
CV 16,16,16
SH 16,16
SH 17,96
HH 18,96
v_fmac_f32 v8, v16, v17
v_fmac_f32 v9, v16, v18
SH 17,97
HH 18,97
v_fmac_f32 v10, v16, v17
v_fmac_f32 v11, v16, v18
SH 17,98
HH 18,98
v_fmac_f32 v12, v16, v17
v_fmac_f32 v13, v16, v18
SH 17,99
HH 18,99
v_fmac_f32 v14, v16, v17
v_fmac_f32 v15, v16, v18
WV 4
SH 129,129
v_mul_f32 v16, s26, v129
v_exp_f32 v16, v16
s_nop 0
v_add_f32 v16, 1.0, v16
v_rcp_f32 v16, v16
s_nop 0
v_mul_f32 v16, v16, v129
CV 16,16,16
SH 16,16
SH 17,100
HH 18,100
v_fmac_f32 v8, v16, v17
v_fmac_f32 v9, v16, v18
SH 17,101
HH 18,101
v_fmac_f32 v10, v16, v17
v_fmac_f32 v11, v16, v18
SH 17,102
HH 18,102
v_fmac_f32 v12, v16, v17
v_fmac_f32 v13, v16, v18
SH 17,103
HH 18,103
v_fmac_f32 v14, v16, v17
v_fmac_f32 v15, v16, v18
WV 2
SH 130,130
v_mul_f32 v16, s26, v130
v_exp_f32 v16, v16
s_nop 0
v_add_f32 v16, 1.0, v16
v_rcp_f32 v16, v16
s_nop 0
v_mul_f32 v16, v16, v130
CV 16,16,16
SH 16,16
SH 17,104
HH 18,104
v_fmac_f32 v8, v16, v17
v_fmac_f32 v9, v16, v18
SH 17,105
HH 18,105
v_fmac_f32 v10, v16, v17
v_fmac_f32 v11, v16, v18
SH 17,106
HH 18,106
v_fmac_f32 v12, v16, v17
v_fmac_f32 v13, v16, v18
SH 17,107
HH 18,107
v_fmac_f32 v14, v16, v17
v_fmac_f32 v15, v16, v18
WV 0
SH 131,131
v_mul_f32 v16, s26, v131
v_exp_f32 v16, v16
s_nop 0
v_add_f32 v16, 1.0, v16
v_rcp_f32 v16, v16
s_nop 0
v_mul_f32 v16, v16, v131
CV 16,16,16
SH 16,16
SH 17,108
HH 18,108
v_fmac_f32 v8, v16, v17
v_fmac_f32 v9, v16, v18
SH 17,109
HH 18,109
v_fmac_f32 v10, v16, v17
v_fmac_f32 v11, v16, v18
SH 17,110
HH 18,110
v_fmac_f32 v12, v16, v17
v_fmac_f32 v13, v16, v18
SH 17,111
HH 18,111
v_fmac_f32 v14, v16, v17
v_fmac_f32 v15, v16, v18
s_nop 1
v_add_f32_dpp v8, v8, v8 row_ror:8 row_mask:0xf bank_mask:0xf
v_mov_b32 v16, v8
s_nop 1
v_permlane16_swap_b32 v8, v16
v_add_f32 v8, v8, v16
v_mov_b32 v16, v8
s_nop 1
v_permlane32_swap_b32 v8, v16
v_add_f32 v8, v8, v16
s_nop 1
v_add_f32_dpp v9, v9, v9 row_ror:8 row_mask:0xf bank_mask:0xf
v_mov_b32 v16, v9
s_nop 1
v_permlane16_swap_b32 v9, v16
v_add_f32 v9, v9, v16
v_mov_b32 v16, v9
s_nop 1
v_permlane32_swap_b32 v9, v16
v_add_f32 v9, v9, v16
s_nop 1
v_add_f32_dpp v10, v10, v10 row_ror:8 row_mask:0xf bank_mask:0xf
v_mov_b32 v16, v10
s_nop 1
v_permlane16_swap_b32 v10, v16
v_add_f32 v10, v10, v16
v_mov_b32 v16, v10
s_nop 1
v_permlane32_swap_b32 v10, v16
v_add_f32 v10, v10, v16
s_nop 1
v_add_f32_dpp v11, v11, v11 row_ror:8 row_mask:0xf bank_mask:0xf
v_mov_b32 v16, v11
s_nop 1
v_permlane16_swap_b32 v11, v16
v_add_f32 v11, v11, v16
v_mov_b32 v16, v11
s_nop 1
v_permlane32_swap_b32 v11, v16
v_add_f32 v11, v11, v16
s_nop 1
v_add_f32_dpp v12, v12, v12 row_ror:8 row_mask:0xf bank_mask:0xf
v_mov_b32 v16, v12
s_nop 1
v_permlane16_swap_b32 v12, v16
v_add_f32 v12, v12, v16
v_mov_b32 v16, v12
s_nop 1
v_permlane32_swap_b32 v12, v16
v_add_f32 v12, v12, v16
s_nop 1
v_add_f32_dpp v13, v13, v13 row_ror:8 row_mask:0xf bank_mask:0xf
v_mov_b32 v16, v13
s_nop 1
v_permlane16_swap_b32 v13, v16
v_add_f32 v13, v13, v16
v_mov_b32 v16, v13
s_nop 1
v_permlane32_swap_b32 v13, v16
v_add_f32 v13, v13, v16
s_nop 1
v_add_f32_dpp v14, v14, v14 row_ror:8 row_mask:0xf bank_mask:0xf
v_mov_b32 v16, v14
s_nop 1
v_permlane16_swap_b32 v14, v16
v_add_f32 v14, v14, v16
v_mov_b32 v16, v14
s_nop 1
v_permlane32_swap_b32 v14, v16
v_add_f32 v14, v14, v16
s_nop 1
v_add_f32_dpp v15, v15, v15 row_ror:8 row_mask:0xf bank_mask:0xf
v_mov_b32 v16, v15
s_nop 1
v_permlane16_swap_b32 v15, v16
v_add_f32 v15, v15, v16
v_mov_b32 v16, v15
s_nop 1
v_permlane32_swap_b32 v15, v16
v_add_f32 v15, v15, v16
v_lshlrev_b32 v16, 5, v4
s_lshl_b32 s23, s16, 8
v_add_u32 v16, s23, v16
s_mov_b64 exec, 0xff
ds_write_b128 v16, v[8:11]
ds_write_b128 v16, v[12:15] offset:16
s_mov_b64 exec, -1
WL 0
s_barrier
v_lshlrev_b32 v16, 2, v2
ds_read_b32 v20, v16 offset:0
ds_read_b32 v21, v16 offset:256
ds_read_b32 v22, v16 offset:512
ds_read_b32 v23, v16 offset:768
WL 0
v_add_f32 v20, v20, v21
v_add_f32 v22, v22, v23
v_add_f32 v20, v20, v22
CV 20,20,20
SH 20,20
s_lshl_b32 s23, s40, 8
s_add_u32 s23, s23, 4096
s_cmp_eq_u32 s16, 0
s_cbranch_scc0 mod_skip_64
buffer_store_dword v20, v16, s[8:11], s23 offen sc1
WV 0
s_mov_b64 exec, 1
v_mov_b32 v2, 1
v_mov_b32 v3, 256
buffer_atomic_add v2, v3, s[8:11], 0 offen
WV 0
s_mov_b64 exec, -1
mod_skip_64:
s_branch U_more
U_a:
s_cmp_lt_u32 s84, 64
s_cbranch_scc0 U_b
s_sub_u32 s40, s84, 60
s_mul_i32 s23, s40, 32768
s_add_u32 s23, s23, 131072
v_lshlrev_b32 v1, 4, v0
v_mov_b32 v4, 0
v_mov_b32 v5, 0
v_mov_b32 v6, 0
v_mov_b32 v7, 0
buffer_store_dwordx4 v[4:7], v1, s[8:11], s23 offen sc1
s_add_u32 s23, s23, 4096
buffer_store_dwordx4 v[4:7], v1, s[8:11], s23 offen sc1
s_add_u32 s23, s23, 4096
buffer_store_dwordx4 v[4:7], v1, s[8:11], s23 offen sc1
s_add_u32 s23, s23, 4096
buffer_store_dwordx4 v[4:7], v1, s[8:11], s23 offen sc1
s_add_u32 s23, s23, 4096
buffer_store_dwordx4 v[4:7], v1, s[8:11], s23 offen sc1
s_add_u32 s23, s23, 4096
buffer_store_dwordx4 v[4:7], v1, s[8:11], s23 offen sc1
s_add_u32 s23, s23, 4096
buffer_store_dwordx4 v[4:7], v1, s[8:11], s23 offen sc1
s_add_u32 s23, s23, 4096
buffer_store_dwordx4 v[4:7], v1, s[8:11], s23 offen sc1
s_add_u32 s23, s23, 4096
WV 0
s_branch U_init
U_b:
s_cmp_lt_u32 s84, 96
s_cbranch_scc0 U_c
s_sub_u32 s40, s84, 64
s_sub_u32 s24, 0, s4
s_and_b32 s24, s24, 0x1fffff
s_add_u32 s24, s24, 2097152
s_mul_i32 s23, s40, 196608
s_add_u32 s23, s23, s24
s_mov_b32 s25, 6
s_cmp_eq_u32 s40, 0
s_cselect_b32 s26, 32768, 0
s_add_u32 s23, s23, s26
s_cselect_b32 s26, 1, 0
s_sub_u32 s25, s25, s26
v_lshlrev_b32 v1, 4, v0
v_mov_b32 v4, -1
v_mov_b32 v5, -1
v_mov_b32 v6, -1
v_mov_b32 v7, -1
buffer_store_dwordx4 v[4:7], v1, s[8:11], s23 offen sc1
s_add_u32 s23, s23, 4096
buffer_store_dwordx4 v[4:7], v1, s[8:11], s23 offen sc1
s_add_u32 s23, s23, 4096
buffer_store_dwordx4 v[4:7], v1, s[8:11], s23 offen sc1
s_add_u32 s23, s23, 4096
buffer_store_dwordx4 v[4:7], v1, s[8:11], s23 offen sc1
s_add_u32 s23, s23, 4096
buffer_store_dwordx4 v[4:7], v1, s[8:11], s23 offen sc1
s_add_u32 s23, s23, 4096
buffer_store_dwordx4 v[4:7], v1, s[8:11], s23 offen sc1
s_add_u32 s23, s23, 4096
buffer_store_dwordx4 v[4:7], v1, s[8:11], s23 offen sc1
s_add_u32 s23, s23, 4096
buffer_store_dwordx4 v[4:7], v1, s[8:11], s23 offen sc1
s_add_u32 s23, s23, 4096
buffer_store_dwordx4 v[4:7], v1, s[8:11], s23 offen sc1
s_add_u32 s23, s23, 4096
buffer_store_dwordx4 v[4:7], v1, s[8:11], s23 offen sc1
s_add_u32 s23, s23, 4096
buffer_store_dwordx4 v[4:7], v1, s[8:11], s23 offen sc1
s_add_u32 s23, s23, 4096
buffer_store_dwordx4 v[4:7], v1, s[8:11], s23 offen sc1
s_add_u32 s23, s23, 4096
buffer_store_dwordx4 v[4:7], v1, s[8:11], s23 offen sc1
s_add_u32 s23, s23, 4096
buffer_store_dwordx4 v[4:7], v1, s[8:11], s23 offen sc1
s_add_u32 s23, s23, 4096
buffer_store_dwordx4 v[4:7], v1, s[8:11], s23 offen sc1
s_add_u32 s23, s23, 4096
buffer_store_dwordx4 v[4:7], v1, s[8:11], s23 offen sc1
s_add_u32 s23, s23, 4096
buffer_store_dwordx4 v[4:7], v1, s[8:11], s23 offen sc1
s_add_u32 s23, s23, 4096
buffer_store_dwordx4 v[4:7], v1, s[8:11], s23 offen sc1
s_add_u32 s23, s23, 4096
buffer_store_dwordx4 v[4:7], v1, s[8:11], s23 offen sc1
s_add_u32 s23, s23, 4096
buffer_store_dwordx4 v[4:7], v1, s[8:11], s23 offen sc1
s_add_u32 s23, s23, 4096
buffer_store_dwordx4 v[4:7], v1, s[8:11], s23 offen sc1
s_add_u32 s23, s23, 4096
buffer_store_dwordx4 v[4:7], v1, s[8:11], s23 offen sc1
s_add_u32 s23, s23, 4096
buffer_store_dwordx4 v[4:7], v1, s[8:11], s23 offen sc1
s_add_u32 s23, s23, 4096
buffer_store_dwordx4 v[4:7], v1, s[8:11], s23 offen sc1
s_add_u32 s23, s23, 4096
buffer_store_dwordx4 v[4:7], v1, s[8:11], s23 offen sc1
s_add_u32 s23, s23, 4096
buffer_store_dwordx4 v[4:7], v1, s[8:11], s23 offen sc1
s_add_u32 s23, s23, 4096
buffer_store_dwordx4 v[4:7], v1, s[8:11], s23 offen sc1
s_add_u32 s23, s23, 4096
buffer_store_dwordx4 v[4:7], v1, s[8:11], s23 offen sc1
s_add_u32 s23, s23, 4096
buffer_store_dwordx4 v[4:7], v1, s[8:11], s23 offen sc1
s_add_u32 s23, s23, 4096
buffer_store_dwordx4 v[4:7], v1, s[8:11], s23 offen sc1
s_add_u32 s23, s23, 4096
buffer_store_dwordx4 v[4:7], v1, s[8:11], s23 offen sc1
s_add_u32 s23, s23, 4096
buffer_store_dwordx4 v[4:7], v1, s[8:11], s23 offen sc1
s_add_u32 s23, s23, 4096
buffer_store_dwordx4 v[4:7], v1, s[8:11], s23 offen sc1
s_add_u32 s23, s23, 4096
buffer_store_dwordx4 v[4:7], v1, s[8:11], s23 offen sc1
s_add_u32 s23, s23, 4096
buffer_store_dwordx4 v[4:7], v1, s[8:11], s23 offen sc1
s_add_u32 s23, s23, 4096
buffer_store_dwordx4 v[4:7], v1, s[8:11], s23 offen sc1
s_add_u32 s23, s23, 4096
buffer_store_dwordx4 v[4:7], v1, s[8:11], s23 offen sc1
s_add_u32 s23, s23, 4096
buffer_store_dwordx4 v[4:7], v1, s[8:11], s23 offen sc1
s_add_u32 s23, s23, 4096
buffer_store_dwordx4 v[4:7], v1, s[8:11], s23 offen sc1
s_add_u32 s23, s23, 4096
buffer_store_dwordx4 v[4:7], v1, s[8:11], s23 offen sc1
s_add_u32 s23, s23, 4096
buffer_store_dwordx4 v[4:7], v1, s[8:11], s23 offen sc1
s_add_u32 s23, s23, 4096
buffer_store_dwordx4 v[4:7], v1, s[8:11], s23 offen sc1
s_add_u32 s23, s23, 4096
buffer_store_dwordx4 v[4:7], v1, s[8:11], s23 offen sc1
s_add_u32 s23, s23, 4096
buffer_store_dwordx4 v[4:7], v1, s[8:11], s23 offen sc1
s_add_u32 s23, s23, 4096
buffer_store_dwordx4 v[4:7], v1, s[8:11], s23 offen sc1
s_add_u32 s23, s23, 4096
buffer_store_dwordx4 v[4:7], v1, s[8:11], s23 offen sc1
s_add_u32 s23, s23, 4096
buffer_store_dwordx4 v[4:7], v1, s[8:11], s23 offen sc1
s_add_u32 s23, s23, 4096
buffer_store_dwordx4 v[4:7], v1, s[8:11], s23 offen sc1
s_add_u32 s23, s23, 4096
WV 0
s_branch U_init
U_c:
s_cmp_eq_u32 s84, 96
s_cbranch_scc0 U_bt
s_load_dwordx2 s[6:7], s[0:1], 8
WL 0
s_mov_b32 s36, s6
s_and_b32 s37, s7, 0xffff
s_mov_b32 s38, 0x2800
s_mov_b32 s39, 0x20000
s_sub_u32 s24, 0, s4
s_and_b32 s24, s24, 0x1fffff
s_add_u32 s24, s24, 2097152
s_add_u32 s25, s24, 8192
v_add_u32 v2, 0, v0
v_lshrrev_b32 v3, 3, v2
v_and_b32 v4, 7, v2
v_mul_u32_u24 v5, 1280, v4
v_lshlrev_b32 v6, 4, v3
v_add_u32 v5, v5, v6
v_lshlrev_b32 v6, 4, v2
v_lshrrev_b32 v7, 13, v6
v_lshlrev_b32 v7, 14, v7
v_and_b32 v6, 0x1fff, v6
v_add_u32 v6, v6, v7
v_cmp_gt_u32 vcc, 640, v2
v_mov_b32 v7, 0x80000000
s_nop 0
v_cndmask_b32 v6, v7, v6, vcc
v_cndmask_b32 v5, v7, v5, vcc
buffer_load_dwordx4 v[8:11], v5, s[36:39], 0 offen
WV 0
v_min_u32 v8, 0xfffffffe, v8
v_min_u32 v9, 0xfffffffe, v9
v_min_u32 v10, 0xfffffffe, v10
v_min_u32 v11, 0xfffffffe, v11
buffer_store_dwordx4 v[8:11], v6, s[8:11], s24 offen sc1
buffer_store_dwordx4 v[8:11], v6, s[8:11], s25 offen sc1
WV 0
v_add_u32 v2, 256, v0
v_lshrrev_b32 v3, 3, v2
v_and_b32 v4, 7, v2
v_mul_u32_u24 v5, 1280, v4
v_lshlrev_b32 v6, 4, v3
v_add_u32 v5, v5, v6
v_lshlrev_b32 v6, 4, v2
v_lshrrev_b32 v7, 13, v6
v_lshlrev_b32 v7, 14, v7
v_and_b32 v6, 0x1fff, v6
v_add_u32 v6, v6, v7
v_cmp_gt_u32 vcc, 640, v2
v_mov_b32 v7, 0x80000000
s_nop 0
v_cndmask_b32 v6, v7, v6, vcc
v_cndmask_b32 v5, v7, v5, vcc
buffer_load_dwordx4 v[8:11], v5, s[36:39], 0 offen
WV 0
v_min_u32 v8, 0xfffffffe, v8
v_min_u32 v9, 0xfffffffe, v9
v_min_u32 v10, 0xfffffffe, v10
v_min_u32 v11, 0xfffffffe, v11
buffer_store_dwordx4 v[8:11], v6, s[8:11], s24 offen sc1
buffer_store_dwordx4 v[8:11], v6, s[8:11], s25 offen sc1
WV 0
v_add_u32 v2, 512, v0
v_lshrrev_b32 v3, 3, v2
v_and_b32 v4, 7, v2
v_mul_u32_u24 v5, 1280, v4
v_lshlrev_b32 v6, 4, v3
v_add_u32 v5, v5, v6
v_lshlrev_b32 v6, 4, v2
v_lshrrev_b32 v7, 13, v6
v_lshlrev_b32 v7, 14, v7
v_and_b32 v6, 0x1fff, v6
v_add_u32 v6, v6, v7
v_cmp_gt_u32 vcc, 640, v2
v_mov_b32 v7, 0x80000000
s_nop 0
v_cndmask_b32 v6, v7, v6, vcc
v_cndmask_b32 v5, v7, v5, vcc
buffer_load_dwordx4 v[8:11], v5, s[36:39], 0 offen
WV 0
v_min_u32 v8, 0xfffffffe, v8
v_min_u32 v9, 0xfffffffe, v9
v_min_u32 v10, 0xfffffffe, v10
v_min_u32 v11, 0xfffffffe, v11
buffer_store_dwordx4 v[8:11], v6, s[8:11], s24 offen sc1
buffer_store_dwordx4 v[8:11], v6, s[8:11], s25 offen sc1
WV 0
U_init:
s_barrier
s_cmp_eq_u32 s16, 0
s_cbranch_scc0 da_65
s_mov_b64 exec, 1
v_mov_b32 v22, 1
v_mov_b32 v23, 384
buffer_atomic_add v22, v23, s[8:11], 0 offen
s_mov_b64 exec, -1
da_65:
U_bt:
s_cmp_eq_u32 s82, 1
s_cbranch_scc0 U_more
s_cmp_eq_u32 s16, 0
s_cbranch_scc0 dw_67
s_mov_b32 s22, 0
v_mov_b32 v22, 108
dw_66:
buffer_load_dword v23, v22, s[12:15], 0 offen sc1
s_add_u32 s22, s22, 1
s_cmp_gt_u32 s22, 1048576
s_cbranch_scc1 dw_67
WV 0
v_readfirstlane_b32 s23, v23
s_nop 3
s_cmp_ge_u32 s23, 1
s_cbranch_scc1 dw_67
s_sleep 2
s_branch dw_66
dw_67:
s_barrier
s_mul_i32 s90, s16, 6144
s_mul_i32 s91, s16, 5120
v_and_b32 v22, 63, v0
v_lshlrev_b32 v1, 4, v22
v_lshrrev_b32 v23, 5, v22
v_lshlrev_b32 v23, 2, v23
v_and_b32 v24, 15, v22
v_lshrrev_b32 v25, 2, v24
v_add_u32 v23, v23, v25
v_lshrrev_b32 v25, 4, v22
v_and_b32 v25, 1, v25
v_lshlrev_b32 v25, 5, v25
v_and_b32 v26, 3, v24
v_lshlrev_b32 v26, 3, v26
v_add_u32 v25, v25, v26
v_mul_u32_u24 v26, 384, v23
v_add_u32 v26, v26, v25
v_lshrrev_b32 v27, 1, v23
v_and_b32 v27, 1, v27
v_lshlrev_b32 v27, 6, v27
v_add_u32 v2, v26, v27
v_sub_u32 v3, v26, v27
v_mul_u32_u24 v26, 320, v23
v_add_u32 v4, v26, v25
s_mov_b32 s85, 0
B_loopX:
s_barrier
s_cmp_eq_u32 s16, 0
s_cbranch_scc0 dt_68
s_mov_b64 exec, 1
v_mov_b32 v22, 1
v_mov_b32 v23, 128
buffer_atomic_add v22, v23, s[8:11], 0 offen sc0
WV 0
v_mov_b32 v23, 163836
ds_write_b32 v23, v22
WL 0
s_mov_b64 exec, -1
dt_68:
s_barrier
v_mov_b32 v23, 163836
ds_read_b32 v22, v23
WL 0
v_readfirstlane_b32 s84, v22
s_nop 3
s_cmp_ge_u32 s84, 320
s_cbranch_scc1 B_endX
s_and_b32 s41, s84, 31
s_lshr_b32 s40, s84, 5
s_cmp_ge_u32 s40, 5
s_cselect_b32 s83, 1, 0
s_mul_i32 s23, s83, 5
s_sub_u32 s40, s40, s23
s_load_dwordx2 s[6:7], s[0:1], 32
s_load_dwordx2 s[56:57], s[0:1], 40
v_and_b32 v22, 63, v0
s_mul_i32 s23, s16, 320
s_add_u32 s23, s23, 0
v_add_u32 v23, s23, v22
v_mul_u32_u24 v24, 3277, v23
v_lshrrev_b32 v24, 16, v24
v_mul_u32_u24 v25, 20, v24
v_sub_u32 v25, v23, v25
v_lshlrev_b32 v25, 4, v25
v_mul_u32_u24 v24, 1280, v24
v_add_u32 v16, v24, v25
s_mul_i32 s23, s16, 320
s_add_u32 s23, s23, 64
v_add_u32 v23, s23, v22
v_mul_u32_u24 v24, 3277, v23
v_lshrrev_b32 v24, 16, v24
v_mul_u32_u24 v25, 20, v24
v_sub_u32 v25, v23, v25
v_lshlrev_b32 v25, 4, v25
v_mul_u32_u24 v24, 1280, v24
v_add_u32 v17, v24, v25
s_mul_i32 s23, s16, 320
s_add_u32 s23, s23, 128
v_add_u32 v23, s23, v22
v_mul_u32_u24 v24, 3277, v23
v_lshrrev_b32 v24, 16, v24
v_mul_u32_u24 v25, 20, v24
v_sub_u32 v25, v23, v25
v_lshlrev_b32 v25, 4, v25
v_mul_u32_u24 v24, 1280, v24
v_add_u32 v18, v24, v25
s_mul_i32 s23, s16, 320
s_add_u32 s23, s23, 192
v_add_u32 v23, s23, v22
v_mul_u32_u24 v24, 3277, v23
v_lshrrev_b32 v24, 16, v24
v_mul_u32_u24 v25, 20, v24
v_sub_u32 v25, v23, v25
v_lshlrev_b32 v25, 4, v25
v_mul_u32_u24 v24, 1280, v24
v_add_u32 v19, v24, v25
s_mul_i32 s23, s16, 320
s_add_u32 s23, s23, 256
v_add_u32 v23, s23, v22
v_mul_u32_u24 v24, 3277, v23
v_lshrrev_b32 v24, 16, v24
v_mul_u32_u24 v25, 20, v24
v_sub_u32 v25, v23, v25
v_lshlrev_b32 v25, 4, v25
v_mul_u32_u24 v24, 1280, v24
v_add_u32 v20, v24, v25
WL 0
s_mov_b32 s36, s6
s_and_b32 s37, s7, 0xffff
s_mov_b32 s38, 0x780000
s_mov_b32 s39, 0x20000
s_mov_b32 s28, s56
s_and_b32 s29, s57, 0xffff
s_mov_b32 s30, 0x780000
s_mov_b32 s31, 0x20000
s_mul_i32 s46, s41, 245760
s_mul_i32 s23, s83, 640
s_add_u32 s46, s46, s23
v_and_b32 v22, 63, v0
v_and_b32 v23, 31, v22
v_mul_u32_u24 v23, 12288, v23
v_lshrrev_b32 v24, 5, v22
v_lshlrev_b32 v24, 4, v24
v_add_u32 v23, v23, v24
s_lshl_b32 s43, s40, 2
s_add_u32 s43, s43, s16
s_mul_i32 s44, s43, 393216
s_mul_i32 s23, s41, 384
s_add_u32 s44, s44, s23
buffer_load_dwordx4 v[128:131], v23, s[36:39], s44 offen offset:0
buffer_load_dwordx4 v[132:135], v23, s[36:39], s44 offen offset:32
buffer_load_dwordx4 v[136:139], v23, s[36:39], s44 offen offset:64
buffer_load_dwordx4 v[140:143], v23, s[36:39], s44 offen offset:96
buffer_load_dwordx4 v[144:147], v23, s[36:39], s44 offen offset:128
buffer_load_dwordx4 v[148:151], v23, s[36:39], s44 offen offset:160
buffer_load_dwordx4 v[152:155], v23, s[36:39], s44 offen offset:192
buffer_load_dwordx4 v[156:159], v23, s[36:39], s44 offen offset:224
buffer_load_dwordx4 v[160:163], v23, s[36:39], s44 offen offset:256
buffer_load_dwordx4 v[164:167], v23, s[36:39], s44 offen offset:288
buffer_load_dwordx4 v[168:171], v23, s[36:39], s44 offen offset:320
buffer_load_dwordx4 v[172:175], v23, s[36:39], s44 offen offset:352
v_and_b32 v25, 31, v22
v_lshrrev_b32 v26, 3, v25
s_mov_b32 s23, 327680
v_mul_lo_u32 v26, v26, s23
v_lshrrev_b32 v27, 5, v22
v_lshlrev_b32 v27, 4, v27
v_and_b32 v25, 7, v25
v_add_u32 v25, v25, v27
s_lshr_b32 s23, s41, 2
s_and_b32 s23, s23, 1
s_lshl_b32 s23, s23, 3
v_add_u32 v25, s23, v25
v_lshlrev_b32 v25, 4, v25
v_add_u32 v21, v25, v26
s_lshr_b32 s47, s41, 3
s_mul_i32 s47, s47, 81920
s_and_b32 s23, s41, 3
s_mul_i32 s23, s23, 20480
s_add_u32 s47, s47, s23
s_lshl_b32 s23, s43, 10
s_add_u32 s47, s47, s23
s_add_u32 s47, s47, 47185920
s_mul_i32 s23, s83, 13107200
s_add_u32 s47, s47, s23
s_mul_i32 s23, s16, 5120
s_add_u32 m0, s23, 0
s_nop 0
DM 16,28,46
s_add_u32 m0, s23, 1024
s_nop 0
DM 17,28,46
s_add_u32 m0, s23, 2048
s_nop 0
DM 18,28,46
s_add_u32 m0, s23, 3072
s_nop 0
DM 19,28,46
s_add_u32 m0, s23, 4096
s_nop 0
DM 20,28,46
s_add_u32 s46, s46, 81920
s_mul_i32 s23, s16, 5120
s_add_u32 m0, s23, 20480
s_nop 0
DM 16,28,46
s_add_u32 m0, s23, 21504
s_nop 0
DM 17,28,46
s_add_u32 m0, s23, 22528
s_nop 0
DM 18,28,46
s_add_u32 m0, s23, 23552
s_nop 0
DM 19,28,46
s_add_u32 m0, s23, 24576
s_nop 0
DM 20,28,46
s_add_u32 s46, s46, 81920
s_mul_i32 s23, s16, 5120
s_add_u32 m0, s23, 40960
s_nop 0
DM 16,28,46
s_add_u32 m0, s23, 41984
s_nop 0
DM 17,28,46
s_add_u32 m0, s23, 43008
s_nop 0
DM 18,28,46
s_add_u32 m0, s23, 44032
s_nop 0
DM 19,28,46
s_add_u32 m0, s23, 45056
s_nop 0
DM 20,28,46
s_add_u32 s46, s46, -163520
WV 15
v_permlane32_swap_b32 v128, v130
v_permlane32_swap_b32 v129, v131
v_permlane32_swap_b32 v132, v134
v_permlane32_swap_b32 v133, v135
v_permlane32_swap_b32 v136, v138
v_permlane32_swap_b32 v137, v139
v_permlane32_swap_b32 v140, v142
v_permlane32_swap_b32 v141, v143
v_permlane32_swap_b32 v144, v146
v_permlane32_swap_b32 v145, v147
v_permlane32_swap_b32 v148, v150
v_permlane32_swap_b32 v149, v151
v_permlane32_swap_b32 v152, v154
v_permlane32_swap_b32 v153, v155
v_permlane32_swap_b32 v156, v158
v_permlane32_swap_b32 v157, v159
v_permlane32_swap_b32 v160, v162
v_permlane32_swap_b32 v161, v163
v_permlane32_swap_b32 v164, v166
v_permlane32_swap_b32 v165, v167
v_permlane32_swap_b32 v168, v170
v_permlane32_swap_b32 v169, v171
v_permlane32_swap_b32 v172, v174
v_permlane32_swap_b32 v173, v175
s_nop 1
WV 10
s_barrier
v_add_u32 v6, 0, v4
TR 0,6,0
TR 2,6,2560
TR 4,6,64
TR 6,6,2624
TR 8,6,128
TR 10,6,2688
TR 12,6,192
TR 14,6,2752
TR 16,6,256
TR 18,6,2816
WL 8
v_mfma_f32_32x32x16_bf16 v[32:47], v[128:131], a[0:3], 0
TR 24,6,5120
TR 26,6,7680
WL 8
v_mfma_f32_32x32x16_bf16 v[48:63], v[128:131], a[4:7], 0
TR 28,6,5184
TR 30,6,7744
WL 8
v_mfma_f32_32x32x16_bf16 v[64:79], v[128:131], a[8:11], 0
TR 32,6,5248
TR 34,6,7808
WL 8
v_mfma_f32_32x32x16_bf16 v[80:95], v[128:131], a[12:15], 0
TR 36,6,5312
TR 38,6,7872
WL 8
v_mfma_f32_32x32x16_bf16 v[96:111], v[128:131], a[16:19], 0
TR 40,6,5376
TR 42,6,7936
WL 8
MB 32,132,24
TR 0,6,10240
TR 2,6,12800
WL 8
MB 48,132,28
TR 4,6,10304
TR 6,6,12864
WL 8
MB 64,132,32
TR 8,6,10368
TR 10,6,12928
WL 8
MB 80,132,36
TR 12,6,10432
TR 14,6,12992
WL 8
MB 96,132,40
TR 16,6,10496
TR 18,6,13056
WV 5
s_barrier
v_add_u32 v8, 20480, v4
WL 8
MB 32,136,0
TR 24,6,15360
TR 26,6,17920
WL 8
MB 48,136,4
TR 28,6,15424
TR 30,6,17984
s_add_u32 m0, s91, 61440
s_nop 0
DM 16,28,46
WL 8
MB 64,136,8
TR 32,6,15488
TR 34,6,18048
WL 8
MB 80,136,12
TR 36,6,15552
TR 38,6,18112
WL 8
MB 96,136,16
TR 40,6,15616
TR 42,6,18176
s_add_u32 m0, s91, 62464
s_nop 0
DM 17,28,46
WL 8
MB 32,140,24
TR 0,8,0
TR 2,8,2560
WL 8
MB 48,140,28
TR 4,8,64
TR 6,8,2624
s_add_u32 m0, s91, 63488
s_nop 0
DM 18,28,46
WL 8
MB 64,140,32
TR 8,8,128
TR 10,8,2688
WL 8
MB 80,140,36
TR 12,8,192
TR 14,8,2752
WL 8
MB 96,140,40
TR 16,8,256
TR 18,8,2816
s_add_u32 m0, s91, 64512
s_nop 0
DM 19,28,46
WL 8
MB 32,144,0
TR 24,8,5120
TR 26,8,7680
WL 8
MB 48,144,4
TR 28,8,5184
TR 30,8,7744
s_add_u32 m0, s91, 65536
s_nop 0
DM 20,28,46
s_add_u32 s46, s46, 81920
WL 8
MB 64,144,8
TR 32,8,5248
TR 34,8,7808
WL 8
MB 80,144,12
TR 36,8,5312
TR 38,8,7872
WL 8
MB 96,144,16
TR 40,8,5376
TR 42,8,7936
WL 8
MB 32,148,24
TR 0,8,10240
TR 2,8,12800
WL 8
MB 48,148,28
TR 4,8,10304
TR 6,8,12864
WL 8
MB 64,148,32
TR 8,8,10368
TR 10,8,12928
WL 8
MB 80,148,36
TR 12,8,10432
TR 14,8,12992
WL 8
MB 96,148,40
TR 16,8,10496
TR 18,8,13056
WV 5
s_barrier
v_add_u32 v6, 40960, v4
WL 8
MB 32,152,0
TR 24,8,15360
TR 26,8,17920
WL 8
MB 48,152,4
TR 28,8,15424
TR 30,8,17984
s_add_u32 m0, s91, 0
s_nop 0
DM 16,28,46
WL 8
MB 64,152,8
TR 32,8,15488
TR 34,8,18048
WL 8
MB 80,152,12
TR 36,8,15552
TR 38,8,18112
WL 8
MB 96,152,16
TR 40,8,15616
TR 42,8,18176
s_add_u32 m0, s91, 1024
s_nop 0
DM 17,28,46
WL 8
MB 32,156,24
TR 0,6,0
TR 2,6,2560
WL 8
MB 48,156,28
TR 4,6,64
TR 6,6,2624
s_add_u32 m0, s91, 2048
s_nop 0
DM 18,28,46
WL 8
MB 64,156,32
TR 8,6,128
TR 10,6,2688
WL 8
MB 80,156,36
TR 12,6,192
TR 14,6,2752
WL 8
MB 96,156,40
TR 16,6,256
TR 18,6,2816
s_add_u32 m0, s91, 3072
s_nop 0
DM 19,28,46
WL 8
MB 32,160,0
TR 24,6,5120
TR 26,6,7680
WL 8
MB 48,160,4
TR 28,6,5184
TR 30,6,7744
s_add_u32 m0, s91, 4096
s_nop 0
DM 20,28,46
s_add_u32 s46, s46, 81920
WL 8
MB 64,160,8
TR 32,6,5248
TR 34,6,7808
WL 8
MB 80,160,12
TR 36,6,5312
TR 38,6,7872
WL 8
MB 96,160,16
TR 40,6,5376
TR 42,6,7936
WL 8
MB 32,164,24
TR 0,6,10240
TR 2,6,12800
WL 8
MB 48,164,28
TR 4,6,10304
TR 6,6,12864
WL 8
MB 64,164,32
TR 8,6,10368
TR 10,6,12928
WL 8
MB 80,164,36
TR 12,6,10432
TR 14,6,12992
WL 8
MB 96,164,40
TR 16,6,10496
TR 18,6,13056
WV 5
s_barrier
v_add_u32 v8, 61440, v4
WL 8
MB 32,168,0
TR 24,6,15360
TR 26,6,17920
WL 8
MB 48,168,4
TR 28,6,15424
TR 30,6,17984
s_add_u32 m0, s91, 20480
s_nop 0
DM 16,28,46
WL 8
MB 64,168,8
TR 32,6,15488
TR 34,6,18048
WL 8
MB 80,168,12
TR 36,6,15552
TR 38,6,18112
WL 8
MB 96,168,16
TR 40,6,15616
TR 42,6,18176
s_add_u32 m0, s91, 21504
s_nop 0
DM 17,28,46
WL 8
MB 32,172,24
TR 0,8,0
TR 2,8,2560
WL 8
MB 48,172,28
TR 4,8,64
TR 6,8,2624
s_add_u32 m0, s91, 22528
s_nop 0
DM 18,28,46
WL 8
MB 64,172,32
TR 8,8,128
TR 10,8,2688
WL 8
MB 80,172,36
TR 12,8,192
TR 14,8,2752
WL 8
MB 96,172,40
TR 16,8,256
TR 18,8,2816
s_add_u32 m0, s91, 23552
s_nop 0
DM 19,28,46
s_nop 7
s_nop 7
CV 112,32,33
CV 113,36,37
CV 114,34,35
CV 115,38,39
CV 116,40,41
CV 117,44,45
CV 118,42,43
CV 119,46,47
s_add_u32 s48, s47, 0
buffer_store_dwordx4 v[112:115], v21, s[8:11], s48 offen sc1
buffer_store_dwordx4 v[116:119], v21, s[8:11], s48 offen offset:512 sc1
CV 120,48,49
CV 121,52,53
CV 122,50,51
CV 123,54,55
CV 124,56,57
CV 125,60,61
CV 126,58,59
CV 127,62,63
s_add_u32 s48, s47, 1310720
buffer_store_dwordx4 v[120:123], v21, s[8:11], s48 offen sc1
buffer_store_dwordx4 v[124:127], v21, s[8:11], s48 offen offset:512 sc1
CV 112,64,65
CV 113,68,69
CV 114,66,67
CV 115,70,71
CV 116,72,73
CV 117,76,77
CV 118,74,75
CV 119,78,79
s_add_u32 s48, s47, 2621440
buffer_store_dwordx4 v[112:115], v21, s[8:11], s48 offen sc1
buffer_store_dwordx4 v[116:119], v21, s[8:11], s48 offen offset:512 sc1
CV 120,80,81
CV 121,84,85
CV 122,82,83
CV 123,86,87
CV 124,88,89
CV 125,92,93
CV 126,90,91
CV 127,94,95
s_add_u32 s48, s47, 3932160
buffer_store_dwordx4 v[120:123], v21, s[8:11], s48 offen sc1
buffer_store_dwordx4 v[124:127], v21, s[8:11], s48 offen offset:512 sc1
CV 112,96,97
CV 113,100,101
CV 114,98,99
CV 115,102,103
CV 116,104,105
CV 117,108,109
CV 118,106,107
CV 119,110,111
s_add_u32 s48, s47, 5242880
buffer_store_dwordx4 v[112:115], v21, s[8:11], s48 offen sc1
buffer_store_dwordx4 v[116:119], v21, s[8:11], s48 offen offset:512 sc1
WL 8
v_mfma_f32_32x32x16_bf16 v[32:47], v[128:131], a[0:3], 0
TR 24,8,5120
TR 26,8,7680
WL 8
v_mfma_f32_32x32x16_bf16 v[48:63], v[128:131], a[4:7], 0
TR 28,8,5184
TR 30,8,7744
s_add_u32 m0, s91, 24576
s_nop 0
DM 20,28,46
s_add_u32 s46, s46, -163520
WL 8
v_mfma_f32_32x32x16_bf16 v[64:79], v[128:131], a[8:11], 0
TR 32,8,5248
TR 34,8,7808
WL 8
v_mfma_f32_32x32x16_bf16 v[80:95], v[128:131], a[12:15], 0
TR 36,8,5312
TR 38,8,7872
WL 8
v_mfma_f32_32x32x16_bf16 v[96:111], v[128:131], a[16:19], 0
TR 40,8,5376
TR 42,8,7936
WL 8
MB 32,132,24
TR 0,8,10240
TR 2,8,12800
WL 8
MB 48,132,28
TR 4,8,10304
TR 6,8,12864
WL 8
MB 64,132,32
TR 8,8,10368
TR 10,8,12928
WL 8
MB 80,132,36
TR 12,8,10432
TR 14,8,12992
WL 8
MB 96,132,40
TR 16,8,10496
TR 18,8,13056
WV 15
s_barrier
v_add_u32 v6, 0, v4
WL 8
MB 32,136,0
TR 24,8,15360
TR 26,8,17920
WL 8
MB 48,136,4
TR 28,8,15424
TR 30,8,17984
WL 8
MB 64,136,8
TR 32,8,15488
TR 34,8,18048
WL 8
MB 80,136,12
TR 36,8,15552
TR 38,8,18112
WL 8
MB 96,136,16
TR 40,8,15616
TR 42,8,18176
WL 8
MB 32,140,24
TR 0,6,0
TR 2,6,2560
WL 8
MB 48,140,28
TR 4,6,64
TR 6,6,2624
WL 8
MB 64,140,32
TR 8,6,128
TR 10,6,2688
WL 8
MB 80,140,36
TR 12,6,192
TR 14,6,2752
WL 8
MB 96,140,40
TR 16,6,256
TR 18,6,2816
WL 8
MB 32,144,0
TR 24,6,5120
TR 26,6,7680
WL 8
MB 48,144,4
TR 28,6,5184
TR 30,6,7744
WL 8
MB 64,144,8
TR 32,6,5248
TR 34,6,7808
WL 8
MB 80,144,12
TR 36,6,5312
TR 38,6,7872
WL 8
MB 96,144,16
TR 40,6,5376
TR 42,6,7936
WL 8
MB 32,148,24
TR 0,6,10240
TR 2,6,12800
WL 8
MB 48,148,28
TR 4,6,10304
TR 6,6,12864
WL 8
MB 64,148,32
TR 8,6,10368
TR 10,6,12928
WL 8
MB 80,148,36
TR 12,6,10432
TR 14,6,12992
WL 8
MB 96,148,40
TR 16,6,10496
TR 18,6,13056
WV 0
s_barrier
v_add_u32 v8, 20480, v4
WL 8
MB 32,152,0
TR 24,6,15360
TR 26,6,17920
WL 8
MB 48,152,4
TR 28,6,15424
TR 30,6,17984
WL 8
MB 64,152,8
TR 32,6,15488
TR 34,6,18048
WL 8
MB 80,152,12
TR 36,6,15552
TR 38,6,18112
WL 8
MB 96,152,16
TR 40,6,15616
TR 42,6,18176
WL 8
MB 32,156,24
TR 0,8,0
TR 2,8,2560
WL 8
MB 48,156,28
TR 4,8,64
TR 6,8,2624
WL 8
MB 64,156,32
TR 8,8,128
TR 10,8,2688
WL 8
MB 80,156,36
TR 12,8,192
TR 14,8,2752
WL 8
MB 96,156,40
TR 16,8,256
TR 18,8,2816
WL 8
MB 32,160,0
TR 24,8,5120
TR 26,8,7680
WL 8
MB 48,160,4
TR 28,8,5184
TR 30,8,7744
WL 8
MB 64,160,8
TR 32,8,5248
TR 34,8,7808
WL 8
MB 80,160,12
TR 36,8,5312
TR 38,8,7872
WL 8
MB 96,160,16
TR 40,8,5376
TR 42,8,7936
WL 8
MB 32,164,24
TR 0,8,10240
TR 2,8,12800
WL 8
MB 48,164,28
TR 4,8,10304
TR 6,8,12864
WL 8
MB 64,164,32
TR 8,8,10368
TR 10,8,12928
WL 8
MB 80,164,36
TR 12,8,10432
TR 14,8,12992
WL 8
MB 96,164,40
TR 16,8,10496
TR 18,8,13056
WL 8
MB 32,168,0
TR 24,8,15360
TR 26,8,17920
WL 8
MB 48,168,4
TR 28,8,15424
TR 30,8,17984
WL 8
MB 64,168,8
TR 32,8,15488
TR 34,8,18048
WL 8
MB 80,168,12
TR 36,8,15552
TR 38,8,18112
WL 8
MB 96,168,16
TR 40,8,15616
TR 42,8,18176
WL 8
MB 32,172,24
WL 6
MB 48,172,28
WL 4
MB 64,172,32
WL 2
MB 80,172,36
WL 0
MB 96,172,40
s_nop 7
s_nop 7
CV 112,32,33
CV 113,36,37
CV 114,34,35
CV 115,38,39
CV 116,40,41
CV 117,44,45
CV 118,42,43
CV 119,46,47
s_add_u32 s48, s47, 6553600
buffer_store_dwordx4 v[112:115], v21, s[8:11], s48 offen sc1
buffer_store_dwordx4 v[116:119], v21, s[8:11], s48 offen offset:512 sc1
CV 120,48,49
CV 121,52,53
CV 122,50,51
CV 123,54,55
CV 124,56,57
CV 125,60,61
CV 126,58,59
CV 127,62,63
s_add_u32 s48, s47, 7864320
buffer_store_dwordx4 v[120:123], v21, s[8:11], s48 offen sc1
buffer_store_dwordx4 v[124:127], v21, s[8:11], s48 offen offset:512 sc1
CV 112,64,65
CV 113,68,69
CV 114,66,67
CV 115,70,71
CV 116,72,73
CV 117,76,77
CV 118,74,75
CV 119,78,79
s_add_u32 s48, s47, 9175040
buffer_store_dwordx4 v[112:115], v21, s[8:11], s48 offen sc1
buffer_store_dwordx4 v[116:119], v21, s[8:11], s48 offen offset:512 sc1
CV 120,80,81
CV 121,84,85
CV 122,82,83
CV 123,86,87
CV 124,88,89
CV 125,92,93
CV 126,90,91
CV 127,94,95
s_add_u32 s48, s47, 10485760
buffer_store_dwordx4 v[120:123], v21, s[8:11], s48 offen sc1
buffer_store_dwordx4 v[124:127], v21, s[8:11], s48 offen offset:512 sc1
CV 112,96,97
CV 113,100,101
CV 114,98,99
CV 115,102,103
CV 116,104,105
CV 117,108,109
CV 118,106,107
CV 119,110,111
s_add_u32 s48, s47, 11796480
buffer_store_dwordx4 v[112:115], v21, s[8:11], s48 offen sc1
buffer_store_dwordx4 v[116:119], v21, s[8:11], s48 offen offset:512 sc1
WV 0
s_barrier
s_cmp_eq_u32 s16, 0
s_cbranch_scc0 da_69
s_mov_b64 exec, 1
v_mov_b32 v22, 1
v_mov_b32 v23, 512
buffer_atomic_add v22, v23, s[8:11], 0 offen
s_mov_b64 exec, -1
da_69:
s_add_u32 s85, s85, 1
s_cmp_lt_u32 s85, 1
s_cbranch_scc1 B_loopX
B_endX:
s_branch U_more
U_ln:
s_barrier
s_cmp_eq_u32 s16, 0
s_cbranch_scc0 dt_70
s_mov_b64 exec, 1
v_mov_b32 v22, 1
v_mov_b32 v23, 640
buffer_atomic_add v22, v23, s[8:11], 0 offen sc0
WV 0
v_mov_b32 v23, 163836
ds_write_b32 v23, v22
WL 0
s_mov_b64 exec, -1
dt_70:
s_barrier
v_mov_b32 v23, 163836
ds_read_b32 v22, v23
WL 0
v_readfirstlane_b32 s84, v22
s_nop 3
s_cmp_lt_u32 s84, 128
s_cbranch_scc0 U_done
s_mov_b32 s40, s84
s_load_dwordx2 s[6:7], s[0:1], 0
WL 0
s_mov_b32 s36, s6
s_and_b32 s37, s7, 0xffff
s_mov_b32 s38, 0x280000
s_mov_b32 s39, 0x20000
v_and_b32 v2, 63, v0
v_lshrrev_b32 v3, 4, v2
v_and_b32 v4, 15, v2
s_lshl_b32 s23, s40, 4
s_lshl_b32 s24, s16, 2
s_add_u32 s23, s23, s24
v_add_u32 v5, s23, v3
v_mul_u32_u24 v6, 1280, v5
v_lshlrev_b32 v7, 4, v4
v_add_u32 v6, v6, v7
buffer_load_dwordx4 v[16:19], v6, s[36:39], 0 offen offset:0 sc1
buffer_load_dwordx4 v[20:23], v6, s[36:39], 0 offen offset:256 sc1
buffer_load_dwordx4 v[24:27], v6, s[36:39], 0 offen offset:512 sc1
buffer_load_dwordx4 v[28:31], v6, s[36:39], 0 offen offset:768 sc1
buffer_load_dwordx4 v[32:35], v6, s[36:39], 0 offen offset:1024 sc1
s_cmp_eq_u32 s16, 0
s_cbranch_scc0 lnw_71_x
v_mov_b32 v8, 256
s_mov_b32 s22, 0
lnw_71:
buffer_load_dword v9, v8, s[8:11], 0 offen sc1
s_add_u32 s22, s22, 1
WV 0
v_readfirstlane_b32 s23, v9
s_cmp_gt_u32 s22, 0x100000
s_cbranch_scc1 lnw_71_x
s_cmp_ge_u32 s23, 60
s_cbranch_scc1 lnw_71_x
s_sleep 4
s_branch lnw_71
lnw_71_x:
s_barrier
v_lshlrev_b32 v7, 5, v4
s_mov_b32 s25, 6656
s_mov_b32 s26, 4096
buffer_load_dwordx4 v[40:43], v7, s[8:11], s25 offen offset:0 sc1
buffer_load_dwordx4 v[44:47], v7, s[8:11], s25 offen offset:16 sc1
buffer_load_dwordx4 v[80:83], v7, s[8:11], s26 offen offset:0 sc1
buffer_load_dwordx4 v[84:87], v7, s[8:11], s26 offen offset:16 sc1
buffer_load_dwordx4 v[48:51], v7, s[8:11], s25 offen offset:512 sc1
buffer_load_dwordx4 v[52:55], v7, s[8:11], s25 offen offset:528 sc1
buffer_load_dwordx4 v[88:91], v7, s[8:11], s26 offen offset:512 sc1
buffer_load_dwordx4 v[92:95], v7, s[8:11], s26 offen offset:528 sc1
buffer_load_dwordx4 v[56:59], v7, s[8:11], s25 offen offset:1024 sc1
buffer_load_dwordx4 v[60:63], v7, s[8:11], s25 offen offset:1040 sc1
buffer_load_dwordx4 v[96:99], v7, s[8:11], s26 offen offset:1024 sc1
buffer_load_dwordx4 v[100:103], v7, s[8:11], s26 offen offset:1040 sc1
buffer_load_dwordx4 v[64:67], v7, s[8:11], s25 offen offset:1536 sc1
buffer_load_dwordx4 v[68:71], v7, s[8:11], s25 offen offset:1552 sc1
buffer_load_dwordx4 v[104:107], v7, s[8:11], s26 offen offset:1536 sc1
buffer_load_dwordx4 v[108:111], v7, s[8:11], s26 offen offset:1552 sc1
buffer_load_dwordx4 v[72:75], v7, s[8:11], s25 offen offset:2048 sc1
buffer_load_dwordx4 v[76:79], v7, s[8:11], s25 offen offset:2064 sc1
buffer_load_dwordx4 v[112:115], v7, s[8:11], s26 offen offset:2048 sc1
buffer_load_dwordx4 v[116:119], v7, s[8:11], s26 offen offset:2064 sc1
WV 20
SH 128,16
HH 129,16
SH 130,17
HH 131,17
SH 132,18
HH 133,18
SH 134,19
HH 135,19
SH 136,20
HH 137,20
SH 138,21
HH 139,21
SH 140,22
HH 141,22
SH 142,23
HH 143,23
SH 144,24
HH 145,24
SH 146,25
HH 147,25
SH 148,26
HH 149,26
SH 150,27
HH 151,27
SH 152,28
HH 153,28
SH 154,29
HH 155,29
SH 156,30
HH 157,30
SH 158,31
HH 159,31
SH 160,32
HH 161,32
SH 162,33
HH 163,33
SH 164,34
HH 165,34
SH 166,35
HH 167,35
v_add_f32 v8, v128, v129
v_add_f32 v8, v8, v130
v_add_f32 v8, v8, v131
v_add_f32 v8, v8, v132
v_add_f32 v8, v8, v133
v_add_f32 v8, v8, v134
v_add_f32 v8, v8, v135
v_add_f32 v8, v8, v136
v_add_f32 v8, v8, v137
v_add_f32 v8, v8, v138
v_add_f32 v8, v8, v139
v_add_f32 v8, v8, v140
v_add_f32 v8, v8, v141
v_add_f32 v8, v8, v142
v_add_f32 v8, v8, v143
v_add_f32 v8, v8, v144
v_add_f32 v8, v8, v145
v_add_f32 v8, v8, v146
v_add_f32 v8, v8, v147
v_add_f32 v8, v8, v148
v_add_f32 v8, v8, v149
v_add_f32 v8, v8, v150
v_add_f32 v8, v8, v151
v_add_f32 v8, v8, v152
v_add_f32 v8, v8, v153
v_add_f32 v8, v8, v154
v_add_f32 v8, v8, v155
v_add_f32 v8, v8, v156
v_add_f32 v8, v8, v157
v_add_f32 v8, v8, v158
v_add_f32 v8, v8, v159
v_add_f32 v8, v8, v160
v_add_f32 v8, v8, v161
v_add_f32 v8, v8, v162
v_add_f32 v8, v8, v163
v_add_f32 v8, v8, v164
v_add_f32 v8, v8, v165
v_add_f32 v8, v8, v166
v_add_f32 v8, v8, v167
s_nop 1
v_add_f32_dpp v8, v8, v8 quad_perm:[1,0,3,2] row_mask:0xf bank_mask:0xf
s_nop 1
v_add_f32_dpp v8, v8, v8 quad_perm:[2,3,0,1] row_mask:0xf bank_mask:0xf
s_nop 1
v_add_f32_dpp v8, v8, v8 row_half_mirror row_mask:0xf bank_mask:0xf
s_nop 1
v_add_f32_dpp v8, v8, v8 row_mirror row_mask:0xf bank_mask:0xf
v_mul_f32 v8, 0x3acccccd, v8
v_mov_b32 v9, 0
v_sub_f32 v10, v128, v8
v_fmac_f32 v9, v10, v10
v_sub_f32 v10, v129, v8
v_fmac_f32 v9, v10, v10
v_sub_f32 v10, v130, v8
v_fmac_f32 v9, v10, v10
v_sub_f32 v10, v131, v8
v_fmac_f32 v9, v10, v10
v_sub_f32 v10, v132, v8
v_fmac_f32 v9, v10, v10
v_sub_f32 v10, v133, v8
v_fmac_f32 v9, v10, v10
v_sub_f32 v10, v134, v8
v_fmac_f32 v9, v10, v10
v_sub_f32 v10, v135, v8
v_fmac_f32 v9, v10, v10
v_sub_f32 v10, v136, v8
v_fmac_f32 v9, v10, v10
v_sub_f32 v10, v137, v8
v_fmac_f32 v9, v10, v10
v_sub_f32 v10, v138, v8
v_fmac_f32 v9, v10, v10
v_sub_f32 v10, v139, v8
v_fmac_f32 v9, v10, v10
v_sub_f32 v10, v140, v8
v_fmac_f32 v9, v10, v10
v_sub_f32 v10, v141, v8
v_fmac_f32 v9, v10, v10
v_sub_f32 v10, v142, v8
v_fmac_f32 v9, v10, v10
v_sub_f32 v10, v143, v8
v_fmac_f32 v9, v10, v10
v_sub_f32 v10, v144, v8
v_fmac_f32 v9, v10, v10
v_sub_f32 v10, v145, v8
v_fmac_f32 v9, v10, v10
v_sub_f32 v10, v146, v8
v_fmac_f32 v9, v10, v10
v_sub_f32 v10, v147, v8
v_fmac_f32 v9, v10, v10
v_sub_f32 v10, v148, v8
v_fmac_f32 v9, v10, v10
v_sub_f32 v10, v149, v8
v_fmac_f32 v9, v10, v10
v_sub_f32 v10, v150, v8
v_fmac_f32 v9, v10, v10
v_sub_f32 v10, v151, v8
v_fmac_f32 v9, v10, v10
v_sub_f32 v10, v152, v8
v_fmac_f32 v9, v10, v10
v_sub_f32 v10, v153, v8
v_fmac_f32 v9, v10, v10
v_sub_f32 v10, v154, v8
v_fmac_f32 v9, v10, v10
v_sub_f32 v10, v155, v8
v_fmac_f32 v9, v10, v10
v_sub_f32 v10, v156, v8
v_fmac_f32 v9, v10, v10
v_sub_f32 v10, v157, v8
v_fmac_f32 v9, v10, v10
v_sub_f32 v10, v158, v8
v_fmac_f32 v9, v10, v10
v_sub_f32 v10, v159, v8
v_fmac_f32 v9, v10, v10
v_sub_f32 v10, v160, v8
v_fmac_f32 v9, v10, v10
v_sub_f32 v10, v161, v8
v_fmac_f32 v9, v10, v10
v_sub_f32 v10, v162, v8
v_fmac_f32 v9, v10, v10
v_sub_f32 v10, v163, v8
v_fmac_f32 v9, v10, v10
v_sub_f32 v10, v164, v8
v_fmac_f32 v9, v10, v10
v_sub_f32 v10, v165, v8
v_fmac_f32 v9, v10, v10
v_sub_f32 v10, v166, v8
v_fmac_f32 v9, v10, v10
v_sub_f32 v10, v167, v8
v_fmac_f32 v9, v10, v10
s_nop 1
v_add_f32_dpp v9, v9, v9 quad_perm:[1,0,3,2] row_mask:0xf bank_mask:0xf
s_nop 1
v_add_f32_dpp v9, v9, v9 quad_perm:[2,3,0,1] row_mask:0xf bank_mask:0xf
s_nop 1
v_add_f32_dpp v9, v9, v9 row_half_mirror row_mask:0xf bank_mask:0xf
s_nop 1
v_add_f32_dpp v9, v9, v9 row_mirror row_mask:0xf bank_mask:0xf
v_mul_f32 v9, 0x3acccccd, v9
CV 8,8,8
SH 8,8
CV 9,9,9
SH 9,9
v_add_f32 v9, 0x3727c5ac, v9
CV 9,9,9
SH 9,9
v_sqrt_f32 v9, v9
s_nop 0
CV 9,9,9
SH 9,9
v_rcp_f32 v9, v9
s_nop 0
WV 0
v_sub_f32 v128, v128, v8
v_sub_f32 v129, v129, v8
CV 10,128,129
SH 128,10
HH 129,10
v_mul_f32 v128, v128, v9
v_mul_f32 v129, v129, v9
CV 10,128,129
SH 128,10
HH 129,10
v_add_f32 v40, 1.0, v40
v_add_f32 v41, 1.0, v41
CV 10,40,41
SH 40,10
HH 41,10
v_mul_f32 v128, v128, v40
v_mul_f32 v129, v129, v41
CV 10,128,129
SH 128,10
HH 129,10
v_add_f32 v128, v128, v80
v_add_f32 v129, v129, v81
CV 16,128,129
v_sub_f32 v130, v130, v8
v_sub_f32 v131, v131, v8
CV 10,130,131
SH 130,10
HH 131,10
v_mul_f32 v130, v130, v9
v_mul_f32 v131, v131, v9
CV 10,130,131
SH 130,10
HH 131,10
v_add_f32 v42, 1.0, v42
v_add_f32 v43, 1.0, v43
CV 10,42,43
SH 42,10
HH 43,10
v_mul_f32 v130, v130, v42
v_mul_f32 v131, v131, v43
CV 10,130,131
SH 130,10
HH 131,10
v_add_f32 v130, v130, v82
v_add_f32 v131, v131, v83
CV 17,130,131
v_sub_f32 v132, v132, v8
v_sub_f32 v133, v133, v8
CV 10,132,133
SH 132,10
HH 133,10
v_mul_f32 v132, v132, v9
v_mul_f32 v133, v133, v9
CV 10,132,133
SH 132,10
HH 133,10
v_add_f32 v44, 1.0, v44
v_add_f32 v45, 1.0, v45
CV 10,44,45
SH 44,10
HH 45,10
v_mul_f32 v132, v132, v44
v_mul_f32 v133, v133, v45
CV 10,132,133
SH 132,10
HH 133,10
v_add_f32 v132, v132, v84
v_add_f32 v133, v133, v85
CV 18,132,133
v_sub_f32 v134, v134, v8
v_sub_f32 v135, v135, v8
CV 10,134,135
SH 134,10
HH 135,10
v_mul_f32 v134, v134, v9
v_mul_f32 v135, v135, v9
CV 10,134,135
SH 134,10
HH 135,10
v_add_f32 v46, 1.0, v46
v_add_f32 v47, 1.0, v47
CV 10,46,47
SH 46,10
HH 47,10
v_mul_f32 v134, v134, v46
v_mul_f32 v135, v135, v47
CV 10,134,135
SH 134,10
HH 135,10
v_add_f32 v134, v134, v86
v_add_f32 v135, v135, v87
CV 19,134,135
v_sub_f32 v136, v136, v8
v_sub_f32 v137, v137, v8
CV 10,136,137
SH 136,10
HH 137,10
v_mul_f32 v136, v136, v9
v_mul_f32 v137, v137, v9
CV 10,136,137
SH 136,10
HH 137,10
v_add_f32 v48, 1.0, v48
v_add_f32 v49, 1.0, v49
CV 10,48,49
SH 48,10
HH 49,10
v_mul_f32 v136, v136, v48
v_mul_f32 v137, v137, v49
CV 10,136,137
SH 136,10
HH 137,10
v_add_f32 v136, v136, v88
v_add_f32 v137, v137, v89
CV 20,136,137
v_sub_f32 v138, v138, v8
v_sub_f32 v139, v139, v8
CV 10,138,139
SH 138,10
HH 139,10
v_mul_f32 v138, v138, v9
v_mul_f32 v139, v139, v9
CV 10,138,139
SH 138,10
HH 139,10
v_add_f32 v50, 1.0, v50
v_add_f32 v51, 1.0, v51
CV 10,50,51
SH 50,10
HH 51,10
v_mul_f32 v138, v138, v50
v_mul_f32 v139, v139, v51
CV 10,138,139
SH 138,10
HH 139,10
v_add_f32 v138, v138, v90
v_add_f32 v139, v139, v91
CV 21,138,139
v_sub_f32 v140, v140, v8
v_sub_f32 v141, v141, v8
CV 10,140,141
SH 140,10
HH 141,10
v_mul_f32 v140, v140, v9
v_mul_f32 v141, v141, v9
CV 10,140,141
SH 140,10
HH 141,10
v_add_f32 v52, 1.0, v52
v_add_f32 v53, 1.0, v53
CV 10,52,53
SH 52,10
HH 53,10
v_mul_f32 v140, v140, v52
v_mul_f32 v141, v141, v53
CV 10,140,141
SH 140,10
HH 141,10
v_add_f32 v140, v140, v92
v_add_f32 v141, v141, v93
CV 22,140,141
v_sub_f32 v142, v142, v8
v_sub_f32 v143, v143, v8
CV 10,142,143
SH 142,10
HH 143,10
v_mul_f32 v142, v142, v9
v_mul_f32 v143, v143, v9
CV 10,142,143
SH 142,10
HH 143,10
v_add_f32 v54, 1.0, v54
v_add_f32 v55, 1.0, v55
CV 10,54,55
SH 54,10
HH 55,10
v_mul_f32 v142, v142, v54
v_mul_f32 v143, v143, v55
CV 10,142,143
SH 142,10
HH 143,10
v_add_f32 v142, v142, v94
v_add_f32 v143, v143, v95
CV 23,142,143
v_sub_f32 v144, v144, v8
v_sub_f32 v145, v145, v8
CV 10,144,145
SH 144,10
HH 145,10
v_mul_f32 v144, v144, v9
v_mul_f32 v145, v145, v9
CV 10,144,145
SH 144,10
HH 145,10
v_add_f32 v56, 1.0, v56
v_add_f32 v57, 1.0, v57
CV 10,56,57
SH 56,10
HH 57,10
v_mul_f32 v144, v144, v56
v_mul_f32 v145, v145, v57
CV 10,144,145
SH 144,10
HH 145,10
v_add_f32 v144, v144, v96
v_add_f32 v145, v145, v97
CV 24,144,145
v_sub_f32 v146, v146, v8
v_sub_f32 v147, v147, v8
CV 10,146,147
SH 146,10
HH 147,10
v_mul_f32 v146, v146, v9
v_mul_f32 v147, v147, v9
CV 10,146,147
SH 146,10
HH 147,10
v_add_f32 v58, 1.0, v58
v_add_f32 v59, 1.0, v59
CV 10,58,59
SH 58,10
HH 59,10
v_mul_f32 v146, v146, v58
v_mul_f32 v147, v147, v59
CV 10,146,147
SH 146,10
HH 147,10
v_add_f32 v146, v146, v98
v_add_f32 v147, v147, v99
CV 25,146,147
v_sub_f32 v148, v148, v8
v_sub_f32 v149, v149, v8
CV 10,148,149
SH 148,10
HH 149,10
v_mul_f32 v148, v148, v9
v_mul_f32 v149, v149, v9
CV 10,148,149
SH 148,10
HH 149,10
v_add_f32 v60, 1.0, v60
v_add_f32 v61, 1.0, v61
CV 10,60,61
SH 60,10
HH 61,10
v_mul_f32 v148, v148, v60
v_mul_f32 v149, v149, v61
CV 10,148,149
SH 148,10
HH 149,10
v_add_f32 v148, v148, v100
v_add_f32 v149, v149, v101
CV 26,148,149
v_sub_f32 v150, v150, v8
v_sub_f32 v151, v151, v8
CV 10,150,151
SH 150,10
HH 151,10
v_mul_f32 v150, v150, v9
v_mul_f32 v151, v151, v9
CV 10,150,151
SH 150,10
HH 151,10
v_add_f32 v62, 1.0, v62
v_add_f32 v63, 1.0, v63
CV 10,62,63
SH 62,10
HH 63,10
v_mul_f32 v150, v150, v62
v_mul_f32 v151, v151, v63
CV 10,150,151
SH 150,10
HH 151,10
v_add_f32 v150, v150, v102
v_add_f32 v151, v151, v103
CV 27,150,151
v_sub_f32 v152, v152, v8
v_sub_f32 v153, v153, v8
CV 10,152,153
SH 152,10
HH 153,10
v_mul_f32 v152, v152, v9
v_mul_f32 v153, v153, v9
CV 10,152,153
SH 152,10
HH 153,10
v_add_f32 v64, 1.0, v64
v_add_f32 v65, 1.0, v65
CV 10,64,65
SH 64,10
HH 65,10
v_mul_f32 v152, v152, v64
v_mul_f32 v153, v153, v65
CV 10,152,153
SH 152,10
HH 153,10
v_add_f32 v152, v152, v104
v_add_f32 v153, v153, v105
CV 28,152,153
v_sub_f32 v154, v154, v8
v_sub_f32 v155, v155, v8
CV 10,154,155
SH 154,10
HH 155,10
v_mul_f32 v154, v154, v9
v_mul_f32 v155, v155, v9
CV 10,154,155
SH 154,10
HH 155,10
v_add_f32 v66, 1.0, v66
v_add_f32 v67, 1.0, v67
CV 10,66,67
SH 66,10
HH 67,10
v_mul_f32 v154, v154, v66
v_mul_f32 v155, v155, v67
CV 10,154,155
SH 154,10
HH 155,10
v_add_f32 v154, v154, v106
v_add_f32 v155, v155, v107
CV 29,154,155
v_sub_f32 v156, v156, v8
v_sub_f32 v157, v157, v8
CV 10,156,157
SH 156,10
HH 157,10
v_mul_f32 v156, v156, v9
v_mul_f32 v157, v157, v9
CV 10,156,157
SH 156,10
HH 157,10
v_add_f32 v68, 1.0, v68
v_add_f32 v69, 1.0, v69
CV 10,68,69
SH 68,10
HH 69,10
v_mul_f32 v156, v156, v68
v_mul_f32 v157, v157, v69
CV 10,156,157
SH 156,10
HH 157,10
v_add_f32 v156, v156, v108
v_add_f32 v157, v157, v109
CV 30,156,157
v_sub_f32 v158, v158, v8
v_sub_f32 v159, v159, v8
CV 10,158,159
SH 158,10
HH 159,10
v_mul_f32 v158, v158, v9
v_mul_f32 v159, v159, v9
CV 10,158,159
SH 158,10
HH 159,10
v_add_f32 v70, 1.0, v70
v_add_f32 v71, 1.0, v71
CV 10,70,71
SH 70,10
HH 71,10
v_mul_f32 v158, v158, v70
v_mul_f32 v159, v159, v71
CV 10,158,159
SH 158,10
HH 159,10
v_add_f32 v158, v158, v110
v_add_f32 v159, v159, v111
CV 31,158,159
v_sub_f32 v160, v160, v8
v_sub_f32 v161, v161, v8
CV 10,160,161
SH 160,10
HH 161,10
v_mul_f32 v160, v160, v9
v_mul_f32 v161, v161, v9
CV 10,160,161
SH 160,10
HH 161,10
v_add_f32 v72, 1.0, v72
v_add_f32 v73, 1.0, v73
CV 10,72,73
SH 72,10
HH 73,10
v_mul_f32 v160, v160, v72
v_mul_f32 v161, v161, v73
CV 10,160,161
SH 160,10
HH 161,10
v_add_f32 v160, v160, v112
v_add_f32 v161, v161, v113
CV 32,160,161
v_sub_f32 v162, v162, v8
v_sub_f32 v163, v163, v8
CV 10,162,163
SH 162,10
HH 163,10
v_mul_f32 v162, v162, v9
v_mul_f32 v163, v163, v9
CV 10,162,163
SH 162,10
HH 163,10
v_add_f32 v74, 1.0, v74
v_add_f32 v75, 1.0, v75
CV 10,74,75
SH 74,10
HH 75,10
v_mul_f32 v162, v162, v74
v_mul_f32 v163, v163, v75
CV 10,162,163
SH 162,10
HH 163,10
v_add_f32 v162, v162, v114
v_add_f32 v163, v163, v115
CV 33,162,163
v_sub_f32 v164, v164, v8
v_sub_f32 v165, v165, v8
CV 10,164,165
SH 164,10
HH 165,10
v_mul_f32 v164, v164, v9
v_mul_f32 v165, v165, v9
CV 10,164,165
SH 164,10
HH 165,10
v_add_f32 v76, 1.0, v76
v_add_f32 v77, 1.0, v77
CV 10,76,77
SH 76,10
HH 77,10
v_mul_f32 v164, v164, v76
v_mul_f32 v165, v165, v77
CV 10,164,165
SH 164,10
HH 165,10
v_add_f32 v164, v164, v116
v_add_f32 v165, v165, v117
CV 34,164,165
v_sub_f32 v166, v166, v8
v_sub_f32 v167, v167, v8
CV 10,166,167
SH 166,10
HH 167,10
v_mul_f32 v166, v166, v9
v_mul_f32 v167, v167, v9
CV 10,166,167
SH 166,10
HH 167,10
v_add_f32 v78, 1.0, v78
v_add_f32 v79, 1.0, v79
CV 10,78,79
SH 78,10
HH 79,10
v_mul_f32 v166, v166, v78
v_mul_f32 v167, v167, v79
CV 10,166,167
SH 166,10
HH 167,10
v_add_f32 v166, v166, v118
v_add_f32 v167, v167, v119
CV 35,166,167
v_lshrrev_b32 v8, 5, v5
v_mul_u32_u24 v8, 40960, v8
v_and_b32 v9, 31, v5
v_lshlrev_b32 v9, 4, v9
v_add_u32 v8, v8, v9
v_lshrrev_b32 v9, 1, v4
v_lshlrev_b32 v9, 10, v9
v_add_u32 v8, v8, v9
v_and_b32 v9, 1, v4
v_lshlrev_b32 v9, 3, v9
v_add_u32 v8, v8, v9
s_mov_b32 s25, 10485760
buffer_store_dwordx2 v[16:17], v8, s[8:11], s25 offen sc1
buffer_store_dwordx2 v[18:19], v8, s[8:11], s25 offen offset:512 sc1
s_add_u32 s25, s25, 8192
buffer_store_dwordx2 v[20:21], v8, s[8:11], s25 offen sc1
buffer_store_dwordx2 v[22:23], v8, s[8:11], s25 offen offset:512 sc1
s_add_u32 s25, s25, 8192
buffer_store_dwordx2 v[24:25], v8, s[8:11], s25 offen sc1
buffer_store_dwordx2 v[26:27], v8, s[8:11], s25 offen offset:512 sc1
s_add_u32 s25, s25, 8192
buffer_store_dwordx2 v[28:29], v8, s[8:11], s25 offen sc1
buffer_store_dwordx2 v[30:31], v8, s[8:11], s25 offen offset:512 sc1
s_add_u32 s25, s25, 8192
buffer_store_dwordx2 v[32:33], v8, s[8:11], s25 offen sc1
buffer_store_dwordx2 v[34:35], v8, s[8:11], s25 offen offset:512 sc1
s_add_u32 s25, s25, 8192
WV 0
s_barrier
s_cmp_eq_u32 s16, 0
s_cbranch_scc0 U_sig_72
s_lshr_b32 s23, s40, 3
s_lshl_b32 s23, s23, 7
s_add_u32 s23, s23, 1024
s_mov_b64 exec, 1
v_mov_b32 v22, 1
v_mov_b32 v23, s23
buffer_atomic_add v22, v23, s[8:11], 0 offen
s_mov_b64 exec, -1
U_sig_72:
s_branch U_ln
U_done:
s_cmp_eq_u32 s16, 0
s_cbranch_scc0 dw_74
s_mov_b32 s22, 0
v_mov_b32 v22, 384
dw_73:
buffer_load_dword v23, v22, s[8:11], 0 offen sc1
s_add_u32 s22, s22, 1
s_cmp_gt_u32 s22, 1048576
s_cbranch_scc1 dw_74
WV 0
v_readfirstlane_b32 s23, v23
s_nop 3
s_cmp_ge_u32 s23, 37
s_cbranch_scc1 dw_74
s_sleep 4
s_branch dw_73
dw_74:
s_barrier
s_mov_b32 s96, -1
s_getreg_b32 s58, hwreg(HW_REG_XCC_ID)
s_and_b32 s58, s58, 7
s_cmp_lt_u32 s58, 4
s_cbranch_scc0 W_pre
W_serveA:
s_barrier
s_cmp_eq_u32 s16, 0
s_cbranch_scc0 W_reg_75
s_mov_b64 exec, 1
v_mov_b32 v22, 1
v_mov_b32 v23, 104
buffer_atomic_add v22, v23, s[12:15], 0 offen sc0
WV 0
v_mov_b32 v23, 147488
ds_write_b32 v23, v22
WL 0
s_mov_b64 exec, -1
W_reg_75:
s_barrier
v_mov_b32 v23, 147488
ds_read_b32 v22, v23
WL 0
v_readfirstlane_b32 s23, v22
s_nop 3
s_cmp_lt_u32 s23, 16
s_cbranch_scc0 W_notA
s_mov_b32 s58, 4
s_getpc_b64 s[92:93]
W_pc:
s_add_u32 s92, s92, P_phase-W_pc
s_addc_u32 s93, s93, 0
s_setpc_b64 s[92:93]
W_notA:
W_pre:
s_load_dwordx2 s[6:7], s[0:1], 16
WL 0
s_mov_b32 s68, s6
s_and_b32 s69, s7, 0xffff
s_mov_b32 s70, 0x780000
s_mov_b32 s71, 0x20000
s_load_dwordx2 s[6:7], s[0:1], 24
WL 0
s_mov_b32 s72, s6
s_and_b32 s73, s7, 0xffff
s_mov_b32 s74, 0x780000
s_mov_b32 s75, 0x20000
s_load_dwordx2 s[6:7], s[0:1], 32
WL 0
s_mov_b32 s76, s6
s_and_b32 s77, s7, 0xffff
s_mov_b32 s78, 0x780000
s_mov_b32 s79, 0x20000
s_load_dwordx2 s[6:7], s[0:1], 40
WL 0
s_mov_b32 s80, s6
s_and_b32 s81, s7, 0xffff
s_mov_b32 s82, 0x780000
s_mov_b32 s83, 0x20000
s_load_dwordx2 s[6:7], s[0:1], 112
WL 0
s_mov_b32 s12, s6
s_and_b32 s13, s7, 0xffff
s_mov_b32 s14, 0x100
s_mov_b32 s15, 0x20000
s_mul_i32 s90, s16, 6144
s_mul_i32 s91, s16, 5120
v_and_b32 v22, 63, v0
v_lshlrev_b32 v1, 4, v22
v_lshrrev_b32 v23, 5, v22
v_lshlrev_b32 v23, 2, v23
v_and_b32 v24, 15, v22
v_lshrrev_b32 v25, 2, v24
v_add_u32 v23, v23, v25
v_lshrrev_b32 v25, 4, v22
v_and_b32 v25, 1, v25
v_lshlrev_b32 v25, 5, v25
v_and_b32 v26, 3, v24
v_lshlrev_b32 v26, 3, v26
v_add_u32 v25, v25, v26
v_mul_u32_u24 v26, 384, v23
v_add_u32 v26, v26, v25
v_lshrrev_b32 v27, 1, v23
v_and_b32 v27, 1, v27
v_lshlrev_b32 v27, 6, v27
v_add_u32 v2, v26, v27
v_sub_u32 v3, v26, v27
v_mul_u32_u24 v26, 320, v23
v_add_u32 v4, v26, v25
v_and_b32 v22, 63, v0
s_mul_i32 s23, s16, 384
s_add_u32 s23, s23, 0
v_add_u32 v23, s23, v22
v_mul_u32_u24 v24, 2731, v23
v_lshrrev_b32 v24, 16, v24
v_mul_u32_u24 v25, 24, v24
v_sub_u32 v25, v23, v25
v_lshrrev_b32 v26, 1, v24
v_and_b32 v26, 1, v26
v_lshlrev_b32 v26, 2, v26
v_xor_b32 v25, v25, v26
v_lshlrev_b32 v25, 4, v25
v_mul_u32_u24 v24, 12288, v24
v_add_u32 v10, v24, v25
s_mul_i32 s23, s16, 384
s_add_u32 s23, s23, 64
v_add_u32 v23, s23, v22
v_mul_u32_u24 v24, 2731, v23
v_lshrrev_b32 v24, 16, v24
v_mul_u32_u24 v25, 24, v24
v_sub_u32 v25, v23, v25
v_lshrrev_b32 v26, 1, v24
v_and_b32 v26, 1, v26
v_lshlrev_b32 v26, 2, v26
v_xor_b32 v25, v25, v26
v_lshlrev_b32 v25, 4, v25
v_mul_u32_u24 v24, 12288, v24
v_add_u32 v11, v24, v25
s_mul_i32 s23, s16, 384
s_add_u32 s23, s23, 128
v_add_u32 v23, s23, v22
v_mul_u32_u24 v24, 2731, v23
v_lshrrev_b32 v24, 16, v24
v_mul_u32_u24 v25, 24, v24
v_sub_u32 v25, v23, v25
v_lshrrev_b32 v26, 1, v24
v_and_b32 v26, 1, v26
v_lshlrev_b32 v26, 2, v26
v_xor_b32 v25, v25, v26
v_lshlrev_b32 v25, 4, v25
v_mul_u32_u24 v24, 12288, v24
v_add_u32 v12, v24, v25
s_mul_i32 s23, s16, 384
s_add_u32 s23, s23, 192
v_add_u32 v23, s23, v22
v_mul_u32_u24 v24, 2731, v23
v_lshrrev_b32 v24, 16, v24
v_mul_u32_u24 v25, 24, v24
v_sub_u32 v25, v23, v25
v_lshrrev_b32 v26, 1, v24
v_and_b32 v26, 1, v26
v_lshlrev_b32 v26, 2, v26
v_xor_b32 v25, v25, v26
v_lshlrev_b32 v25, 4, v25
v_mul_u32_u24 v24, 12288, v24
v_add_u32 v13, v24, v25
s_mul_i32 s23, s16, 384
s_add_u32 s23, s23, 256
v_add_u32 v23, s23, v22
v_mul_u32_u24 v24, 2731, v23
v_lshrrev_b32 v24, 16, v24
v_mul_u32_u24 v25, 24, v24
v_sub_u32 v25, v23, v25
v_lshrrev_b32 v26, 1, v24
v_and_b32 v26, 1, v26
v_lshlrev_b32 v26, 2, v26
v_xor_b32 v25, v25, v26
v_lshlrev_b32 v25, 4, v25
v_mul_u32_u24 v24, 12288, v24
v_add_u32 v14, v24, v25
s_mul_i32 s23, s16, 384
s_add_u32 s23, s23, 320
v_add_u32 v23, s23, v22
v_mul_u32_u24 v24, 2731, v23
v_lshrrev_b32 v24, 16, v24
v_mul_u32_u24 v25, 24, v24
v_sub_u32 v25, v23, v25
v_lshrrev_b32 v26, 1, v24
v_and_b32 v26, 1, v26
v_lshlrev_b32 v26, 2, v26
v_xor_b32 v25, v25, v26
v_lshlrev_b32 v25, 4, v25
v_mul_u32_u24 v24, 12288, v24
v_add_u32 v15, v24, v25
v_and_b32 v22, 63, v0
s_mul_i32 s23, s16, 320
s_add_u32 s23, s23, 0
v_add_u32 v23, s23, v22
v_mul_u32_u24 v24, 3277, v23
v_lshrrev_b32 v24, 16, v24
v_mul_u32_u24 v25, 20, v24
v_sub_u32 v25, v23, v25
v_lshlrev_b32 v25, 4, v25
v_mul_u32_u24 v24, 1280, v24
v_add_u32 v16, v24, v25
s_mul_i32 s23, s16, 320
s_add_u32 s23, s23, 64
v_add_u32 v23, s23, v22
v_mul_u32_u24 v24, 3277, v23
v_lshrrev_b32 v24, 16, v24
v_mul_u32_u24 v25, 20, v24
v_sub_u32 v25, v23, v25
v_lshlrev_b32 v25, 4, v25
v_mul_u32_u24 v24, 1280, v24
v_add_u32 v17, v24, v25
s_mul_i32 s23, s16, 320
s_add_u32 s23, s23, 128
v_add_u32 v23, s23, v22
v_mul_u32_u24 v24, 3277, v23
v_lshrrev_b32 v24, 16, v24
v_mul_u32_u24 v25, 20, v24
v_sub_u32 v25, v23, v25
v_lshlrev_b32 v25, 4, v25
v_mul_u32_u24 v24, 1280, v24
v_add_u32 v18, v24, v25
s_mul_i32 s23, s16, 320
s_add_u32 s23, s23, 192
v_add_u32 v23, s23, v22
v_mul_u32_u24 v24, 3277, v23
v_lshrrev_b32 v24, 16, v24
v_mul_u32_u24 v25, 20, v24
v_sub_u32 v25, v23, v25
v_lshlrev_b32 v25, 4, v25
v_mul_u32_u24 v24, 1280, v24
v_add_u32 v19, v24, v25
s_mul_i32 s23, s16, 320
s_add_u32 s23, s23, 256
v_add_u32 v23, s23, v22
v_mul_u32_u24 v24, 3277, v23
v_lshrrev_b32 v24, 16, v24
v_mul_u32_u24 v25, 20, v24
v_sub_u32 v25, v23, v25
v_lshlrev_b32 v25, 4, v25
v_mul_u32_u24 v24, 1280, v24
v_add_u32 v20, v24, v25
s_getreg_b32 s58, hwreg(HW_REG_XCC_ID)
s_and_b32 s58, s58, 7
s_and_b32 s58, s58, 3
s_mov_b32 s59, 0
s_mov_b32 s52, -1
W_refetch:
s_cmp_eq_u32 s16, 0
s_cbranch_scc0 W_f_76
s_lshl_b32 s23, s58, 2
s_add_u32 s23, s23, 128
s_mov_b64 exec, 1
v_mov_b32 v5, 1
v_mov_b32 v22, s23
buffer_atomic_add v5, v22, s[12:15], 0 offen sc0
s_mov_b64 exec, -1
W_f_76:
WV 0
s_cmp_eq_u32 s16, 0
s_cbranch_scc0 W_p_77
s_mov_b64 exec, 1
v_mov_b32 v22, 147456
ds_write_b32 v22, v5
WL 0
s_mov_b64 exec, -1
W_p_77:
s_barrier
W_loop:
v_mov_b32 v22, 147456
ds_read_b32 v23, v22
WL 0
v_readfirstlane_b32 s60, v23
s_nop 3
s_barrier
s_cmp_ge_u32 s60, 256
s_cbranch_scc0 W_have
s_add_u32 s59, s59, 1
s_cmp_ge_u32 s59, 4
s_cbranch_scc1 W_done
s_add_u32 s58, s58, 1
s_and_b32 s58, s58, 3
s_branch W_refetch
W_have:
s_mov_b32 s61, s58
s_and_b32 s40, s60, 1
s_lshr_b32 s23, s60, 5
s_lshl_b32 s23, s23, 1
s_add_u32 s40, s40, s23
s_lshr_b32 s41, s60, 2
s_and_b32 s41, s41, 7
s_lshl_b32 s23, s61, 3
s_add_u32 s41, s41, s23
s_cmp_eq_u32 s40, s96
s_cbranch_scc1 lnr_78
s_cmp_eq_u32 s16, 0
s_cbranch_scc0 lnr_80
s_lshl_b32 s25, s40, 7
s_add_u32 s25, s25, 1024
v_mov_b32 v22, s25
s_mov_b32 s22, 0
lnr_79:
buffer_load_dword v23, v22, s[8:11], 0 offen sc1
s_add_u32 s22, s22, 1
s_cmp_gt_u32 s22, 1048576
s_cbranch_scc1 lnr_80
WV 0
v_readfirstlane_b32 s23, v23
s_nop 3
s_cmp_ge_u32 s23, 8
s_cbranch_scc1 lnr_80
s_sleep 3
s_branch lnr_79
lnr_80:
s_barrier
s_mov_b32 s96, s40
lnr_78:
s_bitcmp1_b32 s60, 1
s_cbranch_scc1 W_kq
s_mul_i32 s42, s41, 384
s_mul_i32 s46, s41, 245760
s_lshl_b32 s43, s40, 2
s_add_u32 s43, s43, s16
s_mul_i32 s44, s43, 40960
s_add_u32 s44, s44, 10485760
v_and_b32 v22, 63, v0
v_and_b32 v23, 31, v22
v_lshrrev_b32 v24, 3, v23
v_lshlrev_b32 v24, 14, v24
v_lshrrev_b32 v25, 5, v22
v_lshlrev_b32 v25, 8, v25
v_and_b32 v23, 7, v23
v_lshlrev_b32 v23, 4, v23
v_add3_u32 v21, v23, v24, v25
s_mul_i32 s47, s43, 1310720
s_lshr_b32 s23, s41, 1
s_lshl_b32 s23, s23, 10
s_add_u32 s47, s47, s23
s_and_b32 s23, s41, 1
s_lshl_b32 s23, s23, 7
s_add_u32 s47, s47, s23
s_add_u32 s47, s47, 144703488
s_mul_i32 s23, s16, 6144
s_add_u32 m0, s23, 0
s_nop 0
DM 10,76,42
s_add_u32 m0, s23, 1024
s_nop 0
DM 11,76,42
s_add_u32 m0, s23, 2048
s_nop 0
DM 12,76,42
s_add_u32 m0, s23, 3072
s_nop 0
DM 13,76,42
s_add_u32 m0, s23, 4096
s_nop 0
DM 14,76,42
s_add_u32 m0, s23, 5120
s_nop 0
DM 15,76,42
s_add_u32 s42, s42, 786432
buffer_load_dwordx4 a[0:3], v1, s[8:11], s44 offen offset:0 sc1
buffer_load_dwordx4 a[4:7], v1, s[8:11], s44 offen offset:1024 sc1
buffer_load_dwordx4 a[8:11], v1, s[8:11], s44 offen offset:2048 sc1
buffer_load_dwordx4 a[12:15], v1, s[8:11], s44 offen offset:3072 sc1
s_mul_i32 s23, s16, 6144
s_add_u32 m0, s23, 24576
s_nop 0
DM 10,76,42
s_add_u32 m0, s23, 25600
s_nop 0
DM 11,76,42
s_add_u32 m0, s23, 26624
s_nop 0
DM 12,76,42
s_add_u32 m0, s23, 27648
s_nop 0
DM 13,76,42
s_add_u32 m0, s23, 28672
s_nop 0
DM 14,76,42
s_add_u32 m0, s23, 29696
s_nop 0
DM 15,76,42
s_add_u32 s42, s42, 786432
s_add_u32 s44, s44, 4096
buffer_load_dwordx4 a[16:19], v1, s[8:11], s44 offen offset:0 sc1
buffer_load_dwordx4 a[20:23], v1, s[8:11], s44 offen offset:1024 sc1
buffer_load_dwordx4 a[24:27], v1, s[8:11], s44 offen offset:2048 sc1
buffer_load_dwordx4 a[28:31], v1, s[8:11], s44 offen offset:3072 sc1
s_mul_i32 s23, s16, 6144
s_add_u32 m0, s23, 49152
s_nop 0
DM 10,76,42
s_add_u32 m0, s23, 50176
s_nop 0
DM 11,76,42
s_add_u32 m0, s23, 51200
s_nop 0
DM 12,76,42
s_add_u32 m0, s23, 52224
s_nop 0
DM 13,76,42
s_add_u32 m0, s23, 53248
s_nop 0
DM 14,76,42
s_add_u32 m0, s23, 54272
s_nop 0
DM 15,76,42
s_add_u32 s42, s42, 786432
s_add_u32 s44, s44, 4096
buffer_load_dwordx4 a[32:35], v1, s[8:11], s44 offen offset:0 sc1
buffer_load_dwordx4 a[36:39], v1, s[8:11], s44 offen offset:1024 sc1
buffer_load_dwordx4 a[40:43], v1, s[8:11], s44 offen offset:2048 sc1
buffer_load_dwordx4 a[44:47], v1, s[8:11], s44 offen offset:3072 sc1
s_add_u32 s44, s44, 4096
buffer_load_dwordx4 a[48:51], v1, s[8:11], s44 offen offset:0 sc1
buffer_load_dwordx4 a[52:55], v1, s[8:11], s44 offen offset:1024 sc1
buffer_load_dwordx4 a[56:59], v1, s[8:11], s44 offen offset:2048 sc1
buffer_load_dwordx4 a[60:63], v1, s[8:11], s44 offen offset:3072 sc1
s_add_u32 s44, s44, 4096
buffer_load_dwordx4 a[64:67], v1, s[8:11], s44 offen offset:0 sc1
buffer_load_dwordx4 a[68:71], v1, s[8:11], s44 offen offset:1024 sc1
buffer_load_dwordx4 a[72:75], v1, s[8:11], s44 offen offset:2048 sc1
buffer_load_dwordx4 a[76:79], v1, s[8:11], s44 offen offset:3072 sc1
s_add_u32 s44, s44, 4096
buffer_load_dwordx4 a[80:83], v1, s[8:11], s44 offen offset:0 sc1
buffer_load_dwordx4 a[84:87], v1, s[8:11], s44 offen offset:1024 sc1
buffer_load_dwordx4 a[88:91], v1, s[8:11], s44 offen offset:2048 sc1
buffer_load_dwordx4 a[92:95], v1, s[8:11], s44 offen offset:3072 sc1
s_add_u32 s44, s44, 4096
buffer_load_dwordx4 a[96:99], v1, s[8:11], s44 offen offset:0 sc1
buffer_load_dwordx4 a[100:103], v1, s[8:11], s44 offen offset:1024 sc1
buffer_load_dwordx4 a[104:107], v1, s[8:11], s44 offen offset:2048 sc1
buffer_load_dwordx4 a[108:111], v1, s[8:11], s44 offen offset:3072 sc1
s_add_u32 s44, s44, 4096
buffer_load_dwordx4 a[112:115], v1, s[8:11], s44 offen offset:0 sc1
buffer_load_dwordx4 a[116:119], v1, s[8:11], s44 offen offset:1024 sc1
buffer_load_dwordx4 a[120:123], v1, s[8:11], s44 offen offset:2048 sc1
buffer_load_dwordx4 a[124:127], v1, s[8:11], s44 offen offset:3072 sc1
s_add_u32 s44, s44, 4096
buffer_load_dwordx4 a[128:131], v1, s[8:11], s44 offen offset:0 sc1
buffer_load_dwordx4 a[132:135], v1, s[8:11], s44 offen offset:1024 sc1
buffer_load_dwordx4 a[136:139], v1, s[8:11], s44 offen offset:2048 sc1
buffer_load_dwordx4 a[140:143], v1, s[8:11], s44 offen offset:3072 sc1
s_add_u32 s44, s44, 4096
buffer_load_dwordx4 a[144:147], v1, s[8:11], s44 offen offset:0 sc1
buffer_load_dwordx4 a[148:151], v1, s[8:11], s44 offen offset:1024 sc1
buffer_load_dwordx4 a[152:155], v1, s[8:11], s44 offen offset:2048 sc1
buffer_load_dwordx4 a[156:159], v1, s[8:11], s44 offen offset:3072 sc1
WV 52
s_barrier
v_add_u32 v6, 0, v2
v_add_u32 v7, 0, v3
TR 160,6,0
TR 162,6,3072
TR 164,7,64
TR 166,7,3136
TR 168,6,128
TR 170,6,3200
TR 172,7,192
TR 174,7,3264
TR 176,6,256
TR 178,6,3328
TR 180,7,320
TR 182,7,3392
WV 51
WL 10
v_mfma_f32_32x32x16_bf16 v[32:47], a[160:163], a[0:3], 0
TR 184,6,6144
TR 186,6,9216
WL 10
v_mfma_f32_32x32x16_bf16 v[48:63], a[164:167], a[0:3], 0
TR 188,7,6208
TR 190,7,9280
WL 10
v_mfma_f32_32x32x16_bf16 v[64:79], a[168:171], a[0:3], 0
TR 192,6,6272
TR 194,6,9344
WL 10
v_mfma_f32_32x32x16_bf16 v[80:95], a[172:175], a[0:3], 0
TR 196,7,6336
TR 198,7,9408
WL 10
v_mfma_f32_32x32x16_bf16 v[96:111], a[176:179], a[0:3], 0
TR 200,6,6400
TR 202,6,9472
WL 10
v_mfma_f32_32x32x16_bf16 v[112:127], a[180:183], a[0:3], 0
TR 204,7,6464
TR 206,7,9536
WV 50
WL 10
MA 32,184,4
TR 160,6,12288
TR 162,6,15360
WL 10
MA 48,188,4
TR 164,7,12352
TR 166,7,15424
WL 10
MA 64,192,4
TR 168,6,12416
TR 170,6,15488
WL 10
MA 80,196,4
TR 172,7,12480
TR 174,7,15552
WL 10
MA 96,200,4
TR 176,6,12544
TR 178,6,15616
WL 10
MA 112,204,4
TR 180,7,12608
TR 182,7,15680
WV 49
WV 42
s_barrier
v_add_u32 v8, 24576, v2
v_add_u32 v9, 24576, v3
WL 10
MA 32,160,8
TR 184,6,18432
TR 186,6,21504
WL 10
MA 48,164,8
TR 188,7,18496
TR 190,7,21568
s_add_u32 m0, s90, 73728
s_nop 0
DM 10,76,42
WL 10
MA 64,168,8
TR 192,6,18560
TR 194,6,21632
WL 10
MA 80,172,8
TR 196,7,18624
TR 198,7,21696
WL 10
MA 96,176,8
TR 200,6,18688
TR 202,6,21760
s_add_u32 m0, s90, 74752
s_nop 0
DM 11,76,42
WL 10
MA 112,180,8
TR 204,7,18752
TR 206,7,21824
WL 10
MA 32,184,12
TR 160,8,0
TR 162,8,3072
WL 10
MA 48,188,12
TR 164,9,64
TR 166,9,3136
s_add_u32 m0, s90, 75776
s_nop 0
DM 12,76,42
WL 10
MA 64,192,12
TR 168,8,128
TR 170,8,3200
WL 10
MA 80,196,12
TR 172,9,192
TR 174,9,3264
WL 10
MA 96,200,12
TR 176,8,256
TR 178,8,3328
s_add_u32 m0, s90, 76800
s_nop 0
DM 13,76,42
WL 10
MA 112,204,12
TR 180,9,320
TR 182,9,3392
WV 45
WL 10
MA 32,160,16
TR 184,8,6144
TR 186,8,9216
WL 10
MA 48,164,16
TR 188,9,6208
TR 190,9,9280
s_add_u32 m0, s90, 77824
s_nop 0
DM 14,76,42
WL 10
MA 64,168,16
TR 192,8,6272
TR 194,8,9344
WL 10
MA 80,172,16
TR 196,9,6336
TR 198,9,9408
WL 10
MA 96,176,16
TR 200,8,6400
TR 202,8,9472
s_add_u32 m0, s90, 78848
s_nop 0
DM 15,76,42
s_add_u32 s42, s42, 786432
WL 10
MA 112,180,16
TR 204,9,6464
TR 206,9,9536
WV 46
WL 10
MA 32,184,20
TR 160,8,12288
TR 162,8,15360
WL 10
MA 48,188,20
TR 164,9,12352
TR 166,9,15424
WL 10
MA 64,192,20
TR 168,8,12416
TR 170,8,15488
WL 10
MA 80,196,20
TR 172,9,12480
TR 174,9,15552
WL 10
MA 96,200,20
TR 176,8,12544
TR 178,8,15616
WL 10
MA 112,204,20
TR 180,9,12608
TR 182,9,15680
WV 45
WV 38
s_barrier
v_add_u32 v6, 49152, v2
v_add_u32 v7, 49152, v3
WL 10
MA 32,160,24
TR 184,8,18432
TR 186,8,21504
WL 10
MA 48,164,24
TR 188,9,18496
TR 190,9,21568
s_add_u32 m0, s90, 0
s_nop 0
DM 10,76,42
WL 10
MA 64,168,24
TR 192,8,18560
TR 194,8,21632
WL 10
MA 80,172,24
TR 196,9,18624
TR 198,9,21696
WL 10
MA 96,176,24
TR 200,8,18688
TR 202,8,21760
s_add_u32 m0, s90, 1024
s_nop 0
DM 11,76,42
WL 10
MA 112,180,24
TR 204,9,18752
TR 206,9,21824
WL 10
MA 32,184,28
TR 160,6,0
TR 162,6,3072
WL 10
MA 48,188,28
TR 164,7,64
TR 166,7,3136
s_add_u32 m0, s90, 2048
s_nop 0
DM 12,76,42
WL 10
MA 64,192,28
TR 168,6,128
TR 170,6,3200
WL 10
MA 80,196,28
TR 172,7,192
TR 174,7,3264
WL 10
MA 96,200,28
TR 176,6,256
TR 178,6,3328
s_add_u32 m0, s90, 3072
s_nop 0
DM 13,76,42
WL 10
MA 112,204,28
TR 180,7,320
TR 182,7,3392
WV 41
WL 10
MA 32,160,32
TR 184,6,6144
TR 186,6,9216
WL 10
MA 48,164,32
TR 188,7,6208
TR 190,7,9280
s_add_u32 m0, s90, 4096
s_nop 0
DM 14,76,42
WL 10
MA 64,168,32
TR 192,6,6272
TR 194,6,9344
WL 10
MA 80,172,32
TR 196,7,6336
TR 198,7,9408
WL 10
MA 96,176,32
TR 200,6,6400
TR 202,6,9472
s_add_u32 m0, s90, 5120
s_nop 0
DM 15,76,42
s_add_u32 s42, s42, 786432
WL 10
MA 112,180,32
TR 204,7,6464
TR 206,7,9536
WV 42
WL 10
MA 32,184,36
TR 160,6,12288
TR 162,6,15360
WL 10
MA 48,188,36
TR 164,7,12352
TR 166,7,15424
WL 10
MA 64,192,36
TR 168,6,12416
TR 170,6,15488
WL 10
MA 80,196,36
TR 172,7,12480
TR 174,7,15552
WL 10
MA 96,200,36
TR 176,6,12544
TR 178,6,15616
WL 10
MA 112,204,36
TR 180,7,12608
TR 182,7,15680
WV 41
WV 6
s_barrier
v_add_u32 v8, 73728, v2
v_add_u32 v9, 73728, v3
WL 10
MA 32,160,40
TR 184,6,18432
TR 186,6,21504
WL 10
MA 48,164,40
TR 188,7,18496
TR 190,7,21568
s_add_u32 m0, s90, 24576
s_nop 0
DM 10,76,42
WL 10
MA 64,168,40
TR 192,6,18560
TR 194,6,21632
WL 10
MA 80,172,40
TR 196,7,18624
TR 198,7,21696
WL 10
MA 96,176,40
TR 200,6,18688
TR 202,6,21760
s_add_u32 m0, s90, 25600
s_nop 0
DM 11,76,42
WL 10
MA 112,180,40
TR 204,7,18752
TR 206,7,21824
WL 10
MA 32,184,44
TR 160,8,0
TR 162,8,3072
WL 10
MA 48,188,44
TR 164,9,64
TR 166,9,3136
s_add_u32 m0, s90, 26624
s_nop 0
DM 12,76,42
WL 10
MA 64,192,44
TR 168,8,128
TR 170,8,3200
WL 10
MA 80,196,44
TR 172,9,192
TR 174,9,3264
WL 10
MA 96,200,44
TR 176,8,256
TR 178,8,3328
s_add_u32 m0, s90, 27648
s_nop 0
DM 13,76,42
WL 10
MA 112,204,44
TR 180,9,320
TR 182,9,3392
WL 10
MA 32,160,48
TR 184,8,6144
TR 186,8,9216
WL 10
MA 48,164,48
TR 188,9,6208
TR 190,9,9280
s_add_u32 m0, s90, 28672
s_nop 0
DM 14,76,42
WL 10
MA 64,168,48
TR 192,8,6272
TR 194,8,9344
WL 10
MA 80,172,48
TR 196,9,6336
TR 198,9,9408
WL 10
MA 96,176,48
TR 200,8,6400
TR 202,8,9472
s_add_u32 m0, s90, 29696
s_nop 0
DM 15,76,42
s_add_u32 s42, s42, 786432
WL 10
MA 112,180,48
TR 204,9,6464
TR 206,9,9536
WL 10
MA 32,184,52
TR 160,8,12288
TR 162,8,15360
WL 10
MA 48,188,52
TR 164,9,12352
TR 166,9,15424
WL 10
MA 64,192,52
TR 168,8,12416
TR 170,8,15488
WL 10
MA 80,196,52
TR 172,9,12480
TR 174,9,15552
WL 10
MA 96,200,52
TR 176,8,12544
TR 178,8,15616
WL 10
MA 112,204,52
TR 180,9,12608
TR 182,9,15680
WV 6
s_barrier
v_add_u32 v6, 0, v2
v_add_u32 v7, 0, v3
WL 10
MA 32,160,56
TR 184,8,18432
TR 186,8,21504
WL 10
MA 48,164,56
TR 188,9,18496
TR 190,9,21568
s_add_u32 m0, s90, 49152
s_nop 0
DM 10,76,42
WL 10
MA 64,168,56
TR 192,8,18560
TR 194,8,21632
WL 10
MA 80,172,56
TR 196,9,18624
TR 198,9,21696
WL 10
MA 96,176,56
TR 200,8,18688
TR 202,8,21760
s_add_u32 m0, s90, 50176
s_nop 0
DM 11,76,42
WL 10
MA 112,180,56
TR 204,9,18752
TR 206,9,21824
WL 10
MA 32,184,60
TR 160,6,0
TR 162,6,3072
WL 10
MA 48,188,60
TR 164,7,64
TR 166,7,3136
s_add_u32 m0, s90, 51200
s_nop 0
DM 12,76,42
WL 10
MA 64,192,60
TR 168,6,128
TR 170,6,3200
WL 10
MA 80,196,60
TR 172,7,192
TR 174,7,3264
WL 10
MA 96,200,60
TR 176,6,256
TR 178,6,3328
s_add_u32 m0, s90, 52224
s_nop 0
DM 13,76,42
WL 10
MA 112,204,60
TR 180,7,320
TR 182,7,3392
WL 10
MA 32,160,64
TR 184,6,6144
TR 186,6,9216
WL 10
MA 48,164,64
TR 188,7,6208
TR 190,7,9280
s_add_u32 m0, s90, 53248
s_nop 0
DM 14,76,42
WL 10
MA 64,168,64
TR 192,6,6272
TR 194,6,9344
WL 10
MA 80,172,64
TR 196,7,6336
TR 198,7,9408
WL 10
MA 96,176,64
TR 200,6,6400
TR 202,6,9472
s_add_u32 m0, s90, 54272
s_nop 0
DM 15,76,42
s_add_u32 s42, s42, 786432
WL 10
MA 112,180,64
TR 204,7,6464
TR 206,7,9536
WL 10
MA 32,184,68
TR 160,6,12288
TR 162,6,15360
WL 10
MA 48,188,68
TR 164,7,12352
TR 166,7,15424
WL 10
MA 64,192,68
TR 168,6,12416
TR 170,6,15488
WL 10
MA 80,196,68
TR 172,7,12480
TR 174,7,15552
WL 10
MA 96,200,68
TR 176,6,12544
TR 178,6,15616
WL 10
MA 112,204,68
TR 180,7,12608
TR 182,7,15680
WV 6
s_barrier
v_add_u32 v8, 24576, v2
v_add_u32 v9, 24576, v3
WL 10
MA 32,160,72
TR 184,6,18432
TR 186,6,21504
WL 10
MA 48,164,72
TR 188,7,18496
TR 190,7,21568
s_add_u32 m0, s90, 73728
s_nop 0
DM 10,76,42
WL 10
MA 64,168,72
TR 192,6,18560
TR 194,6,21632
WL 10
MA 80,172,72
TR 196,7,18624
TR 198,7,21696
WL 10
MA 96,176,72
TR 200,6,18688
TR 202,6,21760
s_add_u32 m0, s90, 74752
s_nop 0
DM 11,76,42
WL 10
MA 112,180,72
TR 204,7,18752
TR 206,7,21824
WL 10
MA 32,184,76
TR 160,8,0
TR 162,8,3072
WL 10
MA 48,188,76
TR 164,9,64
TR 166,9,3136
s_add_u32 m0, s90, 75776
s_nop 0
DM 12,76,42
WL 10
MA 64,192,76
TR 168,8,128
TR 170,8,3200
WL 10
MA 80,196,76
TR 172,9,192
TR 174,9,3264
WL 10
MA 96,200,76
TR 176,8,256
TR 178,8,3328
s_add_u32 m0, s90, 76800
s_nop 0
DM 13,76,42
WL 10
MA 112,204,76
TR 180,9,320
TR 182,9,3392
WL 10
MA 32,160,80
TR 184,8,6144
TR 186,8,9216
WL 10
MA 48,164,80
TR 188,9,6208
TR 190,9,9280
s_add_u32 m0, s90, 77824
s_nop 0
DM 14,76,42
WL 10
MA 64,168,80
TR 192,8,6272
TR 194,8,9344
WL 10
MA 80,172,80
TR 196,9,6336
TR 198,9,9408
WL 10
MA 96,176,80
TR 200,8,6400
TR 202,8,9472
s_add_u32 m0, s90, 78848
s_nop 0
DM 15,76,42
s_add_u32 s42, s42, 786432
WL 10
MA 112,180,80
TR 204,9,6464
TR 206,9,9536
WL 10
MA 32,184,84
TR 160,8,12288
TR 162,8,15360
WL 10
MA 48,188,84
TR 164,9,12352
TR 166,9,15424
WL 10
MA 64,192,84
TR 168,8,12416
TR 170,8,15488
WL 10
MA 80,196,84
TR 172,9,12480
TR 174,9,15552
WL 10
MA 96,200,84
TR 176,8,12544
TR 178,8,15616
WL 10
MA 112,204,84
TR 180,9,12608
TR 182,9,15680
WV 6
s_barrier
v_add_u32 v6, 49152, v2
v_add_u32 v7, 49152, v3
WL 10
MA 32,160,88
TR 184,8,18432
TR 186,8,21504
WL 10
MA 48,164,88
TR 188,9,18496
TR 190,9,21568
s_add_u32 m0, s90, 0
s_nop 0
DM 10,76,42
WL 10
MA 64,168,88
TR 192,8,18560
TR 194,8,21632
WL 10
MA 80,172,88
TR 196,9,18624
TR 198,9,21696
WL 10
MA 96,176,88
TR 200,8,18688
TR 202,8,21760
s_add_u32 m0, s90, 1024
s_nop 0
DM 11,76,42
WL 10
MA 112,180,88
TR 204,9,18752
TR 206,9,21824
WL 10
MA 32,184,92
TR 160,6,0
TR 162,6,3072
WL 10
MA 48,188,92
TR 164,7,64
TR 166,7,3136
s_add_u32 m0, s90, 2048
s_nop 0
DM 12,76,42
WL 10
MA 64,192,92
TR 168,6,128
TR 170,6,3200
WL 10
MA 80,196,92
TR 172,7,192
TR 174,7,3264
WL 10
MA 96,200,92
TR 176,6,256
TR 178,6,3328
s_add_u32 m0, s90, 3072
s_nop 0
DM 13,76,42
WL 10
MA 112,204,92
TR 180,7,320
TR 182,7,3392
WL 10
MA 32,160,96
TR 184,6,6144
TR 186,6,9216
WL 10
MA 48,164,96
TR 188,7,6208
TR 190,7,9280
s_add_u32 m0, s90, 4096
s_nop 0
DM 14,76,42
WL 10
MA 64,168,96
TR 192,6,6272
TR 194,6,9344
WL 10
MA 80,172,96
TR 196,7,6336
TR 198,7,9408
WL 10
MA 96,176,96
TR 200,6,6400
TR 202,6,9472
s_add_u32 m0, s90, 5120
s_nop 0
DM 15,76,42
s_add_u32 s42, s42, 786432
WL 10
MA 112,180,96
TR 204,7,6464
TR 206,7,9536
WL 10
MA 32,184,100
TR 160,6,12288
TR 162,6,15360
WL 10
MA 48,188,100
TR 164,7,12352
TR 166,7,15424
WL 10
MA 64,192,100
TR 168,6,12416
TR 170,6,15488
WL 10
MA 80,196,100
TR 172,7,12480
TR 174,7,15552
WL 10
MA 96,200,100
TR 176,6,12544
TR 178,6,15616
WL 10
MA 112,204,100
TR 180,7,12608
TR 182,7,15680
WV 6
s_barrier
v_add_u32 v8, 73728, v2
v_add_u32 v9, 73728, v3
WL 10
MA 32,160,104
TR 184,6,18432
TR 186,6,21504
WL 10
MA 48,164,104
TR 188,7,18496
TR 190,7,21568
s_add_u32 m0, s90, 24576
s_nop 0
DM 10,76,42
WL 10
MA 64,168,104
TR 192,6,18560
TR 194,6,21632
WL 10
MA 80,172,104
TR 196,7,18624
TR 198,7,21696
WL 10
MA 96,176,104
TR 200,6,18688
TR 202,6,21760
s_add_u32 m0, s90, 25600
s_nop 0
DM 11,76,42
WL 10
MA 112,180,104
TR 204,7,18752
TR 206,7,21824
WL 10
MA 32,184,108
TR 160,8,0
TR 162,8,3072
WL 10
MA 48,188,108
TR 164,9,64
TR 166,9,3136
s_add_u32 m0, s90, 26624
s_nop 0
DM 12,76,42
WL 10
MA 64,192,108
TR 168,8,128
TR 170,8,3200
WL 10
MA 80,196,108
TR 172,9,192
TR 174,9,3264
WL 10
MA 96,200,108
TR 176,8,256
TR 178,8,3328
s_add_u32 m0, s90, 27648
s_nop 0
DM 13,76,42
WL 10
MA 112,204,108
TR 180,9,320
TR 182,9,3392
WL 10
MA 32,160,112
TR 184,8,6144
TR 186,8,9216
WL 10
MA 48,164,112
TR 188,9,6208
TR 190,9,9280
s_add_u32 m0, s90, 28672
s_nop 0
DM 14,76,42
WL 10
MA 64,168,112
TR 192,8,6272
TR 194,8,9344
WL 10
MA 80,172,112
TR 196,9,6336
TR 198,9,9408
WL 10
MA 96,176,112
TR 200,8,6400
TR 202,8,9472
s_add_u32 m0, s90, 29696
s_nop 0
DM 15,76,42
s_add_u32 s42, s42, 786432
WL 10
MA 112,180,112
TR 204,9,6464
TR 206,9,9536
WL 10
MA 32,184,116
TR 160,8,12288
TR 162,8,15360
WL 10
MA 48,188,116
TR 164,9,12352
TR 166,9,15424
WL 10
MA 64,192,116
TR 168,8,12416
TR 170,8,15488
WL 10
MA 80,196,116
TR 172,9,12480
TR 174,9,15552
WL 10
MA 96,200,116
TR 176,8,12544
TR 178,8,15616
WL 10
MA 112,204,116
TR 180,9,12608
TR 182,9,15680
WV 6
s_barrier
v_add_u32 v6, 0, v2
v_add_u32 v7, 0, v3
WL 10
MA 32,160,120
TR 184,8,18432
TR 186,8,21504
WL 10
MA 48,164,120
TR 188,9,18496
TR 190,9,21568
s_add_u32 m0, s91, 49152
s_nop 0
DM 16,80,46
WL 10
MA 64,168,120
TR 192,8,18560
TR 194,8,21632
WL 10
MA 80,172,120
TR 196,9,18624
TR 198,9,21696
WL 10
MA 96,176,120
TR 200,8,18688
TR 202,8,21760
s_add_u32 m0, s91, 50176
s_nop 0
DM 17,80,46
WL 10
MA 112,180,120
TR 204,9,18752
TR 206,9,21824
WL 10
MA 32,184,124
TR 160,6,0
TR 162,6,3072
WL 10
MA 48,188,124
TR 164,7,64
TR 166,7,3136
s_add_u32 m0, s91, 51200
s_nop 0
DM 18,80,46
WL 10
MA 64,192,124
TR 168,6,128
TR 170,6,3200
WL 10
MA 80,196,124
TR 172,7,192
TR 174,7,3264
WL 10
MA 96,200,124
TR 176,6,256
TR 178,6,3328
s_add_u32 m0, s91, 52224
s_nop 0
DM 19,80,46
WL 10
MA 112,204,124
TR 180,7,320
TR 182,7,3392
WL 10
MA 32,160,128
TR 184,6,6144
TR 186,6,9216
WL 10
MA 48,164,128
TR 188,7,6208
TR 190,7,9280
s_add_u32 m0, s91, 53248
s_nop 0
DM 20,80,46
s_add_u32 s46, s46, 81920
WL 10
MA 64,168,128
TR 192,6,6272
TR 194,6,9344
WL 10
MA 80,172,128
TR 196,7,6336
TR 198,7,9408
WL 10
MA 96,176,128
TR 200,6,6400
TR 202,6,9472
WL 10
MA 112,180,128
TR 204,7,6464
TR 206,7,9536
WL 10
MA 32,184,132
TR 160,6,12288
TR 162,6,15360
WL 10
MA 48,188,132
TR 164,7,12352
TR 166,7,15424
WL 10
MA 64,192,132
TR 168,6,12416
TR 170,6,15488
WL 10
MA 80,196,132
TR 172,7,12480
TR 174,7,15552
WL 10
MA 96,200,132
TR 176,6,12544
TR 178,6,15616
WL 10
MA 112,204,132
TR 180,7,12608
TR 182,7,15680
WV 5
s_barrier
v_add_u32 v8, 24576, v2
v_add_u32 v9, 24576, v3
WL 10
MA 32,160,136
TR 184,6,18432
TR 186,6,21504
WL 10
MA 48,164,136
TR 188,7,18496
TR 190,7,21568
s_add_u32 m0, s91, 73728
s_nop 0
DM 16,80,46
WL 10
MA 64,168,136
TR 192,6,18560
TR 194,6,21632
WL 10
MA 80,172,136
TR 196,7,18624
TR 198,7,21696
WL 10
MA 96,176,136
TR 200,6,18688
TR 202,6,21760
s_add_u32 m0, s91, 74752
s_nop 0
DM 17,80,46
WL 10
MA 112,180,136
TR 204,7,18752
TR 206,7,21824
WL 10
MA 32,184,140
TR 160,8,0
TR 162,8,3072
WL 10
MA 48,188,140
TR 164,9,64
TR 166,9,3136
s_add_u32 m0, s91, 75776
s_nop 0
DM 18,80,46
WL 10
MA 64,192,140
TR 168,8,128
TR 170,8,3200
WL 10
MA 80,196,140
TR 172,9,192
TR 174,9,3264
WL 10
MA 96,200,140
TR 176,8,256
TR 178,8,3328
s_add_u32 m0, s91, 76800
s_nop 0
DM 19,80,46
WL 10
MA 112,204,140
TR 180,9,320
TR 182,9,3392
WL 10
MA 32,160,144
TR 184,8,6144
TR 186,8,9216
WL 10
MA 48,164,144
TR 188,9,6208
TR 190,9,9280
s_add_u32 m0, s91, 77824
s_nop 0
DM 20,80,46
s_add_u32 s46, s46, 81920
WL 10
MA 64,168,144
TR 192,8,6272
TR 194,8,9344
WL 10
MA 80,172,144
TR 196,9,6336
TR 198,9,9408
WL 10
MA 96,176,144
TR 200,8,6400
TR 202,8,9472
WL 10
MA 112,180,144
TR 204,9,6464
TR 206,9,9536
WL 10
MA 32,184,148
TR 160,8,12288
TR 162,8,15360
WL 10
MA 48,188,148
TR 164,9,12352
TR 166,9,15424
WL 10
MA 64,192,148
TR 168,8,12416
TR 170,8,15488
WL 10
MA 80,196,148
TR 172,9,12480
TR 174,9,15552
WL 10
MA 96,200,148
TR 176,8,12544
TR 178,8,15616
WL 10
MA 112,204,148
TR 180,9,12608
TR 182,9,15680
WV 5
s_barrier
v_add_u32 v6, 49152, v4
WL 10
MA 32,160,152
TR 184,8,18432
TR 186,8,21504
WL 10
MA 48,164,152
TR 188,9,18496
TR 190,9,21568
s_add_u32 m0, s91, 0
s_nop 0
DM 16,80,46
WL 10
MA 64,168,152
TR 192,8,18560
TR 194,8,21632
WL 10
MA 80,172,152
TR 196,9,18624
TR 198,9,21696
WL 10
MA 96,176,152
TR 200,8,18688
TR 202,8,21760
s_add_u32 m0, s91, 1024
s_nop 0
DM 17,80,46
WL 10
MA 112,180,152
TR 204,9,18752
TR 206,9,21824
WL 10
MA 32,184,156
TR 160,6,0
TR 162,6,2560
WL 10
MA 48,188,156
TR 164,6,64
TR 166,6,2624
s_add_u32 m0, s91, 2048
s_nop 0
DM 18,80,46
WL 10
MA 64,192,156
TR 168,6,128
TR 170,6,2688
WL 10
MA 80,196,156
TR 172,6,192
TR 174,6,2752
WL 10
MA 96,200,156
TR 176,6,256
TR 178,6,2816
s_add_u32 m0, s91, 3072
s_nop 0
DM 19,80,46
WL 10
MA 112,204,156
s_nop 7
s_nop 7
CV 128,32,33
CV 129,34,35
CV 130,36,37
CV 131,38,39
CV 132,40,41
CV 133,42,43
CV 134,44,45
CV 135,46,47
CV 136,48,49
CV 137,50,51
CV 138,52,53
CV 139,54,55
CV 140,56,57
CV 141,58,59
CV 142,60,61
CV 143,62,63
CV 144,64,65
CV 145,66,67
CV 146,68,69
CV 147,70,71
CV 148,72,73
CV 149,74,75
CV 150,76,77
CV 151,78,79
CV 152,80,81
CV 153,82,83
CV 154,84,85
CV 155,86,87
CV 156,88,89
CV 157,90,91
CV 158,92,93
CV 159,94,95
CV 160,96,97
CV 161,98,99
CV 162,100,101
CV 163,102,103
CV 164,104,105
CV 165,106,107
CV 166,108,109
CV 167,110,111
CV 168,112,113
CV 169,114,115
CV 170,116,117
CV 171,118,119
CV 172,120,121
CV 173,122,123
CV 174,124,125
CV 175,126,127
s_nop 1
WL 8
v_mfma_f32_32x32x16_bf16 v[32:47], v[128:131], a[160:163], 0
TR 184,6,5120
TR 186,6,7680
WL 8
v_mfma_f32_32x32x16_bf16 v[48:63], v[128:131], a[164:167], 0
TR 188,6,5184
TR 190,6,7744
s_add_u32 m0, s91, 4096
s_nop 0
DM 20,80,46
s_add_u32 s46, s46, -163520
WL 8
v_mfma_f32_32x32x16_bf16 v[64:79], v[128:131], a[168:171], 0
TR 192,6,5248
TR 194,6,7808
WL 8
v_mfma_f32_32x32x16_bf16 v[80:95], v[128:131], a[172:175], 0
TR 196,6,5312
TR 198,6,7872
WL 8
v_mfma_f32_32x32x16_bf16 v[96:111], v[128:131], a[176:179], 0
TR 200,6,5376
TR 202,6,7936
WL 8
MB 32,132,184
TR 160,6,10240
TR 162,6,12800
WL 8
MB 48,132,188
TR 164,6,10304
TR 166,6,12864
WL 8
MB 64,132,192
TR 168,6,10368
TR 170,6,12928
WL 8
MB 80,132,196
TR 172,6,10432
TR 174,6,12992
WL 8
MB 96,132,200
TR 176,6,10496
TR 178,6,13056
WV 5
s_barrier
v_add_u32 v8, 73728, v4
WL 8
MB 32,136,160
TR 184,6,15360
TR 186,6,17920
WL 8
MB 48,136,164
TR 188,6,15424
TR 190,6,17984
s_add_u32 m0, s91, 24576
s_nop 0
DM 16,80,46
WL 8
MB 64,136,168
TR 192,6,15488
TR 194,6,18048
WL 8
MB 80,136,172
TR 196,6,15552
TR 198,6,18112
WL 8
MB 96,136,176
TR 200,6,15616
TR 202,6,18176
s_add_u32 m0, s91, 25600
s_nop 0
DM 17,80,46
WL 8
MB 32,140,184
TR 160,8,0
TR 162,8,2560
WL 8
MB 48,140,188
TR 164,8,64
TR 166,8,2624
s_add_u32 m0, s91, 26624
s_nop 0
DM 18,80,46
WL 8
MB 64,140,192
TR 168,8,128
TR 170,8,2688
WL 8
MB 80,140,196
TR 172,8,192
TR 174,8,2752
WL 8
MB 96,140,200
TR 176,8,256
TR 178,8,2816
s_add_u32 m0, s91, 27648
s_nop 0
DM 19,80,46
WL 8
MB 32,144,160
TR 184,8,5120
TR 186,8,7680
WL 8
MB 48,144,164
TR 188,8,5184
TR 190,8,7744
s_add_u32 m0, s91, 28672
s_nop 0
DM 20,80,46
s_add_u32 s46, s46, 81920
WL 8
MB 64,144,168
TR 192,8,5248
TR 194,8,7808
WL 8
MB 80,144,172
TR 196,8,5312
TR 198,8,7872
WL 8
MB 96,144,176
TR 200,8,5376
TR 202,8,7936
WL 8
MB 32,148,184
TR 160,8,10240
TR 162,8,12800
WL 8
MB 48,148,188
TR 164,8,10304
TR 166,8,12864
WL 8
MB 64,148,192
TR 168,8,10368
TR 170,8,12928
WL 8
MB 80,148,196
TR 172,8,10432
TR 174,8,12992
WL 8
MB 96,148,200
TR 176,8,10496
TR 178,8,13056
WV 5
s_barrier
v_add_u32 v6, 0, v4
WL 8
MB 32,152,160
TR 184,8,15360
TR 186,8,17920
WL 8
MB 48,152,164
TR 188,8,15424
TR 190,8,17984
s_add_u32 m0, s91, 49152
s_nop 0
DM 16,80,46
WL 8
MB 64,152,168
TR 192,8,15488
TR 194,8,18048
WL 8
MB 80,152,172
TR 196,8,15552
TR 198,8,18112
WL 8
MB 96,152,176
TR 200,8,15616
TR 202,8,18176
s_add_u32 m0, s91, 50176
s_nop 0
DM 17,80,46
WL 8
MB 32,156,184
TR 160,6,0
TR 162,6,2560
WL 8
MB 48,156,188
TR 164,6,64
TR 166,6,2624
s_add_u32 m0, s91, 51200
s_nop 0
DM 18,80,46
WL 8
MB 64,156,192
TR 168,6,128
TR 170,6,2688
WL 8
MB 80,156,196
TR 172,6,192
TR 174,6,2752
WL 8
MB 96,156,200
TR 176,6,256
TR 178,6,2816
s_add_u32 m0, s91, 52224
s_nop 0
DM 19,80,46
WL 8
MB 32,160,160
TR 184,6,5120
TR 186,6,7680
WL 8
MB 48,160,164
TR 188,6,5184
TR 190,6,7744
s_add_u32 m0, s91, 53248
s_nop 0
DM 20,80,46
s_add_u32 s46, s46, 81920
WL 8
MB 64,160,168
TR 192,6,5248
TR 194,6,7808
WL 8
MB 80,160,172
TR 196,6,5312
TR 198,6,7872
WL 8
MB 96,160,176
TR 200,6,5376
TR 202,6,7936
WL 8
MB 32,164,184
TR 160,6,10240
TR 162,6,12800
WL 8
MB 48,164,188
TR 164,6,10304
TR 166,6,12864
WL 8
MB 64,164,192
TR 168,6,10368
TR 170,6,12928
WL 8
MB 80,164,196
TR 172,6,10432
TR 174,6,12992
WL 8
MB 96,164,200
TR 176,6,10496
TR 178,6,13056
WV 5
s_barrier
v_add_u32 v8, 24576, v4
WL 8
MB 32,168,160
TR 184,6,15360
TR 186,6,17920
WL 8
MB 48,168,164
TR 188,6,15424
TR 190,6,17984
s_add_u32 m0, s91, 73728
s_nop 0
DM 16,80,46
WL 8
MB 64,168,168
TR 192,6,15488
TR 194,6,18048
WL 8
MB 80,168,172
TR 196,6,15552
TR 198,6,18112
WL 8
MB 96,168,176
TR 200,6,15616
TR 202,6,18176
s_add_u32 m0, s91, 74752
s_nop 0
DM 17,80,46
WL 8
MB 32,172,184
TR 160,8,0
TR 162,8,2560
WL 8
MB 48,172,188
TR 164,8,64
TR 166,8,2624
s_add_u32 m0, s91, 75776
s_nop 0
DM 18,80,46
WL 8
MB 64,172,192
TR 168,8,128
TR 170,8,2688
WL 8
MB 80,172,196
TR 172,8,192
TR 174,8,2752
WL 8
MB 96,172,200
TR 176,8,256
TR 178,8,2816
s_add_u32 m0, s91, 76800
s_nop 0
DM 19,80,46
WL 8
v_mfma_f32_32x32x16_bf16 v[176:191], v[128:131], a[160:163], 0
TR 184,8,5120
TR 186,8,7680
WL 8
v_mfma_f32_32x32x16_bf16 v[192:207], v[128:131], a[164:167], 0
TR 188,8,5184
TR 190,8,7744
s_add_u32 m0, s91, 77824
s_nop 0
DM 20,80,46
s_add_u32 s46, s46, -163520
WL 8
v_mfma_f32_32x32x16_bf16 v[208:223], v[128:131], a[168:171], 0
TR 192,8,5248
TR 194,8,7808
WL 8
v_mfma_f32_32x32x16_bf16 v[224:239], v[128:131], a[172:175], 0
TR 196,8,5312
TR 198,8,7872
WL 8
v_mfma_f32_32x32x16_bf16 v[240:255], v[128:131], a[176:179], 0
TR 200,8,5376
TR 202,8,7936
WL 8
MB 176,132,184
TR 160,8,10240
TR 162,8,12800
CV 112,32,33
CV 113,34,35
WL 8
MB 192,132,188
TR 164,8,10304
TR 166,8,12864
CV 114,36,37
CV 115,38,39
WL 8
MB 208,132,192
TR 168,8,10368
TR 170,8,12928
CV 116,40,41
CV 117,42,43
WL 8
MB 224,132,196
TR 172,8,10432
TR 174,8,12992
CV 118,44,45
CV 119,46,47
WL 8
MB 240,132,200
TR 176,8,10496
TR 178,8,13056
s_add_u32 s48, s47, 0
s_nop 0
WV 5
s_barrier
v_add_u32 v6, 49152, v4
WL 8
MB 176,136,160
TR 184,8,15360
TR 186,8,17920
v_permlane32_swap_b32 v112, v114
v_permlane32_swap_b32 v113, v115
WL 8
MB 192,136,164
TR 188,8,15424
TR 190,8,17984
s_add_u32 m0, s91, 0
s_nop 0
DM 16,80,46
v_permlane32_swap_b32 v116, v118
v_permlane32_swap_b32 v117, v119
WL 8
MB 208,136,168
TR 192,8,15488
TR 194,8,18048
buffer_store_dwordx4 v[112:115], v21, s[8:11], s48 offen sc1
buffer_store_dwordx4 v[116:119], v21, s[8:11], s48 offen offset:512 sc1
WL 8
MB 224,136,172
TR 196,8,15552
TR 198,8,18112
CV 120,48,49
CV 121,50,51
WL 8
MB 240,136,176
TR 200,8,15616
TR 202,8,18176
s_add_u32 m0, s91, 1024
s_nop 0
DM 17,80,46
CV 122,52,53
CV 123,54,55
WL 8
MB 176,140,184
TR 160,6,0
TR 162,6,2560
CV 124,56,57
CV 125,58,59
WL 8
MB 192,140,188
TR 164,6,64
TR 166,6,2624
s_add_u32 m0, s91, 2048
s_nop 0
DM 18,80,46
CV 126,60,61
CV 127,62,63
WL 8
MB 208,140,192
TR 168,6,128
TR 170,6,2688
s_add_u32 s48, s47, 65536
s_nop 0
WL 8
MB 224,140,196
TR 172,6,192
TR 174,6,2752
v_permlane32_swap_b32 v120, v122
v_permlane32_swap_b32 v121, v123
WL 8
MB 240,140,200
TR 176,6,256
TR 178,6,2816
s_add_u32 m0, s91, 3072
s_nop 0
DM 19,80,46
v_permlane32_swap_b32 v124, v126
v_permlane32_swap_b32 v125, v127
WL 8
MB 176,144,160
TR 184,6,5120
TR 186,6,7680
buffer_store_dwordx4 v[120:123], v21, s[8:11], s48 offen sc1
buffer_store_dwordx4 v[124:127], v21, s[8:11], s48 offen offset:512 sc1
WL 8
MB 192,144,164
TR 188,6,5184
TR 190,6,7744
s_add_u32 m0, s91, 4096
s_nop 0
DM 20,80,46
s_add_u32 s46, s46, 81920
CV 112,64,65
CV 113,66,67
WL 8
MB 208,144,168
TR 192,6,5248
TR 194,6,7808
CV 114,68,69
CV 115,70,71
WL 8
MB 224,144,172
TR 196,6,5312
TR 198,6,7872
CV 116,72,73
CV 117,74,75
WL 8
MB 240,144,176
TR 200,6,5376
TR 202,6,7936
CV 118,76,77
CV 119,78,79
WL 8
MB 176,148,184
TR 160,6,10240
TR 162,6,12800
s_add_u32 s48, s47, 131072
s_nop 0
WL 8
MB 192,148,188
TR 164,6,10304
TR 166,6,12864
v_permlane32_swap_b32 v112, v114
v_permlane32_swap_b32 v113, v115
WL 8
MB 208,148,192
TR 168,6,10368
TR 170,6,12928
v_permlane32_swap_b32 v116, v118
v_permlane32_swap_b32 v117, v119
WL 8
MB 224,148,196
TR 172,6,10432
TR 174,6,12992
buffer_store_dwordx4 v[112:115], v21, s[8:11], s48 offen sc1
buffer_store_dwordx4 v[116:119], v21, s[8:11], s48 offen offset:512 sc1
WL 8
MB 240,148,200
TR 176,6,10496
TR 178,6,13056
CV 120,80,81
CV 121,82,83
WV 11
s_barrier
v_add_u32 v8, 73728, v4
WL 8
MB 176,152,160
TR 184,6,15360
TR 186,6,17920
CV 122,84,85
CV 123,86,87
WL 8
MB 192,152,164
TR 188,6,15424
TR 190,6,17984
s_add_u32 m0, s91, 24576
s_nop 0
DM 16,80,46
CV 124,88,89
CV 125,90,91
WL 8
MB 208,152,168
TR 192,6,15488
TR 194,6,18048
CV 126,92,93
CV 127,94,95
WL 8
MB 224,152,172
TR 196,6,15552
TR 198,6,18112
s_add_u32 s48, s47, 196608
s_nop 0
WL 8
MB 240,152,176
TR 200,6,15616
TR 202,6,18176
s_add_u32 m0, s91, 25600
s_nop 0
DM 17,80,46
v_permlane32_swap_b32 v120, v122
v_permlane32_swap_b32 v121, v123
WL 8
MB 176,156,184
TR 160,8,0
TR 162,8,2560
v_permlane32_swap_b32 v124, v126
v_permlane32_swap_b32 v125, v127
WL 8
MB 192,156,188
TR 164,8,64
TR 166,8,2624
s_add_u32 m0, s91, 26624
s_nop 0
DM 18,80,46
buffer_store_dwordx4 v[120:123], v21, s[8:11], s48 offen sc1
buffer_store_dwordx4 v[124:127], v21, s[8:11], s48 offen offset:512 sc1
WL 8
MB 208,156,192
TR 168,8,128
TR 170,8,2688
CV 112,96,97
CV 113,98,99
WL 8
MB 224,156,196
TR 172,8,192
TR 174,8,2752
CV 114,100,101
CV 115,102,103
WL 8
MB 240,156,200
TR 176,8,256
TR 178,8,2816
s_add_u32 m0, s91, 27648
s_nop 0
DM 19,80,46
CV 116,104,105
CV 117,106,107
WL 8
MB 176,160,160
TR 184,8,5120
TR 186,8,7680
CV 118,108,109
CV 119,110,111
WL 8
MB 192,160,164
TR 188,8,5184
TR 190,8,7744
s_add_u32 m0, s91, 28672
s_nop 0
DM 20,80,46
s_add_u32 s46, s46, 81920
s_add_u32 s48, s47, 262144
s_nop 0
WL 8
MB 208,160,168
TR 192,8,5248
TR 194,8,7808
v_permlane32_swap_b32 v112, v114
v_permlane32_swap_b32 v113, v115
WL 8
MB 224,160,172
TR 196,8,5312
TR 198,8,7872
v_permlane32_swap_b32 v116, v118
v_permlane32_swap_b32 v117, v119
WL 8
MB 240,160,176
TR 200,8,5376
TR 202,8,7936
buffer_store_dwordx4 v[112:115], v21, s[8:11], s48 offen sc1
buffer_store_dwordx4 v[116:119], v21, s[8:11], s48 offen offset:512 sc1
WL 8
MB 176,164,184
TR 160,8,10240
TR 162,8,12800
WL 8
MB 192,164,188
TR 164,8,10304
TR 166,8,12864
WL 8
MB 208,164,192
TR 168,8,10368
TR 170,8,12928
WL 8
MB 224,164,196
TR 172,8,10432
TR 174,8,12992
WL 8
MB 240,164,200
TR 176,8,10496
TR 178,8,13056
WV 11
s_barrier
v_add_u32 v6, 0, v4
WL 8
MB 176,168,160
TR 184,8,15360
TR 186,8,17920
WL 8
MB 192,168,164
TR 188,8,15424
TR 190,8,17984
s_add_u32 m0, s91, 49152
s_nop 0
DM 16,80,46
WL 8
MB 208,168,168
TR 192,8,15488
TR 194,8,18048
WL 8
MB 224,168,172
TR 196,8,15552
TR 198,8,18112
WL 8
MB 240,168,176
TR 200,8,15616
TR 202,8,18176
s_add_u32 m0, s91, 50176
s_nop 0
DM 17,80,46
WL 8
MB 176,172,184
TR 160,6,0
TR 162,6,2560
WL 8
MB 192,172,188
TR 164,6,64
TR 166,6,2624
s_add_u32 m0, s91, 51200
s_nop 0
DM 18,80,46
WL 8
MB 208,172,192
TR 168,6,128
TR 170,6,2688
WL 8
MB 224,172,196
TR 172,6,192
TR 174,6,2752
WL 8
MB 240,172,200
TR 176,6,256
TR 178,6,2816
s_add_u32 m0, s91, 52224
s_nop 0
DM 19,80,46
WL 8
v_mfma_f32_32x32x16_bf16 v[32:47], v[128:131], a[160:163], 0
TR 184,6,5120
TR 186,6,7680
WL 8
v_mfma_f32_32x32x16_bf16 v[48:63], v[128:131], a[164:167], 0
TR 188,6,5184
TR 190,6,7744
s_add_u32 m0, s91, 53248
s_nop 0
DM 20,80,46
s_add_u32 s46, s46, -163520
WL 8
v_mfma_f32_32x32x16_bf16 v[64:79], v[128:131], a[168:171], 0
TR 192,6,5248
TR 194,6,7808
WL 8
v_mfma_f32_32x32x16_bf16 v[80:95], v[128:131], a[172:175], 0
TR 196,6,5312
TR 198,6,7872
WL 8
v_mfma_f32_32x32x16_bf16 v[96:111], v[128:131], a[176:179], 0
TR 200,6,5376
TR 202,6,7936
WL 8
MB 32,132,184
TR 160,6,10240
TR 162,6,12800
CV 112,176,177
CV 113,178,179
WL 8
MB 48,132,188
TR 164,6,10304
TR 166,6,12864
CV 114,180,181
CV 115,182,183
WL 8
MB 64,132,192
TR 168,6,10368
TR 170,6,12928
CV 116,184,185
CV 117,186,187
WL 8
MB 80,132,196
TR 172,6,10432
TR 174,6,12992
CV 118,188,189
CV 119,190,191
WL 8
MB 96,132,200
TR 176,6,10496
TR 178,6,13056
s_add_u32 s48, s47, 327680
s_nop 0
WV 7
s_barrier
v_add_u32 v8, 24576, v4
WL 8
MB 32,136,160
TR 184,6,15360
TR 186,6,17920
v_permlane32_swap_b32 v112, v114
v_permlane32_swap_b32 v113, v115
WL 8
MB 48,136,164
TR 188,6,15424
TR 190,6,17984
s_add_u32 m0, s91, 73728
s_nop 0
DM 16,80,46
v_permlane32_swap_b32 v116, v118
v_permlane32_swap_b32 v117, v119
WL 8
MB 64,136,168
TR 192,6,15488
TR 194,6,18048
buffer_store_dwordx4 v[112:115], v21, s[8:11], s48 offen sc1
buffer_store_dwordx4 v[116:119], v21, s[8:11], s48 offen offset:512 sc1
WL 8
MB 80,136,172
TR 196,6,15552
TR 198,6,18112
CV 120,192,193
CV 121,194,195
WL 8
MB 96,136,176
TR 200,6,15616
TR 202,6,18176
s_add_u32 m0, s91, 74752
s_nop 0
DM 17,80,46
CV 122,196,197
CV 123,198,199
WL 8
MB 32,140,184
TR 160,8,0
TR 162,8,2560
CV 124,200,201
CV 125,202,203
WL 8
MB 48,140,188
TR 164,8,64
TR 166,8,2624
s_add_u32 m0, s91, 75776
s_nop 0
DM 18,80,46
CV 126,204,205
CV 127,206,207
WL 8
MB 64,140,192
TR 168,8,128
TR 170,8,2688
s_add_u32 s48, s47, 393216
s_nop 0
WL 8
MB 80,140,196
TR 172,8,192
TR 174,8,2752
v_permlane32_swap_b32 v120, v122
v_permlane32_swap_b32 v121, v123
WL 8
MB 96,140,200
TR 176,8,256
TR 178,8,2816
s_add_u32 m0, s91, 76800
s_nop 0
DM 19,80,46
v_permlane32_swap_b32 v124, v126
v_permlane32_swap_b32 v125, v127
WL 8
MB 32,144,160
TR 184,8,5120
TR 186,8,7680
buffer_store_dwordx4 v[120:123], v21, s[8:11], s48 offen sc1
buffer_store_dwordx4 v[124:127], v21, s[8:11], s48 offen offset:512 sc1
WL 8
MB 48,144,164
TR 188,8,5184
TR 190,8,7744
s_add_u32 m0, s91, 77824
s_nop 0
DM 20,80,46
s_add_u32 s46, s46, 81920
CV 112,208,209
CV 113,210,211
WL 8
MB 64,144,168
TR 192,8,5248
TR 194,8,7808
CV 114,212,213
CV 115,214,215
WL 8
MB 80,144,172
TR 196,8,5312
TR 198,8,7872
CV 116,216,217
CV 117,218,219
WL 8
MB 96,144,176
TR 200,8,5376
TR 202,8,7936
CV 118,220,221
CV 119,222,223
WL 8
MB 32,148,184
TR 160,8,10240
TR 162,8,12800
s_add_u32 s48, s47, 458752
s_nop 0
WL 8
MB 48,148,188
TR 164,8,10304
TR 166,8,12864
v_permlane32_swap_b32 v112, v114
v_permlane32_swap_b32 v113, v115
WL 8
MB 64,148,192
TR 168,8,10368
TR 170,8,12928
v_permlane32_swap_b32 v116, v118
v_permlane32_swap_b32 v117, v119
WL 8
MB 80,148,196
TR 172,8,10432
TR 174,8,12992
buffer_store_dwordx4 v[112:115], v21, s[8:11], s48 offen sc1
buffer_store_dwordx4 v[116:119], v21, s[8:11], s48 offen offset:512 sc1
WL 8
MB 96,148,200
TR 176,8,10496
TR 178,8,13056
CV 120,224,225
CV 121,226,227
WV 11
s_barrier
v_add_u32 v6, 49152, v4
WL 8
MB 32,152,160
TR 184,8,15360
TR 186,8,17920
CV 122,228,229
CV 123,230,231
WL 8
MB 48,152,164
TR 188,8,15424
TR 190,8,17984
s_add_u32 m0, s91, 0
s_nop 0
DM 16,80,46
CV 124,232,233
CV 125,234,235
WL 8
MB 64,152,168
TR 192,8,15488
TR 194,8,18048
CV 126,236,237
CV 127,238,239
WL 8
MB 80,152,172
TR 196,8,15552
TR 198,8,18112
s_add_u32 s48, s47, 524288
s_nop 0
WL 8
MB 96,152,176
TR 200,8,15616
TR 202,8,18176
s_add_u32 m0, s91, 1024
s_nop 0
DM 17,80,46
v_permlane32_swap_b32 v120, v122
v_permlane32_swap_b32 v121, v123
WL 8
MB 32,156,184
TR 160,6,0
TR 162,6,2560
v_permlane32_swap_b32 v124, v126
v_permlane32_swap_b32 v125, v127
WL 8
MB 48,156,188
TR 164,6,64
TR 166,6,2624
s_add_u32 m0, s91, 2048
s_nop 0
DM 18,80,46
buffer_store_dwordx4 v[120:123], v21, s[8:11], s48 offen sc1
buffer_store_dwordx4 v[124:127], v21, s[8:11], s48 offen offset:512 sc1
WL 8
MB 64,156,192
TR 168,6,128
TR 170,6,2688
CV 112,240,241
CV 113,242,243
WL 8
MB 80,156,196
TR 172,6,192
TR 174,6,2752
CV 114,244,245
CV 115,246,247
WL 8
MB 96,156,200
TR 176,6,256
TR 178,6,2816
s_add_u32 m0, s91, 3072
s_nop 0
DM 19,80,46
CV 116,248,249
CV 117,250,251
WL 8
MB 32,160,160
TR 184,6,5120
TR 186,6,7680
CV 118,252,253
CV 119,254,255
WL 8
MB 48,160,164
TR 188,6,5184
TR 190,6,7744
s_add_u32 m0, s91, 4096
s_nop 0
DM 20,80,46
s_add_u32 s46, s46, 81920
s_add_u32 s48, s47, 589824
s_nop 0
WL 8
MB 64,160,168
TR 192,6,5248
TR 194,6,7808
v_permlane32_swap_b32 v112, v114
v_permlane32_swap_b32 v113, v115
WL 8
MB 80,160,172
TR 196,6,5312
TR 198,6,7872
v_permlane32_swap_b32 v116, v118
v_permlane32_swap_b32 v117, v119
WL 8
MB 96,160,176
TR 200,6,5376
TR 202,6,7936
buffer_store_dwordx4 v[112:115], v21, s[8:11], s48 offen sc1
buffer_store_dwordx4 v[116:119], v21, s[8:11], s48 offen offset:512 sc1
WL 8
MB 32,164,184
TR 160,6,10240
TR 162,6,12800
WL 8
MB 48,164,188
TR 164,6,10304
TR 166,6,12864
WL 8
MB 64,164,192
TR 168,6,10368
TR 170,6,12928
WL 8
MB 80,164,196
TR 172,6,10432
TR 174,6,12992
WL 8
MB 96,164,200
TR 176,6,10496
TR 178,6,13056
WV 11
s_barrier
v_add_u32 v8, 73728, v4
WL 8
MB 32,168,160
TR 184,6,15360
TR 186,6,17920
WL 8
MB 48,168,164
TR 188,6,15424
TR 190,6,17984
s_add_u32 m0, s91, 24576
s_nop 0
DM 16,80,46
WL 8
MB 64,168,168
TR 192,6,15488
TR 194,6,18048
WL 8
MB 80,168,172
TR 196,6,15552
TR 198,6,18112
WL 8
MB 96,168,176
TR 200,6,15616
TR 202,6,18176
s_add_u32 m0, s91, 25600
s_nop 0
DM 17,80,46
WL 8
MB 32,172,184
TR 160,8,0
TR 162,8,2560
WL 8
MB 48,172,188
TR 164,8,64
TR 166,8,2624
s_add_u32 m0, s91, 26624
s_nop 0
DM 18,80,46
WL 8
MB 64,172,192
TR 168,8,128
TR 170,8,2688
WL 8
MB 80,172,196
TR 172,8,192
TR 174,8,2752
WL 8
MB 96,172,200
TR 176,8,256
TR 178,8,2816
s_add_u32 m0, s91, 27648
s_nop 0
DM 19,80,46
WL 8
v_mfma_f32_32x32x16_bf16 v[176:191], v[128:131], a[160:163], 0
TR 184,8,5120
TR 186,8,7680
WL 8
v_mfma_f32_32x32x16_bf16 v[192:207], v[128:131], a[164:167], 0
TR 188,8,5184
TR 190,8,7744
s_add_u32 m0, s91, 28672
s_nop 0
DM 20,80,46
s_add_u32 s46, s46, -163520
WL 8
v_mfma_f32_32x32x16_bf16 v[208:223], v[128:131], a[168:171], 0
TR 192,8,5248
TR 194,8,7808
WL 8
v_mfma_f32_32x32x16_bf16 v[224:239], v[128:131], a[172:175], 0
TR 196,8,5312
TR 198,8,7872
WL 8
v_mfma_f32_32x32x16_bf16 v[240:255], v[128:131], a[176:179], 0
TR 200,8,5376
TR 202,8,7936
WL 8
MB 176,132,184
TR 160,8,10240
TR 162,8,12800
CV 112,32,33
CV 113,34,35
WL 8
MB 192,132,188
TR 164,8,10304
TR 166,8,12864
CV 114,36,37
CV 115,38,39
WL 8
MB 208,132,192
TR 168,8,10368
TR 170,8,12928
CV 116,40,41
CV 117,42,43
WL 8
MB 224,132,196
TR 172,8,10432
TR 174,8,12992
CV 118,44,45
CV 119,46,47
WL 8
MB 240,132,200
TR 176,8,10496
TR 178,8,13056
s_add_u32 s48, s47, 655360
s_nop 0
WV 7
s_barrier
v_add_u32 v6, 0, v4
WL 8
MB 176,136,160
TR 184,8,15360
TR 186,8,17920
v_permlane32_swap_b32 v112, v114
v_permlane32_swap_b32 v113, v115
WL 8
MB 192,136,164
TR 188,8,15424
TR 190,8,17984
v_permlane32_swap_b32 v116, v118
v_permlane32_swap_b32 v117, v119
WL 8
MB 208,136,168
TR 192,8,15488
TR 194,8,18048
buffer_store_dwordx4 v[112:115], v21, s[8:11], s48 offen sc1
buffer_store_dwordx4 v[116:119], v21, s[8:11], s48 offen offset:512 sc1
WL 8
MB 224,136,172
TR 196,8,15552
TR 198,8,18112
CV 120,48,49
CV 121,50,51
WL 8
MB 240,136,176
TR 200,8,15616
TR 202,8,18176
CV 122,52,53
CV 123,54,55
WL 8
MB 176,140,184
TR 160,6,0
TR 162,6,2560
CV 124,56,57
CV 125,58,59
WL 8
MB 192,140,188
TR 164,6,64
TR 166,6,2624
CV 126,60,61
CV 127,62,63
WL 8
MB 208,140,192
TR 168,6,128
TR 170,6,2688
s_add_u32 s48, s47, 720896
s_nop 0
WL 8
MB 224,140,196
TR 172,6,192
TR 174,6,2752
v_permlane32_swap_b32 v120, v122
v_permlane32_swap_b32 v121, v123
WL 8
MB 240,140,200
TR 176,6,256
TR 178,6,2816
v_permlane32_swap_b32 v124, v126
v_permlane32_swap_b32 v125, v127
WL 8
MB 176,144,160
TR 184,6,5120
TR 186,6,7680
buffer_store_dwordx4 v[120:123], v21, s[8:11], s48 offen sc1
buffer_store_dwordx4 v[124:127], v21, s[8:11], s48 offen offset:512 sc1
WL 8
MB 192,144,164
TR 188,6,5184
TR 190,6,7744
CV 112,64,65
CV 113,66,67
WL 8
MB 208,144,168
TR 192,6,5248
TR 194,6,7808
CV 114,68,69
CV 115,70,71
WL 8
MB 224,144,172
TR 196,6,5312
TR 198,6,7872
CV 116,72,73
CV 117,74,75
WL 8
MB 240,144,176
TR 200,6,5376
TR 202,6,7936
CV 118,76,77
CV 119,78,79
WL 8
MB 176,148,184
TR 160,6,10240
TR 162,6,12800
s_add_u32 s48, s47, 786432
s_nop 0
WL 8
MB 192,148,188
TR 164,6,10304
TR 166,6,12864
v_permlane32_swap_b32 v112, v114
v_permlane32_swap_b32 v113, v115
WL 8
MB 208,148,192
TR 168,6,10368
TR 170,6,12928
v_permlane32_swap_b32 v116, v118
v_permlane32_swap_b32 v117, v119
WL 8
MB 224,148,196
TR 172,6,10432
TR 174,6,12992
buffer_store_dwordx4 v[112:115], v21, s[8:11], s48 offen sc1
buffer_store_dwordx4 v[116:119], v21, s[8:11], s48 offen offset:512 sc1
WL 8
MB 240,148,200
TR 176,6,10496
TR 178,6,13056
CV 120,80,81
CV 121,82,83
WV 6
s_barrier
v_add_u32 v8, 24576, v4
WL 8
MB 176,152,160
TR 184,6,15360
TR 186,6,17920
CV 122,84,85
CV 123,86,87
WL 8
MB 192,152,164
TR 188,6,15424
TR 190,6,17984
CV 124,88,89
CV 125,90,91
WL 8
MB 208,152,168
TR 192,6,15488
TR 194,6,18048
CV 126,92,93
CV 127,94,95
WL 8
MB 224,152,172
TR 196,6,15552
TR 198,6,18112
s_add_u32 s48, s47, 851968
s_nop 0
WL 8
MB 240,152,176
TR 200,6,15616
TR 202,6,18176
v_permlane32_swap_b32 v120, v122
v_permlane32_swap_b32 v121, v123
WL 8
MB 176,156,184
TR 160,8,0
TR 162,8,2560
v_permlane32_swap_b32 v124, v126
v_permlane32_swap_b32 v125, v127
WL 8
MB 192,156,188
TR 164,8,64
TR 166,8,2624
buffer_store_dwordx4 v[120:123], v21, s[8:11], s48 offen sc1
buffer_store_dwordx4 v[124:127], v21, s[8:11], s48 offen offset:512 sc1
WL 8
MB 208,156,192
TR 168,8,128
TR 170,8,2688
CV 112,96,97
CV 113,98,99
WL 8
MB 224,156,196
TR 172,8,192
TR 174,8,2752
CV 114,100,101
CV 115,102,103
WL 8
MB 240,156,200
TR 176,8,256
TR 178,8,2816
CV 116,104,105
CV 117,106,107
WL 8
MB 176,160,160
TR 184,8,5120
TR 186,8,7680
CV 118,108,109
CV 119,110,111
WL 8
MB 192,160,164
TR 188,8,5184
TR 190,8,7744
s_add_u32 s48, s47, 917504
s_nop 0
WL 8
MB 208,160,168
TR 192,8,5248
TR 194,8,7808
v_permlane32_swap_b32 v112, v114
v_permlane32_swap_b32 v113, v115
WL 8
MB 224,160,172
TR 196,8,5312
TR 198,8,7872
v_permlane32_swap_b32 v116, v118
v_permlane32_swap_b32 v117, v119
WL 8
MB 240,160,176
TR 200,8,5376
TR 202,8,7936
buffer_store_dwordx4 v[112:115], v21, s[8:11], s48 offen sc1
buffer_store_dwordx4 v[116:119], v21, s[8:11], s48 offen offset:512 sc1
WL 8
MB 176,164,184
TR 160,8,10240
TR 162,8,12800
WL 8
MB 192,164,188
TR 164,8,10304
TR 166,8,12864
WL 8
MB 208,164,192
TR 168,8,10368
TR 170,8,12928
WL 8
MB 224,164,196
TR 172,8,10432
TR 174,8,12992
WL 8
MB 240,164,200
TR 176,8,10496
TR 178,8,13056
WL 8
MB 176,168,160
TR 184,8,15360
TR 186,8,17920
WL 8
MB 192,168,164
TR 188,8,15424
TR 190,8,17984
WL 8
MB 208,168,168
TR 192,8,15488
TR 194,8,18048
WL 8
MB 224,168,172
TR 196,8,15552
TR 198,8,18112
WL 8
MB 240,168,176
TR 200,8,15616
TR 202,8,18176
WL 8
MB 176,172,184
WL 6
MB 192,172,188
WL 4
MB 208,172,192
WL 2
MB 224,172,196
WL 0
MB 240,172,200
s_cmp_eq_u32 s16, 0
s_cbranch_scc0 W_f_81
s_lshl_b32 s23, s58, 2
s_add_u32 s23, s23, 128
s_mov_b64 exec, 1
v_mov_b32 v5, 1
v_mov_b32 v22, s23
buffer_atomic_add v5, v22, s[12:15], 0 offen sc0
s_mov_b64 exec, -1
W_f_81:
s_nop 7
s_nop 7
CV 112,176,177
CV 113,178,179
CV 114,180,181
CV 115,182,183
CV 116,184,185
CV 117,186,187
CV 118,188,189
CV 119,190,191
s_add_u32 s48, s47, 983040
s_nop 0
v_permlane32_swap_b32 v112, v114
v_permlane32_swap_b32 v113, v115
v_permlane32_swap_b32 v116, v118
v_permlane32_swap_b32 v117, v119
buffer_store_dwordx4 v[112:115], v21, s[8:11], s48 offen sc1
buffer_store_dwordx4 v[116:119], v21, s[8:11], s48 offen offset:512 sc1
CV 120,192,193
CV 121,194,195
CV 122,196,197
CV 123,198,199
CV 124,200,201
CV 125,202,203
CV 126,204,205
CV 127,206,207
s_add_u32 s48, s47, 1048576
s_nop 0
v_permlane32_swap_b32 v120, v122
v_permlane32_swap_b32 v121, v123
v_permlane32_swap_b32 v124, v126
v_permlane32_swap_b32 v125, v127
buffer_store_dwordx4 v[120:123], v21, s[8:11], s48 offen sc1
buffer_store_dwordx4 v[124:127], v21, s[8:11], s48 offen offset:512 sc1
CV 112,208,209
CV 113,210,211
CV 114,212,213
CV 115,214,215
CV 116,216,217
CV 117,218,219
CV 118,220,221
CV 119,222,223
s_add_u32 s48, s47, 1114112
s_nop 0
v_permlane32_swap_b32 v112, v114
v_permlane32_swap_b32 v113, v115
v_permlane32_swap_b32 v116, v118
v_permlane32_swap_b32 v117, v119
buffer_store_dwordx4 v[112:115], v21, s[8:11], s48 offen sc1
buffer_store_dwordx4 v[116:119], v21, s[8:11], s48 offen offset:512 sc1
CV 120,224,225
CV 121,226,227
CV 122,228,229
CV 123,230,231
CV 124,232,233
CV 125,234,235
CV 126,236,237
CV 127,238,239
s_add_u32 s48, s47, 1179648
s_nop 0
v_permlane32_swap_b32 v120, v122
v_permlane32_swap_b32 v121, v123
v_permlane32_swap_b32 v124, v126
v_permlane32_swap_b32 v125, v127
buffer_store_dwordx4 v[120:123], v21, s[8:11], s48 offen sc1
buffer_store_dwordx4 v[124:127], v21, s[8:11], s48 offen offset:512 sc1
CV 112,240,241
CV 113,242,243
CV 114,244,245
CV 115,246,247
CV 116,248,249
CV 117,250,251
CV 118,252,253
CV 119,254,255
s_add_u32 s48, s47, 1245184
s_nop 0
v_permlane32_swap_b32 v112, v114
v_permlane32_swap_b32 v113, v115
v_permlane32_swap_b32 v116, v118
v_permlane32_swap_b32 v117, v119
buffer_store_dwordx4 v[112:115], v21, s[8:11], s48 offen sc1
buffer_store_dwordx4 v[116:119], v21, s[8:11], s48 offen offset:512 sc1
WV 0
s_lshl_b32 s48, s40, 7
s_add_u32 s48, s48, 196608
s_mov_b32 s49, -1
s_branch W_end
W_kq:
s_mul_i32 s42, s41, 384
s_mov_b32 s46, s42
s_lshl_b32 s43, s40, 2
s_add_u32 s43, s43, s16
s_mul_i32 s44, s43, 40960
s_add_u32 s44, s44, 10485760
v_and_b32 v22, 63, v0
v_lshrrev_b32 v23, 4, v22
v_and_b32 v23, 1, v23
v_mul_u32_u24 v23, 6144, v23
v_lshrrev_b32 v24, 5, v22
v_lshlrev_b32 v24, 4, v24
v_and_b32 v25, 15, v22
v_add_u32 v24, v24, v25
v_lshlrev_b32 v24, 4, v24
v_add_u32 v21, v23, v24
s_lshl_b32 s45, s43, 5
s_add_u32 s45, s45, s41
s_mul_i32 s45, s45, 12288
s_add_u32 s47, s45, 98566144
s_add_u32 s45, s45, 73400320
s_mul_i32 s23, s16, 6144
s_add_u32 m0, s23, 0
s_nop 0
DM 10,72,42
s_add_u32 m0, s23, 1024
s_nop 0
DM 11,72,42
s_add_u32 m0, s23, 2048
s_nop 0
DM 12,72,42
s_add_u32 m0, s23, 3072
s_nop 0
DM 13,72,42
s_add_u32 m0, s23, 4096
s_nop 0
DM 14,72,42
s_add_u32 m0, s23, 5120
s_nop 0
DM 15,72,42
s_add_u32 s42, s42, 786432
buffer_load_dwordx4 a[0:3], v1, s[8:11], s44 offen offset:0 sc1
buffer_load_dwordx4 a[4:7], v1, s[8:11], s44 offen offset:1024 sc1
buffer_load_dwordx4 a[8:11], v1, s[8:11], s44 offen offset:2048 sc1
buffer_load_dwordx4 a[12:15], v1, s[8:11], s44 offen offset:3072 sc1
s_mul_i32 s23, s16, 6144
s_add_u32 m0, s23, 24576
s_nop 0
DM 10,72,42
s_add_u32 m0, s23, 25600
s_nop 0
DM 11,72,42
s_add_u32 m0, s23, 26624
s_nop 0
DM 12,72,42
s_add_u32 m0, s23, 27648
s_nop 0
DM 13,72,42
s_add_u32 m0, s23, 28672
s_nop 0
DM 14,72,42
s_add_u32 m0, s23, 29696
s_nop 0
DM 15,72,42
s_add_u32 s42, s42, 786432
s_add_u32 s44, s44, 4096
buffer_load_dwordx4 a[16:19], v1, s[8:11], s44 offen offset:0 sc1
buffer_load_dwordx4 a[20:23], v1, s[8:11], s44 offen offset:1024 sc1
buffer_load_dwordx4 a[24:27], v1, s[8:11], s44 offen offset:2048 sc1
buffer_load_dwordx4 a[28:31], v1, s[8:11], s44 offen offset:3072 sc1
s_mul_i32 s23, s16, 6144
s_add_u32 m0, s23, 49152
s_nop 0
DM 10,72,42
s_add_u32 m0, s23, 50176
s_nop 0
DM 11,72,42
s_add_u32 m0, s23, 51200
s_nop 0
DM 12,72,42
s_add_u32 m0, s23, 52224
s_nop 0
DM 13,72,42
s_add_u32 m0, s23, 53248
s_nop 0
DM 14,72,42
s_add_u32 m0, s23, 54272
s_nop 0
DM 15,72,42
s_add_u32 s42, s42, 786432
s_add_u32 s44, s44, 4096
buffer_load_dwordx4 a[32:35], v1, s[8:11], s44 offen offset:0 sc1
buffer_load_dwordx4 a[36:39], v1, s[8:11], s44 offen offset:1024 sc1
buffer_load_dwordx4 a[40:43], v1, s[8:11], s44 offen offset:2048 sc1
buffer_load_dwordx4 a[44:47], v1, s[8:11], s44 offen offset:3072 sc1
s_add_u32 s44, s44, 4096
buffer_load_dwordx4 a[48:51], v1, s[8:11], s44 offen offset:0 sc1
buffer_load_dwordx4 a[52:55], v1, s[8:11], s44 offen offset:1024 sc1
buffer_load_dwordx4 a[56:59], v1, s[8:11], s44 offen offset:2048 sc1
buffer_load_dwordx4 a[60:63], v1, s[8:11], s44 offen offset:3072 sc1
s_add_u32 s44, s44, 4096
buffer_load_dwordx4 a[64:67], v1, s[8:11], s44 offen offset:0 sc1
buffer_load_dwordx4 a[68:71], v1, s[8:11], s44 offen offset:1024 sc1
buffer_load_dwordx4 a[72:75], v1, s[8:11], s44 offen offset:2048 sc1
buffer_load_dwordx4 a[76:79], v1, s[8:11], s44 offen offset:3072 sc1
s_add_u32 s44, s44, 4096
buffer_load_dwordx4 a[80:83], v1, s[8:11], s44 offen offset:0 sc1
buffer_load_dwordx4 a[84:87], v1, s[8:11], s44 offen offset:1024 sc1
buffer_load_dwordx4 a[88:91], v1, s[8:11], s44 offen offset:2048 sc1
buffer_load_dwordx4 a[92:95], v1, s[8:11], s44 offen offset:3072 sc1
s_add_u32 s44, s44, 4096
buffer_load_dwordx4 a[96:99], v1, s[8:11], s44 offen offset:0 sc1
buffer_load_dwordx4 a[100:103], v1, s[8:11], s44 offen offset:1024 sc1
buffer_load_dwordx4 a[104:107], v1, s[8:11], s44 offen offset:2048 sc1
buffer_load_dwordx4 a[108:111], v1, s[8:11], s44 offen offset:3072 sc1
s_add_u32 s44, s44, 4096
buffer_load_dwordx4 a[112:115], v1, s[8:11], s44 offen offset:0 sc1
buffer_load_dwordx4 a[116:119], v1, s[8:11], s44 offen offset:1024 sc1
buffer_load_dwordx4 a[120:123], v1, s[8:11], s44 offen offset:2048 sc1
buffer_load_dwordx4 a[124:127], v1, s[8:11], s44 offen offset:3072 sc1
s_add_u32 s44, s44, 4096
buffer_load_dwordx4 a[128:131], v1, s[8:11], s44 offen offset:0 sc1
buffer_load_dwordx4 a[132:135], v1, s[8:11], s44 offen offset:1024 sc1
buffer_load_dwordx4 a[136:139], v1, s[8:11], s44 offen offset:2048 sc1
buffer_load_dwordx4 a[140:143], v1, s[8:11], s44 offen offset:3072 sc1
s_add_u32 s44, s44, 4096
buffer_load_dwordx4 a[144:147], v1, s[8:11], s44 offen offset:0 sc1
buffer_load_dwordx4 a[148:151], v1, s[8:11], s44 offen offset:1024 sc1
buffer_load_dwordx4 a[152:155], v1, s[8:11], s44 offen offset:2048 sc1
buffer_load_dwordx4 a[156:159], v1, s[8:11], s44 offen offset:3072 sc1
WV 52
s_barrier
v_add_u32 v6, 0, v2
v_add_u32 v7, 0, v3
TR 160,6,0
TR 162,6,3072
TR 164,7,64
TR 166,7,3136
TR 168,6,128
TR 170,6,3200
TR 172,7,192
TR 174,7,3264
TR 176,6,256
TR 178,6,3328
TR 180,7,320
TR 182,7,3392
WV 51
WL 10
v_mfma_f32_32x32x16_bf16 v[32:47], a[160:163], a[0:3], 0
TR 184,6,6144
TR 186,6,9216
WL 10
v_mfma_f32_32x32x16_bf16 v[48:63], a[164:167], a[0:3], 0
TR 188,7,6208
TR 190,7,9280
WL 10
v_mfma_f32_32x32x16_bf16 v[64:79], a[168:171], a[0:3], 0
TR 192,6,6272
TR 194,6,9344
WL 10
v_mfma_f32_32x32x16_bf16 v[80:95], a[172:175], a[0:3], 0
TR 196,7,6336
TR 198,7,9408
WL 10
v_mfma_f32_32x32x16_bf16 v[96:111], a[176:179], a[0:3], 0
TR 200,6,6400
TR 202,6,9472
WL 10
v_mfma_f32_32x32x16_bf16 v[112:127], a[180:183], a[0:3], 0
TR 204,7,6464
TR 206,7,9536
WV 50
WL 10
MA 32,184,4
TR 160,6,12288
TR 162,6,15360
WL 10
MA 48,188,4
TR 164,7,12352
TR 166,7,15424
WL 10
MA 64,192,4
TR 168,6,12416
TR 170,6,15488
WL 10
MA 80,196,4
TR 172,7,12480
TR 174,7,15552
WL 10
MA 96,200,4
TR 176,6,12544
TR 178,6,15616
WL 10
MA 112,204,4
TR 180,7,12608
TR 182,7,15680
WV 49
WV 42
s_barrier
v_add_u32 v8, 24576, v2
v_add_u32 v9, 24576, v3
WL 10
MA 32,160,8
TR 184,6,18432
TR 186,6,21504
WL 10
MA 48,164,8
TR 188,7,18496
TR 190,7,21568
s_add_u32 m0, s90, 73728
s_nop 0
DM 10,72,42
WL 10
MA 64,168,8
TR 192,6,18560
TR 194,6,21632
WL 10
MA 80,172,8
TR 196,7,18624
TR 198,7,21696
WL 10
MA 96,176,8
TR 200,6,18688
TR 202,6,21760
s_add_u32 m0, s90, 74752
s_nop 0
DM 11,72,42
WL 10
MA 112,180,8
TR 204,7,18752
TR 206,7,21824
WL 10
MA 32,184,12
TR 160,8,0
TR 162,8,3072
WL 10
MA 48,188,12
TR 164,9,64
TR 166,9,3136
s_add_u32 m0, s90, 75776
s_nop 0
DM 12,72,42
WL 10
MA 64,192,12
TR 168,8,128
TR 170,8,3200
WL 10
MA 80,196,12
TR 172,9,192
TR 174,9,3264
WL 10
MA 96,200,12
TR 176,8,256
TR 178,8,3328
s_add_u32 m0, s90, 76800
s_nop 0
DM 13,72,42
WL 10
MA 112,204,12
TR 180,9,320
TR 182,9,3392
WV 45
WL 10
MA 32,160,16
TR 184,8,6144
TR 186,8,9216
WL 10
MA 48,164,16
TR 188,9,6208
TR 190,9,9280
s_add_u32 m0, s90, 77824
s_nop 0
DM 14,72,42
WL 10
MA 64,168,16
TR 192,8,6272
TR 194,8,9344
WL 10
MA 80,172,16
TR 196,9,6336
TR 198,9,9408
WL 10
MA 96,176,16
TR 200,8,6400
TR 202,8,9472
s_add_u32 m0, s90, 78848
s_nop 0
DM 15,72,42
s_add_u32 s42, s42, 786432
WL 10
MA 112,180,16
TR 204,9,6464
TR 206,9,9536
WV 46
WL 10
MA 32,184,20
TR 160,8,12288
TR 162,8,15360
WL 10
MA 48,188,20
TR 164,9,12352
TR 166,9,15424
WL 10
MA 64,192,20
TR 168,8,12416
TR 170,8,15488
WL 10
MA 80,196,20
TR 172,9,12480
TR 174,9,15552
WL 10
MA 96,200,20
TR 176,8,12544
TR 178,8,15616
WL 10
MA 112,204,20
TR 180,9,12608
TR 182,9,15680
WV 45
WV 38
s_barrier
v_add_u32 v6, 49152, v2
v_add_u32 v7, 49152, v3
WL 10
MA 32,160,24
TR 184,8,18432
TR 186,8,21504
WL 10
MA 48,164,24
TR 188,9,18496
TR 190,9,21568
s_add_u32 m0, s90, 0
s_nop 0
DM 10,72,42
WL 10
MA 64,168,24
TR 192,8,18560
TR 194,8,21632
WL 10
MA 80,172,24
TR 196,9,18624
TR 198,9,21696
WL 10
MA 96,176,24
TR 200,8,18688
TR 202,8,21760
s_add_u32 m0, s90, 1024
s_nop 0
DM 11,72,42
WL 10
MA 112,180,24
TR 204,9,18752
TR 206,9,21824
WL 10
MA 32,184,28
TR 160,6,0
TR 162,6,3072
WL 10
MA 48,188,28
TR 164,7,64
TR 166,7,3136
s_add_u32 m0, s90, 2048
s_nop 0
DM 12,72,42
WL 10
MA 64,192,28
TR 168,6,128
TR 170,6,3200
WL 10
MA 80,196,28
TR 172,7,192
TR 174,7,3264
WL 10
MA 96,200,28
TR 176,6,256
TR 178,6,3328
s_add_u32 m0, s90, 3072
s_nop 0
DM 13,72,42
WL 10
MA 112,204,28
TR 180,7,320
TR 182,7,3392
WV 41
WL 10
MA 32,160,32
TR 184,6,6144
TR 186,6,9216
WL 10
MA 48,164,32
TR 188,7,6208
TR 190,7,9280
s_add_u32 m0, s90, 4096
s_nop 0
DM 14,72,42
WL 10
MA 64,168,32
TR 192,6,6272
TR 194,6,9344
WL 10
MA 80,172,32
TR 196,7,6336
TR 198,7,9408
WL 10
MA 96,176,32
TR 200,6,6400
TR 202,6,9472
s_add_u32 m0, s90, 5120
s_nop 0
DM 15,72,42
s_add_u32 s42, s42, 786432
WL 10
MA 112,180,32
TR 204,7,6464
TR 206,7,9536
WV 42
WL 10
MA 32,184,36
TR 160,6,12288
TR 162,6,15360
WL 10
MA 48,188,36
TR 164,7,12352
TR 166,7,15424
WL 10
MA 64,192,36
TR 168,6,12416
TR 170,6,15488
WL 10
MA 80,196,36
TR 172,7,12480
TR 174,7,15552
WL 10
MA 96,200,36
TR 176,6,12544
TR 178,6,15616
WL 10
MA 112,204,36
TR 180,7,12608
TR 182,7,15680
WV 41
WV 6
s_barrier
v_add_u32 v8, 73728, v2
v_add_u32 v9, 73728, v3
WL 10
MA 32,160,40
TR 184,6,18432
TR 186,6,21504
WL 10
MA 48,164,40
TR 188,7,18496
TR 190,7,21568
s_add_u32 m0, s90, 24576
s_nop 0
DM 10,72,42
WL 10
MA 64,168,40
TR 192,6,18560
TR 194,6,21632
WL 10
MA 80,172,40
TR 196,7,18624
TR 198,7,21696
WL 10
MA 96,176,40
TR 200,6,18688
TR 202,6,21760
s_add_u32 m0, s90, 25600
s_nop 0
DM 11,72,42
WL 10
MA 112,180,40
TR 204,7,18752
TR 206,7,21824
WL 10
MA 32,184,44
TR 160,8,0
TR 162,8,3072
WL 10
MA 48,188,44
TR 164,9,64
TR 166,9,3136
s_add_u32 m0, s90, 26624
s_nop 0
DM 12,72,42
WL 10
MA 64,192,44
TR 168,8,128
TR 170,8,3200
WL 10
MA 80,196,44
TR 172,9,192
TR 174,9,3264
WL 10
MA 96,200,44
TR 176,8,256
TR 178,8,3328
s_add_u32 m0, s90, 27648
s_nop 0
DM 13,72,42
WL 10
MA 112,204,44
TR 180,9,320
TR 182,9,3392
WL 10
MA 32,160,48
TR 184,8,6144
TR 186,8,9216
WL 10
MA 48,164,48
TR 188,9,6208
TR 190,9,9280
s_add_u32 m0, s90, 28672
s_nop 0
DM 14,72,42
WL 10
MA 64,168,48
TR 192,8,6272
TR 194,8,9344
WL 10
MA 80,172,48
TR 196,9,6336
TR 198,9,9408
WL 10
MA 96,176,48
TR 200,8,6400
TR 202,8,9472
s_add_u32 m0, s90, 29696
s_nop 0
DM 15,72,42
s_add_u32 s42, s42, 786432
WL 10
MA 112,180,48
TR 204,9,6464
TR 206,9,9536
WL 10
MA 32,184,52
TR 160,8,12288
TR 162,8,15360
WL 10
MA 48,188,52
TR 164,9,12352
TR 166,9,15424
WL 10
MA 64,192,52
TR 168,8,12416
TR 170,8,15488
WL 10
MA 80,196,52
TR 172,9,12480
TR 174,9,15552
WL 10
MA 96,200,52
TR 176,8,12544
TR 178,8,15616
WL 10
MA 112,204,52
TR 180,9,12608
TR 182,9,15680
WV 6
s_barrier
v_add_u32 v6, 0, v2
v_add_u32 v7, 0, v3
WL 10
MA 32,160,56
TR 184,8,18432
TR 186,8,21504
WL 10
MA 48,164,56
TR 188,9,18496
TR 190,9,21568
s_add_u32 m0, s90, 49152
s_nop 0
DM 10,72,42
WL 10
MA 64,168,56
TR 192,8,18560
TR 194,8,21632
WL 10
MA 80,172,56
TR 196,9,18624
TR 198,9,21696
WL 10
MA 96,176,56
TR 200,8,18688
TR 202,8,21760
s_add_u32 m0, s90, 50176
s_nop 0
DM 11,72,42
WL 10
MA 112,180,56
TR 204,9,18752
TR 206,9,21824
WL 10
MA 32,184,60
TR 160,6,0
TR 162,6,3072
WL 10
MA 48,188,60
TR 164,7,64
TR 166,7,3136
s_add_u32 m0, s90, 51200
s_nop 0
DM 12,72,42
WL 10
MA 64,192,60
TR 168,6,128
TR 170,6,3200
WL 10
MA 80,196,60
TR 172,7,192
TR 174,7,3264
WL 10
MA 96,200,60
TR 176,6,256
TR 178,6,3328
s_add_u32 m0, s90, 52224
s_nop 0
DM 13,72,42
WL 10
MA 112,204,60
TR 180,7,320
TR 182,7,3392
WL 10
MA 32,160,64
TR 184,6,6144
TR 186,6,9216
WL 10
MA 48,164,64
TR 188,7,6208
TR 190,7,9280
s_add_u32 m0, s90, 53248
s_nop 0
DM 14,72,42
WL 10
MA 64,168,64
TR 192,6,6272
TR 194,6,9344
WL 10
MA 80,172,64
TR 196,7,6336
TR 198,7,9408
WL 10
MA 96,176,64
TR 200,6,6400
TR 202,6,9472
s_add_u32 m0, s90, 54272
s_nop 0
DM 15,72,42
s_add_u32 s42, s42, 786432
WL 10
MA 112,180,64
TR 204,7,6464
TR 206,7,9536
WL 10
MA 32,184,68
TR 160,6,12288
TR 162,6,15360
WL 10
MA 48,188,68
TR 164,7,12352
TR 166,7,15424
WL 10
MA 64,192,68
TR 168,6,12416
TR 170,6,15488
WL 10
MA 80,196,68
TR 172,7,12480
TR 174,7,15552
WL 10
MA 96,200,68
TR 176,6,12544
TR 178,6,15616
WL 10
MA 112,204,68
TR 180,7,12608
TR 182,7,15680
WV 6
s_barrier
v_add_u32 v8, 24576, v2
v_add_u32 v9, 24576, v3
WL 10
MA 32,160,72
TR 184,6,18432
TR 186,6,21504
WL 10
MA 48,164,72
TR 188,7,18496
TR 190,7,21568
s_add_u32 m0, s90, 73728
s_nop 0
DM 10,72,42
WL 10
MA 64,168,72
TR 192,6,18560
TR 194,6,21632
WL 10
MA 80,172,72
TR 196,7,18624
TR 198,7,21696
WL 10
MA 96,176,72
TR 200,6,18688
TR 202,6,21760
s_add_u32 m0, s90, 74752
s_nop 0
DM 11,72,42
WL 10
MA 112,180,72
TR 204,7,18752
TR 206,7,21824
WL 10
MA 32,184,76
TR 160,8,0
TR 162,8,3072
WL 10
MA 48,188,76
TR 164,9,64
TR 166,9,3136
s_add_u32 m0, s90, 75776
s_nop 0
DM 12,72,42
WL 10
MA 64,192,76
TR 168,8,128
TR 170,8,3200
WL 10
MA 80,196,76
TR 172,9,192
TR 174,9,3264
WL 10
MA 96,200,76
TR 176,8,256
TR 178,8,3328
s_add_u32 m0, s90, 76800
s_nop 0
DM 13,72,42
WL 10
MA 112,204,76
TR 180,9,320
TR 182,9,3392
WL 10
MA 32,160,80
TR 184,8,6144
TR 186,8,9216
WL 10
MA 48,164,80
TR 188,9,6208
TR 190,9,9280
s_add_u32 m0, s90, 77824
s_nop 0
DM 14,72,42
WL 10
MA 64,168,80
TR 192,8,6272
TR 194,8,9344
WL 10
MA 80,172,80
TR 196,9,6336
TR 198,9,9408
WL 10
MA 96,176,80
TR 200,8,6400
TR 202,8,9472
s_add_u32 m0, s90, 78848
s_nop 0
DM 15,72,42
s_add_u32 s42, s42, 786432
WL 10
MA 112,180,80
TR 204,9,6464
TR 206,9,9536
WL 10
MA 32,184,84
TR 160,8,12288
TR 162,8,15360
WL 10
MA 48,188,84
TR 164,9,12352
TR 166,9,15424
WL 10
MA 64,192,84
TR 168,8,12416
TR 170,8,15488
WL 10
MA 80,196,84
TR 172,9,12480
TR 174,9,15552
WL 10
MA 96,200,84
TR 176,8,12544
TR 178,8,15616
WL 10
MA 112,204,84
TR 180,9,12608
TR 182,9,15680
WV 6
s_barrier
v_add_u32 v6, 49152, v2
v_add_u32 v7, 49152, v3
WL 10
MA 32,160,88
TR 184,8,18432
TR 186,8,21504
WL 10
MA 48,164,88
TR 188,9,18496
TR 190,9,21568
s_add_u32 m0, s90, 0
s_nop 0
DM 10,72,42
WL 10
MA 64,168,88
TR 192,8,18560
TR 194,8,21632
WL 10
MA 80,172,88
TR 196,9,18624
TR 198,9,21696
WL 10
MA 96,176,88
TR 200,8,18688
TR 202,8,21760
s_add_u32 m0, s90, 1024
s_nop 0
DM 11,72,42
WL 10
MA 112,180,88
TR 204,9,18752
TR 206,9,21824
WL 10
MA 32,184,92
TR 160,6,0
TR 162,6,3072
WL 10
MA 48,188,92
TR 164,7,64
TR 166,7,3136
s_add_u32 m0, s90, 2048
s_nop 0
DM 12,72,42
WL 10
MA 64,192,92
TR 168,6,128
TR 170,6,3200
WL 10
MA 80,196,92
TR 172,7,192
TR 174,7,3264
WL 10
MA 96,200,92
TR 176,6,256
TR 178,6,3328
s_add_u32 m0, s90, 3072
s_nop 0
DM 13,72,42
WL 10
MA 112,204,92
TR 180,7,320
TR 182,7,3392
WL 10
MA 32,160,96
TR 184,6,6144
TR 186,6,9216
WL 10
MA 48,164,96
TR 188,7,6208
TR 190,7,9280
s_add_u32 m0, s90, 4096
s_nop 0
DM 14,72,42
WL 10
MA 64,168,96
TR 192,6,6272
TR 194,6,9344
WL 10
MA 80,172,96
TR 196,7,6336
TR 198,7,9408
WL 10
MA 96,176,96
TR 200,6,6400
TR 202,6,9472
s_add_u32 m0, s90, 5120
s_nop 0
DM 15,72,42
s_add_u32 s42, s42, 786432
WL 10
MA 112,180,96
TR 204,7,6464
TR 206,7,9536
WL 10
MA 32,184,100
TR 160,6,12288
TR 162,6,15360
WL 10
MA 48,188,100
TR 164,7,12352
TR 166,7,15424
WL 10
MA 64,192,100
TR 168,6,12416
TR 170,6,15488
WL 10
MA 80,196,100
TR 172,7,12480
TR 174,7,15552
WL 10
MA 96,200,100
TR 176,6,12544
TR 178,6,15616
WL 10
MA 112,204,100
TR 180,7,12608
TR 182,7,15680
WV 6
s_barrier
v_add_u32 v8, 73728, v2
v_add_u32 v9, 73728, v3
WL 10
MA 32,160,104
TR 184,6,18432
TR 186,6,21504
WL 10
MA 48,164,104
TR 188,7,18496
TR 190,7,21568
s_add_u32 m0, s90, 24576
s_nop 0
DM 10,72,42
WL 10
MA 64,168,104
TR 192,6,18560
TR 194,6,21632
WL 10
MA 80,172,104
TR 196,7,18624
TR 198,7,21696
WL 10
MA 96,176,104
TR 200,6,18688
TR 202,6,21760
s_add_u32 m0, s90, 25600
s_nop 0
DM 11,72,42
WL 10
MA 112,180,104
TR 204,7,18752
TR 206,7,21824
WL 10
MA 32,184,108
TR 160,8,0
TR 162,8,3072
WL 10
MA 48,188,108
TR 164,9,64
TR 166,9,3136
s_add_u32 m0, s90, 26624
s_nop 0
DM 12,72,42
WL 10
MA 64,192,108
TR 168,8,128
TR 170,8,3200
WL 10
MA 80,196,108
TR 172,9,192
TR 174,9,3264
WL 10
MA 96,200,108
TR 176,8,256
TR 178,8,3328
s_add_u32 m0, s90, 27648
s_nop 0
DM 13,72,42
WL 10
MA 112,204,108
TR 180,9,320
TR 182,9,3392
WL 10
MA 32,160,112
TR 184,8,6144
TR 186,8,9216
WL 10
MA 48,164,112
TR 188,9,6208
TR 190,9,9280
s_add_u32 m0, s90, 28672
s_nop 0
DM 14,72,42
WL 10
MA 64,168,112
TR 192,8,6272
TR 194,8,9344
WL 10
MA 80,172,112
TR 196,9,6336
TR 198,9,9408
WL 10
MA 96,176,112
TR 200,8,6400
TR 202,8,9472
s_add_u32 m0, s90, 29696
s_nop 0
DM 15,72,42
s_add_u32 s42, s42, 786432
WL 10
MA 112,180,112
TR 204,9,6464
TR 206,9,9536
WL 10
MA 32,184,116
TR 160,8,12288
TR 162,8,15360
WL 10
MA 48,188,116
TR 164,9,12352
TR 166,9,15424
WL 10
MA 64,192,116
TR 168,8,12416
TR 170,8,15488
WL 10
MA 80,196,116
TR 172,9,12480
TR 174,9,15552
WL 10
MA 96,200,116
TR 176,8,12544
TR 178,8,15616
WL 10
MA 112,204,116
TR 180,9,12608
TR 182,9,15680
WV 6
s_barrier
v_add_u32 v6, 0, v2
v_add_u32 v7, 0, v3
WL 10
MA 32,160,120
TR 184,8,18432
TR 186,8,21504
WL 10
MA 48,164,120
TR 188,9,18496
TR 190,9,21568
s_add_u32 m0, s90, 49152
s_nop 0
DM 10,68,46
WL 10
MA 64,168,120
TR 192,8,18560
TR 194,8,21632
WL 10
MA 80,172,120
TR 196,9,18624
TR 198,9,21696
WL 10
MA 96,176,120
TR 200,8,18688
TR 202,8,21760
s_add_u32 m0, s90, 50176
s_nop 0
DM 11,68,46
WL 10
MA 112,180,120
TR 204,9,18752
TR 206,9,21824
WL 10
MA 32,184,124
TR 160,6,0
TR 162,6,3072
WL 10
MA 48,188,124
TR 164,7,64
TR 166,7,3136
s_add_u32 m0, s90, 51200
s_nop 0
DM 12,68,46
WL 10
MA 64,192,124
TR 168,6,128
TR 170,6,3200
WL 10
MA 80,196,124
TR 172,7,192
TR 174,7,3264
WL 10
MA 96,200,124
TR 176,6,256
TR 178,6,3328
s_add_u32 m0, s90, 52224
s_nop 0
DM 13,68,46
WL 10
MA 112,204,124
TR 180,7,320
TR 182,7,3392
WL 10
MA 32,160,128
TR 184,6,6144
TR 186,6,9216
WL 10
MA 48,164,128
TR 188,7,6208
TR 190,7,9280
s_add_u32 m0, s90, 53248
s_nop 0
DM 14,68,46
WL 10
MA 64,168,128
TR 192,6,6272
TR 194,6,9344
WL 10
MA 80,172,128
TR 196,7,6336
TR 198,7,9408
WL 10
MA 96,176,128
TR 200,6,6400
TR 202,6,9472
s_add_u32 m0, s90, 54272
s_nop 0
DM 15,68,46
s_add_u32 s46, s46, 786432
WL 10
MA 112,180,128
TR 204,7,6464
TR 206,7,9536
WL 10
MA 32,184,132
TR 160,6,12288
TR 162,6,15360
WL 10
MA 48,188,132
TR 164,7,12352
TR 166,7,15424
WL 10
MA 64,192,132
TR 168,6,12416
TR 170,6,15488
WL 10
MA 80,196,132
TR 172,7,12480
TR 174,7,15552
WL 10
MA 96,200,132
TR 176,6,12544
TR 178,6,15616
WL 10
MA 112,204,132
TR 180,7,12608
TR 182,7,15680
WV 6
s_barrier
v_add_u32 v8, 24576, v2
v_add_u32 v9, 24576, v3
WL 10
MA 32,160,136
TR 184,6,18432
TR 186,6,21504
WL 10
MA 48,164,136
TR 188,7,18496
TR 190,7,21568
s_add_u32 m0, s90, 73728
s_nop 0
DM 10,68,46
WL 10
MA 64,168,136
TR 192,6,18560
TR 194,6,21632
WL 10
MA 80,172,136
TR 196,7,18624
TR 198,7,21696
WL 10
MA 96,176,136
TR 200,6,18688
TR 202,6,21760
s_add_u32 m0, s90, 74752
s_nop 0
DM 11,68,46
WL 10
MA 112,180,136
TR 204,7,18752
TR 206,7,21824
WL 10
MA 32,184,140
TR 160,8,0
TR 162,8,3072
WL 10
MA 48,188,140
TR 164,9,64
TR 166,9,3136
s_add_u32 m0, s90, 75776
s_nop 0
DM 12,68,46
WL 10
MA 64,192,140
TR 168,8,128
TR 170,8,3200
WL 10
MA 80,196,140
TR 172,9,192
TR 174,9,3264
WL 10
MA 96,200,140
TR 176,8,256
TR 178,8,3328
s_add_u32 m0, s90, 76800
s_nop 0
DM 13,68,46
WL 10
MA 112,204,140
TR 180,9,320
TR 182,9,3392
WL 10
MA 32,160,144
TR 184,8,6144
TR 186,8,9216
WL 10
MA 48,164,144
TR 188,9,6208
TR 190,9,9280
s_add_u32 m0, s90, 77824
s_nop 0
DM 14,68,46
WL 10
MA 64,168,144
TR 192,8,6272
TR 194,8,9344
WL 10
MA 80,172,144
TR 196,9,6336
TR 198,9,9408
WL 10
MA 96,176,144
TR 200,8,6400
TR 202,8,9472
s_add_u32 m0, s90, 78848
s_nop 0
DM 15,68,46
s_add_u32 s46, s46, 786432
WL 10
MA 112,180,144
TR 204,9,6464
TR 206,9,9536
WL 10
MA 32,184,148
TR 160,8,12288
TR 162,8,15360
WL 10
MA 48,188,148
TR 164,9,12352
TR 166,9,15424
WL 10
MA 64,192,148
TR 168,8,12416
TR 170,8,15488
WL 10
MA 80,196,148
TR 172,9,12480
TR 174,9,15552
WL 10
MA 96,200,148
TR 176,8,12544
TR 178,8,15616
WL 10
MA 112,204,148
TR 180,9,12608
TR 182,9,15680
WV 6
s_barrier
v_add_u32 v6, 49152, v2
v_add_u32 v7, 49152, v3
WL 10
MA 32,160,152
TR 184,8,18432
TR 186,8,21504
WL 10
MA 48,164,152
TR 188,9,18496
TR 190,9,21568
s_add_u32 m0, s90, 0
s_nop 0
DM 10,68,46
WL 10
MA 64,168,152
TR 192,8,18560
TR 194,8,21632
WL 10
MA 80,172,152
TR 196,9,18624
TR 198,9,21696
WL 10
MA 96,176,152
TR 200,8,18688
TR 202,8,21760
s_add_u32 m0, s90, 1024
s_nop 0
DM 11,68,46
WL 10
MA 112,180,152
TR 204,9,18752
TR 206,9,21824
WL 10
MA 32,184,156
TR 160,6,0
TR 162,6,3072
WL 10
MA 48,188,156
TR 164,7,64
TR 166,7,3136
s_add_u32 m0, s90, 2048
s_nop 0
DM 12,68,46
WL 10
MA 64,192,156
TR 168,6,128
TR 170,6,3200
WL 10
MA 80,196,156
TR 172,7,192
TR 174,7,3264
WL 10
MA 96,200,156
TR 176,6,256
TR 178,6,3328
s_add_u32 m0, s90, 3072
s_nop 0
DM 13,68,46
WL 10
MA 112,204,156
TR 180,7,320
TR 182,7,3392
WL 10
v_mfma_f32_32x32x16_bf16 v[128:143], a[160:163], a[0:3], 0
TR 184,6,6144
TR 186,6,9216
WL 10
v_mfma_f32_32x32x16_bf16 v[144:159], a[164:167], a[0:3], 0
TR 188,7,6208
TR 190,7,9280
s_add_u32 m0, s90, 4096
s_nop 0
DM 14,68,46
WL 10
v_mfma_f32_32x32x16_bf16 v[160:175], a[168:171], a[0:3], 0
TR 192,6,6272
TR 194,6,9344
WL 10
v_mfma_f32_32x32x16_bf16 v[176:191], a[172:175], a[0:3], 0
TR 196,7,6336
TR 198,7,9408
WL 10
v_mfma_f32_32x32x16_bf16 v[192:207], a[176:179], a[0:3], 0
TR 200,6,6400
TR 202,6,9472
s_add_u32 m0, s90, 5120
s_nop 0
DM 15,68,46
s_add_u32 s46, s46, 786432
WL 10
v_mfma_f32_32x32x16_bf16 v[208:223], a[180:183], a[0:3], 0
TR 204,7,6464
TR 206,7,9536
WL 10
MA 128,184,4
TR 160,6,12288
TR 162,6,15360
WL 10
MA 144,188,4
TR 164,7,12352
TR 166,7,15424
WL 10
MA 160,192,4
TR 168,6,12416
TR 170,6,15488
WL 10
MA 176,196,4
TR 172,7,12480
TR 174,7,15552
WL 10
MA 192,200,4
TR 176,6,12544
TR 178,6,15616
WL 10
MA 208,204,4
TR 180,7,12608
TR 182,7,15680
WV 6
s_barrier
v_add_u32 v8, 73728, v2
v_add_u32 v9, 73728, v3
WL 10
MA 128,160,8
TR 184,6,18432
TR 186,6,21504
CV 224,32,33
CV 225,34,35
WL 10
MA 144,164,8
TR 188,7,18496
TR 190,7,21568
s_add_u32 m0, s90, 24576
s_nop 0
DM 10,68,46
CV 226,40,41
CV 227,42,43
WL 10
MA 160,168,8
TR 192,6,18560
TR 194,6,21632
CV 228,36,37
CV 229,38,39
WL 10
MA 176,172,8
TR 196,7,18624
TR 198,7,21696
CV 230,44,45
CV 231,46,47
WL 10
MA 192,176,8
TR 200,6,18688
TR 202,6,21760
s_add_u32 m0, s90, 25600
s_nop 0
DM 11,68,46
buffer_store_dwordx4 v[224:227], v21, s[8:11], s45 offen offset:0 sc1
buffer_store_dwordx4 v[228:231], v21, s[8:11], s45 offen offset:512 sc1
WL 10
MA 208,180,8
TR 204,7,18752
TR 206,7,21824
CV 232,48,49
CV 233,50,51
WL 10
MA 128,184,12
TR 160,8,0
TR 162,8,3072
CV 234,56,57
CV 235,58,59
WL 10
MA 144,188,12
TR 164,9,64
TR 166,9,3136
s_add_u32 m0, s90, 26624
s_nop 0
DM 12,68,46
CV 236,52,53
CV 237,54,55
WL 10
MA 160,192,12
TR 168,8,128
TR 170,8,3200
CV 238,60,61
CV 239,62,63
WL 10
MA 176,196,12
TR 172,9,192
TR 174,9,3264
buffer_store_dwordx4 v[232:235], v21, s[8:11], s45 offen offset:1024 sc1
buffer_store_dwordx4 v[236:239], v21, s[8:11], s45 offen offset:1536 sc1
WL 10
MA 192,200,12
TR 176,8,256
TR 178,8,3328
s_add_u32 m0, s90, 27648
s_nop 0
DM 13,68,46
CV 224,64,65
CV 225,66,67
WL 10
MA 208,204,12
TR 180,9,320
TR 182,9,3392
CV 226,72,73
CV 227,74,75
WL 10
MA 128,160,16
TR 184,8,6144
TR 186,8,9216
CV 228,68,69
CV 229,70,71
WL 10
MA 144,164,16
TR 188,9,6208
TR 190,9,9280
s_add_u32 m0, s90, 28672
s_nop 0
DM 14,68,46
CV 230,76,77
CV 231,78,79
WL 10
MA 160,168,16
TR 192,8,6272
TR 194,8,9344
buffer_store_dwordx4 v[224:227], v21, s[8:11], s45 offen offset:2048 sc1
buffer_store_dwordx4 v[228:231], v21, s[8:11], s45 offen offset:2560 sc1
WL 10
MA 176,172,16
TR 196,9,6336
TR 198,9,9408
CV 232,80,81
CV 233,82,83
WL 10
MA 192,176,16
TR 200,8,6400
TR 202,8,9472
s_add_u32 m0, s90, 29696
s_nop 0
DM 15,68,46
s_add_u32 s46, s46, 786432
CV 234,88,89
CV 235,90,91
WL 10
MA 208,180,16
TR 204,9,6464
TR 206,9,9536
CV 236,84,85
CV 237,86,87
WL 10
MA 128,184,20
TR 160,8,12288
TR 162,8,15360
CV 238,92,93
CV 239,94,95
WL 10
MA 144,188,20
TR 164,9,12352
TR 166,9,15424
buffer_store_dwordx4 v[232:235], v21, s[8:11], s45 offen offset:3072 sc1
buffer_store_dwordx4 v[236:239], v21, s[8:11], s45 offen offset:3584 sc1
WL 10
MA 160,192,20
TR 168,8,12416
TR 170,8,15488
CV 224,96,97
CV 225,98,99
WL 10
MA 176,196,20
TR 172,9,12480
TR 174,9,15552
CV 226,104,105
CV 227,106,107
WL 10
MA 192,200,20
TR 176,8,12544
TR 178,8,15616
CV 228,100,101
CV 229,102,103
WL 10
MA 208,204,20
TR 180,9,12608
TR 182,9,15680
CV 230,108,109
CV 231,110,111
WV 14
s_barrier
v_add_u32 v6, 0, v2
v_add_u32 v7, 0, v3
WL 10
MA 128,160,24
TR 184,8,18432
TR 186,8,21504
s_add_u32 s45, s45, 4096
buffer_store_dwordx4 v[224:227], v21, s[8:11], s45 offen offset:0 sc1
WL 10
MA 144,164,24
TR 188,9,18496
TR 190,9,21568
s_add_u32 m0, s90, 49152
s_nop 0
DM 10,68,46
buffer_store_dwordx4 v[228:231], v21, s[8:11], s45 offen offset:512 sc1
CV 232,112,113
WL 10
MA 160,168,24
TR 192,8,18560
TR 194,8,21632
CV 233,114,115
CV 234,120,121
WL 10
MA 176,172,24
TR 196,9,18624
TR 198,9,21696
CV 235,122,123
CV 236,116,117
WL 10
MA 192,176,24
TR 200,8,18688
TR 202,8,21760
s_add_u32 m0, s90, 50176
s_nop 0
DM 11,68,46
CV 237,118,119
CV 238,124,125
WL 10
MA 208,180,24
TR 204,9,18752
TR 206,9,21824
CV 239,126,127
buffer_store_dwordx4 v[232:235], v21, s[8:11], s45 offen offset:1024 sc1
WL 10
MA 128,184,28
TR 160,6,0
TR 162,6,3072
buffer_store_dwordx4 v[236:239], v21, s[8:11], s45 offen offset:1536 sc1
WL 10
MA 144,188,28
TR 164,7,64
TR 166,7,3136
s_add_u32 m0, s90, 51200
s_nop 0
DM 12,68,46
WL 10
MA 160,192,28
TR 168,6,128
TR 170,6,3200
WL 10
MA 176,196,28
TR 172,7,192
TR 174,7,3264
WL 10
MA 192,200,28
TR 176,6,256
TR 178,6,3328
s_add_u32 m0, s90, 52224
s_nop 0
DM 13,68,46
WL 10
MA 208,204,28
TR 180,7,320
TR 182,7,3392
WL 10
MA 128,160,32
TR 184,6,6144
TR 186,6,9216
WL 10
MA 144,164,32
TR 188,7,6208
TR 190,7,9280
s_add_u32 m0, s90, 53248
s_nop 0
DM 14,68,46
WL 10
MA 160,168,32
TR 192,6,6272
TR 194,6,9344
WL 10
MA 176,172,32
TR 196,7,6336
TR 198,7,9408
WL 10
MA 192,176,32
TR 200,6,6400
TR 202,6,9472
s_add_u32 m0, s90, 54272
s_nop 0
DM 15,68,46
s_add_u32 s46, s46, 786432
WL 10
MA 208,180,32
TR 204,7,6464
TR 206,7,9536
WL 10
MA 128,184,36
TR 160,6,12288
TR 162,6,15360
WL 10
MA 144,188,36
TR 164,7,12352
TR 166,7,15424
WL 10
MA 160,192,36
TR 168,6,12416
TR 170,6,15488
WL 10
MA 176,196,36
TR 172,7,12480
TR 174,7,15552
WL 10
MA 192,200,36
TR 176,6,12544
TR 178,6,15616
WL 10
MA 208,204,36
TR 180,7,12608
TR 182,7,15680
WV 12
s_barrier
v_add_u32 v8, 24576, v2
v_add_u32 v9, 24576, v3
WL 10
MA 128,160,40
TR 184,6,18432
TR 186,6,21504
WL 10
MA 144,164,40
TR 188,7,18496
TR 190,7,21568
s_add_u32 m0, s90, 73728
s_nop 0
DM 10,68,46
WL 10
MA 160,168,40
TR 192,6,18560
TR 194,6,21632
WL 10
MA 176,172,40
TR 196,7,18624
TR 198,7,21696
WL 10
MA 192,176,40
TR 200,6,18688
TR 202,6,21760
s_add_u32 m0, s90, 74752
s_nop 0
DM 11,68,46
WL 10
MA 208,180,40
TR 204,7,18752
TR 206,7,21824
WL 10
MA 128,184,44
TR 160,8,0
TR 162,8,3072
WL 10
MA 144,188,44
TR 164,9,64
TR 166,9,3136
s_add_u32 m0, s90, 75776
s_nop 0
DM 12,68,46
WL 10
MA 160,192,44
TR 168,8,128
TR 170,8,3200
WL 10
MA 176,196,44
TR 172,9,192
TR 174,9,3264
WL 10
MA 192,200,44
TR 176,8,256
TR 178,8,3328
s_add_u32 m0, s90, 76800
s_nop 0
DM 13,68,46
WL 10
MA 208,204,44
TR 180,9,320
TR 182,9,3392
WL 10
MA 128,160,48
TR 184,8,6144
TR 186,8,9216
WL 10
MA 144,164,48
TR 188,9,6208
TR 190,9,9280
s_add_u32 m0, s90, 77824
s_nop 0
DM 14,68,46
WL 10
MA 160,168,48
TR 192,8,6272
TR 194,8,9344
WL 10
MA 176,172,48
TR 196,9,6336
TR 198,9,9408
WL 10
MA 192,176,48
TR 200,8,6400
TR 202,8,9472
s_add_u32 m0, s90, 78848
s_nop 0
DM 15,68,46
s_add_u32 s46, s46, 786432
WL 10
MA 208,180,48
TR 204,9,6464
TR 206,9,9536
WL 10
MA 128,184,52
TR 160,8,12288
TR 162,8,15360
WL 10
MA 144,188,52
TR 164,9,12352
TR 166,9,15424
WL 10
MA 160,192,52
TR 168,8,12416
TR 170,8,15488
WL 10
MA 176,196,52
TR 172,9,12480
TR 174,9,15552
WL 10
MA 192,200,52
TR 176,8,12544
TR 178,8,15616
WL 10
MA 208,204,52
TR 180,9,12608
TR 182,9,15680
WV 6
s_barrier
v_add_u32 v6, 49152, v2
v_add_u32 v7, 49152, v3
WL 10
MA 128,160,56
TR 184,8,18432
TR 186,8,21504
WL 10
MA 144,164,56
TR 188,9,18496
TR 190,9,21568
s_add_u32 m0, s90, 0
s_nop 0
DM 10,68,46
WL 10
MA 160,168,56
TR 192,8,18560
TR 194,8,21632
WL 10
MA 176,172,56
TR 196,9,18624
TR 198,9,21696
WL 10
MA 192,176,56
TR 200,8,18688
TR 202,8,21760
s_add_u32 m0, s90, 1024
s_nop 0
DM 11,68,46
WL 10
MA 208,180,56
TR 204,9,18752
TR 206,9,21824
WL 10
MA 128,184,60
TR 160,6,0
TR 162,6,3072
WL 10
MA 144,188,60
TR 164,7,64
TR 166,7,3136
s_add_u32 m0, s90, 2048
s_nop 0
DM 12,68,46
WL 10
MA 160,192,60
TR 168,6,128
TR 170,6,3200
WL 10
MA 176,196,60
TR 172,7,192
TR 174,7,3264
WL 10
MA 192,200,60
TR 176,6,256
TR 178,6,3328
s_add_u32 m0, s90, 3072
s_nop 0
DM 13,68,46
WL 10
MA 208,204,60
TR 180,7,320
TR 182,7,3392
WL 10
MA 128,160,64
TR 184,6,6144
TR 186,6,9216
WL 10
MA 144,164,64
TR 188,7,6208
TR 190,7,9280
s_add_u32 m0, s90, 4096
s_nop 0
DM 14,68,46
WL 10
MA 160,168,64
TR 192,6,6272
TR 194,6,9344
WL 10
MA 176,172,64
TR 196,7,6336
TR 198,7,9408
WL 10
MA 192,176,64
TR 200,6,6400
TR 202,6,9472
s_add_u32 m0, s90, 5120
s_nop 0
DM 15,68,46
s_add_u32 s46, s46, 786432
WL 10
MA 208,180,64
TR 204,7,6464
TR 206,7,9536
WL 10
MA 128,184,68
TR 160,6,12288
TR 162,6,15360
WL 10
MA 144,188,68
TR 164,7,12352
TR 166,7,15424
WL 10
MA 160,192,68
TR 168,6,12416
TR 170,6,15488
WL 10
MA 176,196,68
TR 172,7,12480
TR 174,7,15552
WL 10
MA 192,200,68
TR 176,6,12544
TR 178,6,15616
WL 10
MA 208,204,68
TR 180,7,12608
TR 182,7,15680
WV 6
s_barrier
v_add_u32 v8, 73728, v2
v_add_u32 v9, 73728, v3
WL 10
MA 128,160,72
TR 184,6,18432
TR 186,6,21504
WL 10
MA 144,164,72
TR 188,7,18496
TR 190,7,21568
s_add_u32 m0, s90, 24576
s_nop 0
DM 10,68,46
WL 10
MA 160,168,72
TR 192,6,18560
TR 194,6,21632
WL 10
MA 176,172,72
TR 196,7,18624
TR 198,7,21696
WL 10
MA 192,176,72
TR 200,6,18688
TR 202,6,21760
s_add_u32 m0, s90, 25600
s_nop 0
DM 11,68,46
WL 10
MA 208,180,72
TR 204,7,18752
TR 206,7,21824
WL 10
MA 128,184,76
TR 160,8,0
TR 162,8,3072
WL 10
MA 144,188,76
TR 164,9,64
TR 166,9,3136
s_add_u32 m0, s90, 26624
s_nop 0
DM 12,68,46
WL 10
MA 160,192,76
TR 168,8,128
TR 170,8,3200
WL 10
MA 176,196,76
TR 172,9,192
TR 174,9,3264
WL 10
MA 192,200,76
TR 176,8,256
TR 178,8,3328
s_add_u32 m0, s90, 27648
s_nop 0
DM 13,68,46
WL 10
MA 208,204,76
TR 180,9,320
TR 182,9,3392
WL 10
MA 128,160,80
TR 184,8,6144
TR 186,8,9216
WL 10
MA 144,164,80
TR 188,9,6208
TR 190,9,9280
s_add_u32 m0, s90, 28672
s_nop 0
DM 14,68,46
WL 10
MA 160,168,80
TR 192,8,6272
TR 194,8,9344
WL 10
MA 176,172,80
TR 196,9,6336
TR 198,9,9408
WL 10
MA 192,176,80
TR 200,8,6400
TR 202,8,9472
s_add_u32 m0, s90, 29696
s_nop 0
DM 15,68,46
s_add_u32 s46, s46, 786432
WL 10
MA 208,180,80
TR 204,9,6464
TR 206,9,9536
WL 10
MA 128,184,84
TR 160,8,12288
TR 162,8,15360
WL 10
MA 144,188,84
TR 164,9,12352
TR 166,9,15424
WL 10
MA 160,192,84
TR 168,8,12416
TR 170,8,15488
WL 10
MA 176,196,84
TR 172,9,12480
TR 174,9,15552
WL 10
MA 192,200,84
TR 176,8,12544
TR 178,8,15616
WL 10
MA 208,204,84
TR 180,9,12608
TR 182,9,15680
WV 6
s_barrier
v_add_u32 v6, 0, v2
v_add_u32 v7, 0, v3
WL 10
MA 128,160,88
TR 184,8,18432
TR 186,8,21504
WL 10
MA 144,164,88
TR 188,9,18496
TR 190,9,21568
s_add_u32 m0, s90, 49152
s_nop 0
DM 10,68,46
WL 10
MA 160,168,88
TR 192,8,18560
TR 194,8,21632
WL 10
MA 176,172,88
TR 196,9,18624
TR 198,9,21696
WL 10
MA 192,176,88
TR 200,8,18688
TR 202,8,21760
s_add_u32 m0, s90, 50176
s_nop 0
DM 11,68,46
WL 10
MA 208,180,88
TR 204,9,18752
TR 206,9,21824
WL 10
MA 128,184,92
TR 160,6,0
TR 162,6,3072
WL 10
MA 144,188,92
TR 164,7,64
TR 166,7,3136
s_add_u32 m0, s90, 51200
s_nop 0
DM 12,68,46
WL 10
MA 160,192,92
TR 168,6,128
TR 170,6,3200
WL 10
MA 176,196,92
TR 172,7,192
TR 174,7,3264
WL 10
MA 192,200,92
TR 176,6,256
TR 178,6,3328
s_add_u32 m0, s90, 52224
s_nop 0
DM 13,68,46
WL 10
MA 208,204,92
TR 180,7,320
TR 182,7,3392
WL 10
MA 128,160,96
TR 184,6,6144
TR 186,6,9216
WL 10
MA 144,164,96
TR 188,7,6208
TR 190,7,9280
s_add_u32 m0, s90, 53248
s_nop 0
DM 14,68,46
WL 10
MA 160,168,96
TR 192,6,6272
TR 194,6,9344
WL 10
MA 176,172,96
TR 196,7,6336
TR 198,7,9408
WL 10
MA 192,176,96
TR 200,6,6400
TR 202,6,9472
s_add_u32 m0, s90, 54272
s_nop 0
DM 15,68,46
s_add_u32 s46, s46, 786432
WL 10
MA 208,180,96
TR 204,7,6464
TR 206,7,9536
WL 10
MA 128,184,100
TR 160,6,12288
TR 162,6,15360
WL 10
MA 144,188,100
TR 164,7,12352
TR 166,7,15424
WL 10
MA 160,192,100
TR 168,6,12416
TR 170,6,15488
WL 10
MA 176,196,100
TR 172,7,12480
TR 174,7,15552
WL 10
MA 192,200,100
TR 176,6,12544
TR 178,6,15616
WL 10
MA 208,204,100
TR 180,7,12608
TR 182,7,15680
WV 6
s_barrier
v_add_u32 v8, 24576, v2
v_add_u32 v9, 24576, v3
WL 10
MA 128,160,104
TR 184,6,18432
TR 186,6,21504
WL 10
MA 144,164,104
TR 188,7,18496
TR 190,7,21568
s_add_u32 m0, s90, 73728
s_nop 0
DM 10,68,46
WL 10
MA 160,168,104
TR 192,6,18560
TR 194,6,21632
WL 10
MA 176,172,104
TR 196,7,18624
TR 198,7,21696
WL 10
MA 192,176,104
TR 200,6,18688
TR 202,6,21760
s_add_u32 m0, s90, 74752
s_nop 0
DM 11,68,46
WL 10
MA 208,180,104
TR 204,7,18752
TR 206,7,21824
WL 10
MA 128,184,108
TR 160,8,0
TR 162,8,3072
WL 10
MA 144,188,108
TR 164,9,64
TR 166,9,3136
s_add_u32 m0, s90, 75776
s_nop 0
DM 12,68,46
WL 10
MA 160,192,108
TR 168,8,128
TR 170,8,3200
WL 10
MA 176,196,108
TR 172,9,192
TR 174,9,3264
WL 10
MA 192,200,108
TR 176,8,256
TR 178,8,3328
s_add_u32 m0, s90, 76800
s_nop 0
DM 13,68,46
WL 10
MA 208,204,108
TR 180,9,320
TR 182,9,3392
WL 10
MA 128,160,112
TR 184,8,6144
TR 186,8,9216
WL 10
MA 144,164,112
TR 188,9,6208
TR 190,9,9280
s_add_u32 m0, s90, 77824
s_nop 0
DM 14,68,46
WL 10
MA 160,168,112
TR 192,8,6272
TR 194,8,9344
WL 10
MA 176,172,112
TR 196,9,6336
TR 198,9,9408
WL 10
MA 192,176,112
TR 200,8,6400
TR 202,8,9472
s_add_u32 m0, s90, 78848
s_nop 0
DM 15,68,46
s_add_u32 s46, s46, 786432
WL 10
MA 208,180,112
TR 204,9,6464
TR 206,9,9536
WL 10
MA 128,184,116
TR 160,8,12288
TR 162,8,15360
WL 10
MA 144,188,116
TR 164,9,12352
TR 166,9,15424
WL 10
MA 160,192,116
TR 168,8,12416
TR 170,8,15488
WL 10
MA 176,196,116
TR 172,9,12480
TR 174,9,15552
WL 10
MA 192,200,116
TR 176,8,12544
TR 178,8,15616
WL 10
MA 208,204,116
TR 180,9,12608
TR 182,9,15680
WV 6
s_barrier
v_add_u32 v6, 49152, v2
v_add_u32 v7, 49152, v3
WL 10
MA 128,160,120
TR 184,8,18432
TR 186,8,21504
WL 10
MA 144,164,120
TR 188,9,18496
TR 190,9,21568
WL 10
MA 160,168,120
TR 192,8,18560
TR 194,8,21632
WL 10
MA 176,172,120
TR 196,9,18624
TR 198,9,21696
WL 10
MA 192,176,120
TR 200,8,18688
TR 202,8,21760
WL 10
MA 208,180,120
TR 204,9,18752
TR 206,9,21824
WL 10
MA 128,184,124
TR 160,6,0
TR 162,6,3072
WL 10
MA 144,188,124
TR 164,7,64
TR 166,7,3136
WL 10
MA 160,192,124
TR 168,6,128
TR 170,6,3200
WL 10
MA 176,196,124
TR 172,7,192
TR 174,7,3264
WL 10
MA 192,200,124
TR 176,6,256
TR 178,6,3328
WL 10
MA 208,204,124
TR 180,7,320
TR 182,7,3392
WL 10
MA 128,160,128
TR 184,6,6144
TR 186,6,9216
WL 10
MA 144,164,128
TR 188,7,6208
TR 190,7,9280
WL 10
MA 160,168,128
TR 192,6,6272
TR 194,6,9344
WL 10
MA 176,172,128
TR 196,7,6336
TR 198,7,9408
WL 10
MA 192,176,128
TR 200,6,6400
TR 202,6,9472
WL 10
MA 208,180,128
TR 204,7,6464
TR 206,7,9536
WL 10
MA 128,184,132
TR 160,6,12288
TR 162,6,15360
WL 10
MA 144,188,132
TR 164,7,12352
TR 166,7,15424
WL 10
MA 160,192,132
TR 168,6,12416
TR 170,6,15488
WL 10
MA 176,196,132
TR 172,7,12480
TR 174,7,15552
WL 10
MA 192,200,132
TR 176,6,12544
TR 178,6,15616
WL 10
MA 208,204,132
TR 180,7,12608
TR 182,7,15680
WV 0
s_barrier
v_add_u32 v8, 73728, v2
v_add_u32 v9, 73728, v3
WL 10
MA 128,160,136
TR 184,6,18432
TR 186,6,21504
WL 10
MA 144,164,136
TR 188,7,18496
TR 190,7,21568
WL 10
MA 160,168,136
TR 192,6,18560
TR 194,6,21632
WL 10
MA 176,172,136
TR 196,7,18624
TR 198,7,21696
WL 10
MA 192,176,136
TR 200,6,18688
TR 202,6,21760
WL 10
MA 208,180,136
TR 204,7,18752
TR 206,7,21824
WL 10
MA 128,184,140
TR 160,8,0
TR 162,8,3072
WL 10
MA 144,188,140
TR 164,9,64
TR 166,9,3136
WL 10
MA 160,192,140
TR 168,8,128
TR 170,8,3200
WL 10
MA 176,196,140
TR 172,9,192
TR 174,9,3264
WL 10
MA 192,200,140
TR 176,8,256
TR 178,8,3328
WL 10
MA 208,204,140
TR 180,9,320
TR 182,9,3392
WL 10
MA 128,160,144
TR 184,8,6144
TR 186,8,9216
WL 10
MA 144,164,144
TR 188,9,6208
TR 190,9,9280
WL 10
MA 160,168,144
TR 192,8,6272
TR 194,8,9344
WL 10
MA 176,172,144
TR 196,9,6336
TR 198,9,9408
WL 10
MA 192,176,144
TR 200,8,6400
TR 202,8,9472
WL 10
MA 208,180,144
TR 204,9,6464
TR 206,9,9536
WL 10
MA 128,184,148
TR 160,8,12288
TR 162,8,15360
WL 10
MA 144,188,148
TR 164,9,12352
TR 166,9,15424
WL 10
MA 160,192,148
TR 168,8,12416
TR 170,8,15488
WL 10
MA 176,196,148
TR 172,9,12480
TR 174,9,15552
WL 10
MA 192,200,148
TR 176,8,12544
TR 178,8,15616
WL 10
MA 208,204,148
TR 180,9,12608
TR 182,9,15680
WL 10
MA 128,160,152
TR 184,8,18432
TR 186,8,21504
WL 10
MA 144,164,152
TR 188,9,18496
TR 190,9,21568
WL 10
MA 160,168,152
TR 192,8,18560
TR 194,8,21632
WL 10
MA 176,172,152
TR 196,9,18624
TR 198,9,21696
WL 10
MA 192,176,152
TR 200,8,18688
TR 202,8,21760
WL 10
MA 208,180,152
TR 204,9,18752
TR 206,9,21824
WL 10
MA 128,184,156
WL 8
MA 144,188,156
WL 6
MA 160,192,156
WL 4
MA 176,196,156
WL 2
MA 192,200,156
WL 0
MA 208,204,156
s_cmp_eq_u32 s16, 0
s_cbranch_scc0 W_f_82
s_lshl_b32 s23, s58, 2
s_add_u32 s23, s23, 128
s_mov_b64 exec, 1
v_mov_b32 v5, 1
v_mov_b32 v22, s23
buffer_atomic_add v5, v22, s[12:15], 0 offen sc0
s_mov_b64 exec, -1
W_f_82:
s_nop 7
CV 224,128,129
CV 225,130,131
CV 226,136,137
CV 227,138,139
CV 228,132,133
CV 229,134,135
CV 230,140,141
CV 231,142,143
buffer_store_dwordx4 v[224:227], v21, s[8:11], s47 offen offset:0 sc1
buffer_store_dwordx4 v[228:231], v21, s[8:11], s47 offen offset:512 sc1
CV 232,144,145
CV 233,146,147
CV 234,152,153
CV 235,154,155
CV 236,148,149
CV 237,150,151
CV 238,156,157
CV 239,158,159
buffer_store_dwordx4 v[232:235], v21, s[8:11], s47 offen offset:1024 sc1
buffer_store_dwordx4 v[236:239], v21, s[8:11], s47 offen offset:1536 sc1
CV 224,160,161
CV 225,162,163
CV 226,168,169
CV 227,170,171
CV 228,164,165
CV 229,166,167
CV 230,172,173
CV 231,174,175
buffer_store_dwordx4 v[224:227], v21, s[8:11], s47 offen offset:2048 sc1
buffer_store_dwordx4 v[228:231], v21, s[8:11], s47 offen offset:2560 sc1
CV 232,176,177
CV 233,178,179
CV 234,184,185
CV 235,186,187
CV 236,180,181
CV 237,182,183
CV 238,188,189
CV 239,190,191
buffer_store_dwordx4 v[232:235], v21, s[8:11], s47 offen offset:3072 sc1
buffer_store_dwordx4 v[236:239], v21, s[8:11], s47 offen offset:3584 sc1
CV 224,192,193
CV 225,194,195
CV 226,200,201
CV 227,202,203
CV 228,196,197
CV 229,198,199
CV 230,204,205
CV 231,206,207
s_add_u32 s47, s47, 4096
buffer_store_dwordx4 v[224:227], v21, s[8:11], s47 offen offset:0 sc1
buffer_store_dwordx4 v[228:231], v21, s[8:11], s47 offen offset:512 sc1
CV 232,208,209
CV 233,210,211
CV 234,216,217
CV 235,218,219
CV 236,212,213
CV 237,214,215
CV 238,220,221
CV 239,222,223
buffer_store_dwordx4 v[232:235], v21, s[8:11], s47 offen offset:1024 sc1
buffer_store_dwordx4 v[236:239], v21, s[8:11], s47 offen offset:1536 sc1
WV 0
s_lshl_b32 s48, s40, 5
s_add_u32 s48, s48, s41
s_lshl_b32 s48, s48, 7
s_add_u32 s48, s48, 131072
s_mov_b32 s49, s48
s_mov_b32 s48, -1
W_end:
s_cmp_eq_u32 s16, 0
s_cbranch_scc0 W_p_83
s_mov_b64 exec, 1
v_mov_b32 v22, 147456
ds_write_b32 v22, v5
WL 0
s_mov_b64 exec, -1
W_p_83:
s_barrier
s_cmp_eq_u32 s48, -1
s_cbranch_scc1 W_nosig_84
s_cmp_eq_u32 s16, 0
s_cbranch_scc0 sig_85
s_mov_b64 exec, 1
v_mov_b32 v22, 1
v_mov_b32 v23, 0
buffer_atomic_add v22, v23, s[8:11], s48 offen
s_mov_b64 exec, -1
sig_85:
W_nosig_84:
s_cmp_eq_u32 s49, -1
s_cbranch_scc1 W_nosig_86
s_cmp_eq_u32 s16, 0
s_cbranch_scc0 sig_87
s_mov_b64 exec, 1
v_mov_b32 v22, 1
v_mov_b32 v23, 0
buffer_atomic_add v22, v23, s[8:11], s49 offen
s_mov_b64 exec, -1
sig_87:
W_nosig_86:
s_branch W_loop
W_done:
s_cmp_eq_u32 s16, 0
s_cbranch_scc0 W_cnt_88
v_mov_b32 v22, 104
buffer_load_dword v23, v22, s[12:15], 0 offen sc1
WV 0
v_mov_b32 v22, 147472
ds_write_b32 v22, v23
WL 0
W_cnt_88:
s_barrier
v_mov_b32 v22, 147472
ds_read_b32 v23, v22
WL 0
v_readfirstlane_b32 s23, v23
s_nop 3
s_cmp_lt_u32 s23, 4
s_cbranch_scc0 W_toB
s_getpc_b64 s[92:93]
W_pc2:
s_sub_u32 s92, s92, W_pc2-W_serveA
s_subb_u32 s93, s93, 0
s_setpc_b64 s[92:93]
W_toB:
s_mov_b32 s58, 5
P_phase:
s_load_dwordx2 s[6:7], s[0:1], 64
WL 0
s_mov_b32 s68, s6
s_and_b32 s69, s7, 0xffff
s_mov_b32 s70, 0x1e0000
s_mov_b32 s71, 0x20000
s_load_dwordx2 s[6:7], s[0:1], 72
WL 0
s_mov_b32 s72, s6
s_and_b32 s73, s7, 0xffff
s_mov_b32 s74, 0x1e0000
s_mov_b32 s75, 0x20000
s_load_dwordx2 s[6:7], s[0:1], 80
WL 0
s_mov_b32 s76, s6
s_and_b32 s77, s7, 0xffff
s_mov_b32 s78, 0x1e0000
s_mov_b32 s79, 0x20000
s_load_dwordx2 s[6:7], s[0:1], 0
WL 0
s_mov_b32 s80, s6
s_and_b32 s81, s7, 0xffff
s_mov_b32 s82, 0x280000
s_mov_b32 s83, 0x20000
s_load_dwordx2 s[6:7], s[0:1], 104
WL 0
s_mov_b32 s84, s6
s_and_b32 s85, s7, 0xffff
s_mov_b32 s86, 0x280000
s_mov_b32 s87, 0x20000
s_load_dwordx2 s[6:7], s[0:1], 112
WL 0
s_mov_b32 s12, s6
s_and_b32 s13, s7, 0xffff
s_mov_b32 s14, 0x100
s_mov_b32 s15, 0x20000
s_mov_b32 s54, 0
s_mov_b32 s95, -1
P_refetch:
s_cmp_eq_u32 s16, 0
s_cbranch_scc0 W_f_89
s_lshl_b32 s23, s58, 2
s_add_u32 s23, s23, 128
s_mov_b64 exec, 1
v_mov_b32 v5, 1
v_mov_b32 v22, s23
buffer_atomic_add v5, v22, s[12:15], 0 offen sc0
s_mov_b64 exec, -1
W_f_89:
WV 0
s_cmp_eq_u32 s16, 0
s_cbranch_scc0 W_p_90
s_mov_b64 exec, 1
v_mov_b32 v22, 147456
ds_write_b32 v22, v5
WL 0
s_mov_b64 exec, -1
W_p_90:
s_barrier
P_loop:
v_mov_b32 v22, 147456
ds_read_b32 v23, v22
WL 0
v_readfirstlane_b32 s60, v23
s_nop 3
s_barrier
s_cmp_eq_u32 s58, 4
s_cbranch_scc0 P_qb
s_cmp_ge_u32 s60, 312
s_cbranch_scc0 P_go
s_mov_b32 s58, 5
s_branch P_refetch
P_qb:
s_add_u32 s60, s60, 312
s_cmp_ge_u32 s60, 1236
s_cbranch_scc0 P_go
WV 0
s_endpgm
P_go:
s_getpc_b64 s[92:93]
P_pc:
s_add_u32 s92, s92, P_table-P_pc
s_addc_u32 s93, s93, 0
s_lshl_b32 s23, s60, 2
s_load_dword s57, s[92:93], s23
WL 0
s_lshr_b32 s56, s57, 16
s_lshr_b32 s40, s57, 8
s_and_b32 s40, s40, 255
s_and_b32 s41, s57, 255
s_cmp_eq_u32 s56, 9
s_cbranch_scc1 P_f2g
s_cmp_eq_u32 s56, 8
s_cbranch_scc1 P_wf
s_cmp_eq_u32 s56, 7
s_cbranch_scc1 P_f2f
s_cmp_eq_u32 s56, 6
s_cbranch_scc1 P_f1f
s_cmp_eq_u32 s56, 5
s_cbranch_scc1 P_lnf
s_cmp_eq_u32 s56, 4
s_cbranch_scc1 P_t2f
s_cmp_eq_u32 s56, 3
s_cbranch_scc1 P_f2
s_cmp_eq_u32 s56, 2
s_cbranch_scc1 P_f1
s_cmp_eq_u32 s56, 1
s_cbranch_scc1 P_ln
s_mul_i32 s24, s41, 13108
s_lshr_b32 s24, s24, 16
s_mul_i32 s25, s24, 5
s_sub_u32 s41, s41, s25
s_mov_b32 s55, s40
s_lshl_b32 s40, s40, 2
s_add_u32 s40, s40, s24
s_cmp_ge_u32 s40, 62
s_cbranch_scc1 ws_91
s_add_u32 s48, s40, 1
s_lshl_b32 s48, s48, 9
s_add_u32 s48, s48, 229376
s_cmp_eq_u32 s16, 0
s_cbranch_scc0 dw_94
s_mov_b32 s22, 0
v_and_b32 v22, 63, v0
v_min_u32 v24, 31, v22
v_lshrrev_b32 v25, 3, v24
v_lshlrev_b32 v25, 7, v25
v_and_b32 v24, 7, v24
v_lshlrev_b32 v24, 2, v24
v_add_u32 v24, v24, v25
dw_93:
buffer_load_dword v23, v24, s[8:11], s48 offen sc1
s_add_u32 s22, s22, 1
s_cmp_gt_u32 s22, 524288
s_cbranch_scc1 dw_94
WV 0
v_cmp_eq_u32 vcc, 0, v23
s_cbranch_vccz dw_94
s_sleep 40
s_branch dw_93
dw_94:
s_barrier
s_branch ws_92
ws_91:
s_mov_b32 s48, 261632
s_mov_b32 s49, 200704
s_cmp_eq_u32 s16, 0
s_cbranch_scc0 dw_96
s_mov_b32 s22, 0
v_and_b32 v22, 63, v0
v_min_u32 v24, 31, v22
v_lshrrev_b32 v25, 3, v24
v_lshlrev_b32 v25, 7, v25
v_and_b32 v24, 7, v24
v_lshlrev_b32 v24, 2, v24
v_add_u32 v24, v24, v25
dw_95:
buffer_load_dword v23, v24, s[8:11], s48 offen sc1
s_add_u32 s22, s22, 1
s_cmp_gt_u32 s22, 524288
s_cbranch_scc1 dw_96
WV 0
v_cmp_eq_u32 vcc, 0, v23
s_cbranch_vccz dw_96
s_sleep 2
s_branch dw_95
dw_96:
s_barrier
s_cmp_eq_u32 s16, 0
s_cbranch_scc0 dw_98
s_mov_b32 s22, 0
v_and_b32 v22, 63, v0
v_min_u32 v24, 63, v22
v_lshlrev_b32 v24, 2, v24
v_add_u32 v25, 64, v22
v_min_u32 v25, 79, v25
v_lshlrev_b32 v25, 2, v25
dw_97:
buffer_load_dword v23, v24, s[8:11], s49 offen sc1
buffer_load_dword v26, v25, s[8:11], s49 offen sc1
s_add_u32 s22, s22, 1
s_cmp_gt_u32 s22, 524288
s_cbranch_scc1 dw_98
WV 0
v_min_u32 v23, v23, v26
v_cmp_eq_u32 vcc, 0, v23
s_cbranch_vccz dw_98
s_sleep 2
s_branch dw_97
dw_98:
s_barrier
ws_92:
v_and_b32 v22, 63, v0
v_lshlrev_b32 v1, 4, v22
s_mul_i32 s42, s40, 81920
s_mul_i32 s23, s16, 20480
s_add_u32 s42, s42, s23
s_add_u32 s42, s42, 26214400
s_add_u32 m0, s23, 0
s_nop 0
buffer_load_dwordx4 v1, s[8:11], s42 offen offset:0 sc1 lds
buffer_load_dwordx4 v1, s[8:11], s42 offen offset:1024 sc1 lds
buffer_load_dwordx4 v1, s[8:11], s42 offen offset:2048 sc1 lds
buffer_load_dwordx4 v1, s[8:11], s42 offen offset:3072 sc1 lds
s_add_u32 s42, s42, 4096
s_add_u32 m0, s23, 4096
s_nop 0
buffer_load_dwordx4 v1, s[8:11], s42 offen offset:0 sc1 lds
buffer_load_dwordx4 v1, s[8:11], s42 offen offset:1024 sc1 lds
buffer_load_dwordx4 v1, s[8:11], s42 offen offset:2048 sc1 lds
buffer_load_dwordx4 v1, s[8:11], s42 offen offset:3072 sc1 lds
s_add_u32 s42, s42, 4096
s_add_u32 m0, s23, 8192
s_nop 0
buffer_load_dwordx4 v1, s[8:11], s42 offen offset:0 sc1 lds
buffer_load_dwordx4 v1, s[8:11], s42 offen offset:1024 sc1 lds
buffer_load_dwordx4 v1, s[8:11], s42 offen offset:2048 sc1 lds
buffer_load_dwordx4 v1, s[8:11], s42 offen offset:3072 sc1 lds
s_add_u32 s42, s42, 4096
s_add_u32 m0, s23, 12288
s_nop 0
buffer_load_dwordx4 v1, s[8:11], s42 offen offset:0 sc1 lds
buffer_load_dwordx4 v1, s[8:11], s42 offen offset:1024 sc1 lds
buffer_load_dwordx4 v1, s[8:11], s42 offen offset:2048 sc1 lds
buffer_load_dwordx4 v1, s[8:11], s42 offen offset:3072 sc1 lds
s_add_u32 s42, s42, 4096
s_add_u32 m0, s23, 16384
s_nop 0
buffer_load_dwordx4 v1, s[8:11], s42 offen offset:0 sc1 lds
buffer_load_dwordx4 v1, s[8:11], s42 offen offset:1024 sc1 lds
buffer_load_dwordx4 v1, s[8:11], s42 offen offset:2048 sc1 lds
buffer_load_dwordx4 v1, s[8:11], s42 offen offset:3072 sc1 lds
s_add_u32 s42, s42, 4096
v_and_b32 v23, 31, v22
v_lshrrev_b32 v24, 3, v23
v_and_b32 v23, 7, v23
v_lshlrev_b32 v23, 4, v23
v_lshrrev_b32 v25, 5, v22
v_lshlrev_b32 v26, 8, v25
v_add_u32 v23, v23, v26
v_lshlrev_b32 v26, 14, v24
v_add_u32 v2, v23, v26
v_lshlrev_b32 v26, 12, v24
v_add_u32 v3, v23, v26
s_lshl_b32 s43, s41, 4
s_lshl_b32 s23, s16, 2
s_add_u32 s43, s43, s23
s_mul_i32 s44, s40, 80
s_add_u32 s44, s44, s43
s_lshl_b32 s45, s44, 12
s_add_u32 s45, s45, 123731968
s_lshl_b32 s44, s44, 14
s_add_u32 s44, s44, 144703488
v_mul_u32_u24 v26, 2560, v25
v_and_b32 v27, 31, v22
v_lshlrev_b32 v27, 4, v27
v_add3_u32 v4, v26, v27, 0
v_add_u32 v4, 2048, v4
v_add_u32 v5, 40960, v1
v_add_u32 v6, 40960, v4
buffer_load_dwordx4 v[64:67], v2, s[8:11], s44 offen offset:0 sc1
buffer_load_dwordx4 v[68:71], v2, s[8:11], s44 offen offset:512 sc1
buffer_load_dwordx4 v[72:75], v2, s[8:11], s44 offen offset:128 sc1
buffer_load_dwordx4 v[76:79], v2, s[8:11], s44 offen offset:640 sc1
buffer_load_dwordx4 v[80:83], v2, s[8:11], s44 offen offset:1024 sc1
buffer_load_dwordx4 v[84:87], v2, s[8:11], s44 offen offset:1536 sc1
buffer_load_dwordx4 v[88:91], v2, s[8:11], s44 offen offset:1152 sc1
buffer_load_dwordx4 v[92:95], v2, s[8:11], s44 offen offset:1664 sc1
buffer_load_dwordx4 v[96:99], v2, s[8:11], s44 offen offset:2048 sc1
buffer_load_dwordx4 v[100:103], v2, s[8:11], s44 offen offset:2560 sc1
buffer_load_dwordx4 v[104:107], v2, s[8:11], s44 offen offset:2176 sc1
buffer_load_dwordx4 v[108:111], v2, s[8:11], s44 offen offset:2688 sc1
WV 12
s_barrier
ds_read_b128 v[48:51], v1 offset:0
ds_read_b128 v[52:55], v1 offset:1024
ds_read_b128 v[56:59], v1 offset:2560
WV 11
WL 2
v_mfma_f32_32x32x16_bf16 v[32:47], v[64:67], v[48:51], 0
buffer_load_dwordx4 v[64:67], v2, s[8:11], s44 offen offset:3072 sc1
ds_read_b128 v[60:63], v1 offset:3584
WV 11
WL 2
MV 32,68,52
buffer_load_dwordx4 v[68:71], v2, s[8:11], s44 offen offset:3584 sc1
ds_read_b128 v[48:51], v1 offset:5120
WV 11
WL 2
MV 32,72,56
buffer_load_dwordx4 v[72:75], v2, s[8:11], s44 offen offset:3200 sc1
ds_read_b128 v[52:55], v1 offset:6144
WV 11
WL 2
MV 32,76,60
buffer_load_dwordx4 v[76:79], v2, s[8:11], s44 offen offset:3712 sc1
ds_read_b128 v[56:59], v1 offset:7680
WV 11
WL 2
MV 32,80,48
s_add_u32 s44, s44, 4096
buffer_load_dwordx4 v[80:83], v2, s[8:11], s44 offen offset:0 sc1
ds_read_b128 v[60:63], v1 offset:8704
WV 11
WL 2
MV 32,84,52
buffer_load_dwordx4 v[84:87], v2, s[8:11], s44 offen offset:512 sc1
ds_read_b128 v[48:51], v1 offset:10240
WV 11
WL 2
MV 32,88,56
buffer_load_dwordx4 v[88:91], v2, s[8:11], s44 offen offset:128 sc1
ds_read_b128 v[52:55], v1 offset:11264
WV 11
WL 2
MV 32,92,60
buffer_load_dwordx4 v[92:95], v2, s[8:11], s44 offen offset:640 sc1
ds_read_b128 v[56:59], v1 offset:12800
WV 11
WL 2
MV 32,96,48
buffer_load_dwordx4 v[96:99], v2, s[8:11], s44 offen offset:1024 sc1
ds_read_b128 v[60:63], v1 offset:13824
WV 11
WL 2
MV 32,100,52
buffer_load_dwordx4 v[100:103], v2, s[8:11], s44 offen offset:1536 sc1
ds_read_b128 v[48:51], v1 offset:15360
WV 11
WL 2
MV 32,104,56
buffer_load_dwordx4 v[104:107], v2, s[8:11], s44 offen offset:1152 sc1
ds_read_b128 v[52:55], v1 offset:16384
WV 11
WL 2
MV 32,108,60
buffer_load_dwordx4 v[108:111], v2, s[8:11], s44 offen offset:1664 sc1
ds_read_b128 v[56:59], v1 offset:17920
WV 11
WL 2
MV 32,64,48
buffer_load_dwordx4 v[64:67], v2, s[8:11], s44 offen offset:2048 sc1
ds_read_b128 v[60:63], v1 offset:18944
WV 11
WL 2
MV 32,68,52
buffer_load_dwordx4 v[68:71], v2, s[8:11], s44 offen offset:2560 sc1
ds_read_b128 v[48:51], v1 offset:20480
WV 11
WL 2
MV 32,72,56
buffer_load_dwordx4 v[72:75], v2, s[8:11], s44 offen offset:2176 sc1
ds_read_b128 v[52:55], v1 offset:21504
WV 11
WL 2
MV 32,76,60
buffer_load_dwordx4 v[76:79], v2, s[8:11], s44 offen offset:2688 sc1
ds_read_b128 v[56:59], v1 offset:23040
WV 11
WL 2
MV 32,80,48
buffer_load_dwordx4 v[80:83], v2, s[8:11], s44 offen offset:3072 sc1
ds_read_b128 v[60:63], v1 offset:24064
WV 11
WL 2
MV 32,84,52
buffer_load_dwordx4 v[84:87], v2, s[8:11], s44 offen offset:3584 sc1
ds_read_b128 v[48:51], v1 offset:25600
WV 11
WL 2
MV 32,88,56
buffer_load_dwordx4 v[88:91], v2, s[8:11], s44 offen offset:3200 sc1
ds_read_b128 v[52:55], v1 offset:26624
WV 11
WL 2
MV 32,92,60
buffer_load_dwordx4 v[92:95], v2, s[8:11], s44 offen offset:3712 sc1
ds_read_b128 v[56:59], v1 offset:28160
WV 11
WL 2
MV 32,96,48
s_add_u32 s44, s44, 4096
buffer_load_dwordx4 v[96:99], v2, s[8:11], s44 offen offset:0 sc1
ds_read_b128 v[60:63], v1 offset:29184
WV 11
WL 2
MV 32,100,52
buffer_load_dwordx4 v[100:103], v2, s[8:11], s44 offen offset:512 sc1
ds_read_b128 v[48:51], v1 offset:30720
WV 11
WL 2
MV 32,104,56
buffer_load_dwordx4 v[104:107], v2, s[8:11], s44 offen offset:128 sc1
ds_read_b128 v[52:55], v1 offset:31744
WV 11
WL 2
MV 32,108,60
buffer_load_dwordx4 v[108:111], v2, s[8:11], s44 offen offset:640 sc1
ds_read_b128 v[56:59], v1 offset:33280
WV 11
WL 2
MV 32,64,48
buffer_load_dwordx4 v[64:67], v2, s[8:11], s44 offen offset:1024 sc1
ds_read_b128 v[60:63], v1 offset:34304
WV 11
WL 2
MV 32,68,52
buffer_load_dwordx4 v[68:71], v2, s[8:11], s44 offen offset:1536 sc1
ds_read_b128 v[48:51], v1 offset:35840
WV 11
WL 2
MV 32,72,56
buffer_load_dwordx4 v[72:75], v2, s[8:11], s44 offen offset:1152 sc1
ds_read_b128 v[52:55], v1 offset:36864
WV 11
WL 2
MV 32,76,60
buffer_load_dwordx4 v[76:79], v2, s[8:11], s44 offen offset:1664 sc1
ds_read_b128 v[56:59], v1 offset:38400
WV 11
WL 2
MV 32,80,48
buffer_load_dwordx4 v[80:83], v2, s[8:11], s44 offen offset:2048 sc1
ds_read_b128 v[60:63], v1 offset:39424
WV 11
WL 2
MV 32,84,52
buffer_load_dwordx4 v[84:87], v2, s[8:11], s44 offen offset:2560 sc1
ds_read_b128 v[48:51], v1 offset:40960
WV 11
WL 2
MV 32,88,56
buffer_load_dwordx4 v[88:91], v2, s[8:11], s44 offen offset:2176 sc1
ds_read_b128 v[52:55], v1 offset:41984
WV 11
WL 2
MV 32,92,60
buffer_load_dwordx4 v[92:95], v2, s[8:11], s44 offen offset:2688 sc1
ds_read_b128 v[56:59], v1 offset:43520
WV 11
WL 2
MV 32,96,48
buffer_load_dwordx4 v[96:99], v2, s[8:11], s44 offen offset:3072 sc1
ds_read_b128 v[60:63], v1 offset:44544
WV 11
WL 2
MV 32,100,52
buffer_load_dwordx4 v[100:103], v2, s[8:11], s44 offen offset:3584 sc1
ds_read_b128 v[48:51], v1 offset:46080
WV 11
WL 2
MV 32,104,56
buffer_load_dwordx4 v[104:107], v2, s[8:11], s44 offen offset:3200 sc1
ds_read_b128 v[52:55], v1 offset:47104
WV 11
WL 2
MV 32,108,60
buffer_load_dwordx4 v[108:111], v2, s[8:11], s44 offen offset:3712 sc1
ds_read_b128 v[56:59], v1 offset:48640
WV 11
WL 2
MV 32,64,48
s_add_u32 s44, s44, 4096
buffer_load_dwordx4 v[64:67], v2, s[8:11], s44 offen offset:0 sc1
ds_read_b128 v[60:63], v1 offset:49664
WV 11
WL 2
MV 32,68,52
buffer_load_dwordx4 v[68:71], v2, s[8:11], s44 offen offset:512 sc1
ds_read_b128 v[48:51], v1 offset:51200
WV 11
WL 2
MV 32,72,56
buffer_load_dwordx4 v[72:75], v2, s[8:11], s44 offen offset:128 sc1
ds_read_b128 v[52:55], v1 offset:52224
WV 11
WL 2
MV 32,76,60
buffer_load_dwordx4 v[76:79], v2, s[8:11], s44 offen offset:640 sc1
ds_read_b128 v[56:59], v1 offset:53760
WV 11
WL 2
MV 32,80,48
buffer_load_dwordx4 v[80:83], v2, s[8:11], s44 offen offset:1024 sc1
ds_read_b128 v[60:63], v1 offset:54784
WV 11
WL 2
MV 32,84,52
buffer_load_dwordx4 v[84:87], v2, s[8:11], s44 offen offset:1536 sc1
ds_read_b128 v[48:51], v1 offset:56320
WV 11
WL 2
MV 32,88,56
buffer_load_dwordx4 v[88:91], v2, s[8:11], s44 offen offset:1152 sc1
ds_read_b128 v[52:55], v1 offset:57344
WV 11
WL 2
MV 32,92,60
buffer_load_dwordx4 v[92:95], v2, s[8:11], s44 offen offset:1664 sc1
ds_read_b128 v[56:59], v1 offset:58880
WV 11
WL 2
MV 32,96,48
buffer_load_dwordx4 v[96:99], v2, s[8:11], s44 offen offset:2048 sc1
ds_read_b128 v[60:63], v1 offset:59904
WV 11
WL 2
MV 32,100,52
buffer_load_dwordx4 v[100:103], v2, s[8:11], s44 offen offset:2560 sc1
ds_read_b128 v[48:51], v1 offset:61440
WV 11
WL 2
MV 32,104,56
buffer_load_dwordx4 v[104:107], v2, s[8:11], s44 offen offset:2176 sc1
ds_read_b128 v[52:55], v1 offset:62464
WV 11
WL 2
MV 32,108,60
buffer_load_dwordx4 v[108:111], v2, s[8:11], s44 offen offset:2688 sc1
ds_read_b128 v[56:59], v1 offset:64000
WV 11
WL 2
MV 32,64,48
buffer_load_dwordx4 v[64:67], v2, s[8:11], s44 offen offset:3072 sc1
ds_read_b128 v[60:63], v1 offset:65024
WV 11
WL 2
MV 32,68,52
buffer_load_dwordx4 v[68:71], v2, s[8:11], s44 offen offset:3584 sc1
ds_read_b128 v[48:51], v5 offset:25600
WV 11
WL 2
MV 32,72,56
buffer_load_dwordx4 v[72:75], v2, s[8:11], s44 offen offset:3200 sc1
ds_read_b128 v[52:55], v5 offset:26624
WV 11
WL 2
MV 32,76,60
buffer_load_dwordx4 v[76:79], v2, s[8:11], s44 offen offset:3712 sc1
ds_read_b128 v[56:59], v5 offset:28160
WV 11
WL 2
MV 32,80,48
buffer_load_dwordx4 v[80:83], v3, s[8:11], s45 offen offset:0 sc1
ds_read_b128 v[60:63], v5 offset:29184
WV 11
WL 2
MV 32,84,52
buffer_load_dwordx4 v[84:87], v3, s[8:11], s45 offen offset:512 sc1
ds_read_b128 v[48:51], v5 offset:30720
WV 11
WL 2
MV 32,88,56
buffer_load_dwordx4 v[88:91], v3, s[8:11], s45 offen offset:128 sc1
ds_read_b128 v[52:55], v5 offset:31744
WV 11
WL 2
MV 32,92,60
buffer_load_dwordx4 v[92:95], v3, s[8:11], s45 offen offset:640 sc1
ds_read_b128 v[56:59], v5 offset:33280
WV 11
WL 2
MV 32,96,48
buffer_load_dwordx4 v[96:99], v3, s[8:11], s45 offen offset:1024 sc1
ds_read_b128 v[60:63], v5 offset:34304
WV 11
WL 2
MV 32,100,52
buffer_load_dwordx4 v[100:103], v3, s[8:11], s45 offen offset:1536 sc1
ds_read_b128 v[48:51], v5 offset:35840
WV 11
WL 2
MV 32,104,56
buffer_load_dwordx4 v[104:107], v3, s[8:11], s45 offen offset:1152 sc1
ds_read_b128 v[52:55], v5 offset:36864
WV 11
WL 2
MV 32,108,60
buffer_load_dwordx4 v[108:111], v3, s[8:11], s45 offen offset:1664 sc1
ds_read_b128 v[56:59], v5 offset:38400
WV 11
WL 2
MV 32,64,48
buffer_load_dwordx4 v[64:67], v3, s[8:11], s45 offen offset:2048 sc1
ds_read_b128 v[60:63], v5 offset:39424
WV 11
WL 2
MV 32,68,52
buffer_load_dwordx4 v[68:71], v3, s[8:11], s45 offen offset:2560 sc1
ds_read_b128 v[48:51], v4 offset:0
WV 11
WL 2
MV 32,72,56
buffer_load_dwordx4 v[72:75], v3, s[8:11], s45 offen offset:2176 sc1
ds_read_b128 v[52:55], v4 offset:5120
WV 11
WL 2
MV 32,76,60
buffer_load_dwordx4 v[76:79], v3, s[8:11], s45 offen offset:2688 sc1
ds_read_b128 v[56:59], v4 offset:10240
WV 11
WL 2
MV 32,80,48
buffer_load_dwordx4 v[80:83], v3, s[8:11], s45 offen offset:3072 sc1
ds_read_b128 v[60:63], v4 offset:15360
WV 11
WL 2
MV 32,84,52
buffer_load_dwordx4 v[84:87], v3, s[8:11], s45 offen offset:3584 sc1
ds_read_b128 v[48:51], v4 offset:20480
WV 11
WL 2
MV 32,88,56
buffer_load_dwordx4 v[88:91], v3, s[8:11], s45 offen offset:3200 sc1
ds_read_b128 v[52:55], v4 offset:25600
WV 11
WL 2
MV 32,92,60
buffer_load_dwordx4 v[92:95], v3, s[8:11], s45 offen offset:3712 sc1
ds_read_b128 v[56:59], v4 offset:30720
WV 11
WL 2
MV 32,96,48
ds_read_b128 v[60:63], v4 offset:35840
s_lshl_b32 s46, s43, 3
s_lshl_b32 s47, s40, 5
s_mov_b32 s49, 13631488
v_and_b32 v22, 63, v0
v_and_b32 v23, 31, v22
v_add_u32 v23, s47, v23
v_mul_u32_u24 v23, 1280, v23
v_lshrrev_b32 v24, 5, v22
v_lshlrev_b32 v25, 3, v24
v_add_u32 v23, v23, v25
s_lshl_b32 s23, s46, 1
v_add_u32 v23, s23, v23
v_lshlrev_b32 v24, 4, v24
s_lshl_b32 s23, s46, 2
v_add_u32 v24, s23, v24
s_mov_b32 s24, 9216
buffer_load_dwordx4 v[112:115], v24, s[8:11], s24 offen offset:0
buffer_load_dwordx2 v[128:129], v23, s[80:83], 0 offen offset:0
buffer_load_dwordx4 v[116:119], v24, s[8:11], s24 offen offset:32
buffer_load_dwordx2 v[130:131], v23, s[80:83], 0 offen offset:16
buffer_load_dwordx4 v[120:123], v24, s[8:11], s24 offen offset:64
buffer_load_dwordx2 v[132:133], v23, s[80:83], 0 offen offset:32
buffer_load_dwordx4 v[124:127], v24, s[8:11], s24 offen offset:96
buffer_load_dwordx2 v[134:135], v23, s[80:83], 0 offen offset:48
WV 18
WL 2
MV 32,100,52
ds_read_b128 v[48:51], v4 offset:40960
WV 17
WL 2
MV 32,104,56
ds_read_b128 v[52:55], v4 offset:46080
WV 16
WL 2
MV 32,108,60
ds_read_b128 v[56:59], v4 offset:51200
WV 15
WL 2
MV 32,64,48
ds_read_b128 v[60:63], v4 offset:56320
WV 14
WL 2
MV 32,68,52
ds_read_b128 v[48:51], v6 offset:20480
WV 13
WL 2
MV 32,72,56
ds_read_b128 v[52:55], v6 offset:25600
WV 12
WL 2
MV 32,76,60
ds_read_b128 v[56:59], v6 offset:30720
WV 11
WL 2
MV 32,80,48
ds_read_b128 v[60:63], v6 offset:35840
WV 10
WL 2
MV 32,84,52
WV 9
WL 1
MV 32,88,56
WV 8
WL 0
MV 32,92,60
s_nop 7
s_nop 7
s_cmp_eq_u32 s16, 0
s_cbranch_scc0 W_f_99
s_lshl_b32 s23, s58, 2
s_add_u32 s23, s23, 128
s_mov_b64 exec, 1
v_mov_b32 v5, 1
v_mov_b32 v22, s23
buffer_atomic_add v5, v22, s[12:15], 0 offen sc0
s_mov_b64 exec, -1
W_f_99:
WV 0
CV 26,32,33
SH 32,26
HH 33,26
v_mul_f32 v32, v32, v112
v_mul_f32 v33, v33, v113
CV 26,32,33
SH 32,26
HH 33,26
SH 27,128
HH 28,128
v_add_f32 v32, v32, v27
v_add_f32 v33, v33, v28
CV 128,32,33
CV 26,34,35
SH 34,26
HH 35,26
v_mul_f32 v34, v34, v114
v_mul_f32 v35, v35, v115
CV 26,34,35
SH 34,26
HH 35,26
SH 27,129
HH 28,129
v_add_f32 v34, v34, v27
v_add_f32 v35, v35, v28
CV 129,34,35
buffer_store_dwordx2 v[128:129], v23, s[8:11], s49 offen offset:0 sc1
CV 26,36,37
SH 36,26
HH 37,26
v_mul_f32 v36, v36, v116
v_mul_f32 v37, v37, v117
CV 26,36,37
SH 36,26
HH 37,26
SH 27,130
HH 28,130
v_add_f32 v36, v36, v27
v_add_f32 v37, v37, v28
CV 130,36,37
CV 26,38,39
SH 38,26
HH 39,26
v_mul_f32 v38, v38, v118
v_mul_f32 v39, v39, v119
CV 26,38,39
SH 38,26
HH 39,26
SH 27,131
HH 28,131
v_add_f32 v38, v38, v27
v_add_f32 v39, v39, v28
CV 131,38,39
buffer_store_dwordx2 v[130:131], v23, s[8:11], s49 offen offset:16 sc1
CV 26,40,41
SH 40,26
HH 41,26
v_mul_f32 v40, v40, v120
v_mul_f32 v41, v41, v121
CV 26,40,41
SH 40,26
HH 41,26
SH 27,132
HH 28,132
v_add_f32 v40, v40, v27
v_add_f32 v41, v41, v28
CV 132,40,41
CV 26,42,43
SH 42,26
HH 43,26
v_mul_f32 v42, v42, v122
v_mul_f32 v43, v43, v123
CV 26,42,43
SH 42,26
HH 43,26
SH 27,133
HH 28,133
v_add_f32 v42, v42, v27
v_add_f32 v43, v43, v28
CV 133,42,43
buffer_store_dwordx2 v[132:133], v23, s[8:11], s49 offen offset:32 sc1
CV 26,44,45
SH 44,26
HH 45,26
v_mul_f32 v44, v44, v124
v_mul_f32 v45, v45, v125
CV 26,44,45
SH 44,26
HH 45,26
SH 27,134
HH 28,134
v_add_f32 v44, v44, v27
v_add_f32 v45, v45, v28
CV 134,44,45
CV 26,46,47
SH 46,26
HH 47,26
v_mul_f32 v46, v46, v126
v_mul_f32 v47, v47, v127
CV 26,46,47
SH 46,26
HH 47,26
SH 27,135
HH 28,135
v_add_f32 v46, v46, v27
v_add_f32 v47, v47, v28
CV 135,46,47
buffer_store_dwordx2 v[134:135], v23, s[8:11], s49 offen offset:48 sc1
WV 0
s_lshl_b32 s48, s55, 7
s_add_u32 s48, s48, 217088
s_branch P_end
P_ln:
s_mov_b32 s55, s40
s_lshl_b32 s48, s40, 7
s_add_u32 s48, s48, 217088
s_cmp_eq_u32 s16, 0
s_cbranch_scc0 dep_101
s_mov_b32 s22, 0
v_mov_b32 v22, 0
dep_100:
buffer_load_dword v23, v22, s[8:11], s48 offen sc1
s_add_u32 s22, s22, 1
s_cmp_gt_u32 s22, 524288
s_cbranch_scc1 dep_101
WV 0
v_readfirstlane_b32 s23, v23
s_nop 3
s_cmp_ge_u32 s23, 20
s_cbranch_scc1 dep_101
s_sleep 12
s_branch dep_100
dep_101:
s_barrier
s_lshl_b32 s40, s40, 2
s_add_u32 s40, s40, s41
s_lshl_b32 s40, s40, 1
s_mov_b32 s27, 13631488
v_and_b32 v2, 63, v0
v_lshrrev_b32 v3, 4, v2
v_and_b32 v4, 15, v2
s_lshl_b32 s23, s40, 4
s_lshl_b32 s24, s16, 2
s_add_u32 s23, s23, s24
v_add_u32 v5, s23, v3
v_mul_u32_u24 v6, 1280, v5
v_lshlrev_b32 v7, 4, v4
v_add_u32 v6, v6, v7
buffer_load_dwordx4 v[16:19], v6, s[8:11], s27 offen offset:0 sc1
buffer_load_dwordx4 v[20:23], v6, s[8:11], s27 offen offset:256 sc1
buffer_load_dwordx4 v[24:27], v6, s[8:11], s27 offen offset:512 sc1
buffer_load_dwordx4 v[28:31], v6, s[8:11], s27 offen offset:768 sc1
buffer_load_dwordx4 v[32:35], v6, s[8:11], s27 offen offset:1024 sc1
v_lshlrev_b32 v7, 5, v4
s_mov_b32 s25, 14336
s_mov_b32 s26, 11776
buffer_load_dwordx4 v[40:43], v7, s[8:11], s25 offen offset:0
buffer_load_dwordx4 v[44:47], v7, s[8:11], s25 offen offset:16
buffer_load_dwordx4 v[80:83], v7, s[8:11], s26 offen offset:0
buffer_load_dwordx4 v[84:87], v7, s[8:11], s26 offen offset:16
buffer_load_dwordx4 v[48:51], v7, s[8:11], s25 offen offset:512
buffer_load_dwordx4 v[52:55], v7, s[8:11], s25 offen offset:528
buffer_load_dwordx4 v[88:91], v7, s[8:11], s26 offen offset:512
buffer_load_dwordx4 v[92:95], v7, s[8:11], s26 offen offset:528
buffer_load_dwordx4 v[56:59], v7, s[8:11], s25 offen offset:1024
buffer_load_dwordx4 v[60:63], v7, s[8:11], s25 offen offset:1040
buffer_load_dwordx4 v[96:99], v7, s[8:11], s26 offen offset:1024
buffer_load_dwordx4 v[100:103], v7, s[8:11], s26 offen offset:1040
buffer_load_dwordx4 v[64:67], v7, s[8:11], s25 offen offset:1536
buffer_load_dwordx4 v[68:71], v7, s[8:11], s25 offen offset:1552
buffer_load_dwordx4 v[104:107], v7, s[8:11], s26 offen offset:1536
buffer_load_dwordx4 v[108:111], v7, s[8:11], s26 offen offset:1552
buffer_load_dwordx4 v[72:75], v7, s[8:11], s25 offen offset:2048
buffer_load_dwordx4 v[76:79], v7, s[8:11], s25 offen offset:2064
buffer_load_dwordx4 v[112:115], v7, s[8:11], s26 offen offset:2048
buffer_load_dwordx4 v[116:119], v7, s[8:11], s26 offen offset:2064
WV 20
SH 128,16
HH 129,16
SH 130,17
HH 131,17
SH 132,18
HH 133,18
SH 134,19
HH 135,19
SH 136,20
HH 137,20
SH 138,21
HH 139,21
SH 140,22
HH 141,22
SH 142,23
HH 143,23
SH 144,24
HH 145,24
SH 146,25
HH 147,25
SH 148,26
HH 149,26
SH 150,27
HH 151,27
SH 152,28
HH 153,28
SH 154,29
HH 155,29
SH 156,30
HH 157,30
SH 158,31
HH 159,31
SH 160,32
HH 161,32
SH 162,33
HH 163,33
SH 164,34
HH 165,34
SH 166,35
HH 167,35
v_add_f32 v8, v128, v129
v_add_f32 v8, v8, v130
v_add_f32 v8, v8, v131
v_add_f32 v8, v8, v132
v_add_f32 v8, v8, v133
v_add_f32 v8, v8, v134
v_add_f32 v8, v8, v135
v_add_f32 v8, v8, v136
v_add_f32 v8, v8, v137
v_add_f32 v8, v8, v138
v_add_f32 v8, v8, v139
v_add_f32 v8, v8, v140
v_add_f32 v8, v8, v141
v_add_f32 v8, v8, v142
v_add_f32 v8, v8, v143
v_add_f32 v8, v8, v144
v_add_f32 v8, v8, v145
v_add_f32 v8, v8, v146
v_add_f32 v8, v8, v147
v_add_f32 v8, v8, v148
v_add_f32 v8, v8, v149
v_add_f32 v8, v8, v150
v_add_f32 v8, v8, v151
v_add_f32 v8, v8, v152
v_add_f32 v8, v8, v153
v_add_f32 v8, v8, v154
v_add_f32 v8, v8, v155
v_add_f32 v8, v8, v156
v_add_f32 v8, v8, v157
v_add_f32 v8, v8, v158
v_add_f32 v8, v8, v159
v_add_f32 v8, v8, v160
v_add_f32 v8, v8, v161
v_add_f32 v8, v8, v162
v_add_f32 v8, v8, v163
v_add_f32 v8, v8, v164
v_add_f32 v8, v8, v165
v_add_f32 v8, v8, v166
v_add_f32 v8, v8, v167
s_nop 1
v_add_f32_dpp v8, v8, v8 quad_perm:[1,0,3,2] row_mask:0xf bank_mask:0xf
s_nop 1
v_add_f32_dpp v8, v8, v8 quad_perm:[2,3,0,1] row_mask:0xf bank_mask:0xf
s_nop 1
v_add_f32_dpp v8, v8, v8 row_half_mirror row_mask:0xf bank_mask:0xf
s_nop 1
v_add_f32_dpp v8, v8, v8 row_mirror row_mask:0xf bank_mask:0xf
v_mul_f32 v8, 0x3acccccd, v8
v_mov_b32 v9, 0
v_sub_f32 v10, v128, v8
v_fmac_f32 v9, v10, v10
v_sub_f32 v10, v129, v8
v_fmac_f32 v9, v10, v10
v_sub_f32 v10, v130, v8
v_fmac_f32 v9, v10, v10
v_sub_f32 v10, v131, v8
v_fmac_f32 v9, v10, v10
v_sub_f32 v10, v132, v8
v_fmac_f32 v9, v10, v10
v_sub_f32 v10, v133, v8
v_fmac_f32 v9, v10, v10
v_sub_f32 v10, v134, v8
v_fmac_f32 v9, v10, v10
v_sub_f32 v10, v135, v8
v_fmac_f32 v9, v10, v10
v_sub_f32 v10, v136, v8
v_fmac_f32 v9, v10, v10
v_sub_f32 v10, v137, v8
v_fmac_f32 v9, v10, v10
v_sub_f32 v10, v138, v8
v_fmac_f32 v9, v10, v10
v_sub_f32 v10, v139, v8
v_fmac_f32 v9, v10, v10
v_sub_f32 v10, v140, v8
v_fmac_f32 v9, v10, v10
v_sub_f32 v10, v141, v8
v_fmac_f32 v9, v10, v10
v_sub_f32 v10, v142, v8
v_fmac_f32 v9, v10, v10
v_sub_f32 v10, v143, v8
v_fmac_f32 v9, v10, v10
v_sub_f32 v10, v144, v8
v_fmac_f32 v9, v10, v10
v_sub_f32 v10, v145, v8
v_fmac_f32 v9, v10, v10
v_sub_f32 v10, v146, v8
v_fmac_f32 v9, v10, v10
v_sub_f32 v10, v147, v8
v_fmac_f32 v9, v10, v10
v_sub_f32 v10, v148, v8
v_fmac_f32 v9, v10, v10
v_sub_f32 v10, v149, v8
v_fmac_f32 v9, v10, v10
v_sub_f32 v10, v150, v8
v_fmac_f32 v9, v10, v10
v_sub_f32 v10, v151, v8
v_fmac_f32 v9, v10, v10
v_sub_f32 v10, v152, v8
v_fmac_f32 v9, v10, v10
v_sub_f32 v10, v153, v8
v_fmac_f32 v9, v10, v10
v_sub_f32 v10, v154, v8
v_fmac_f32 v9, v10, v10
v_sub_f32 v10, v155, v8
v_fmac_f32 v9, v10, v10
v_sub_f32 v10, v156, v8
v_fmac_f32 v9, v10, v10
v_sub_f32 v10, v157, v8
v_fmac_f32 v9, v10, v10
v_sub_f32 v10, v158, v8
v_fmac_f32 v9, v10, v10
v_sub_f32 v10, v159, v8
v_fmac_f32 v9, v10, v10
v_sub_f32 v10, v160, v8
v_fmac_f32 v9, v10, v10
v_sub_f32 v10, v161, v8
v_fmac_f32 v9, v10, v10
v_sub_f32 v10, v162, v8
v_fmac_f32 v9, v10, v10
v_sub_f32 v10, v163, v8
v_fmac_f32 v9, v10, v10
v_sub_f32 v10, v164, v8
v_fmac_f32 v9, v10, v10
v_sub_f32 v10, v165, v8
v_fmac_f32 v9, v10, v10
v_sub_f32 v10, v166, v8
v_fmac_f32 v9, v10, v10
v_sub_f32 v10, v167, v8
v_fmac_f32 v9, v10, v10
s_nop 1
v_add_f32_dpp v9, v9, v9 quad_perm:[1,0,3,2] row_mask:0xf bank_mask:0xf
s_nop 1
v_add_f32_dpp v9, v9, v9 quad_perm:[2,3,0,1] row_mask:0xf bank_mask:0xf
s_nop 1
v_add_f32_dpp v9, v9, v9 row_half_mirror row_mask:0xf bank_mask:0xf
s_nop 1
v_add_f32_dpp v9, v9, v9 row_mirror row_mask:0xf bank_mask:0xf
v_mul_f32 v9, 0x3acccccd, v9
CV 8,8,8
SH 8,8
CV 9,9,9
SH 9,9
v_add_f32 v9, 0x3727c5ac, v9
CV 9,9,9
SH 9,9
v_sqrt_f32 v9, v9
s_nop 0
CV 9,9,9
SH 9,9
v_rcp_f32 v9, v9
s_nop 0
WV 0
v_sub_f32 v128, v128, v8
v_sub_f32 v129, v129, v8
CV 10,128,129
SH 128,10
HH 129,10
v_mul_f32 v128, v128, v9
v_mul_f32 v129, v129, v9
CV 10,128,129
SH 128,10
HH 129,10
v_add_f32 v40, 1.0, v40
v_add_f32 v41, 1.0, v41
CV 10,40,41
SH 40,10
HH 41,10
v_mul_f32 v128, v128, v40
v_mul_f32 v129, v129, v41
CV 10,128,129
SH 128,10
HH 129,10
v_add_f32 v128, v128, v80
v_add_f32 v129, v129, v81
CV 16,128,129
v_sub_f32 v130, v130, v8
v_sub_f32 v131, v131, v8
CV 10,130,131
SH 130,10
HH 131,10
v_mul_f32 v130, v130, v9
v_mul_f32 v131, v131, v9
CV 10,130,131
SH 130,10
HH 131,10
v_add_f32 v42, 1.0, v42
v_add_f32 v43, 1.0, v43
CV 10,42,43
SH 42,10
HH 43,10
v_mul_f32 v130, v130, v42
v_mul_f32 v131, v131, v43
CV 10,130,131
SH 130,10
HH 131,10
v_add_f32 v130, v130, v82
v_add_f32 v131, v131, v83
CV 17,130,131
v_sub_f32 v132, v132, v8
v_sub_f32 v133, v133, v8
CV 10,132,133
SH 132,10
HH 133,10
v_mul_f32 v132, v132, v9
v_mul_f32 v133, v133, v9
CV 10,132,133
SH 132,10
HH 133,10
v_add_f32 v44, 1.0, v44
v_add_f32 v45, 1.0, v45
CV 10,44,45
SH 44,10
HH 45,10
v_mul_f32 v132, v132, v44
v_mul_f32 v133, v133, v45
CV 10,132,133
SH 132,10
HH 133,10
v_add_f32 v132, v132, v84
v_add_f32 v133, v133, v85
CV 18,132,133
v_sub_f32 v134, v134, v8
v_sub_f32 v135, v135, v8
CV 10,134,135
SH 134,10
HH 135,10
v_mul_f32 v134, v134, v9
v_mul_f32 v135, v135, v9
CV 10,134,135
SH 134,10
HH 135,10
v_add_f32 v46, 1.0, v46
v_add_f32 v47, 1.0, v47
CV 10,46,47
SH 46,10
HH 47,10
v_mul_f32 v134, v134, v46
v_mul_f32 v135, v135, v47
CV 10,134,135
SH 134,10
HH 135,10
v_add_f32 v134, v134, v86
v_add_f32 v135, v135, v87
CV 19,134,135
v_sub_f32 v136, v136, v8
v_sub_f32 v137, v137, v8
CV 10,136,137
SH 136,10
HH 137,10
v_mul_f32 v136, v136, v9
v_mul_f32 v137, v137, v9
CV 10,136,137
SH 136,10
HH 137,10
v_add_f32 v48, 1.0, v48
v_add_f32 v49, 1.0, v49
CV 10,48,49
SH 48,10
HH 49,10
v_mul_f32 v136, v136, v48
v_mul_f32 v137, v137, v49
CV 10,136,137
SH 136,10
HH 137,10
v_add_f32 v136, v136, v88
v_add_f32 v137, v137, v89
CV 20,136,137
v_sub_f32 v138, v138, v8
v_sub_f32 v139, v139, v8
CV 10,138,139
SH 138,10
HH 139,10
v_mul_f32 v138, v138, v9
v_mul_f32 v139, v139, v9
CV 10,138,139
SH 138,10
HH 139,10
v_add_f32 v50, 1.0, v50
v_add_f32 v51, 1.0, v51
CV 10,50,51
SH 50,10
HH 51,10
v_mul_f32 v138, v138, v50
v_mul_f32 v139, v139, v51
CV 10,138,139
SH 138,10
HH 139,10
v_add_f32 v138, v138, v90
v_add_f32 v139, v139, v91
CV 21,138,139
v_sub_f32 v140, v140, v8
v_sub_f32 v141, v141, v8
CV 10,140,141
SH 140,10
HH 141,10
v_mul_f32 v140, v140, v9
v_mul_f32 v141, v141, v9
CV 10,140,141
SH 140,10
HH 141,10
v_add_f32 v52, 1.0, v52
v_add_f32 v53, 1.0, v53
CV 10,52,53
SH 52,10
HH 53,10
v_mul_f32 v140, v140, v52
v_mul_f32 v141, v141, v53
CV 10,140,141
SH 140,10
HH 141,10
v_add_f32 v140, v140, v92
v_add_f32 v141, v141, v93
CV 22,140,141
v_sub_f32 v142, v142, v8
v_sub_f32 v143, v143, v8
CV 10,142,143
SH 142,10
HH 143,10
v_mul_f32 v142, v142, v9
v_mul_f32 v143, v143, v9
CV 10,142,143
SH 142,10
HH 143,10
v_add_f32 v54, 1.0, v54
v_add_f32 v55, 1.0, v55
CV 10,54,55
SH 54,10
HH 55,10
v_mul_f32 v142, v142, v54
v_mul_f32 v143, v143, v55
CV 10,142,143
SH 142,10
HH 143,10
v_add_f32 v142, v142, v94
v_add_f32 v143, v143, v95
CV 23,142,143
v_sub_f32 v144, v144, v8
v_sub_f32 v145, v145, v8
CV 10,144,145
SH 144,10
HH 145,10
v_mul_f32 v144, v144, v9
v_mul_f32 v145, v145, v9
CV 10,144,145
SH 144,10
HH 145,10
v_add_f32 v56, 1.0, v56
v_add_f32 v57, 1.0, v57
CV 10,56,57
SH 56,10
HH 57,10
v_mul_f32 v144, v144, v56
v_mul_f32 v145, v145, v57
CV 10,144,145
SH 144,10
HH 145,10
v_add_f32 v144, v144, v96
v_add_f32 v145, v145, v97
CV 24,144,145
v_sub_f32 v146, v146, v8
v_sub_f32 v147, v147, v8
CV 10,146,147
SH 146,10
HH 147,10
v_mul_f32 v146, v146, v9
v_mul_f32 v147, v147, v9
CV 10,146,147
SH 146,10
HH 147,10
v_add_f32 v58, 1.0, v58
v_add_f32 v59, 1.0, v59
CV 10,58,59
SH 58,10
HH 59,10
v_mul_f32 v146, v146, v58
v_mul_f32 v147, v147, v59
CV 10,146,147
SH 146,10
HH 147,10
v_add_f32 v146, v146, v98
v_add_f32 v147, v147, v99
CV 25,146,147
v_sub_f32 v148, v148, v8
v_sub_f32 v149, v149, v8
CV 10,148,149
SH 148,10
HH 149,10
v_mul_f32 v148, v148, v9
v_mul_f32 v149, v149, v9
CV 10,148,149
SH 148,10
HH 149,10
v_add_f32 v60, 1.0, v60
v_add_f32 v61, 1.0, v61
CV 10,60,61
SH 60,10
HH 61,10
v_mul_f32 v148, v148, v60
v_mul_f32 v149, v149, v61
CV 10,148,149
SH 148,10
HH 149,10
v_add_f32 v148, v148, v100
v_add_f32 v149, v149, v101
CV 26,148,149
v_sub_f32 v150, v150, v8
v_sub_f32 v151, v151, v8
CV 10,150,151
SH 150,10
HH 151,10
v_mul_f32 v150, v150, v9
v_mul_f32 v151, v151, v9
CV 10,150,151
SH 150,10
HH 151,10
v_add_f32 v62, 1.0, v62
v_add_f32 v63, 1.0, v63
CV 10,62,63
SH 62,10
HH 63,10
v_mul_f32 v150, v150, v62
v_mul_f32 v151, v151, v63
CV 10,150,151
SH 150,10
HH 151,10
v_add_f32 v150, v150, v102
v_add_f32 v151, v151, v103
CV 27,150,151
v_sub_f32 v152, v152, v8
v_sub_f32 v153, v153, v8
CV 10,152,153
SH 152,10
HH 153,10
v_mul_f32 v152, v152, v9
v_mul_f32 v153, v153, v9
CV 10,152,153
SH 152,10
HH 153,10
v_add_f32 v64, 1.0, v64
v_add_f32 v65, 1.0, v65
CV 10,64,65
SH 64,10
HH 65,10
v_mul_f32 v152, v152, v64
v_mul_f32 v153, v153, v65
CV 10,152,153
SH 152,10
HH 153,10
v_add_f32 v152, v152, v104
v_add_f32 v153, v153, v105
CV 28,152,153
v_sub_f32 v154, v154, v8
v_sub_f32 v155, v155, v8
CV 10,154,155
SH 154,10
HH 155,10
v_mul_f32 v154, v154, v9
v_mul_f32 v155, v155, v9
CV 10,154,155
SH 154,10
HH 155,10
v_add_f32 v66, 1.0, v66
v_add_f32 v67, 1.0, v67
CV 10,66,67
SH 66,10
HH 67,10
v_mul_f32 v154, v154, v66
v_mul_f32 v155, v155, v67
CV 10,154,155
SH 154,10
HH 155,10
v_add_f32 v154, v154, v106
v_add_f32 v155, v155, v107
CV 29,154,155
v_sub_f32 v156, v156, v8
v_sub_f32 v157, v157, v8
CV 10,156,157
SH 156,10
HH 157,10
v_mul_f32 v156, v156, v9
v_mul_f32 v157, v157, v9
CV 10,156,157
SH 156,10
HH 157,10
v_add_f32 v68, 1.0, v68
v_add_f32 v69, 1.0, v69
CV 10,68,69
SH 68,10
HH 69,10
v_mul_f32 v156, v156, v68
v_mul_f32 v157, v157, v69
CV 10,156,157
SH 156,10
HH 157,10
v_add_f32 v156, v156, v108
v_add_f32 v157, v157, v109
CV 30,156,157
v_sub_f32 v158, v158, v8
v_sub_f32 v159, v159, v8
CV 10,158,159
SH 158,10
HH 159,10
v_mul_f32 v158, v158, v9
v_mul_f32 v159, v159, v9
CV 10,158,159
SH 158,10
HH 159,10
v_add_f32 v70, 1.0, v70
v_add_f32 v71, 1.0, v71
CV 10,70,71
SH 70,10
HH 71,10
v_mul_f32 v158, v158, v70
v_mul_f32 v159, v159, v71
CV 10,158,159
SH 158,10
HH 159,10
v_add_f32 v158, v158, v110
v_add_f32 v159, v159, v111
CV 31,158,159
v_sub_f32 v160, v160, v8
v_sub_f32 v161, v161, v8
CV 10,160,161
SH 160,10
HH 161,10
v_mul_f32 v160, v160, v9
v_mul_f32 v161, v161, v9
CV 10,160,161
SH 160,10
HH 161,10
v_add_f32 v72, 1.0, v72
v_add_f32 v73, 1.0, v73
CV 10,72,73
SH 72,10
HH 73,10
v_mul_f32 v160, v160, v72
v_mul_f32 v161, v161, v73
CV 10,160,161
SH 160,10
HH 161,10
v_add_f32 v160, v160, v112
v_add_f32 v161, v161, v113
CV 32,160,161
v_sub_f32 v162, v162, v8
v_sub_f32 v163, v163, v8
CV 10,162,163
SH 162,10
HH 163,10
v_mul_f32 v162, v162, v9
v_mul_f32 v163, v163, v9
CV 10,162,163
SH 162,10
HH 163,10
v_add_f32 v74, 1.0, v74
v_add_f32 v75, 1.0, v75
CV 10,74,75
SH 74,10
HH 75,10
v_mul_f32 v162, v162, v74
v_mul_f32 v163, v163, v75
CV 10,162,163
SH 162,10
HH 163,10
v_add_f32 v162, v162, v114
v_add_f32 v163, v163, v115
CV 33,162,163
v_sub_f32 v164, v164, v8
v_sub_f32 v165, v165, v8
CV 10,164,165
SH 164,10
HH 165,10
v_mul_f32 v164, v164, v9
v_mul_f32 v165, v165, v9
CV 10,164,165
SH 164,10
HH 165,10
v_add_f32 v76, 1.0, v76
v_add_f32 v77, 1.0, v77
CV 10,76,77
SH 76,10
HH 77,10
v_mul_f32 v164, v164, v76
v_mul_f32 v165, v165, v77
CV 10,164,165
SH 164,10
HH 165,10
v_add_f32 v164, v164, v116
v_add_f32 v165, v165, v117
CV 34,164,165
v_sub_f32 v166, v166, v8
v_sub_f32 v167, v167, v8
CV 10,166,167
SH 166,10
HH 167,10
v_mul_f32 v166, v166, v9
v_mul_f32 v167, v167, v9
CV 10,166,167
SH 166,10
HH 167,10
v_add_f32 v78, 1.0, v78
v_add_f32 v79, 1.0, v79
CV 10,78,79
SH 78,10
HH 79,10
v_mul_f32 v166, v166, v78
v_mul_f32 v167, v167, v79
CV 10,166,167
SH 166,10
HH 167,10
v_add_f32 v166, v166, v118
v_add_f32 v167, v167, v119
CV 35,166,167
v_lshrrev_b32 v8, 5, v5
v_mul_u32_u24 v8, 40960, v8
v_and_b32 v9, 31, v5
v_lshlrev_b32 v9, 4, v9
v_add_u32 v8, v8, v9
v_lshrrev_b32 v9, 1, v4
v_lshlrev_b32 v9, 10, v9
v_add_u32 v8, v8, v9
v_and_b32 v9, 1, v4
v_lshlrev_b32 v9, 3, v9
v_add_u32 v8, v8, v9
s_mov_b32 s25, 16777216
buffer_store_dwordx2 v[16:17], v8, s[8:11], s25 offen sc1
buffer_store_dwordx2 v[18:19], v8, s[8:11], s25 offen offset:512 sc1
s_add_u32 s25, s25, 8192
buffer_store_dwordx2 v[20:21], v8, s[8:11], s25 offen sc1
buffer_store_dwordx2 v[22:23], v8, s[8:11], s25 offen offset:512 sc1
s_add_u32 s25, s25, 8192
buffer_store_dwordx2 v[24:25], v8, s[8:11], s25 offen sc1
buffer_store_dwordx2 v[26:27], v8, s[8:11], s25 offen offset:512 sc1
s_add_u32 s25, s25, 8192
buffer_store_dwordx2 v[28:29], v8, s[8:11], s25 offen sc1
buffer_store_dwordx2 v[30:31], v8, s[8:11], s25 offen offset:512 sc1
s_add_u32 s25, s25, 8192
buffer_store_dwordx2 v[32:33], v8, s[8:11], s25 offen sc1
buffer_store_dwordx2 v[34:35], v8, s[8:11], s25 offen offset:512 sc1
s_add_u32 s25, s25, 8192
WV 0
s_add_u32 s40, s40, 1
v_and_b32 v2, 63, v0
v_lshrrev_b32 v3, 4, v2
v_and_b32 v4, 15, v2
s_lshl_b32 s23, s40, 4
s_lshl_b32 s24, s16, 2
s_add_u32 s23, s23, s24
v_add_u32 v5, s23, v3
v_mul_u32_u24 v6, 1280, v5
v_lshlrev_b32 v7, 4, v4
v_add_u32 v6, v6, v7
buffer_load_dwordx4 v[16:19], v6, s[8:11], s27 offen offset:0 sc1
buffer_load_dwordx4 v[20:23], v6, s[8:11], s27 offen offset:256 sc1
buffer_load_dwordx4 v[24:27], v6, s[8:11], s27 offen offset:512 sc1
buffer_load_dwordx4 v[28:31], v6, s[8:11], s27 offen offset:768 sc1
buffer_load_dwordx4 v[32:35], v6, s[8:11], s27 offen offset:1024 sc1
v_lshlrev_b32 v7, 5, v4
s_mov_b32 s25, 14336
s_mov_b32 s26, 11776
buffer_load_dwordx4 v[40:43], v7, s[8:11], s25 offen offset:0
buffer_load_dwordx4 v[44:47], v7, s[8:11], s25 offen offset:16
buffer_load_dwordx4 v[80:83], v7, s[8:11], s26 offen offset:0
buffer_load_dwordx4 v[84:87], v7, s[8:11], s26 offen offset:16
buffer_load_dwordx4 v[48:51], v7, s[8:11], s25 offen offset:512
buffer_load_dwordx4 v[52:55], v7, s[8:11], s25 offen offset:528
buffer_load_dwordx4 v[88:91], v7, s[8:11], s26 offen offset:512
buffer_load_dwordx4 v[92:95], v7, s[8:11], s26 offen offset:528
buffer_load_dwordx4 v[56:59], v7, s[8:11], s25 offen offset:1024
buffer_load_dwordx4 v[60:63], v7, s[8:11], s25 offen offset:1040
buffer_load_dwordx4 v[96:99], v7, s[8:11], s26 offen offset:1024
buffer_load_dwordx4 v[100:103], v7, s[8:11], s26 offen offset:1040
buffer_load_dwordx4 v[64:67], v7, s[8:11], s25 offen offset:1536
buffer_load_dwordx4 v[68:71], v7, s[8:11], s25 offen offset:1552
buffer_load_dwordx4 v[104:107], v7, s[8:11], s26 offen offset:1536
buffer_load_dwordx4 v[108:111], v7, s[8:11], s26 offen offset:1552
buffer_load_dwordx4 v[72:75], v7, s[8:11], s25 offen offset:2048
buffer_load_dwordx4 v[76:79], v7, s[8:11], s25 offen offset:2064
buffer_load_dwordx4 v[112:115], v7, s[8:11], s26 offen offset:2048
buffer_load_dwordx4 v[116:119], v7, s[8:11], s26 offen offset:2064
WV 20
SH 128,16
HH 129,16
SH 130,17
HH 131,17
SH 132,18
HH 133,18
SH 134,19
HH 135,19
SH 136,20
HH 137,20
SH 138,21
HH 139,21
SH 140,22
HH 141,22
SH 142,23
HH 143,23
SH 144,24
HH 145,24
SH 146,25
HH 147,25
SH 148,26
HH 149,26
SH 150,27
HH 151,27
SH 152,28
HH 153,28
SH 154,29
HH 155,29
SH 156,30
HH 157,30
SH 158,31
HH 159,31
SH 160,32
HH 161,32
SH 162,33
HH 163,33
SH 164,34
HH 165,34
SH 166,35
HH 167,35
v_add_f32 v8, v128, v129
v_add_f32 v8, v8, v130
v_add_f32 v8, v8, v131
v_add_f32 v8, v8, v132
v_add_f32 v8, v8, v133
v_add_f32 v8, v8, v134
v_add_f32 v8, v8, v135
v_add_f32 v8, v8, v136
v_add_f32 v8, v8, v137
v_add_f32 v8, v8, v138
v_add_f32 v8, v8, v139
v_add_f32 v8, v8, v140
v_add_f32 v8, v8, v141
v_add_f32 v8, v8, v142
v_add_f32 v8, v8, v143
v_add_f32 v8, v8, v144
v_add_f32 v8, v8, v145
v_add_f32 v8, v8, v146
v_add_f32 v8, v8, v147
v_add_f32 v8, v8, v148
v_add_f32 v8, v8, v149
v_add_f32 v8, v8, v150
v_add_f32 v8, v8, v151
v_add_f32 v8, v8, v152
v_add_f32 v8, v8, v153
v_add_f32 v8, v8, v154
v_add_f32 v8, v8, v155
v_add_f32 v8, v8, v156
v_add_f32 v8, v8, v157
v_add_f32 v8, v8, v158
v_add_f32 v8, v8, v159
v_add_f32 v8, v8, v160
v_add_f32 v8, v8, v161
v_add_f32 v8, v8, v162
v_add_f32 v8, v8, v163
v_add_f32 v8, v8, v164
v_add_f32 v8, v8, v165
v_add_f32 v8, v8, v166
v_add_f32 v8, v8, v167
s_nop 1
v_add_f32_dpp v8, v8, v8 quad_perm:[1,0,3,2] row_mask:0xf bank_mask:0xf
s_nop 1
v_add_f32_dpp v8, v8, v8 quad_perm:[2,3,0,1] row_mask:0xf bank_mask:0xf
s_nop 1
v_add_f32_dpp v8, v8, v8 row_half_mirror row_mask:0xf bank_mask:0xf
s_nop 1
v_add_f32_dpp v8, v8, v8 row_mirror row_mask:0xf bank_mask:0xf
v_mul_f32 v8, 0x3acccccd, v8
v_mov_b32 v9, 0
v_sub_f32 v10, v128, v8
v_fmac_f32 v9, v10, v10
v_sub_f32 v10, v129, v8
v_fmac_f32 v9, v10, v10
v_sub_f32 v10, v130, v8
v_fmac_f32 v9, v10, v10
v_sub_f32 v10, v131, v8
v_fmac_f32 v9, v10, v10
v_sub_f32 v10, v132, v8
v_fmac_f32 v9, v10, v10
v_sub_f32 v10, v133, v8
v_fmac_f32 v9, v10, v10
v_sub_f32 v10, v134, v8
v_fmac_f32 v9, v10, v10
v_sub_f32 v10, v135, v8
v_fmac_f32 v9, v10, v10
v_sub_f32 v10, v136, v8
v_fmac_f32 v9, v10, v10
v_sub_f32 v10, v137, v8
v_fmac_f32 v9, v10, v10
v_sub_f32 v10, v138, v8
v_fmac_f32 v9, v10, v10
v_sub_f32 v10, v139, v8
v_fmac_f32 v9, v10, v10
v_sub_f32 v10, v140, v8
v_fmac_f32 v9, v10, v10
v_sub_f32 v10, v141, v8
v_fmac_f32 v9, v10, v10
v_sub_f32 v10, v142, v8
v_fmac_f32 v9, v10, v10
v_sub_f32 v10, v143, v8
v_fmac_f32 v9, v10, v10
v_sub_f32 v10, v144, v8
v_fmac_f32 v9, v10, v10
v_sub_f32 v10, v145, v8
v_fmac_f32 v9, v10, v10
v_sub_f32 v10, v146, v8
v_fmac_f32 v9, v10, v10
v_sub_f32 v10, v147, v8
v_fmac_f32 v9, v10, v10
v_sub_f32 v10, v148, v8
v_fmac_f32 v9, v10, v10
v_sub_f32 v10, v149, v8
v_fmac_f32 v9, v10, v10
v_sub_f32 v10, v150, v8
v_fmac_f32 v9, v10, v10
v_sub_f32 v10, v151, v8
v_fmac_f32 v9, v10, v10
v_sub_f32 v10, v152, v8
v_fmac_f32 v9, v10, v10
v_sub_f32 v10, v153, v8
v_fmac_f32 v9, v10, v10
v_sub_f32 v10, v154, v8
v_fmac_f32 v9, v10, v10
v_sub_f32 v10, v155, v8
v_fmac_f32 v9, v10, v10
v_sub_f32 v10, v156, v8
v_fmac_f32 v9, v10, v10
v_sub_f32 v10, v157, v8
v_fmac_f32 v9, v10, v10
v_sub_f32 v10, v158, v8
v_fmac_f32 v9, v10, v10
v_sub_f32 v10, v159, v8
v_fmac_f32 v9, v10, v10
v_sub_f32 v10, v160, v8
v_fmac_f32 v9, v10, v10
v_sub_f32 v10, v161, v8
v_fmac_f32 v9, v10, v10
v_sub_f32 v10, v162, v8
v_fmac_f32 v9, v10, v10
v_sub_f32 v10, v163, v8
v_fmac_f32 v9, v10, v10
v_sub_f32 v10, v164, v8
v_fmac_f32 v9, v10, v10
v_sub_f32 v10, v165, v8
v_fmac_f32 v9, v10, v10
v_sub_f32 v10, v166, v8
v_fmac_f32 v9, v10, v10
v_sub_f32 v10, v167, v8
v_fmac_f32 v9, v10, v10
s_nop 1
v_add_f32_dpp v9, v9, v9 quad_perm:[1,0,3,2] row_mask:0xf bank_mask:0xf
s_nop 1
v_add_f32_dpp v9, v9, v9 quad_perm:[2,3,0,1] row_mask:0xf bank_mask:0xf
s_nop 1
v_add_f32_dpp v9, v9, v9 row_half_mirror row_mask:0xf bank_mask:0xf
s_nop 1
v_add_f32_dpp v9, v9, v9 row_mirror row_mask:0xf bank_mask:0xf
v_mul_f32 v9, 0x3acccccd, v9
CV 8,8,8
SH 8,8
CV 9,9,9
SH 9,9
v_add_f32 v9, 0x3727c5ac, v9
CV 9,9,9
SH 9,9
v_sqrt_f32 v9, v9
s_nop 0
CV 9,9,9
SH 9,9
v_rcp_f32 v9, v9
s_nop 0
WV 0
v_sub_f32 v128, v128, v8
v_sub_f32 v129, v129, v8
CV 10,128,129
SH 128,10
HH 129,10
v_mul_f32 v128, v128, v9
v_mul_f32 v129, v129, v9
CV 10,128,129
SH 128,10
HH 129,10
v_add_f32 v40, 1.0, v40
v_add_f32 v41, 1.0, v41
CV 10,40,41
SH 40,10
HH 41,10
v_mul_f32 v128, v128, v40
v_mul_f32 v129, v129, v41
CV 10,128,129
SH 128,10
HH 129,10
v_add_f32 v128, v128, v80
v_add_f32 v129, v129, v81
CV 16,128,129
v_sub_f32 v130, v130, v8
v_sub_f32 v131, v131, v8
CV 10,130,131
SH 130,10
HH 131,10
v_mul_f32 v130, v130, v9
v_mul_f32 v131, v131, v9
CV 10,130,131
SH 130,10
HH 131,10
v_add_f32 v42, 1.0, v42
v_add_f32 v43, 1.0, v43
CV 10,42,43
SH 42,10
HH 43,10
v_mul_f32 v130, v130, v42
v_mul_f32 v131, v131, v43
CV 10,130,131
SH 130,10
HH 131,10
v_add_f32 v130, v130, v82
v_add_f32 v131, v131, v83
CV 17,130,131
v_sub_f32 v132, v132, v8
v_sub_f32 v133, v133, v8
CV 10,132,133
SH 132,10
HH 133,10
v_mul_f32 v132, v132, v9
v_mul_f32 v133, v133, v9
CV 10,132,133
SH 132,10
HH 133,10
v_add_f32 v44, 1.0, v44
v_add_f32 v45, 1.0, v45
CV 10,44,45
SH 44,10
HH 45,10
v_mul_f32 v132, v132, v44
v_mul_f32 v133, v133, v45
CV 10,132,133
SH 132,10
HH 133,10
v_add_f32 v132, v132, v84
v_add_f32 v133, v133, v85
CV 18,132,133
v_sub_f32 v134, v134, v8
v_sub_f32 v135, v135, v8
CV 10,134,135
SH 134,10
HH 135,10
v_mul_f32 v134, v134, v9
v_mul_f32 v135, v135, v9
CV 10,134,135
SH 134,10
HH 135,10
v_add_f32 v46, 1.0, v46
v_add_f32 v47, 1.0, v47
CV 10,46,47
SH 46,10
HH 47,10
v_mul_f32 v134, v134, v46
v_mul_f32 v135, v135, v47
CV 10,134,135
SH 134,10
HH 135,10
v_add_f32 v134, v134, v86
v_add_f32 v135, v135, v87
CV 19,134,135
v_sub_f32 v136, v136, v8
v_sub_f32 v137, v137, v8
CV 10,136,137
SH 136,10
HH 137,10
v_mul_f32 v136, v136, v9
v_mul_f32 v137, v137, v9
CV 10,136,137
SH 136,10
HH 137,10
v_add_f32 v48, 1.0, v48
v_add_f32 v49, 1.0, v49
CV 10,48,49
SH 48,10
HH 49,10
v_mul_f32 v136, v136, v48
v_mul_f32 v137, v137, v49
CV 10,136,137
SH 136,10
HH 137,10
v_add_f32 v136, v136, v88
v_add_f32 v137, v137, v89
CV 20,136,137
v_sub_f32 v138, v138, v8
v_sub_f32 v139, v139, v8
CV 10,138,139
SH 138,10
HH 139,10
v_mul_f32 v138, v138, v9
v_mul_f32 v139, v139, v9
CV 10,138,139
SH 138,10
HH 139,10
v_add_f32 v50, 1.0, v50
v_add_f32 v51, 1.0, v51
CV 10,50,51
SH 50,10
HH 51,10
v_mul_f32 v138, v138, v50
v_mul_f32 v139, v139, v51
CV 10,138,139
SH 138,10
HH 139,10
v_add_f32 v138, v138, v90
v_add_f32 v139, v139, v91
CV 21,138,139
v_sub_f32 v140, v140, v8
v_sub_f32 v141, v141, v8
CV 10,140,141
SH 140,10
HH 141,10
v_mul_f32 v140, v140, v9
v_mul_f32 v141, v141, v9
CV 10,140,141
SH 140,10
HH 141,10
v_add_f32 v52, 1.0, v52
v_add_f32 v53, 1.0, v53
CV 10,52,53
SH 52,10
HH 53,10
v_mul_f32 v140, v140, v52
v_mul_f32 v141, v141, v53
CV 10,140,141
SH 140,10
HH 141,10
v_add_f32 v140, v140, v92
v_add_f32 v141, v141, v93
CV 22,140,141
v_sub_f32 v142, v142, v8
v_sub_f32 v143, v143, v8
CV 10,142,143
SH 142,10
HH 143,10
v_mul_f32 v142, v142, v9
v_mul_f32 v143, v143, v9
CV 10,142,143
SH 142,10
HH 143,10
v_add_f32 v54, 1.0, v54
v_add_f32 v55, 1.0, v55
CV 10,54,55
SH 54,10
HH 55,10
v_mul_f32 v142, v142, v54
v_mul_f32 v143, v143, v55
CV 10,142,143
SH 142,10
HH 143,10
v_add_f32 v142, v142, v94
v_add_f32 v143, v143, v95
CV 23,142,143
v_sub_f32 v144, v144, v8
v_sub_f32 v145, v145, v8
CV 10,144,145
SH 144,10
HH 145,10
v_mul_f32 v144, v144, v9
v_mul_f32 v145, v145, v9
CV 10,144,145
SH 144,10
HH 145,10
v_add_f32 v56, 1.0, v56
v_add_f32 v57, 1.0, v57
CV 10,56,57
SH 56,10
HH 57,10
v_mul_f32 v144, v144, v56
v_mul_f32 v145, v145, v57
CV 10,144,145
SH 144,10
HH 145,10
v_add_f32 v144, v144, v96
v_add_f32 v145, v145, v97
CV 24,144,145
v_sub_f32 v146, v146, v8
v_sub_f32 v147, v147, v8
CV 10,146,147
SH 146,10
HH 147,10
v_mul_f32 v146, v146, v9
v_mul_f32 v147, v147, v9
CV 10,146,147
SH 146,10
HH 147,10
v_add_f32 v58, 1.0, v58
v_add_f32 v59, 1.0, v59
CV 10,58,59
SH 58,10
HH 59,10
v_mul_f32 v146, v146, v58
v_mul_f32 v147, v147, v59
CV 10,146,147
SH 146,10
HH 147,10
v_add_f32 v146, v146, v98
v_add_f32 v147, v147, v99
CV 25,146,147
v_sub_f32 v148, v148, v8
v_sub_f32 v149, v149, v8
CV 10,148,149
SH 148,10
HH 149,10
v_mul_f32 v148, v148, v9
v_mul_f32 v149, v149, v9
CV 10,148,149
SH 148,10
HH 149,10
v_add_f32 v60, 1.0, v60
v_add_f32 v61, 1.0, v61
CV 10,60,61
SH 60,10
HH 61,10
v_mul_f32 v148, v148, v60
v_mul_f32 v149, v149, v61
CV 10,148,149
SH 148,10
HH 149,10
v_add_f32 v148, v148, v100
v_add_f32 v149, v149, v101
CV 26,148,149
v_sub_f32 v150, v150, v8
v_sub_f32 v151, v151, v8
CV 10,150,151
SH 150,10
HH 151,10
v_mul_f32 v150, v150, v9
v_mul_f32 v151, v151, v9
CV 10,150,151
SH 150,10
HH 151,10
v_add_f32 v62, 1.0, v62
v_add_f32 v63, 1.0, v63
CV 10,62,63
SH 62,10
HH 63,10
v_mul_f32 v150, v150, v62
v_mul_f32 v151, v151, v63
CV 10,150,151
SH 150,10
HH 151,10
v_add_f32 v150, v150, v102
v_add_f32 v151, v151, v103
CV 27,150,151
v_sub_f32 v152, v152, v8
v_sub_f32 v153, v153, v8
CV 10,152,153
SH 152,10
HH 153,10
v_mul_f32 v152, v152, v9
v_mul_f32 v153, v153, v9
CV 10,152,153
SH 152,10
HH 153,10
v_add_f32 v64, 1.0, v64
v_add_f32 v65, 1.0, v65
CV 10,64,65
SH 64,10
HH 65,10
v_mul_f32 v152, v152, v64
v_mul_f32 v153, v153, v65
CV 10,152,153
SH 152,10
HH 153,10
v_add_f32 v152, v152, v104
v_add_f32 v153, v153, v105
CV 28,152,153
v_sub_f32 v154, v154, v8
v_sub_f32 v155, v155, v8
CV 10,154,155
SH 154,10
HH 155,10
v_mul_f32 v154, v154, v9
v_mul_f32 v155, v155, v9
CV 10,154,155
SH 154,10
HH 155,10
v_add_f32 v66, 1.0, v66
v_add_f32 v67, 1.0, v67
CV 10,66,67
SH 66,10
HH 67,10
v_mul_f32 v154, v154, v66
v_mul_f32 v155, v155, v67
CV 10,154,155
SH 154,10
HH 155,10
v_add_f32 v154, v154, v106
v_add_f32 v155, v155, v107
CV 29,154,155
v_sub_f32 v156, v156, v8
v_sub_f32 v157, v157, v8
CV 10,156,157
SH 156,10
HH 157,10
v_mul_f32 v156, v156, v9
v_mul_f32 v157, v157, v9
CV 10,156,157
SH 156,10
HH 157,10
v_add_f32 v68, 1.0, v68
v_add_f32 v69, 1.0, v69
CV 10,68,69
SH 68,10
HH 69,10
v_mul_f32 v156, v156, v68
v_mul_f32 v157, v157, v69
CV 10,156,157
SH 156,10
HH 157,10
v_add_f32 v156, v156, v108
v_add_f32 v157, v157, v109
CV 30,156,157
v_sub_f32 v158, v158, v8
v_sub_f32 v159, v159, v8
CV 10,158,159
SH 158,10
HH 159,10
v_mul_f32 v158, v158, v9
v_mul_f32 v159, v159, v9
CV 10,158,159
SH 158,10
HH 159,10
v_add_f32 v70, 1.0, v70
v_add_f32 v71, 1.0, v71
CV 10,70,71
SH 70,10
HH 71,10
v_mul_f32 v158, v158, v70
v_mul_f32 v159, v159, v71
CV 10,158,159
SH 158,10
HH 159,10
v_add_f32 v158, v158, v110
v_add_f32 v159, v159, v111
CV 31,158,159
v_sub_f32 v160, v160, v8
v_sub_f32 v161, v161, v8
CV 10,160,161
SH 160,10
HH 161,10
v_mul_f32 v160, v160, v9
v_mul_f32 v161, v161, v9
CV 10,160,161
SH 160,10
HH 161,10
v_add_f32 v72, 1.0, v72
v_add_f32 v73, 1.0, v73
CV 10,72,73
SH 72,10
HH 73,10
v_mul_f32 v160, v160, v72
v_mul_f32 v161, v161, v73
CV 10,160,161
SH 160,10
HH 161,10
v_add_f32 v160, v160, v112
v_add_f32 v161, v161, v113
CV 32,160,161
v_sub_f32 v162, v162, v8
v_sub_f32 v163, v163, v8
CV 10,162,163
SH 162,10
HH 163,10
v_mul_f32 v162, v162, v9
v_mul_f32 v163, v163, v9
CV 10,162,163
SH 162,10
HH 163,10
v_add_f32 v74, 1.0, v74
v_add_f32 v75, 1.0, v75
CV 10,74,75
SH 74,10
HH 75,10
v_mul_f32 v162, v162, v74
v_mul_f32 v163, v163, v75
CV 10,162,163
SH 162,10
HH 163,10
v_add_f32 v162, v162, v114
v_add_f32 v163, v163, v115
CV 33,162,163
v_sub_f32 v164, v164, v8
v_sub_f32 v165, v165, v8
CV 10,164,165
SH 164,10
HH 165,10
v_mul_f32 v164, v164, v9
v_mul_f32 v165, v165, v9
CV 10,164,165
SH 164,10
HH 165,10
v_add_f32 v76, 1.0, v76
v_add_f32 v77, 1.0, v77
CV 10,76,77
SH 76,10
HH 77,10
v_mul_f32 v164, v164, v76
v_mul_f32 v165, v165, v77
CV 10,164,165
SH 164,10
HH 165,10
v_add_f32 v164, v164, v116
v_add_f32 v165, v165, v117
CV 34,164,165
v_sub_f32 v166, v166, v8
v_sub_f32 v167, v167, v8
CV 10,166,167
SH 166,10
HH 167,10
v_mul_f32 v166, v166, v9
v_mul_f32 v167, v167, v9
CV 10,166,167
SH 166,10
HH 167,10
v_add_f32 v78, 1.0, v78
v_add_f32 v79, 1.0, v79
CV 10,78,79
SH 78,10
HH 79,10
v_mul_f32 v166, v166, v78
v_mul_f32 v167, v167, v79
CV 10,166,167
SH 166,10
HH 167,10
v_add_f32 v166, v166, v118
v_add_f32 v167, v167, v119
CV 35,166,167
v_lshrrev_b32 v8, 5, v5
v_mul_u32_u24 v8, 40960, v8
v_and_b32 v9, 31, v5
v_lshlrev_b32 v9, 4, v9
v_add_u32 v8, v8, v9
v_lshrrev_b32 v9, 1, v4
v_lshlrev_b32 v9, 10, v9
v_add_u32 v8, v8, v9
v_and_b32 v9, 1, v4
v_lshlrev_b32 v9, 3, v9
v_add_u32 v8, v8, v9
s_mov_b32 s25, 16777216
buffer_store_dwordx2 v[16:17], v8, s[8:11], s25 offen sc1
buffer_store_dwordx2 v[18:19], v8, s[8:11], s25 offen offset:512 sc1
s_add_u32 s25, s25, 8192
buffer_store_dwordx2 v[20:21], v8, s[8:11], s25 offen sc1
buffer_store_dwordx2 v[22:23], v8, s[8:11], s25 offen offset:512 sc1
s_add_u32 s25, s25, 8192
buffer_store_dwordx2 v[24:25], v8, s[8:11], s25 offen sc1
buffer_store_dwordx2 v[26:27], v8, s[8:11], s25 offen offset:512 sc1
s_add_u32 s25, s25, 8192
buffer_store_dwordx2 v[28:29], v8, s[8:11], s25 offen sc1
buffer_store_dwordx2 v[30:31], v8, s[8:11], s25 offen offset:512 sc1
s_add_u32 s25, s25, 8192
buffer_store_dwordx2 v[32:33], v8, s[8:11], s25 offen sc1
buffer_store_dwordx2 v[34:35], v8, s[8:11], s25 offen offset:512 sc1
s_add_u32 s25, s25, 8192
WV 0
s_cmp_eq_u32 s16, 0
s_cbranch_scc0 W_f_102
s_lshl_b32 s23, s58, 2
s_add_u32 s23, s23, 128
s_mov_b64 exec, 1
v_mov_b32 v5, 1
v_mov_b32 v22, s23
buffer_atomic_add v5, v22, s[12:15], 0 offen sc0
s_mov_b64 exec, -1
W_f_102:
WV 0
s_lshl_b32 s48, s55, 7
s_add_u32 s48, s48, 219136
s_branch P_end
P_f1:
s_lshl_b32 s48, s40, 7
s_add_u32 s48, s48, 219136
s_cmp_eq_u32 s16, 0
s_cbranch_scc0 dep_104
s_mov_b32 s22, 0
v_mov_b32 v22, 0
dep_103:
buffer_load_dword v23, v22, s[8:11], s48 offen sc1
s_add_u32 s22, s22, 1
s_cmp_gt_u32 s22, 524288
s_cbranch_scc1 dep_104
WV 0
v_readfirstlane_b32 s23, v23
s_nop 3
s_cmp_ge_u32 s23, 4
s_cbranch_scc1 dep_104
s_sleep 12
s_branch dep_103
dep_104:
s_barrier
s_mul_i32 s90, s16, 6144
s_mul_i32 s91, s16, 5120
v_and_b32 v22, 63, v0
v_lshlrev_b32 v1, 4, v22
v_lshrrev_b32 v23, 5, v22
v_lshlrev_b32 v23, 2, v23
v_and_b32 v24, 15, v22
v_lshrrev_b32 v25, 2, v24
v_add_u32 v23, v23, v25
v_lshrrev_b32 v25, 4, v22
v_and_b32 v25, 1, v25
v_lshlrev_b32 v25, 5, v25
v_and_b32 v26, 3, v24
v_lshlrev_b32 v26, 3, v26
v_add_u32 v25, v25, v26
v_mul_u32_u24 v26, 384, v23
v_add_u32 v26, v26, v25
v_lshrrev_b32 v27, 1, v23
v_and_b32 v27, 1, v27
v_lshlrev_b32 v27, 6, v27
v_add_u32 v2, v26, v27
v_sub_u32 v3, v26, v27
v_mul_u32_u24 v26, 320, v23
v_add_u32 v4, v26, v25
v_and_b32 v22, 63, v0
s_mul_i32 s23, s16, 384
s_add_u32 s23, s23, 0
v_add_u32 v23, s23, v22
v_mul_u32_u24 v24, 2731, v23
v_lshrrev_b32 v24, 16, v24
v_mul_u32_u24 v25, 24, v24
v_sub_u32 v25, v23, v25
v_lshrrev_b32 v26, 1, v24
v_and_b32 v26, 1, v26
v_lshlrev_b32 v26, 2, v26
v_xor_b32 v25, v25, v26
v_lshlrev_b32 v25, 4, v25
v_mul_u32_u24 v24, 3072, v24
v_add_u32 v10, v24, v25
s_mul_i32 s23, s16, 384
s_add_u32 s23, s23, 64
v_add_u32 v23, s23, v22
v_mul_u32_u24 v24, 2731, v23
v_lshrrev_b32 v24, 16, v24
v_mul_u32_u24 v25, 24, v24
v_sub_u32 v25, v23, v25
v_lshrrev_b32 v26, 1, v24
v_and_b32 v26, 1, v26
v_lshlrev_b32 v26, 2, v26
v_xor_b32 v25, v25, v26
v_lshlrev_b32 v25, 4, v25
v_mul_u32_u24 v24, 3072, v24
v_add_u32 v11, v24, v25
s_mul_i32 s23, s16, 384
s_add_u32 s23, s23, 128
v_add_u32 v23, s23, v22
v_mul_u32_u24 v24, 2731, v23
v_lshrrev_b32 v24, 16, v24
v_mul_u32_u24 v25, 24, v24
v_sub_u32 v25, v23, v25
v_lshrrev_b32 v26, 1, v24
v_and_b32 v26, 1, v26
v_lshlrev_b32 v26, 2, v26
v_xor_b32 v25, v25, v26
v_lshlrev_b32 v25, 4, v25
v_mul_u32_u24 v24, 3072, v24
v_add_u32 v12, v24, v25
s_mul_i32 s23, s16, 384
s_add_u32 s23, s23, 192
v_add_u32 v23, s23, v22
v_mul_u32_u24 v24, 2731, v23
v_lshrrev_b32 v24, 16, v24
v_mul_u32_u24 v25, 24, v24
v_sub_u32 v25, v23, v25
v_lshrrev_b32 v26, 1, v24
v_and_b32 v26, 1, v26
v_lshlrev_b32 v26, 2, v26
v_xor_b32 v25, v25, v26
v_lshlrev_b32 v25, 4, v25
v_mul_u32_u24 v24, 3072, v24
v_add_u32 v13, v24, v25
s_mul_i32 s23, s16, 384
s_add_u32 s23, s23, 256
v_add_u32 v23, s23, v22
v_mul_u32_u24 v24, 2731, v23
v_lshrrev_b32 v24, 16, v24
v_mul_u32_u24 v25, 24, v24
v_sub_u32 v25, v23, v25
v_lshrrev_b32 v26, 1, v24
v_and_b32 v26, 1, v26
v_lshlrev_b32 v26, 2, v26
v_xor_b32 v25, v25, v26
v_lshlrev_b32 v25, 4, v25
v_mul_u32_u24 v24, 3072, v24
v_add_u32 v14, v24, v25
s_mul_i32 s23, s16, 384
s_add_u32 s23, s23, 320
v_add_u32 v23, s23, v22
v_mul_u32_u24 v24, 2731, v23
v_lshrrev_b32 v24, 16, v24
v_mul_u32_u24 v25, 24, v24
v_sub_u32 v25, v23, v25
v_lshrrev_b32 v26, 1, v24
v_and_b32 v26, 1, v26
v_lshlrev_b32 v26, 2, v26
v_xor_b32 v25, v25, v26
v_lshlrev_b32 v25, 4, v25
v_mul_u32_u24 v24, 3072, v24
v_add_u32 v15, v24, v25
s_mul_i32 s42, s41, 384
s_mov_b32 s46, s42
s_lshl_b32 s43, s40, 2
s_add_u32 s43, s43, s16
s_mul_i32 s44, s43, 40960
s_add_u32 s44, s44, 16777216
s_mul_i32 s23, s16, 6144
s_add_u32 m0, s23, 0
s_nop 0
DM 10,68,42
s_add_u32 m0, s23, 1024
s_nop 0
DM 11,68,42
s_add_u32 m0, s23, 2048
s_nop 0
DM 12,68,42
s_add_u32 m0, s23, 3072
s_nop 0
DM 13,68,42
s_add_u32 m0, s23, 4096
s_nop 0
DM 14,68,42
s_add_u32 m0, s23, 5120
s_nop 0
DM 15,68,42
s_add_u32 s42, s42, 196608
buffer_load_dwordx4 a[0:3], v1, s[8:11], s44 offen offset:0 sc1
buffer_load_dwordx4 a[4:7], v1, s[8:11], s44 offen offset:1024 sc1
buffer_load_dwordx4 a[8:11], v1, s[8:11], s44 offen offset:2048 sc1
buffer_load_dwordx4 a[12:15], v1, s[8:11], s44 offen offset:3072 sc1
s_mul_i32 s23, s16, 6144
s_add_u32 m0, s23, 24576
s_nop 0
DM 10,68,42
s_add_u32 m0, s23, 25600
s_nop 0
DM 11,68,42
s_add_u32 m0, s23, 26624
s_nop 0
DM 12,68,42
s_add_u32 m0, s23, 27648
s_nop 0
DM 13,68,42
s_add_u32 m0, s23, 28672
s_nop 0
DM 14,68,42
s_add_u32 m0, s23, 29696
s_nop 0
DM 15,68,42
s_add_u32 s42, s42, 196608
s_add_u32 s44, s44, 4096
buffer_load_dwordx4 a[16:19], v1, s[8:11], s44 offen offset:0 sc1
buffer_load_dwordx4 a[20:23], v1, s[8:11], s44 offen offset:1024 sc1
buffer_load_dwordx4 a[24:27], v1, s[8:11], s44 offen offset:2048 sc1
buffer_load_dwordx4 a[28:31], v1, s[8:11], s44 offen offset:3072 sc1
s_mul_i32 s23, s16, 6144
s_add_u32 m0, s23, 49152
s_nop 0
DM 10,68,42
s_add_u32 m0, s23, 50176
s_nop 0
DM 11,68,42
s_add_u32 m0, s23, 51200
s_nop 0
DM 12,68,42
s_add_u32 m0, s23, 52224
s_nop 0
DM 13,68,42
s_add_u32 m0, s23, 53248
s_nop 0
DM 14,68,42
s_add_u32 m0, s23, 54272
s_nop 0
DM 15,68,42
s_add_u32 s42, s42, 196608
s_add_u32 s44, s44, 4096
buffer_load_dwordx4 a[32:35], v1, s[8:11], s44 offen offset:0 sc1
buffer_load_dwordx4 a[36:39], v1, s[8:11], s44 offen offset:1024 sc1
buffer_load_dwordx4 a[40:43], v1, s[8:11], s44 offen offset:2048 sc1
buffer_load_dwordx4 a[44:47], v1, s[8:11], s44 offen offset:3072 sc1
s_add_u32 s44, s44, 4096
buffer_load_dwordx4 a[48:51], v1, s[8:11], s44 offen offset:0 sc1
buffer_load_dwordx4 a[52:55], v1, s[8:11], s44 offen offset:1024 sc1
buffer_load_dwordx4 a[56:59], v1, s[8:11], s44 offen offset:2048 sc1
buffer_load_dwordx4 a[60:63], v1, s[8:11], s44 offen offset:3072 sc1
s_add_u32 s44, s44, 4096
buffer_load_dwordx4 a[64:67], v1, s[8:11], s44 offen offset:0 sc1
buffer_load_dwordx4 a[68:71], v1, s[8:11], s44 offen offset:1024 sc1
buffer_load_dwordx4 a[72:75], v1, s[8:11], s44 offen offset:2048 sc1
buffer_load_dwordx4 a[76:79], v1, s[8:11], s44 offen offset:3072 sc1
s_add_u32 s44, s44, 4096
buffer_load_dwordx4 a[80:83], v1, s[8:11], s44 offen offset:0 sc1
buffer_load_dwordx4 a[84:87], v1, s[8:11], s44 offen offset:1024 sc1
buffer_load_dwordx4 a[88:91], v1, s[8:11], s44 offen offset:2048 sc1
buffer_load_dwordx4 a[92:95], v1, s[8:11], s44 offen offset:3072 sc1
s_add_u32 s44, s44, 4096
buffer_load_dwordx4 a[96:99], v1, s[8:11], s44 offen offset:0 sc1
buffer_load_dwordx4 a[100:103], v1, s[8:11], s44 offen offset:1024 sc1
buffer_load_dwordx4 a[104:107], v1, s[8:11], s44 offen offset:2048 sc1
buffer_load_dwordx4 a[108:111], v1, s[8:11], s44 offen offset:3072 sc1
s_add_u32 s44, s44, 4096
buffer_load_dwordx4 a[112:115], v1, s[8:11], s44 offen offset:0 sc1
buffer_load_dwordx4 a[116:119], v1, s[8:11], s44 offen offset:1024 sc1
buffer_load_dwordx4 a[120:123], v1, s[8:11], s44 offen offset:2048 sc1
buffer_load_dwordx4 a[124:127], v1, s[8:11], s44 offen offset:3072 sc1
s_add_u32 s44, s44, 4096
buffer_load_dwordx4 a[128:131], v1, s[8:11], s44 offen offset:0 sc1
buffer_load_dwordx4 a[132:135], v1, s[8:11], s44 offen offset:1024 sc1
buffer_load_dwordx4 a[136:139], v1, s[8:11], s44 offen offset:2048 sc1
buffer_load_dwordx4 a[140:143], v1, s[8:11], s44 offen offset:3072 sc1
s_add_u32 s44, s44, 4096
buffer_load_dwordx4 a[144:147], v1, s[8:11], s44 offen offset:0 sc1
buffer_load_dwordx4 a[148:151], v1, s[8:11], s44 offen offset:1024 sc1
buffer_load_dwordx4 a[152:155], v1, s[8:11], s44 offen offset:2048 sc1
buffer_load_dwordx4 a[156:159], v1, s[8:11], s44 offen offset:3072 sc1
WV 52
s_barrier
v_add_u32 v6, 0, v2
v_add_u32 v7, 0, v3
TR 160,6,0
TR 162,6,3072
TR 164,7,64
TR 166,7,3136
TR 168,6,128
TR 170,6,3200
TR 172,7,192
TR 174,7,3264
TR 176,6,256
TR 178,6,3328
TR 180,7,320
TR 182,7,3392
WV 51
WL 10
v_mfma_f32_32x32x16_bf16 v[32:47], a[160:163], a[0:3], 0
TR 184,6,6144
TR 186,6,9216
WL 10
v_mfma_f32_32x32x16_bf16 v[48:63], a[164:167], a[0:3], 0
TR 188,7,6208
TR 190,7,9280
WL 10
v_mfma_f32_32x32x16_bf16 v[64:79], a[168:171], a[0:3], 0
TR 192,6,6272
TR 194,6,9344
WL 10
v_mfma_f32_32x32x16_bf16 v[80:95], a[172:175], a[0:3], 0
TR 196,7,6336
TR 198,7,9408
WL 10
v_mfma_f32_32x32x16_bf16 v[96:111], a[176:179], a[0:3], 0
TR 200,6,6400
TR 202,6,9472
WL 10
v_mfma_f32_32x32x16_bf16 v[112:127], a[180:183], a[0:3], 0
TR 204,7,6464
TR 206,7,9536
WV 50
WL 10
MA 32,184,4
TR 160,6,12288
TR 162,6,15360
WL 10
MA 48,188,4
TR 164,7,12352
TR 166,7,15424
WL 10
MA 64,192,4
TR 168,6,12416
TR 170,6,15488
WL 10
MA 80,196,4
TR 172,7,12480
TR 174,7,15552
WL 10
MA 96,200,4
TR 176,6,12544
TR 178,6,15616
WL 10
MA 112,204,4
TR 180,7,12608
TR 182,7,15680
WV 49
WV 42
s_barrier
v_add_u32 v8, 24576, v2
v_add_u32 v9, 24576, v3
WL 10
MA 32,160,8
TR 184,6,18432
TR 186,6,21504
WL 10
MA 48,164,8
TR 188,7,18496
TR 190,7,21568
s_add_u32 m0, s90, 73728
s_nop 0
DM 10,68,42
WL 10
MA 64,168,8
TR 192,6,18560
TR 194,6,21632
WL 10
MA 80,172,8
TR 196,7,18624
TR 198,7,21696
WL 10
MA 96,176,8
TR 200,6,18688
TR 202,6,21760
s_add_u32 m0, s90, 74752
s_nop 0
DM 11,68,42
WL 10
MA 112,180,8
TR 204,7,18752
TR 206,7,21824
WL 10
MA 32,184,12
TR 160,8,0
TR 162,8,3072
WL 10
MA 48,188,12
TR 164,9,64
TR 166,9,3136
s_add_u32 m0, s90, 75776
s_nop 0
DM 12,68,42
WL 10
MA 64,192,12
TR 168,8,128
TR 170,8,3200
WL 10
MA 80,196,12
TR 172,9,192
TR 174,9,3264
WL 10
MA 96,200,12
TR 176,8,256
TR 178,8,3328
s_add_u32 m0, s90, 76800
s_nop 0
DM 13,68,42
WL 10
MA 112,204,12
TR 180,9,320
TR 182,9,3392
WV 45
WL 10
MA 32,160,16
TR 184,8,6144
TR 186,8,9216
WL 10
MA 48,164,16
TR 188,9,6208
TR 190,9,9280
s_add_u32 m0, s90, 77824
s_nop 0
DM 14,68,42
WL 10
MA 64,168,16
TR 192,8,6272
TR 194,8,9344
WL 10
MA 80,172,16
TR 196,9,6336
TR 198,9,9408
WL 10
MA 96,176,16
TR 200,8,6400
TR 202,8,9472
s_add_u32 m0, s90, 78848
s_nop 0
DM 15,68,42
s_add_u32 s42, s42, 196608
WL 10
MA 112,180,16
TR 204,9,6464
TR 206,9,9536
WV 46
WL 10
MA 32,184,20
TR 160,8,12288
TR 162,8,15360
WL 10
MA 48,188,20
TR 164,9,12352
TR 166,9,15424
WL 10
MA 64,192,20
TR 168,8,12416
TR 170,8,15488
WL 10
MA 80,196,20
TR 172,9,12480
TR 174,9,15552
WL 10
MA 96,200,20
TR 176,8,12544
TR 178,8,15616
WL 10
MA 112,204,20
TR 180,9,12608
TR 182,9,15680
WV 45
WV 38
s_barrier
v_add_u32 v6, 49152, v2
v_add_u32 v7, 49152, v3
WL 10
MA 32,160,24
TR 184,8,18432
TR 186,8,21504
WL 10
MA 48,164,24
TR 188,9,18496
TR 190,9,21568
s_add_u32 m0, s90, 0
s_nop 0
DM 10,68,42
WL 10
MA 64,168,24
TR 192,8,18560
TR 194,8,21632
WL 10
MA 80,172,24
TR 196,9,18624
TR 198,9,21696
WL 10
MA 96,176,24
TR 200,8,18688
TR 202,8,21760
s_add_u32 m0, s90, 1024
s_nop 0
DM 11,68,42
WL 10
MA 112,180,24
TR 204,9,18752
TR 206,9,21824
WL 10
MA 32,184,28
TR 160,6,0
TR 162,6,3072
WL 10
MA 48,188,28
TR 164,7,64
TR 166,7,3136
s_add_u32 m0, s90, 2048
s_nop 0
DM 12,68,42
WL 10
MA 64,192,28
TR 168,6,128
TR 170,6,3200
WL 10
MA 80,196,28
TR 172,7,192
TR 174,7,3264
WL 10
MA 96,200,28
TR 176,6,256
TR 178,6,3328
s_add_u32 m0, s90, 3072
s_nop 0
DM 13,68,42
WL 10
MA 112,204,28
TR 180,7,320
TR 182,7,3392
WV 41
WL 10
MA 32,160,32
TR 184,6,6144
TR 186,6,9216
WL 10
MA 48,164,32
TR 188,7,6208
TR 190,7,9280
s_add_u32 m0, s90, 4096
s_nop 0
DM 14,68,42
WL 10
MA 64,168,32
TR 192,6,6272
TR 194,6,9344
WL 10
MA 80,172,32
TR 196,7,6336
TR 198,7,9408
WL 10
MA 96,176,32
TR 200,6,6400
TR 202,6,9472
s_add_u32 m0, s90, 5120
s_nop 0
DM 15,68,42
s_add_u32 s42, s42, 196608
WL 10
MA 112,180,32
TR 204,7,6464
TR 206,7,9536
WV 42
WL 10
MA 32,184,36
TR 160,6,12288
TR 162,6,15360
WL 10
MA 48,188,36
TR 164,7,12352
TR 166,7,15424
WL 10
MA 64,192,36
TR 168,6,12416
TR 170,6,15488
WL 10
MA 80,196,36
TR 172,7,12480
TR 174,7,15552
WL 10
MA 96,200,36
TR 176,6,12544
TR 178,6,15616
WL 10
MA 112,204,36
TR 180,7,12608
TR 182,7,15680
WV 41
WV 6
s_barrier
v_add_u32 v8, 73728, v2
v_add_u32 v9, 73728, v3
WL 10
MA 32,160,40
TR 184,6,18432
TR 186,6,21504
WL 10
MA 48,164,40
TR 188,7,18496
TR 190,7,21568
s_add_u32 m0, s90, 24576
s_nop 0
DM 10,68,42
WL 10
MA 64,168,40
TR 192,6,18560
TR 194,6,21632
WL 10
MA 80,172,40
TR 196,7,18624
TR 198,7,21696
WL 10
MA 96,176,40
TR 200,6,18688
TR 202,6,21760
s_add_u32 m0, s90, 25600
s_nop 0
DM 11,68,42
WL 10
MA 112,180,40
TR 204,7,18752
TR 206,7,21824
WL 10
MA 32,184,44
TR 160,8,0
TR 162,8,3072
WL 10
MA 48,188,44
TR 164,9,64
TR 166,9,3136
s_add_u32 m0, s90, 26624
s_nop 0
DM 12,68,42
WL 10
MA 64,192,44
TR 168,8,128
TR 170,8,3200
WL 10
MA 80,196,44
TR 172,9,192
TR 174,9,3264
WL 10
MA 96,200,44
TR 176,8,256
TR 178,8,3328
s_add_u32 m0, s90, 27648
s_nop 0
DM 13,68,42
WL 10
MA 112,204,44
TR 180,9,320
TR 182,9,3392
WL 10
MA 32,160,48
TR 184,8,6144
TR 186,8,9216
WL 10
MA 48,164,48
TR 188,9,6208
TR 190,9,9280
s_add_u32 m0, s90, 28672
s_nop 0
DM 14,68,42
WL 10
MA 64,168,48
TR 192,8,6272
TR 194,8,9344
WL 10
MA 80,172,48
TR 196,9,6336
TR 198,9,9408
WL 10
MA 96,176,48
TR 200,8,6400
TR 202,8,9472
s_add_u32 m0, s90, 29696
s_nop 0
DM 15,68,42
s_add_u32 s42, s42, 196608
WL 10
MA 112,180,48
TR 204,9,6464
TR 206,9,9536
WL 10
MA 32,184,52
TR 160,8,12288
TR 162,8,15360
WL 10
MA 48,188,52
TR 164,9,12352
TR 166,9,15424
WL 10
MA 64,192,52
TR 168,8,12416
TR 170,8,15488
WL 10
MA 80,196,52
TR 172,9,12480
TR 174,9,15552
WL 10
MA 96,200,52
TR 176,8,12544
TR 178,8,15616
WL 10
MA 112,204,52
TR 180,9,12608
TR 182,9,15680
WV 6
s_barrier
v_add_u32 v6, 0, v2
v_add_u32 v7, 0, v3
WL 10
MA 32,160,56
TR 184,8,18432
TR 186,8,21504
WL 10
MA 48,164,56
TR 188,9,18496
TR 190,9,21568
s_add_u32 m0, s90, 49152
s_nop 0
DM 10,68,42
WL 10
MA 64,168,56
TR 192,8,18560
TR 194,8,21632
WL 10
MA 80,172,56
TR 196,9,18624
TR 198,9,21696
WL 10
MA 96,176,56
TR 200,8,18688
TR 202,8,21760
s_add_u32 m0, s90, 50176
s_nop 0
DM 11,68,42
WL 10
MA 112,180,56
TR 204,9,18752
TR 206,9,21824
WL 10
MA 32,184,60
TR 160,6,0
TR 162,6,3072
WL 10
MA 48,188,60
TR 164,7,64
TR 166,7,3136
s_add_u32 m0, s90, 51200
s_nop 0
DM 12,68,42
WL 10
MA 64,192,60
TR 168,6,128
TR 170,6,3200
WL 10
MA 80,196,60
TR 172,7,192
TR 174,7,3264
WL 10
MA 96,200,60
TR 176,6,256
TR 178,6,3328
s_add_u32 m0, s90, 52224
s_nop 0
DM 13,68,42
WL 10
MA 112,204,60
TR 180,7,320
TR 182,7,3392
WL 10
MA 32,160,64
TR 184,6,6144
TR 186,6,9216
WL 10
MA 48,164,64
TR 188,7,6208
TR 190,7,9280
s_add_u32 m0, s90, 53248
s_nop 0
DM 14,68,42
WL 10
MA 64,168,64
TR 192,6,6272
TR 194,6,9344
WL 10
MA 80,172,64
TR 196,7,6336
TR 198,7,9408
WL 10
MA 96,176,64
TR 200,6,6400
TR 202,6,9472
s_add_u32 m0, s90, 54272
s_nop 0
DM 15,68,42
s_add_u32 s42, s42, 196608
WL 10
MA 112,180,64
TR 204,7,6464
TR 206,7,9536
WL 10
MA 32,184,68
TR 160,6,12288
TR 162,6,15360
WL 10
MA 48,188,68
TR 164,7,12352
TR 166,7,15424
WL 10
MA 64,192,68
TR 168,6,12416
TR 170,6,15488
WL 10
MA 80,196,68
TR 172,7,12480
TR 174,7,15552
WL 10
MA 96,200,68
TR 176,6,12544
TR 178,6,15616
WL 10
MA 112,204,68
TR 180,7,12608
TR 182,7,15680
WV 6
s_barrier
v_add_u32 v8, 24576, v2
v_add_u32 v9, 24576, v3
WL 10
MA 32,160,72
TR 184,6,18432
TR 186,6,21504
WL 10
MA 48,164,72
TR 188,7,18496
TR 190,7,21568
s_add_u32 m0, s90, 73728
s_nop 0
DM 10,68,42
WL 10
MA 64,168,72
TR 192,6,18560
TR 194,6,21632
WL 10
MA 80,172,72
TR 196,7,18624
TR 198,7,21696
WL 10
MA 96,176,72
TR 200,6,18688
TR 202,6,21760
s_add_u32 m0, s90, 74752
s_nop 0
DM 11,68,42
WL 10
MA 112,180,72
TR 204,7,18752
TR 206,7,21824
WL 10
MA 32,184,76
TR 160,8,0
TR 162,8,3072
WL 10
MA 48,188,76
TR 164,9,64
TR 166,9,3136
s_add_u32 m0, s90, 75776
s_nop 0
DM 12,68,42
WL 10
MA 64,192,76
TR 168,8,128
TR 170,8,3200
WL 10
MA 80,196,76
TR 172,9,192
TR 174,9,3264
WL 10
MA 96,200,76
TR 176,8,256
TR 178,8,3328
s_add_u32 m0, s90, 76800
s_nop 0
DM 13,68,42
WL 10
MA 112,204,76
TR 180,9,320
TR 182,9,3392
WL 10
MA 32,160,80
TR 184,8,6144
TR 186,8,9216
WL 10
MA 48,164,80
TR 188,9,6208
TR 190,9,9280
s_add_u32 m0, s90, 77824
s_nop 0
DM 14,68,42
WL 10
MA 64,168,80
TR 192,8,6272
TR 194,8,9344
WL 10
MA 80,172,80
TR 196,9,6336
TR 198,9,9408
WL 10
MA 96,176,80
TR 200,8,6400
TR 202,8,9472
s_add_u32 m0, s90, 78848
s_nop 0
DM 15,68,42
s_add_u32 s42, s42, 196608
WL 10
MA 112,180,80
TR 204,9,6464
TR 206,9,9536
WL 10
MA 32,184,84
TR 160,8,12288
TR 162,8,15360
WL 10
MA 48,188,84
TR 164,9,12352
TR 166,9,15424
WL 10
MA 64,192,84
TR 168,8,12416
TR 170,8,15488
WL 10
MA 80,196,84
TR 172,9,12480
TR 174,9,15552
WL 10
MA 96,200,84
TR 176,8,12544
TR 178,8,15616
WL 10
MA 112,204,84
TR 180,9,12608
TR 182,9,15680
WV 6
s_barrier
v_add_u32 v6, 49152, v2
v_add_u32 v7, 49152, v3
WL 10
MA 32,160,88
TR 184,8,18432
TR 186,8,21504
WL 10
MA 48,164,88
TR 188,9,18496
TR 190,9,21568
s_add_u32 m0, s90, 0
s_nop 0
DM 10,68,42
WL 10
MA 64,168,88
TR 192,8,18560
TR 194,8,21632
WL 10
MA 80,172,88
TR 196,9,18624
TR 198,9,21696
WL 10
MA 96,176,88
TR 200,8,18688
TR 202,8,21760
s_add_u32 m0, s90, 1024
s_nop 0
DM 11,68,42
WL 10
MA 112,180,88
TR 204,9,18752
TR 206,9,21824
WL 10
MA 32,184,92
TR 160,6,0
TR 162,6,3072
WL 10
MA 48,188,92
TR 164,7,64
TR 166,7,3136
s_add_u32 m0, s90, 2048
s_nop 0
DM 12,68,42
WL 10
MA 64,192,92
TR 168,6,128
TR 170,6,3200
WL 10
MA 80,196,92
TR 172,7,192
TR 174,7,3264
WL 10
MA 96,200,92
TR 176,6,256
TR 178,6,3328
s_add_u32 m0, s90, 3072
s_nop 0
DM 13,68,42
WL 10
MA 112,204,92
TR 180,7,320
TR 182,7,3392
WL 10
MA 32,160,96
TR 184,6,6144
TR 186,6,9216
WL 10
MA 48,164,96
TR 188,7,6208
TR 190,7,9280
s_add_u32 m0, s90, 4096
s_nop 0
DM 14,68,42
WL 10
MA 64,168,96
TR 192,6,6272
TR 194,6,9344
WL 10
MA 80,172,96
TR 196,7,6336
TR 198,7,9408
WL 10
MA 96,176,96
TR 200,6,6400
TR 202,6,9472
s_add_u32 m0, s90, 5120
s_nop 0
DM 15,68,42
s_add_u32 s42, s42, 196608
WL 10
MA 112,180,96
TR 204,7,6464
TR 206,7,9536
WL 10
MA 32,184,100
TR 160,6,12288
TR 162,6,15360
WL 10
MA 48,188,100
TR 164,7,12352
TR 166,7,15424
WL 10
MA 64,192,100
TR 168,6,12416
TR 170,6,15488
WL 10
MA 80,196,100
TR 172,7,12480
TR 174,7,15552
WL 10
MA 96,200,100
TR 176,6,12544
TR 178,6,15616
WL 10
MA 112,204,100
TR 180,7,12608
TR 182,7,15680
WV 6
s_barrier
v_add_u32 v8, 73728, v2
v_add_u32 v9, 73728, v3
WL 10
MA 32,160,104
TR 184,6,18432
TR 186,6,21504
WL 10
MA 48,164,104
TR 188,7,18496
TR 190,7,21568
s_add_u32 m0, s90, 24576
s_nop 0
DM 10,68,42
WL 10
MA 64,168,104
TR 192,6,18560
TR 194,6,21632
WL 10
MA 80,172,104
TR 196,7,18624
TR 198,7,21696
WL 10
MA 96,176,104
TR 200,6,18688
TR 202,6,21760
s_add_u32 m0, s90, 25600
s_nop 0
DM 11,68,42
WL 10
MA 112,180,104
TR 204,7,18752
TR 206,7,21824
WL 10
MA 32,184,108
TR 160,8,0
TR 162,8,3072
WL 10
MA 48,188,108
TR 164,9,64
TR 166,9,3136
s_add_u32 m0, s90, 26624
s_nop 0
DM 12,68,42
WL 10
MA 64,192,108
TR 168,8,128
TR 170,8,3200
WL 10
MA 80,196,108
TR 172,9,192
TR 174,9,3264
WL 10
MA 96,200,108
TR 176,8,256
TR 178,8,3328
s_add_u32 m0, s90, 27648
s_nop 0
DM 13,68,42
WL 10
MA 112,204,108
TR 180,9,320
TR 182,9,3392
WL 10
MA 32,160,112
TR 184,8,6144
TR 186,8,9216
WL 10
MA 48,164,112
TR 188,9,6208
TR 190,9,9280
s_add_u32 m0, s90, 28672
s_nop 0
DM 14,68,42
WL 10
MA 64,168,112
TR 192,8,6272
TR 194,8,9344
WL 10
MA 80,172,112
TR 196,9,6336
TR 198,9,9408
WL 10
MA 96,176,112
TR 200,8,6400
TR 202,8,9472
s_add_u32 m0, s90, 29696
s_nop 0
DM 15,68,42
s_add_u32 s42, s42, 196608
WL 10
MA 112,180,112
TR 204,9,6464
TR 206,9,9536
WL 10
MA 32,184,116
TR 160,8,12288
TR 162,8,15360
WL 10
MA 48,188,116
TR 164,9,12352
TR 166,9,15424
WL 10
MA 64,192,116
TR 168,8,12416
TR 170,8,15488
WL 10
MA 80,196,116
TR 172,9,12480
TR 174,9,15552
WL 10
MA 96,200,116
TR 176,8,12544
TR 178,8,15616
WL 10
MA 112,204,116
TR 180,9,12608
TR 182,9,15680
WV 6
s_barrier
v_add_u32 v6, 0, v2
v_add_u32 v7, 0, v3
WL 10
MA 32,160,120
TR 184,8,18432
TR 186,8,21504
WL 10
MA 48,164,120
TR 188,9,18496
TR 190,9,21568
s_add_u32 m0, s90, 49152
s_nop 0
DM 10,72,46
WL 10
MA 64,168,120
TR 192,8,18560
TR 194,8,21632
WL 10
MA 80,172,120
TR 196,9,18624
TR 198,9,21696
WL 10
MA 96,176,120
TR 200,8,18688
TR 202,8,21760
s_add_u32 m0, s90, 50176
s_nop 0
DM 11,72,46
WL 10
MA 112,180,120
TR 204,9,18752
TR 206,9,21824
WL 10
MA 32,184,124
TR 160,6,0
TR 162,6,3072
WL 10
MA 48,188,124
TR 164,7,64
TR 166,7,3136
s_add_u32 m0, s90, 51200
s_nop 0
DM 12,72,46
WL 10
MA 64,192,124
TR 168,6,128
TR 170,6,3200
WL 10
MA 80,196,124
TR 172,7,192
TR 174,7,3264
WL 10
MA 96,200,124
TR 176,6,256
TR 178,6,3328
s_add_u32 m0, s90, 52224
s_nop 0
DM 13,72,46
WL 10
MA 112,204,124
TR 180,7,320
TR 182,7,3392
WL 10
MA 32,160,128
TR 184,6,6144
TR 186,6,9216
WL 10
MA 48,164,128
TR 188,7,6208
TR 190,7,9280
s_add_u32 m0, s90, 53248
s_nop 0
DM 14,72,46
WL 10
MA 64,168,128
TR 192,6,6272
TR 194,6,9344
WL 10
MA 80,172,128
TR 196,7,6336
TR 198,7,9408
WL 10
MA 96,176,128
TR 200,6,6400
TR 202,6,9472
s_add_u32 m0, s90, 54272
s_nop 0
DM 15,72,46
s_add_u32 s46, s46, 196608
WL 10
MA 112,180,128
TR 204,7,6464
TR 206,7,9536
WL 10
MA 32,184,132
TR 160,6,12288
TR 162,6,15360
WL 10
MA 48,188,132
TR 164,7,12352
TR 166,7,15424
WL 10
MA 64,192,132
TR 168,6,12416
TR 170,6,15488
WL 10
MA 80,196,132
TR 172,7,12480
TR 174,7,15552
WL 10
MA 96,200,132
TR 176,6,12544
TR 178,6,15616
WL 10
MA 112,204,132
TR 180,7,12608
TR 182,7,15680
WV 6
s_barrier
v_add_u32 v8, 24576, v2
v_add_u32 v9, 24576, v3
WL 10
MA 32,160,136
TR 184,6,18432
TR 186,6,21504
WL 10
MA 48,164,136
TR 188,7,18496
TR 190,7,21568
s_add_u32 m0, s90, 73728
s_nop 0
DM 10,72,46
WL 10
MA 64,168,136
TR 192,6,18560
TR 194,6,21632
WL 10
MA 80,172,136
TR 196,7,18624
TR 198,7,21696
WL 10
MA 96,176,136
TR 200,6,18688
TR 202,6,21760
s_add_u32 m0, s90, 74752
s_nop 0
DM 11,72,46
WL 10
MA 112,180,136
TR 204,7,18752
TR 206,7,21824
WL 10
MA 32,184,140
TR 160,8,0
TR 162,8,3072
WL 10
MA 48,188,140
TR 164,9,64
TR 166,9,3136
s_add_u32 m0, s90, 75776
s_nop 0
DM 12,72,46
WL 10
MA 64,192,140
TR 168,8,128
TR 170,8,3200
WL 10
MA 80,196,140
TR 172,9,192
TR 174,9,3264
WL 10
MA 96,200,140
TR 176,8,256
TR 178,8,3328
s_add_u32 m0, s90, 76800
s_nop 0
DM 13,72,46
WL 10
MA 112,204,140
TR 180,9,320
TR 182,9,3392
WL 10
MA 32,160,144
TR 184,8,6144
TR 186,8,9216
WL 10
MA 48,164,144
TR 188,9,6208
TR 190,9,9280
s_add_u32 m0, s90, 77824
s_nop 0
DM 14,72,46
WL 10
MA 64,168,144
TR 192,8,6272
TR 194,8,9344
WL 10
MA 80,172,144
TR 196,9,6336
TR 198,9,9408
WL 10
MA 96,176,144
TR 200,8,6400
TR 202,8,9472
s_add_u32 m0, s90, 78848
s_nop 0
DM 15,72,46
s_add_u32 s46, s46, 196608
WL 10
MA 112,180,144
TR 204,9,6464
TR 206,9,9536
WL 10
MA 32,184,148
TR 160,8,12288
TR 162,8,15360
WL 10
MA 48,188,148
TR 164,9,12352
TR 166,9,15424
WL 10
MA 64,192,148
TR 168,8,12416
TR 170,8,15488
WL 10
MA 80,196,148
TR 172,9,12480
TR 174,9,15552
WL 10
MA 96,200,148
TR 176,8,12544
TR 178,8,15616
WL 10
MA 112,204,148
TR 180,9,12608
TR 182,9,15680
WV 6
s_barrier
v_add_u32 v6, 49152, v2
v_add_u32 v7, 49152, v3
WL 10
MA 32,160,152
TR 184,8,18432
TR 186,8,21504
WL 10
MA 48,164,152
TR 188,9,18496
TR 190,9,21568
s_add_u32 m0, s90, 0
s_nop 0
DM 10,72,46
WL 10
MA 64,168,152
TR 192,8,18560
TR 194,8,21632
WL 10
MA 80,172,152
TR 196,9,18624
TR 198,9,21696
WL 10
MA 96,176,152
TR 200,8,18688
TR 202,8,21760
s_add_u32 m0, s90, 1024
s_nop 0
DM 11,72,46
WL 10
MA 112,180,152
TR 204,9,18752
TR 206,9,21824
WL 10
MA 32,184,156
TR 160,6,0
TR 162,6,3072
WL 10
MA 48,188,156
TR 164,7,64
TR 166,7,3136
s_add_u32 m0, s90, 2048
s_nop 0
DM 12,72,46
WL 10
MA 64,192,156
TR 168,6,128
TR 170,6,3200
WL 10
MA 80,196,156
TR 172,7,192
TR 174,7,3264
WL 10
MA 96,200,156
TR 176,6,256
TR 178,6,3328
s_add_u32 m0, s90, 3072
s_nop 0
DM 13,72,46
WL 10
MA 112,204,156
TR 180,7,320
TR 182,7,3392
WL 10
v_mfma_f32_32x32x16_bf16 v[128:143], a[160:163], a[0:3], 0
TR 184,6,6144
TR 186,6,9216
WL 10
v_mfma_f32_32x32x16_bf16 v[144:159], a[164:167], a[0:3], 0
TR 188,7,6208
TR 190,7,9280
s_add_u32 m0, s90, 4096
s_nop 0
DM 14,72,46
WL 10
v_mfma_f32_32x32x16_bf16 v[160:175], a[168:171], a[0:3], 0
TR 192,6,6272
TR 194,6,9344
WL 10
v_mfma_f32_32x32x16_bf16 v[176:191], a[172:175], a[0:3], 0
TR 196,7,6336
TR 198,7,9408
WL 10
v_mfma_f32_32x32x16_bf16 v[192:207], a[176:179], a[0:3], 0
TR 200,6,6400
TR 202,6,9472
s_add_u32 m0, s90, 5120
s_nop 0
DM 15,72,46
s_add_u32 s46, s46, 196608
WL 10
v_mfma_f32_32x32x16_bf16 v[208:223], a[180:183], a[0:3], 0
TR 204,7,6464
TR 206,7,9536
WL 10
MA 128,184,4
TR 160,6,12288
TR 162,6,15360
WL 10
MA 144,188,4
TR 164,7,12352
TR 166,7,15424
WL 10
MA 160,192,4
TR 168,6,12416
TR 170,6,15488
WL 10
MA 176,196,4
TR 172,7,12480
TR 174,7,15552
WL 10
MA 192,200,4
TR 176,6,12544
TR 178,6,15616
WL 10
MA 208,204,4
TR 180,7,12608
TR 182,7,15680
WV 6
s_barrier
v_add_u32 v8, 73728, v2
v_add_u32 v9, 73728, v3
WL 10
MA 128,160,8
TR 184,6,18432
TR 186,6,21504
WL 10
MA 144,164,8
TR 188,7,18496
TR 190,7,21568
s_add_u32 m0, s90, 24576
s_nop 0
DM 10,72,46
WL 10
MA 160,168,8
TR 192,6,18560
TR 194,6,21632
WL 10
MA 176,172,8
TR 196,7,18624
TR 198,7,21696
WL 10
MA 192,176,8
TR 200,6,18688
TR 202,6,21760
s_add_u32 m0, s90, 25600
s_nop 0
DM 11,72,46
WL 10
MA 208,180,8
TR 204,7,18752
TR 206,7,21824
WL 10
MA 128,184,12
TR 160,8,0
TR 162,8,3072
WL 10
MA 144,188,12
TR 164,9,64
TR 166,9,3136
s_add_u32 m0, s90, 26624
s_nop 0
DM 12,72,46
WL 10
MA 160,192,12
TR 168,8,128
TR 170,8,3200
WL 10
MA 176,196,12
TR 172,9,192
TR 174,9,3264
WL 10
MA 192,200,12
TR 176,8,256
TR 178,8,3328
s_add_u32 m0, s90, 27648
s_nop 0
DM 13,72,46
WL 10
MA 208,204,12
TR 180,9,320
TR 182,9,3392
WL 10
MA 128,160,16
TR 184,8,6144
TR 186,8,9216
WL 10
MA 144,164,16
TR 188,9,6208
TR 190,9,9280
s_add_u32 m0, s90, 28672
s_nop 0
DM 14,72,46
WL 10
MA 160,168,16
TR 192,8,6272
TR 194,8,9344
WL 10
MA 176,172,16
TR 196,9,6336
TR 198,9,9408
WL 10
MA 192,176,16
TR 200,8,6400
TR 202,8,9472
s_add_u32 m0, s90, 29696
s_nop 0
DM 15,72,46
s_add_u32 s46, s46, 196608
WL 10
MA 208,180,16
TR 204,9,6464
TR 206,9,9536
WL 10
MA 128,184,20
TR 160,8,12288
TR 162,8,15360
WL 10
MA 144,188,20
TR 164,9,12352
TR 166,9,15424
WL 10
MA 160,192,20
TR 168,8,12416
TR 170,8,15488
WL 10
MA 176,196,20
TR 172,9,12480
TR 174,9,15552
WL 10
MA 192,200,20
TR 176,8,12544
TR 178,8,15616
WL 10
MA 208,204,20
TR 180,9,12608
TR 182,9,15680
WV 6
s_barrier
v_add_u32 v6, 0, v2
v_add_u32 v7, 0, v3
WL 10
MA 128,160,24
TR 184,8,18432
TR 186,8,21504
WL 10
MA 144,164,24
TR 188,9,18496
TR 190,9,21568
s_add_u32 m0, s90, 49152
s_nop 0
DM 10,72,46
WL 10
MA 160,168,24
TR 192,8,18560
TR 194,8,21632
WL 10
MA 176,172,24
TR 196,9,18624
TR 198,9,21696
WL 10
MA 192,176,24
TR 200,8,18688
TR 202,8,21760
s_add_u32 m0, s90, 50176
s_nop 0
DM 11,72,46
WL 10
MA 208,180,24
TR 204,9,18752
TR 206,9,21824
WL 10
MA 128,184,28
TR 160,6,0
TR 162,6,3072
WL 10
MA 144,188,28
TR 164,7,64
TR 166,7,3136
s_add_u32 m0, s90, 51200
s_nop 0
DM 12,72,46
WL 10
MA 160,192,28
TR 168,6,128
TR 170,6,3200
WL 10
MA 176,196,28
TR 172,7,192
TR 174,7,3264
WL 10
MA 192,200,28
TR 176,6,256
TR 178,6,3328
s_add_u32 m0, s90, 52224
s_nop 0
DM 13,72,46
WL 10
MA 208,204,28
TR 180,7,320
TR 182,7,3392
WL 10
MA 128,160,32
TR 184,6,6144
TR 186,6,9216
WL 10
MA 144,164,32
TR 188,7,6208
TR 190,7,9280
s_add_u32 m0, s90, 53248
s_nop 0
DM 14,72,46
WL 10
MA 160,168,32
TR 192,6,6272
TR 194,6,9344
WL 10
MA 176,172,32
TR 196,7,6336
TR 198,7,9408
WL 10
MA 192,176,32
TR 200,6,6400
TR 202,6,9472
s_add_u32 m0, s90, 54272
s_nop 0
DM 15,72,46
s_add_u32 s46, s46, 196608
WL 10
MA 208,180,32
TR 204,7,6464
TR 206,7,9536
WL 10
MA 128,184,36
TR 160,6,12288
TR 162,6,15360
WL 10
MA 144,188,36
TR 164,7,12352
TR 166,7,15424
WL 10
MA 160,192,36
TR 168,6,12416
TR 170,6,15488
WL 10
MA 176,196,36
TR 172,7,12480
TR 174,7,15552
WL 10
MA 192,200,36
TR 176,6,12544
TR 178,6,15616
WL 10
MA 208,204,36
TR 180,7,12608
TR 182,7,15680
WV 6
s_barrier
v_add_u32 v8, 24576, v2
v_add_u32 v9, 24576, v3
WL 10
MA 128,160,40
TR 184,6,18432
TR 186,6,21504
WL 10
MA 144,164,40
TR 188,7,18496
TR 190,7,21568
s_add_u32 m0, s90, 73728
s_nop 0
DM 10,72,46
WL 10
MA 160,168,40
TR 192,6,18560
TR 194,6,21632
WL 10
MA 176,172,40
TR 196,7,18624
TR 198,7,21696
WL 10
MA 192,176,40
TR 200,6,18688
TR 202,6,21760
s_add_u32 m0, s90, 74752
s_nop 0
DM 11,72,46
WL 10
MA 208,180,40
TR 204,7,18752
TR 206,7,21824
WL 10
MA 128,184,44
TR 160,8,0
TR 162,8,3072
WL 10
MA 144,188,44
TR 164,9,64
TR 166,9,3136
s_add_u32 m0, s90, 75776
s_nop 0
DM 12,72,46
WL 10
MA 160,192,44
TR 168,8,128
TR 170,8,3200
WL 10
MA 176,196,44
TR 172,9,192
TR 174,9,3264
WL 10
MA 192,200,44
TR 176,8,256
TR 178,8,3328
s_add_u32 m0, s90, 76800
s_nop 0
DM 13,72,46
WL 10
MA 208,204,44
TR 180,9,320
TR 182,9,3392
WL 10
MA 128,160,48
TR 184,8,6144
TR 186,8,9216
WL 10
MA 144,164,48
TR 188,9,6208
TR 190,9,9280
s_add_u32 m0, s90, 77824
s_nop 0
DM 14,72,46
WL 10
MA 160,168,48
TR 192,8,6272
TR 194,8,9344
WL 10
MA 176,172,48
TR 196,9,6336
TR 198,9,9408
WL 10
MA 192,176,48
TR 200,8,6400
TR 202,8,9472
s_add_u32 m0, s90, 78848
s_nop 0
DM 15,72,46
s_add_u32 s46, s46, 196608
WL 10
MA 208,180,48
TR 204,9,6464
TR 206,9,9536
WL 10
MA 128,184,52
TR 160,8,12288
TR 162,8,15360
WL 10
MA 144,188,52
TR 164,9,12352
TR 166,9,15424
WL 10
MA 160,192,52
TR 168,8,12416
TR 170,8,15488
WL 10
MA 176,196,52
TR 172,9,12480
TR 174,9,15552
WL 10
MA 192,200,52
TR 176,8,12544
TR 178,8,15616
WL 10
MA 208,204,52
TR 180,9,12608
TR 182,9,15680
WV 6
s_barrier
v_add_u32 v6, 49152, v2
v_add_u32 v7, 49152, v3
WL 10
MA 128,160,56
TR 184,8,18432
TR 186,8,21504
WL 10
MA 144,164,56
TR 188,9,18496
TR 190,9,21568
s_add_u32 m0, s90, 0
s_nop 0
DM 10,72,46
WL 10
MA 160,168,56
TR 192,8,18560
TR 194,8,21632
WL 10
MA 176,172,56
TR 196,9,18624
TR 198,9,21696
WL 10
MA 192,176,56
TR 200,8,18688
TR 202,8,21760
s_add_u32 m0, s90, 1024
s_nop 0
DM 11,72,46
WL 10
MA 208,180,56
TR 204,9,18752
TR 206,9,21824
WL 10
MA 128,184,60
TR 160,6,0
TR 162,6,3072
WL 10
MA 144,188,60
TR 164,7,64
TR 166,7,3136
s_add_u32 m0, s90, 2048
s_nop 0
DM 12,72,46
WL 10
MA 160,192,60
TR 168,6,128
TR 170,6,3200
WL 10
MA 176,196,60
TR 172,7,192
TR 174,7,3264
WL 10
MA 192,200,60
TR 176,6,256
TR 178,6,3328
s_add_u32 m0, s90, 3072
s_nop 0
DM 13,72,46
WL 10
MA 208,204,60
TR 180,7,320
TR 182,7,3392
WL 10
MA 128,160,64
TR 184,6,6144
TR 186,6,9216
WL 10
MA 144,164,64
TR 188,7,6208
TR 190,7,9280
s_add_u32 m0, s90, 4096
s_nop 0
DM 14,72,46
WL 10
MA 160,168,64
TR 192,6,6272
TR 194,6,9344
WL 10
MA 176,172,64
TR 196,7,6336
TR 198,7,9408
WL 10
MA 192,176,64
TR 200,6,6400
TR 202,6,9472
s_add_u32 m0, s90, 5120
s_nop 0
DM 15,72,46
s_add_u32 s46, s46, 196608
WL 10
MA 208,180,64
TR 204,7,6464
TR 206,7,9536
WL 10
MA 128,184,68
TR 160,6,12288
TR 162,6,15360
WL 10
MA 144,188,68
TR 164,7,12352
TR 166,7,15424
WL 10
MA 160,192,68
TR 168,6,12416
TR 170,6,15488
WL 10
MA 176,196,68
TR 172,7,12480
TR 174,7,15552
WL 10
MA 192,200,68
TR 176,6,12544
TR 178,6,15616
WL 10
MA 208,204,68
TR 180,7,12608
TR 182,7,15680
WV 6
s_barrier
v_add_u32 v8, 73728, v2
v_add_u32 v9, 73728, v3
WL 10
MA 128,160,72
TR 184,6,18432
TR 186,6,21504
WL 10
MA 144,164,72
TR 188,7,18496
TR 190,7,21568
s_add_u32 m0, s90, 24576
s_nop 0
DM 10,72,46
WL 10
MA 160,168,72
TR 192,6,18560
TR 194,6,21632
WL 10
MA 176,172,72
TR 196,7,18624
TR 198,7,21696
WL 10
MA 192,176,72
TR 200,6,18688
TR 202,6,21760
s_add_u32 m0, s90, 25600
s_nop 0
DM 11,72,46
WL 10
MA 208,180,72
TR 204,7,18752
TR 206,7,21824
WL 10
MA 128,184,76
TR 160,8,0
TR 162,8,3072
WL 10
MA 144,188,76
TR 164,9,64
TR 166,9,3136
s_add_u32 m0, s90, 26624
s_nop 0
DM 12,72,46
WL 10
MA 160,192,76
TR 168,8,128
TR 170,8,3200
WL 10
MA 176,196,76
TR 172,9,192
TR 174,9,3264
WL 10
MA 192,200,76
TR 176,8,256
TR 178,8,3328
s_add_u32 m0, s90, 27648
s_nop 0
DM 13,72,46
WL 10
MA 208,204,76
TR 180,9,320
TR 182,9,3392
WL 10
MA 128,160,80
TR 184,8,6144
TR 186,8,9216
WL 10
MA 144,164,80
TR 188,9,6208
TR 190,9,9280
s_add_u32 m0, s90, 28672
s_nop 0
DM 14,72,46
WL 10
MA 160,168,80
TR 192,8,6272
TR 194,8,9344
WL 10
MA 176,172,80
TR 196,9,6336
TR 198,9,9408
WL 10
MA 192,176,80
TR 200,8,6400
TR 202,8,9472
s_add_u32 m0, s90, 29696
s_nop 0
DM 15,72,46
s_add_u32 s46, s46, 196608
WL 10
MA 208,180,80
TR 204,9,6464
TR 206,9,9536
WL 10
MA 128,184,84
TR 160,8,12288
TR 162,8,15360
WL 10
MA 144,188,84
TR 164,9,12352
TR 166,9,15424
WL 10
MA 160,192,84
TR 168,8,12416
TR 170,8,15488
WL 10
MA 176,196,84
TR 172,9,12480
TR 174,9,15552
WL 10
MA 192,200,84
TR 176,8,12544
TR 178,8,15616
WL 10
MA 208,204,84
TR 180,9,12608
TR 182,9,15680
WV 6
s_barrier
v_add_u32 v6, 0, v2
v_add_u32 v7, 0, v3
WL 10
MA 128,160,88
TR 184,8,18432
TR 186,8,21504
WL 10
MA 144,164,88
TR 188,9,18496
TR 190,9,21568
s_add_u32 m0, s90, 49152
s_nop 0
DM 10,72,46
WL 10
MA 160,168,88
TR 192,8,18560
TR 194,8,21632
WL 10
MA 176,172,88
TR 196,9,18624
TR 198,9,21696
WL 10
MA 192,176,88
TR 200,8,18688
TR 202,8,21760
s_add_u32 m0, s90, 50176
s_nop 0
DM 11,72,46
WL 10
MA 208,180,88
TR 204,9,18752
TR 206,9,21824
WL 10
MA 128,184,92
TR 160,6,0
TR 162,6,3072
WL 10
MA 144,188,92
TR 164,7,64
TR 166,7,3136
s_add_u32 m0, s90, 51200
s_nop 0
DM 12,72,46
WL 10
MA 160,192,92
TR 168,6,128
TR 170,6,3200
WL 10
MA 176,196,92
TR 172,7,192
TR 174,7,3264
WL 10
MA 192,200,92
TR 176,6,256
TR 178,6,3328
s_add_u32 m0, s90, 52224
s_nop 0
DM 13,72,46
WL 10
MA 208,204,92
TR 180,7,320
TR 182,7,3392
WL 10
MA 128,160,96
TR 184,6,6144
TR 186,6,9216
WL 10
MA 144,164,96
TR 188,7,6208
TR 190,7,9280
s_add_u32 m0, s90, 53248
s_nop 0
DM 14,72,46
WL 10
MA 160,168,96
TR 192,6,6272
TR 194,6,9344
WL 10
MA 176,172,96
TR 196,7,6336
TR 198,7,9408
WL 10
MA 192,176,96
TR 200,6,6400
TR 202,6,9472
s_add_u32 m0, s90, 54272
s_nop 0
DM 15,72,46
s_add_u32 s46, s46, 196608
WL 10
MA 208,180,96
TR 204,7,6464
TR 206,7,9536
WL 10
MA 128,184,100
TR 160,6,12288
TR 162,6,15360
WL 10
MA 144,188,100
TR 164,7,12352
TR 166,7,15424
WL 10
MA 160,192,100
TR 168,6,12416
TR 170,6,15488
WL 10
MA 176,196,100
TR 172,7,12480
TR 174,7,15552
WL 10
MA 192,200,100
TR 176,6,12544
TR 178,6,15616
WL 10
MA 208,204,100
TR 180,7,12608
TR 182,7,15680
WV 6
s_barrier
v_add_u32 v8, 24576, v2
v_add_u32 v9, 24576, v3
WL 10
MA 128,160,104
TR 184,6,18432
TR 186,6,21504
WL 10
MA 144,164,104
TR 188,7,18496
TR 190,7,21568
s_add_u32 m0, s90, 73728
s_nop 0
DM 10,72,46
WL 10
MA 160,168,104
TR 192,6,18560
TR 194,6,21632
WL 10
MA 176,172,104
TR 196,7,18624
TR 198,7,21696
WL 10
MA 192,176,104
TR 200,6,18688
TR 202,6,21760
s_add_u32 m0, s90, 74752
s_nop 0
DM 11,72,46
WL 10
MA 208,180,104
TR 204,7,18752
TR 206,7,21824
WL 10
MA 128,184,108
TR 160,8,0
TR 162,8,3072
WL 10
MA 144,188,108
TR 164,9,64
TR 166,9,3136
s_add_u32 m0, s90, 75776
s_nop 0
DM 12,72,46
WL 10
MA 160,192,108
TR 168,8,128
TR 170,8,3200
WL 10
MA 176,196,108
TR 172,9,192
TR 174,9,3264
WL 10
MA 192,200,108
TR 176,8,256
TR 178,8,3328
s_add_u32 m0, s90, 76800
s_nop 0
DM 13,72,46
WL 10
MA 208,204,108
TR 180,9,320
TR 182,9,3392
WL 10
MA 128,160,112
TR 184,8,6144
TR 186,8,9216
WL 10
MA 144,164,112
TR 188,9,6208
TR 190,9,9280
s_add_u32 m0, s90, 77824
s_nop 0
DM 14,72,46
WL 10
MA 160,168,112
TR 192,8,6272
TR 194,8,9344
WL 10
MA 176,172,112
TR 196,9,6336
TR 198,9,9408
WL 10
MA 192,176,112
TR 200,8,6400
TR 202,8,9472
s_add_u32 m0, s90, 78848
s_nop 0
DM 15,72,46
s_add_u32 s46, s46, 196608
WL 10
MA 208,180,112
TR 204,9,6464
TR 206,9,9536
WL 10
MA 128,184,116
TR 160,8,12288
TR 162,8,15360
WL 10
MA 144,188,116
TR 164,9,12352
TR 166,9,15424
WL 10
MA 160,192,116
TR 168,8,12416
TR 170,8,15488
WL 10
MA 176,196,116
TR 172,9,12480
TR 174,9,15552
WL 10
MA 192,200,116
TR 176,8,12544
TR 178,8,15616
WL 10
MA 208,204,116
TR 180,9,12608
TR 182,9,15680
WV 6
s_barrier
v_add_u32 v6, 49152, v2
v_add_u32 v7, 49152, v3
WL 10
MA 128,160,120
TR 184,8,18432
TR 186,8,21504
WL 10
MA 144,164,120
TR 188,9,18496
TR 190,9,21568
WL 10
MA 160,168,120
TR 192,8,18560
TR 194,8,21632
WL 10
MA 176,172,120
TR 196,9,18624
TR 198,9,21696
WL 10
MA 192,176,120
TR 200,8,18688
TR 202,8,21760
WL 10
MA 208,180,120
TR 204,9,18752
TR 206,9,21824
WL 10
MA 128,184,124
TR 160,6,0
TR 162,6,3072
WL 10
MA 144,188,124
TR 164,7,64
TR 166,7,3136
WL 10
MA 160,192,124
TR 168,6,128
TR 170,6,3200
WL 10
MA 176,196,124
TR 172,7,192
TR 174,7,3264
WL 10
MA 192,200,124
TR 176,6,256
TR 178,6,3328
WL 10
MA 208,204,124
TR 180,7,320
TR 182,7,3392
WL 10
MA 128,160,128
TR 184,6,6144
TR 186,6,9216
WL 10
MA 144,164,128
TR 188,7,6208
TR 190,7,9280
WL 10
MA 160,168,128
TR 192,6,6272
TR 194,6,9344
WL 10
MA 176,172,128
TR 196,7,6336
TR 198,7,9408
WL 10
MA 192,176,128
TR 200,6,6400
TR 202,6,9472
WL 10
MA 208,180,128
TR 204,7,6464
TR 206,7,9536
WL 10
MA 128,184,132
TR 160,6,12288
TR 162,6,15360
WL 10
MA 144,188,132
TR 164,7,12352
TR 166,7,15424
WL 10
MA 160,192,132
TR 168,6,12416
TR 170,6,15488
WL 10
MA 176,196,132
TR 172,7,12480
TR 174,7,15552
WL 10
MA 192,200,132
TR 176,6,12544
TR 178,6,15616
WL 10
MA 208,204,132
TR 180,7,12608
TR 182,7,15680
WV 0
s_barrier
v_add_u32 v8, 73728, v2
v_add_u32 v9, 73728, v3
WL 10
MA 128,160,136
TR 184,6,18432
TR 186,6,21504
WL 10
MA 144,164,136
TR 188,7,18496
TR 190,7,21568
WL 10
MA 160,168,136
TR 192,6,18560
TR 194,6,21632
WL 10
MA 176,172,136
TR 196,7,18624
TR 198,7,21696
WL 10
MA 192,176,136
TR 200,6,18688
TR 202,6,21760
WL 10
MA 208,180,136
TR 204,7,18752
TR 206,7,21824
WL 10
MA 128,184,140
TR 160,8,0
TR 162,8,3072
WL 10
MA 144,188,140
TR 164,9,64
TR 166,9,3136
WL 10
MA 160,192,140
TR 168,8,128
TR 170,8,3200
WL 10
MA 176,196,140
TR 172,9,192
TR 174,9,3264
WL 10
MA 192,200,140
TR 176,8,256
TR 178,8,3328
WL 10
MA 208,204,140
TR 180,9,320
TR 182,9,3392
WL 10
MA 128,160,144
TR 184,8,6144
TR 186,8,9216
WL 10
MA 144,164,144
TR 188,9,6208
TR 190,9,9280
WL 10
MA 160,168,144
TR 192,8,6272
TR 194,8,9344
WL 10
MA 176,172,144
TR 196,9,6336
TR 198,9,9408
WL 10
MA 192,176,144
TR 200,8,6400
TR 202,8,9472
WL 10
MA 208,180,144
TR 204,9,6464
TR 206,9,9536
WL 10
MA 128,184,148
TR 160,8,12288
TR 162,8,15360
WL 10
MA 144,188,148
TR 164,9,12352
TR 166,9,15424
WL 10
MA 160,192,148
TR 168,8,12416
TR 170,8,15488
WL 10
MA 176,196,148
TR 172,9,12480
TR 174,9,15552
WL 10
MA 192,200,148
TR 176,8,12544
TR 178,8,15616
WL 10
MA 208,204,148
TR 180,9,12608
TR 182,9,15680
WL 10
MA 128,160,152
TR 184,8,18432
TR 186,8,21504
WL 10
MA 144,164,152
TR 188,9,18496
TR 190,9,21568
WL 10
MA 160,168,152
TR 192,8,18560
TR 194,8,21632
WL 10
MA 176,172,152
TR 196,9,18624
TR 198,9,21696
WL 10
MA 192,176,152
TR 200,8,18688
TR 202,8,21760
WL 10
MA 208,180,152
TR 204,9,18752
TR 206,9,21824
WL 10
MA 128,184,156
WL 8
MA 144,188,156
WL 6
MA 160,192,156
WL 4
MA 176,196,156
WL 2
MA 192,200,156
WL 0
MA 208,204,156
s_cmp_eq_u32 s16, 0
s_cbranch_scc0 W_f_105
s_lshl_b32 s23, s58, 2
s_add_u32 s23, s23, 128
s_mov_b64 exec, 1
v_mov_b32 v5, 1
v_mov_b32 v22, s23
buffer_atomic_add v5, v22, s[12:15], 0 offen sc0
s_mov_b64 exec, -1
W_f_105:
s_nop 7
s_nop 7
s_mul_i32 s45, s43, 98304
s_mul_i32 s23, s41, 12288
s_add_u32 s45, s45, s23
s_add_u32 s45, s45, 19922944
CV 22,32,33
SH 32,22
HH 33,22
CV 22,128,129
SH 128,22
HH 129,22
v_mul_f32 v32, v32, v128
v_mul_f32 v33, v33, v129
CV 24,32,33
CV 22,34,35
SH 34,22
HH 35,22
CV 22,130,131
SH 130,22
HH 131,22
v_mul_f32 v34, v34, v130
v_mul_f32 v35, v35, v131
CV 25,34,35
CV 22,36,37
SH 36,22
HH 37,22
CV 22,132,133
SH 132,22
HH 133,22
v_mul_f32 v36, v36, v132
v_mul_f32 v37, v37, v133
CV 26,36,37
CV 22,38,39
SH 38,22
HH 39,22
CV 22,134,135
SH 134,22
HH 135,22
v_mul_f32 v38, v38, v134
v_mul_f32 v39, v39, v135
CV 27,38,39
buffer_store_dwordx4 v[24:27], v1, s[8:11], s45 offen offset:0 sc1
CV 22,40,41
SH 40,22
HH 41,22
CV 22,136,137
SH 136,22
HH 137,22
v_mul_f32 v40, v40, v136
v_mul_f32 v41, v41, v137
CV 28,40,41
CV 22,42,43
SH 42,22
HH 43,22
CV 22,138,139
SH 138,22
HH 139,22
v_mul_f32 v42, v42, v138
v_mul_f32 v43, v43, v139
CV 29,42,43
CV 22,44,45
SH 44,22
HH 45,22
CV 22,140,141
SH 140,22
HH 141,22
v_mul_f32 v44, v44, v140
v_mul_f32 v45, v45, v141
CV 30,44,45
CV 22,46,47
SH 46,22
HH 47,22
CV 22,142,143
SH 142,22
HH 143,22
v_mul_f32 v46, v46, v142
v_mul_f32 v47, v47, v143
CV 31,46,47
buffer_store_dwordx4 v[28:31], v1, s[8:11], s45 offen offset:1024 sc1
CV 22,48,49
SH 48,22
HH 49,22
CV 22,144,145
SH 144,22
HH 145,22
v_mul_f32 v48, v48, v144
v_mul_f32 v49, v49, v145
CV 24,48,49
CV 22,50,51
SH 50,22
HH 51,22
CV 22,146,147
SH 146,22
HH 147,22
v_mul_f32 v50, v50, v146
v_mul_f32 v51, v51, v147
CV 25,50,51
CV 22,52,53
SH 52,22
HH 53,22
CV 22,148,149
SH 148,22
HH 149,22
v_mul_f32 v52, v52, v148
v_mul_f32 v53, v53, v149
CV 26,52,53
CV 22,54,55
SH 54,22
HH 55,22
CV 22,150,151
SH 150,22
HH 151,22
v_mul_f32 v54, v54, v150
v_mul_f32 v55, v55, v151
CV 27,54,55
buffer_store_dwordx4 v[24:27], v1, s[8:11], s45 offen offset:2048 sc1
CV 22,56,57
SH 56,22
HH 57,22
CV 22,152,153
SH 152,22
HH 153,22
v_mul_f32 v56, v56, v152
v_mul_f32 v57, v57, v153
CV 28,56,57
CV 22,58,59
SH 58,22
HH 59,22
CV 22,154,155
SH 154,22
HH 155,22
v_mul_f32 v58, v58, v154
v_mul_f32 v59, v59, v155
CV 29,58,59
CV 22,60,61
SH 60,22
HH 61,22
CV 22,156,157
SH 156,22
HH 157,22
v_mul_f32 v60, v60, v156
v_mul_f32 v61, v61, v157
CV 30,60,61
CV 22,62,63
SH 62,22
HH 63,22
CV 22,158,159
SH 158,22
HH 159,22
v_mul_f32 v62, v62, v158
v_mul_f32 v63, v63, v159
CV 31,62,63
buffer_store_dwordx4 v[28:31], v1, s[8:11], s45 offen offset:3072 sc1
CV 22,64,65
SH 64,22
HH 65,22
CV 22,160,161
SH 160,22
HH 161,22
v_mul_f32 v64, v64, v160
v_mul_f32 v65, v65, v161
CV 24,64,65
CV 22,66,67
SH 66,22
HH 67,22
CV 22,162,163
SH 162,22
HH 163,22
v_mul_f32 v66, v66, v162
v_mul_f32 v67, v67, v163
CV 25,66,67
CV 22,68,69
SH 68,22
HH 69,22
CV 22,164,165
SH 164,22
HH 165,22
v_mul_f32 v68, v68, v164
v_mul_f32 v69, v69, v165
CV 26,68,69
CV 22,70,71
SH 70,22
HH 71,22
CV 22,166,167
SH 166,22
HH 167,22
v_mul_f32 v70, v70, v166
v_mul_f32 v71, v71, v167
CV 27,70,71
s_add_u32 s45, s45, 4096
buffer_store_dwordx4 v[24:27], v1, s[8:11], s45 offen offset:0 sc1
CV 22,72,73
SH 72,22
HH 73,22
CV 22,168,169
SH 168,22
HH 169,22
v_mul_f32 v72, v72, v168
v_mul_f32 v73, v73, v169
CV 28,72,73
CV 22,74,75
SH 74,22
HH 75,22
CV 22,170,171
SH 170,22
HH 171,22
v_mul_f32 v74, v74, v170
v_mul_f32 v75, v75, v171
CV 29,74,75
CV 22,76,77
SH 76,22
HH 77,22
CV 22,172,173
SH 172,22
HH 173,22
v_mul_f32 v76, v76, v172
v_mul_f32 v77, v77, v173
CV 30,76,77
CV 22,78,79
SH 78,22
HH 79,22
CV 22,174,175
SH 174,22
HH 175,22
v_mul_f32 v78, v78, v174
v_mul_f32 v79, v79, v175
CV 31,78,79
buffer_store_dwordx4 v[28:31], v1, s[8:11], s45 offen offset:1024 sc1
CV 22,80,81
SH 80,22
HH 81,22
CV 22,176,177
SH 176,22
HH 177,22
v_mul_f32 v80, v80, v176
v_mul_f32 v81, v81, v177
CV 24,80,81
CV 22,82,83
SH 82,22
HH 83,22
CV 22,178,179
SH 178,22
HH 179,22
v_mul_f32 v82, v82, v178
v_mul_f32 v83, v83, v179
CV 25,82,83
CV 22,84,85
SH 84,22
HH 85,22
CV 22,180,181
SH 180,22
HH 181,22
v_mul_f32 v84, v84, v180
v_mul_f32 v85, v85, v181
CV 26,84,85
CV 22,86,87
SH 86,22
HH 87,22
CV 22,182,183
SH 182,22
HH 183,22
v_mul_f32 v86, v86, v182
v_mul_f32 v87, v87, v183
CV 27,86,87
buffer_store_dwordx4 v[24:27], v1, s[8:11], s45 offen offset:2048 sc1
CV 22,88,89
SH 88,22
HH 89,22
CV 22,184,185
SH 184,22
HH 185,22
v_mul_f32 v88, v88, v184
v_mul_f32 v89, v89, v185
CV 28,88,89
CV 22,90,91
SH 90,22
HH 91,22
CV 22,186,187
SH 186,22
HH 187,22
v_mul_f32 v90, v90, v186
v_mul_f32 v91, v91, v187
CV 29,90,91
CV 22,92,93
SH 92,22
HH 93,22
CV 22,188,189
SH 188,22
HH 189,22
v_mul_f32 v92, v92, v188
v_mul_f32 v93, v93, v189
CV 30,92,93
CV 22,94,95
SH 94,22
HH 95,22
CV 22,190,191
SH 190,22
HH 191,22
v_mul_f32 v94, v94, v190
v_mul_f32 v95, v95, v191
CV 31,94,95
buffer_store_dwordx4 v[28:31], v1, s[8:11], s45 offen offset:3072 sc1
CV 22,96,97
SH 96,22
HH 97,22
CV 22,192,193
SH 192,22
HH 193,22
v_mul_f32 v96, v96, v192
v_mul_f32 v97, v97, v193
CV 24,96,97
CV 22,98,99
SH 98,22
HH 99,22
CV 22,194,195
SH 194,22
HH 195,22
v_mul_f32 v98, v98, v194
v_mul_f32 v99, v99, v195
CV 25,98,99
CV 22,100,101
SH 100,22
HH 101,22
CV 22,196,197
SH 196,22
HH 197,22
v_mul_f32 v100, v100, v196
v_mul_f32 v101, v101, v197
CV 26,100,101
CV 22,102,103
SH 102,22
HH 103,22
CV 22,198,199
SH 198,22
HH 199,22
v_mul_f32 v102, v102, v198
v_mul_f32 v103, v103, v199
CV 27,102,103
s_add_u32 s45, s45, 4096
buffer_store_dwordx4 v[24:27], v1, s[8:11], s45 offen offset:0 sc1
CV 22,104,105
SH 104,22
HH 105,22
CV 22,200,201
SH 200,22
HH 201,22
v_mul_f32 v104, v104, v200
v_mul_f32 v105, v105, v201
CV 28,104,105
CV 22,106,107
SH 106,22
HH 107,22
CV 22,202,203
SH 202,22
HH 203,22
v_mul_f32 v106, v106, v202
v_mul_f32 v107, v107, v203
CV 29,106,107
CV 22,108,109
SH 108,22
HH 109,22
CV 22,204,205
SH 204,22
HH 205,22
v_mul_f32 v108, v108, v204
v_mul_f32 v109, v109, v205
CV 30,108,109
CV 22,110,111
SH 110,22
HH 111,22
CV 22,206,207
SH 206,22
HH 207,22
v_mul_f32 v110, v110, v206
v_mul_f32 v111, v111, v207
CV 31,110,111
buffer_store_dwordx4 v[28:31], v1, s[8:11], s45 offen offset:1024 sc1
CV 22,112,113
SH 112,22
HH 113,22
CV 22,208,209
SH 208,22
HH 209,22
v_mul_f32 v112, v112, v208
v_mul_f32 v113, v113, v209
CV 24,112,113
CV 22,114,115
SH 114,22
HH 115,22
CV 22,210,211
SH 210,22
HH 211,22
v_mul_f32 v114, v114, v210
v_mul_f32 v115, v115, v211
CV 25,114,115
CV 22,116,117
SH 116,22
HH 117,22
CV 22,212,213
SH 212,22
HH 213,22
v_mul_f32 v116, v116, v212
v_mul_f32 v117, v117, v213
CV 26,116,117
CV 22,118,119
SH 118,22
HH 119,22
CV 22,214,215
SH 214,22
HH 215,22
v_mul_f32 v118, v118, v214
v_mul_f32 v119, v119, v215
CV 27,118,119
buffer_store_dwordx4 v[24:27], v1, s[8:11], s45 offen offset:2048 sc1
CV 22,120,121
SH 120,22
HH 121,22
CV 22,216,217
SH 216,22
HH 217,22
v_mul_f32 v120, v120, v216
v_mul_f32 v121, v121, v217
CV 28,120,121
CV 22,122,123
SH 122,22
HH 123,22
CV 22,218,219
SH 218,22
HH 219,22
v_mul_f32 v122, v122, v218
v_mul_f32 v123, v123, v219
CV 29,122,123
CV 22,124,125
SH 124,22
HH 125,22
CV 22,220,221
SH 220,22
HH 221,22
v_mul_f32 v124, v124, v220
v_mul_f32 v125, v125, v221
CV 30,124,125
CV 22,126,127
SH 126,22
HH 127,22
CV 22,222,223
SH 222,22
HH 223,22
v_mul_f32 v126, v126, v222
v_mul_f32 v127, v127, v223
CV 31,126,127
buffer_store_dwordx4 v[28:31], v1, s[8:11], s45 offen offset:3072 sc1
WV 0
s_lshl_b32 s48, s40, 7
s_add_u32 s48, s48, 221184
s_branch P_end
P_f2:
s_lshl_b32 s48, s40, 7
s_add_u32 s48, s48, 221184
s_cmp_eq_u32 s16, 0
s_cbranch_scc0 dep_107
s_mov_b32 s22, 0
v_mov_b32 v22, 0
dep_106:
buffer_load_dword v23, v22, s[8:11], s48 offen sc1
s_add_u32 s22, s22, 1
s_cmp_gt_u32 s22, 524288
s_cbranch_scc1 dep_107
WV 0
v_readfirstlane_b32 s23, v23
s_nop 3
s_cmp_ge_u32 s23, 8
s_cbranch_scc1 dep_107
s_sleep 12
s_branch dep_106
dep_107:
s_barrier
s_mul_i32 s90, s16, 6144
s_mul_i32 s91, s16, 5120
v_and_b32 v22, 63, v0
v_lshlrev_b32 v1, 4, v22
v_lshrrev_b32 v23, 5, v22
v_lshlrev_b32 v23, 2, v23
v_and_b32 v24, 15, v22
v_lshrrev_b32 v25, 2, v24
v_add_u32 v23, v23, v25
v_lshrrev_b32 v25, 4, v22
v_and_b32 v25, 1, v25
v_lshlrev_b32 v25, 5, v25
v_and_b32 v26, 3, v24
v_lshlrev_b32 v26, 3, v26
v_add_u32 v25, v25, v26
v_mul_u32_u24 v26, 384, v23
v_add_u32 v26, v26, v25
v_lshrrev_b32 v27, 1, v23
v_and_b32 v27, 1, v27
v_lshlrev_b32 v27, 6, v27
v_add_u32 v2, v26, v27
v_sub_u32 v3, v26, v27
v_mul_u32_u24 v26, 320, v23
v_add_u32 v4, v26, v25
v_and_b32 v22, 63, v0
s_mul_i32 s23, s16, 320
s_add_u32 s23, s23, 0
v_add_u32 v23, s23, v22
v_mul_u32_u24 v24, 3277, v23
v_lshrrev_b32 v24, 16, v24
v_mul_u32_u24 v25, 20, v24
v_sub_u32 v25, v23, v25
v_lshlrev_b32 v25, 4, v25
v_mul_u32_u24 v24, 1280, v24
v_add_u32 v16, v24, v25
s_mul_i32 s23, s16, 320
s_add_u32 s23, s23, 64
v_add_u32 v23, s23, v22
v_mul_u32_u24 v24, 3277, v23
v_lshrrev_b32 v24, 16, v24
v_mul_u32_u24 v25, 20, v24
v_sub_u32 v25, v23, v25
v_lshlrev_b32 v25, 4, v25
v_mul_u32_u24 v24, 1280, v24
v_add_u32 v17, v24, v25
s_mul_i32 s23, s16, 320
s_add_u32 s23, s23, 128
v_add_u32 v23, s23, v22
v_mul_u32_u24 v24, 3277, v23
v_lshrrev_b32 v24, 16, v24
v_mul_u32_u24 v25, 20, v24
v_sub_u32 v25, v23, v25
v_lshlrev_b32 v25, 4, v25
v_mul_u32_u24 v24, 1280, v24
v_add_u32 v18, v24, v25
s_mul_i32 s23, s16, 320
s_add_u32 s23, s23, 192
v_add_u32 v23, s23, v22
v_mul_u32_u24 v24, 3277, v23
v_lshrrev_b32 v24, 16, v24
v_mul_u32_u24 v25, 20, v24
v_sub_u32 v25, v23, v25
v_lshlrev_b32 v25, 4, v25
v_mul_u32_u24 v24, 1280, v24
v_add_u32 v19, v24, v25
s_mul_i32 s23, s16, 320
s_add_u32 s23, s23, 256
v_add_u32 v23, s23, v22
v_mul_u32_u24 v24, 3277, v23
v_lshrrev_b32 v24, 16, v24
v_mul_u32_u24 v25, 20, v24
v_sub_u32 v25, v23, v25
v_lshlrev_b32 v25, 4, v25
v_mul_u32_u24 v24, 1280, v24
v_add_u32 v20, v24, v25
s_mul_i32 s46, s41, 320
s_lshl_b32 s43, s40, 2
s_add_u32 s43, s43, s16
s_mul_i32 s44, s43, 98304
s_add_u32 s44, s44, 19922944
s_mul_i32 s23, s16, 5120
s_add_u32 m0, s23, 0
s_nop 0
DM 16,76,46
s_add_u32 m0, s23, 1024
s_nop 0
DM 17,76,46
s_add_u32 m0, s23, 2048
s_nop 0
DM 18,76,46
s_add_u32 m0, s23, 3072
s_nop 0
DM 19,76,46
s_add_u32 m0, s23, 4096
s_nop 0
DM 20,76,46
s_add_u32 s46, s46, 81920
s_mul_i32 s23, s16, 5120
s_add_u32 m0, s23, 24576
s_nop 0
DM 16,76,46
s_add_u32 m0, s23, 25600
s_nop 0
DM 17,76,46
s_add_u32 m0, s23, 26624
s_nop 0
DM 18,76,46
s_add_u32 m0, s23, 27648
s_nop 0
DM 19,76,46
s_add_u32 m0, s23, 28672
s_nop 0
DM 20,76,46
s_add_u32 s46, s46, 81920
s_mul_i32 s23, s16, 5120
s_add_u32 m0, s23, 49152
s_nop 0
DM 16,76,46
s_add_u32 m0, s23, 50176
s_nop 0
DM 17,76,46
s_add_u32 m0, s23, 51200
s_nop 0
DM 18,76,46
s_add_u32 m0, s23, 52224
s_nop 0
DM 19,76,46
s_add_u32 m0, s23, 53248
s_nop 0
DM 20,76,46
s_add_u32 s46, s46, 81920
buffer_load_dwordx4 a[0:3], v1, s[8:11], s44 offen offset:0 sc1
buffer_load_dwordx4 a[4:7], v1, s[8:11], s44 offen offset:1024 sc1
buffer_load_dwordx4 a[8:11], v1, s[8:11], s44 offen offset:2048 sc1
buffer_load_dwordx4 a[12:15], v1, s[8:11], s44 offen offset:3072 sc1
s_add_u32 s44, s44, 4096
buffer_load_dwordx4 a[16:19], v1, s[8:11], s44 offen offset:0 sc1
buffer_load_dwordx4 a[20:23], v1, s[8:11], s44 offen offset:1024 sc1
buffer_load_dwordx4 a[24:27], v1, s[8:11], s44 offen offset:2048 sc1
buffer_load_dwordx4 a[28:31], v1, s[8:11], s44 offen offset:3072 sc1
s_add_u32 s44, s44, 4096
buffer_load_dwordx4 a[32:35], v1, s[8:11], s44 offen offset:0 sc1
buffer_load_dwordx4 a[36:39], v1, s[8:11], s44 offen offset:1024 sc1
buffer_load_dwordx4 a[40:43], v1, s[8:11], s44 offen offset:2048 sc1
buffer_load_dwordx4 a[44:47], v1, s[8:11], s44 offen offset:3072 sc1
s_add_u32 s44, s44, 4096
buffer_load_dwordx4 a[48:51], v1, s[8:11], s44 offen offset:0 sc1
buffer_load_dwordx4 a[52:55], v1, s[8:11], s44 offen offset:1024 sc1
buffer_load_dwordx4 a[56:59], v1, s[8:11], s44 offen offset:2048 sc1
buffer_load_dwordx4 a[60:63], v1, s[8:11], s44 offen offset:3072 sc1
s_add_u32 s44, s44, 4096
buffer_load_dwordx4 a[64:67], v1, s[8:11], s44 offen offset:0 sc1
buffer_load_dwordx4 a[68:71], v1, s[8:11], s44 offen offset:1024 sc1
buffer_load_dwordx4 a[72:75], v1, s[8:11], s44 offen offset:2048 sc1
buffer_load_dwordx4 a[76:79], v1, s[8:11], s44 offen offset:3072 sc1
s_add_u32 s44, s44, 4096
buffer_load_dwordx4 a[80:83], v1, s[8:11], s44 offen offset:0 sc1
buffer_load_dwordx4 a[84:87], v1, s[8:11], s44 offen offset:1024 sc1
buffer_load_dwordx4 a[88:91], v1, s[8:11], s44 offen offset:2048 sc1
buffer_load_dwordx4 a[92:95], v1, s[8:11], s44 offen offset:3072 sc1
s_add_u32 s44, s44, 4096
buffer_load_dwordx4 a[96:99], v1, s[8:11], s44 offen offset:0 sc1
buffer_load_dwordx4 a[100:103], v1, s[8:11], s44 offen offset:1024 sc1
buffer_load_dwordx4 a[104:107], v1, s[8:11], s44 offen offset:2048 sc1
buffer_load_dwordx4 a[108:111], v1, s[8:11], s44 offen offset:3072 sc1
s_add_u32 s44, s44, 4096
buffer_load_dwordx4 a[112:115], v1, s[8:11], s44 offen offset:0 sc1
buffer_load_dwordx4 a[116:119], v1, s[8:11], s44 offen offset:1024 sc1
buffer_load_dwordx4 a[120:123], v1, s[8:11], s44 offen offset:2048 sc1
buffer_load_dwordx4 a[124:127], v1, s[8:11], s44 offen offset:3072 sc1
WV 42
s_barrier
v_add_u32 v6, 0, v4
TR 160,6,0
TR 162,6,2560
TR 164,6,64
TR 166,6,2624
TR 168,6,128
TR 170,6,2688
TR 172,6,192
TR 174,6,2752
TR 176,6,256
TR 178,6,2816
WV 31
WL 8
v_mfma_f32_32x32x16_bf16 v[32:47], a[160:163], a[0:3], 0
TR 184,6,5120
TR 186,6,7680
WL 8
v_mfma_f32_32x32x16_bf16 v[48:63], a[164:167], a[0:3], 0
TR 188,6,5184
TR 190,6,7744
WL 8
v_mfma_f32_32x32x16_bf16 v[64:79], a[168:171], a[0:3], 0
TR 192,6,5248
TR 194,6,7808
WL 8
v_mfma_f32_32x32x16_bf16 v[80:95], a[172:175], a[0:3], 0
TR 196,6,5312
TR 198,6,7872
WL 8
v_mfma_f32_32x32x16_bf16 v[96:111], a[176:179], a[0:3], 0
TR 200,6,5376
TR 202,6,7936
s_add_u32 s44, s44, 4096
buffer_load_dwordx4 a[0:3], v1, s[8:11], s44 offen offset:0 sc1
WV 31
WL 8
MA 32,184,4
TR 160,6,10240
TR 162,6,12800
WL 8
MA 48,188,4
TR 164,6,10304
TR 166,6,12864
WL 8
MA 64,192,4
TR 168,6,10368
TR 170,6,12928
WL 8
MA 80,196,4
TR 172,6,10432
TR 174,6,12992
WL 8
MA 96,200,4
TR 176,6,10496
TR 178,6,13056
buffer_load_dwordx4 a[4:7], v1, s[8:11], s44 offen offset:1024 sc1
WV 31
s_barrier
v_add_u32 v8, 24576, v4
WL 8
MA 32,160,8
TR 184,6,15360
TR 186,6,17920
WL 8
MA 48,164,8
TR 188,6,15424
TR 190,6,17984
s_add_u32 m0, s91, 73728
s_nop 0
DM 16,76,46
WL 8
MA 64,168,8
TR 192,6,15488
TR 194,6,18048
WL 8
MA 80,172,8
TR 196,6,15552
TR 198,6,18112
WL 8
MA 96,176,8
TR 200,6,15616
TR 202,6,18176
s_add_u32 m0, s91, 74752
s_nop 0
DM 17,76,46
buffer_load_dwordx4 a[8:11], v1, s[8:11], s44 offen offset:2048 sc1
WV 33
WL 8
MA 32,184,12
TR 160,8,0
TR 162,8,2560
WL 8
MA 48,188,12
TR 164,8,64
TR 166,8,2624
s_add_u32 m0, s91, 75776
s_nop 0
DM 18,76,46
WL 8
MA 64,192,12
TR 168,8,128
TR 170,8,2688
WL 8
MA 80,196,12
TR 172,8,192
TR 174,8,2752
WL 8
MA 96,200,12
TR 176,8,256
TR 178,8,2816
s_add_u32 m0, s91, 76800
s_nop 0
DM 19,76,46
buffer_load_dwordx4 a[12:15], v1, s[8:11], s44 offen offset:3072 sc1
WV 35
WL 8
MA 32,160,16
TR 184,8,5120
TR 186,8,7680
WL 8
MA 48,164,16
TR 188,8,5184
TR 190,8,7744
s_add_u32 m0, s91, 77824
s_nop 0
DM 20,76,46
s_add_u32 s46, s46, 81920
WL 8
MA 64,168,16
TR 192,8,5248
TR 194,8,7808
WL 8
MA 80,172,16
TR 196,8,5312
TR 198,8,7872
WL 8
MA 96,176,16
TR 200,8,5376
TR 202,8,7936
s_add_u32 s44, s44, 4096
buffer_load_dwordx4 a[16:19], v1, s[8:11], s44 offen offset:0 sc1
WV 36
WL 8
MA 32,184,20
TR 160,8,10240
TR 162,8,12800
WL 8
MA 48,188,20
TR 164,8,10304
TR 166,8,12864
WL 8
MA 64,192,20
TR 168,8,10368
TR 170,8,12928
WL 8
MA 80,196,20
TR 172,8,10432
TR 174,8,12992
WL 8
MA 96,200,20
TR 176,8,10496
TR 178,8,13056
buffer_load_dwordx4 a[20:23], v1, s[8:11], s44 offen offset:1024 sc1
WV 36
s_barrier
v_add_u32 v6, 49152, v4
WL 8
MA 32,160,24
TR 184,8,15360
TR 186,8,17920
WL 8
MA 48,164,24
TR 188,8,15424
TR 190,8,17984
s_add_u32 m0, s91, 0
s_nop 0
DM 16,76,46
WL 8
MA 64,168,24
TR 192,8,15488
TR 194,8,18048
WL 8
MA 80,172,24
TR 196,8,15552
TR 198,8,18112
WL 8
MA 96,176,24
TR 200,8,15616
TR 202,8,18176
s_add_u32 m0, s91, 1024
s_nop 0
DM 17,76,46
buffer_load_dwordx4 a[24:27], v1, s[8:11], s44 offen offset:2048 sc1
WV 38
WL 8
MA 32,184,28
TR 160,6,0
TR 162,6,2560
WL 8
MA 48,188,28
TR 164,6,64
TR 166,6,2624
s_add_u32 m0, s91, 2048
s_nop 0
DM 18,76,46
WL 8
MA 64,192,28
TR 168,6,128
TR 170,6,2688
WL 8
MA 80,196,28
TR 172,6,192
TR 174,6,2752
WL 8
MA 96,200,28
TR 176,6,256
TR 178,6,2816
s_add_u32 m0, s91, 3072
s_nop 0
DM 19,76,46
buffer_load_dwordx4 a[28:31], v1, s[8:11], s44 offen offset:3072 sc1
WV 40
WL 8
MA 32,160,32
TR 184,6,5120
TR 186,6,7680
WL 8
MA 48,164,32
TR 188,6,5184
TR 190,6,7744
s_add_u32 m0, s91, 4096
s_nop 0
DM 20,76,46
s_add_u32 s46, s46, 81920
WL 8
MA 64,168,32
TR 192,6,5248
TR 194,6,7808
WL 8
MA 80,172,32
TR 196,6,5312
TR 198,6,7872
WL 8
MA 96,176,32
TR 200,6,5376
TR 202,6,7936
s_add_u32 s44, s44, 4096
buffer_load_dwordx4 a[32:35], v1, s[8:11], s44 offen offset:0 sc1
WV 41
WL 8
MA 32,184,36
TR 160,6,10240
TR 162,6,12800
WL 8
MA 48,188,36
TR 164,6,10304
TR 166,6,12864
WL 8
MA 64,192,36
TR 168,6,10368
TR 170,6,12928
WL 8
MA 80,196,36
TR 172,6,10432
TR 174,6,12992
WL 8
MA 96,200,36
TR 176,6,10496
TR 178,6,13056
buffer_load_dwordx4 a[36:39], v1, s[8:11], s44 offen offset:1024 sc1
WV 41
WV 11
s_barrier
v_add_u32 v8, 73728, v4
WL 8
MA 32,160,40
TR 184,6,15360
TR 186,6,17920
WL 8
MA 48,164,40
TR 188,6,15424
TR 190,6,17984
s_add_u32 m0, s91, 24576
s_nop 0
DM 16,76,46
WL 8
MA 64,168,40
TR 192,6,15488
TR 194,6,18048
WL 8
MA 80,172,40
TR 196,6,15552
TR 198,6,18112
WL 8
MA 96,176,40
TR 200,6,15616
TR 202,6,18176
s_add_u32 m0, s91, 25600
s_nop 0
DM 17,76,46
buffer_load_dwordx4 a[40:43], v1, s[8:11], s44 offen offset:2048 sc1
WL 8
MA 32,184,44
TR 160,8,0
TR 162,8,2560
WL 8
MA 48,188,44
TR 164,8,64
TR 166,8,2624
s_add_u32 m0, s91, 26624
s_nop 0
DM 18,76,46
WL 8
MA 64,192,44
TR 168,8,128
TR 170,8,2688
WL 8
MA 80,196,44
TR 172,8,192
TR 174,8,2752
WL 8
MA 96,200,44
TR 176,8,256
TR 178,8,2816
s_add_u32 m0, s91, 27648
s_nop 0
DM 19,76,46
buffer_load_dwordx4 a[44:47], v1, s[8:11], s44 offen offset:3072 sc1
WL 8
MA 32,160,48
TR 184,8,5120
TR 186,8,7680
WL 8
MA 48,164,48
TR 188,8,5184
TR 190,8,7744
s_add_u32 m0, s91, 28672
s_nop 0
DM 20,76,46
s_add_u32 s46, s46, 81920
WL 8
MA 64,168,48
TR 192,8,5248
TR 194,8,7808
WL 8
MA 80,172,48
TR 196,8,5312
TR 198,8,7872
WL 8
MA 96,176,48
TR 200,8,5376
TR 202,8,7936
s_add_u32 s44, s44, 4096
buffer_load_dwordx4 a[48:51], v1, s[8:11], s44 offen offset:0 sc1
WL 8
MA 32,184,52
TR 160,8,10240
TR 162,8,12800
WL 8
MA 48,188,52
TR 164,8,10304
TR 166,8,12864
WL 8
MA 64,192,52
TR 168,8,10368
TR 170,8,12928
WL 8
MA 80,196,52
TR 172,8,10432
TR 174,8,12992
WL 8
MA 96,200,52
TR 176,8,10496
TR 178,8,13056
buffer_load_dwordx4 a[52:55], v1, s[8:11], s44 offen offset:1024 sc1
WV 11
s_barrier
v_add_u32 v6, 0, v4
WL 8
MA 32,160,56
TR 184,8,15360
TR 186,8,17920
WL 8
MA 48,164,56
TR 188,8,15424
TR 190,8,17984
s_add_u32 m0, s91, 49152
s_nop 0
DM 16,76,46
WL 8
MA 64,168,56
TR 192,8,15488
TR 194,8,18048
WL 8
MA 80,172,56
TR 196,8,15552
TR 198,8,18112
WL 8
MA 96,176,56
TR 200,8,15616
TR 202,8,18176
s_add_u32 m0, s91, 50176
s_nop 0
DM 17,76,46
buffer_load_dwordx4 a[56:59], v1, s[8:11], s44 offen offset:2048 sc1
WL 8
MA 32,184,60
TR 160,6,0
TR 162,6,2560
WL 8
MA 48,188,60
TR 164,6,64
TR 166,6,2624
s_add_u32 m0, s91, 51200
s_nop 0
DM 18,76,46
WL 8
MA 64,192,60
TR 168,6,128
TR 170,6,2688
WL 8
MA 80,196,60
TR 172,6,192
TR 174,6,2752
WL 8
MA 96,200,60
TR 176,6,256
TR 178,6,2816
s_add_u32 m0, s91, 52224
s_nop 0
DM 19,76,46
buffer_load_dwordx4 a[60:63], v1, s[8:11], s44 offen offset:3072 sc1
WL 8
MA 32,160,64
TR 184,6,5120
TR 186,6,7680
WL 8
MA 48,164,64
TR 188,6,5184
TR 190,6,7744
s_add_u32 m0, s91, 53248
s_nop 0
DM 20,76,46
s_add_u32 s46, s46, 81920
WL 8
MA 64,168,64
TR 192,6,5248
TR 194,6,7808
WL 8
MA 80,172,64
TR 196,6,5312
TR 198,6,7872
WL 8
MA 96,176,64
TR 200,6,5376
TR 202,6,7936
s_add_u32 s44, s44, 4096
buffer_load_dwordx4 a[64:67], v1, s[8:11], s44 offen offset:0 sc1
WL 8
MA 32,184,68
TR 160,6,10240
TR 162,6,12800
WL 8
MA 48,188,68
TR 164,6,10304
TR 166,6,12864
WL 8
MA 64,192,68
TR 168,6,10368
TR 170,6,12928
WL 8
MA 80,196,68
TR 172,6,10432
TR 174,6,12992
WL 8
MA 96,200,68
TR 176,6,10496
TR 178,6,13056
buffer_load_dwordx4 a[68:71], v1, s[8:11], s44 offen offset:1024 sc1
WV 11
s_barrier
v_add_u32 v8, 24576, v4
WL 8
MA 32,160,72
TR 184,6,15360
TR 186,6,17920
WL 8
MA 48,164,72
TR 188,6,15424
TR 190,6,17984
s_add_u32 m0, s91, 73728
s_nop 0
DM 16,76,46
WL 8
MA 64,168,72
TR 192,6,15488
TR 194,6,18048
WL 8
MA 80,172,72
TR 196,6,15552
TR 198,6,18112
WL 8
MA 96,176,72
TR 200,6,15616
TR 202,6,18176
s_add_u32 m0, s91, 74752
s_nop 0
DM 17,76,46
buffer_load_dwordx4 a[72:75], v1, s[8:11], s44 offen offset:2048 sc1
WL 8
MA 32,184,76
TR 160,8,0
TR 162,8,2560
WL 8
MA 48,188,76
TR 164,8,64
TR 166,8,2624
s_add_u32 m0, s91, 75776
s_nop 0
DM 18,76,46
WL 8
MA 64,192,76
TR 168,8,128
TR 170,8,2688
WL 8
MA 80,196,76
TR 172,8,192
TR 174,8,2752
WL 8
MA 96,200,76
TR 176,8,256
TR 178,8,2816
s_add_u32 m0, s91, 76800
s_nop 0
DM 19,76,46
buffer_load_dwordx4 a[76:79], v1, s[8:11], s44 offen offset:3072 sc1
WL 8
MA 32,160,80
TR 184,8,5120
TR 186,8,7680
WL 8
MA 48,164,80
TR 188,8,5184
TR 190,8,7744
s_add_u32 m0, s91, 77824
s_nop 0
DM 20,76,46
s_add_u32 s46, s46, 81920
WL 8
MA 64,168,80
TR 192,8,5248
TR 194,8,7808
WL 8
MA 80,172,80
TR 196,8,5312
TR 198,8,7872
WL 8
MA 96,176,80
TR 200,8,5376
TR 202,8,7936
s_add_u32 s44, s44, 4096
buffer_load_dwordx4 a[80:83], v1, s[8:11], s44 offen offset:0 sc1
WL 8
MA 32,184,84
TR 160,8,10240
TR 162,8,12800
WL 8
MA 48,188,84
TR 164,8,10304
TR 166,8,12864
WL 8
MA 64,192,84
TR 168,8,10368
TR 170,8,12928
WL 8
MA 80,196,84
TR 172,8,10432
TR 174,8,12992
WL 8
MA 96,200,84
TR 176,8,10496
TR 178,8,13056
buffer_load_dwordx4 a[84:87], v1, s[8:11], s44 offen offset:1024 sc1
WV 11
s_barrier
v_add_u32 v6, 49152, v4
WL 8
MA 32,160,88
TR 184,8,15360
TR 186,8,17920
WL 8
MA 48,164,88
TR 188,8,15424
TR 190,8,17984
s_add_u32 m0, s91, 0
s_nop 0
DM 16,76,46
WL 8
MA 64,168,88
TR 192,8,15488
TR 194,8,18048
WL 8
MA 80,172,88
TR 196,8,15552
TR 198,8,18112
WL 8
MA 96,176,88
TR 200,8,15616
TR 202,8,18176
s_add_u32 m0, s91, 1024
s_nop 0
DM 17,76,46
buffer_load_dwordx4 a[88:91], v1, s[8:11], s44 offen offset:2048 sc1
WL 8
MA 32,184,92
TR 160,6,0
TR 162,6,2560
WL 8
MA 48,188,92
TR 164,6,64
TR 166,6,2624
s_add_u32 m0, s91, 2048
s_nop 0
DM 18,76,46
WL 8
MA 64,192,92
TR 168,6,128
TR 170,6,2688
WL 8
MA 80,196,92
TR 172,6,192
TR 174,6,2752
WL 8
MA 96,200,92
TR 176,6,256
TR 178,6,2816
s_add_u32 m0, s91, 3072
s_nop 0
DM 19,76,46
buffer_load_dwordx4 a[92:95], v1, s[8:11], s44 offen offset:3072 sc1
WL 8
MA 32,160,96
TR 184,6,5120
TR 186,6,7680
WL 8
MA 48,164,96
TR 188,6,5184
TR 190,6,7744
s_add_u32 m0, s91, 4096
s_nop 0
DM 20,76,46
s_add_u32 s46, s46, 81920
WL 8
MA 64,168,96
TR 192,6,5248
TR 194,6,7808
WL 8
MA 80,172,96
TR 196,6,5312
TR 198,6,7872
WL 8
MA 96,176,96
TR 200,6,5376
TR 202,6,7936
s_add_u32 s44, s44, 4096
buffer_load_dwordx4 a[96:99], v1, s[8:11], s44 offen offset:0 sc1
WL 8
MA 32,184,100
TR 160,6,10240
TR 162,6,12800
WL 8
MA 48,188,100
TR 164,6,10304
TR 166,6,12864
WL 8
MA 64,192,100
TR 168,6,10368
TR 170,6,12928
WL 8
MA 80,196,100
TR 172,6,10432
TR 174,6,12992
WL 8
MA 96,200,100
TR 176,6,10496
TR 178,6,13056
buffer_load_dwordx4 a[100:103], v1, s[8:11], s44 offen offset:1024 sc1
WV 11
s_barrier
v_add_u32 v8, 73728, v4
WL 8
MA 32,160,104
TR 184,6,15360
TR 186,6,17920
WL 8
MA 48,164,104
TR 188,6,15424
TR 190,6,17984
s_add_u32 m0, s91, 24576
s_nop 0
DM 16,76,46
WL 8
MA 64,168,104
TR 192,6,15488
TR 194,6,18048
WL 8
MA 80,172,104
TR 196,6,15552
TR 198,6,18112
WL 8
MA 96,176,104
TR 200,6,15616
TR 202,6,18176
s_add_u32 m0, s91, 25600
s_nop 0
DM 17,76,46
buffer_load_dwordx4 a[104:107], v1, s[8:11], s44 offen offset:2048 sc1
WL 8
MA 32,184,108
TR 160,8,0
TR 162,8,2560
WL 8
MA 48,188,108
TR 164,8,64
TR 166,8,2624
s_add_u32 m0, s91, 26624
s_nop 0
DM 18,76,46
WL 8
MA 64,192,108
TR 168,8,128
TR 170,8,2688
WL 8
MA 80,196,108
TR 172,8,192
TR 174,8,2752
WL 8
MA 96,200,108
TR 176,8,256
TR 178,8,2816
s_add_u32 m0, s91, 27648
s_nop 0
DM 19,76,46
buffer_load_dwordx4 a[108:111], v1, s[8:11], s44 offen offset:3072 sc1
WL 8
MA 32,160,112
TR 184,8,5120
TR 186,8,7680
WL 8
MA 48,164,112
TR 188,8,5184
TR 190,8,7744
s_add_u32 m0, s91, 28672
s_nop 0
DM 20,76,46
s_add_u32 s46, s46, 81920
WL 8
MA 64,168,112
TR 192,8,5248
TR 194,8,7808
WL 8
MA 80,172,112
TR 196,8,5312
TR 198,8,7872
WL 8
MA 96,176,112
TR 200,8,5376
TR 202,8,7936
s_add_u32 s44, s44, 4096
buffer_load_dwordx4 a[112:115], v1, s[8:11], s44 offen offset:0 sc1
WL 8
MA 32,184,116
TR 160,8,10240
TR 162,8,12800
WL 8
MA 48,188,116
TR 164,8,10304
TR 166,8,12864
WL 8
MA 64,192,116
TR 168,8,10368
TR 170,8,12928
WL 8
MA 80,196,116
TR 172,8,10432
TR 174,8,12992
WL 8
MA 96,200,116
TR 176,8,10496
TR 178,8,13056
buffer_load_dwordx4 a[116:119], v1, s[8:11], s44 offen offset:1024 sc1
WV 11
s_barrier
v_add_u32 v6, 0, v4
WL 8
MA 32,160,120
TR 184,8,15360
TR 186,8,17920
WL 8
MA 48,164,120
TR 188,8,15424
TR 190,8,17984
s_add_u32 m0, s91, 49152
s_nop 0
DM 16,76,46
WL 8
MA 64,168,120
TR 192,8,15488
TR 194,8,18048
WL 8
MA 80,172,120
TR 196,8,15552
TR 198,8,18112
WL 8
MA 96,176,120
TR 200,8,15616
TR 202,8,18176
s_add_u32 m0, s91, 50176
s_nop 0
DM 17,76,46
buffer_load_dwordx4 a[120:123], v1, s[8:11], s44 offen offset:2048 sc1
WL 8
MA 32,184,124
TR 160,6,0
TR 162,6,2560
WL 8
MA 48,188,124
TR 164,6,64
TR 166,6,2624
s_add_u32 m0, s91, 51200
s_nop 0
DM 18,76,46
WL 8
MA 64,192,124
TR 168,6,128
TR 170,6,2688
WL 8
MA 80,196,124
TR 172,6,192
TR 174,6,2752
WL 8
MA 96,200,124
TR 176,6,256
TR 178,6,2816
s_add_u32 m0, s91, 52224
s_nop 0
DM 19,76,46
buffer_load_dwordx4 a[124:127], v1, s[8:11], s44 offen offset:3072 sc1
WL 8
MA 32,160,0
TR 184,6,5120
TR 186,6,7680
WL 8
MA 48,164,0
TR 188,6,5184
TR 190,6,7744
s_add_u32 m0, s91, 53248
s_nop 0
DM 20,76,46
s_add_u32 s46, s46, 81920
WL 8
MA 64,168,0
TR 192,6,5248
TR 194,6,7808
WL 8
MA 80,172,0
TR 196,6,5312
TR 198,6,7872
WL 8
MA 96,176,0
TR 200,6,5376
TR 202,6,7936
s_add_u32 s44, s44, 4096
buffer_load_dwordx4 a[0:3], v1, s[8:11], s44 offen offset:0 sc1
WL 8
MA 32,184,4
TR 160,6,10240
TR 162,6,12800
WL 8
MA 48,188,4
TR 164,6,10304
TR 166,6,12864
WL 8
MA 64,192,4
TR 168,6,10368
TR 170,6,12928
WL 8
MA 80,196,4
TR 172,6,10432
TR 174,6,12992
WL 8
MA 96,200,4
TR 176,6,10496
TR 178,6,13056
buffer_load_dwordx4 a[4:7], v1, s[8:11], s44 offen offset:1024 sc1
WV 11
s_barrier
v_add_u32 v8, 24576, v4
WL 8
MA 32,160,8
TR 184,6,15360
TR 186,6,17920
WL 8
MA 48,164,8
TR 188,6,15424
TR 190,6,17984
s_add_u32 m0, s91, 73728
s_nop 0
DM 16,76,46
WL 8
MA 64,168,8
TR 192,6,15488
TR 194,6,18048
WL 8
MA 80,172,8
TR 196,6,15552
TR 198,6,18112
WL 8
MA 96,176,8
TR 200,6,15616
TR 202,6,18176
s_add_u32 m0, s91, 74752
s_nop 0
DM 17,76,46
buffer_load_dwordx4 a[8:11], v1, s[8:11], s44 offen offset:2048 sc1
WL 8
MA 32,184,12
TR 160,8,0
TR 162,8,2560
WL 8
MA 48,188,12
TR 164,8,64
TR 166,8,2624
s_add_u32 m0, s91, 75776
s_nop 0
DM 18,76,46
WL 8
MA 64,192,12
TR 168,8,128
TR 170,8,2688
WL 8
MA 80,196,12
TR 172,8,192
TR 174,8,2752
WL 8
MA 96,200,12
TR 176,8,256
TR 178,8,2816
s_add_u32 m0, s91, 76800
s_nop 0
DM 19,76,46
buffer_load_dwordx4 a[12:15], v1, s[8:11], s44 offen offset:3072 sc1
WL 8
MA 32,160,16
TR 184,8,5120
TR 186,8,7680
WL 8
MA 48,164,16
TR 188,8,5184
TR 190,8,7744
s_add_u32 m0, s91, 77824
s_nop 0
DM 20,76,46
s_add_u32 s46, s46, 81920
WL 8
MA 64,168,16
TR 192,8,5248
TR 194,8,7808
WL 8
MA 80,172,16
TR 196,8,5312
TR 198,8,7872
WL 8
MA 96,176,16
TR 200,8,5376
TR 202,8,7936
s_add_u32 s44, s44, 4096
buffer_load_dwordx4 a[16:19], v1, s[8:11], s44 offen offset:0 sc1
WL 8
MA 32,184,20
TR 160,8,10240
TR 162,8,12800
WL 8
MA 48,188,20
TR 164,8,10304
TR 166,8,12864
WL 8
MA 64,192,20
TR 168,8,10368
TR 170,8,12928
WL 8
MA 80,196,20
TR 172,8,10432
TR 174,8,12992
WL 8
MA 96,200,20
TR 176,8,10496
TR 178,8,13056
buffer_load_dwordx4 a[20:23], v1, s[8:11], s44 offen offset:1024 sc1
WV 11
s_barrier
v_add_u32 v6, 49152, v4
WL 8
MA 32,160,24
TR 184,8,15360
TR 186,8,17920
WL 8
MA 48,164,24
TR 188,8,15424
TR 190,8,17984
s_add_u32 m0, s91, 0
s_nop 0
DM 16,76,46
WL 8
MA 64,168,24
TR 192,8,15488
TR 194,8,18048
WL 8
MA 80,172,24
TR 196,8,15552
TR 198,8,18112
WL 8
MA 96,176,24
TR 200,8,15616
TR 202,8,18176
s_add_u32 m0, s91, 1024
s_nop 0
DM 17,76,46
buffer_load_dwordx4 a[24:27], v1, s[8:11], s44 offen offset:2048 sc1
WL 8
MA 32,184,28
TR 160,6,0
TR 162,6,2560
WL 8
MA 48,188,28
TR 164,6,64
TR 166,6,2624
s_add_u32 m0, s91, 2048
s_nop 0
DM 18,76,46
WL 8
MA 64,192,28
TR 168,6,128
TR 170,6,2688
WL 8
MA 80,196,28
TR 172,6,192
TR 174,6,2752
WL 8
MA 96,200,28
TR 176,6,256
TR 178,6,2816
s_add_u32 m0, s91, 3072
s_nop 0
DM 19,76,46
buffer_load_dwordx4 a[28:31], v1, s[8:11], s44 offen offset:3072 sc1
WL 8
MA 32,160,32
TR 184,6,5120
TR 186,6,7680
WL 8
MA 48,164,32
TR 188,6,5184
TR 190,6,7744
s_add_u32 m0, s91, 4096
s_nop 0
DM 20,76,46
s_add_u32 s46, s46, 81920
WL 8
MA 64,168,32
TR 192,6,5248
TR 194,6,7808
WL 8
MA 80,172,32
TR 196,6,5312
TR 198,6,7872
WL 8
MA 96,176,32
TR 200,6,5376
TR 202,6,7936
s_add_u32 s44, s44, 4096
buffer_load_dwordx4 a[32:35], v1, s[8:11], s44 offen offset:0 sc1
WL 8
MA 32,184,36
TR 160,6,10240
TR 162,6,12800
WL 8
MA 48,188,36
TR 164,6,10304
TR 166,6,12864
WL 8
MA 64,192,36
TR 168,6,10368
TR 170,6,12928
WL 8
MA 80,196,36
TR 172,6,10432
TR 174,6,12992
WL 8
MA 96,200,36
TR 176,6,10496
TR 178,6,13056
buffer_load_dwordx4 a[36:39], v1, s[8:11], s44 offen offset:1024 sc1
WV 11
s_barrier
v_add_u32 v8, 73728, v4
WL 8
MA 32,160,40
TR 184,6,15360
TR 186,6,17920
WL 8
MA 48,164,40
TR 188,6,15424
TR 190,6,17984
s_add_u32 m0, s91, 24576
s_nop 0
DM 16,76,46
WL 8
MA 64,168,40
TR 192,6,15488
TR 194,6,18048
WL 8
MA 80,172,40
TR 196,6,15552
TR 198,6,18112
WL 8
MA 96,176,40
TR 200,6,15616
TR 202,6,18176
s_add_u32 m0, s91, 25600
s_nop 0
DM 17,76,46
buffer_load_dwordx4 a[40:43], v1, s[8:11], s44 offen offset:2048 sc1
WL 8
MA 32,184,44
TR 160,8,0
TR 162,8,2560
WL 8
MA 48,188,44
TR 164,8,64
TR 166,8,2624
s_add_u32 m0, s91, 26624
s_nop 0
DM 18,76,46
WL 8
MA 64,192,44
TR 168,8,128
TR 170,8,2688
WL 8
MA 80,196,44
TR 172,8,192
TR 174,8,2752
WL 8
MA 96,200,44
TR 176,8,256
TR 178,8,2816
s_add_u32 m0, s91, 27648
s_nop 0
DM 19,76,46
buffer_load_dwordx4 a[44:47], v1, s[8:11], s44 offen offset:3072 sc1
WL 8
MA 32,160,48
TR 184,8,5120
TR 186,8,7680
WL 8
MA 48,164,48
TR 188,8,5184
TR 190,8,7744
s_add_u32 m0, s91, 28672
s_nop 0
DM 20,76,46
s_add_u32 s46, s46, 81920
WL 8
MA 64,168,48
TR 192,8,5248
TR 194,8,7808
WL 8
MA 80,172,48
TR 196,8,5312
TR 198,8,7872
WL 8
MA 96,176,48
TR 200,8,5376
TR 202,8,7936
s_add_u32 s44, s44, 4096
buffer_load_dwordx4 a[48:51], v1, s[8:11], s44 offen offset:0 sc1
WL 8
MA 32,184,52
TR 160,8,10240
TR 162,8,12800
WL 8
MA 48,188,52
TR 164,8,10304
TR 166,8,12864
WL 8
MA 64,192,52
TR 168,8,10368
TR 170,8,12928
WL 8
MA 80,196,52
TR 172,8,10432
TR 174,8,12992
WL 8
MA 96,200,52
TR 176,8,10496
TR 178,8,13056
buffer_load_dwordx4 a[52:55], v1, s[8:11], s44 offen offset:1024 sc1
WV 11
s_barrier
v_add_u32 v6, 0, v4
WL 8
MA 32,160,56
TR 184,8,15360
TR 186,8,17920
WL 8
MA 48,164,56
TR 188,8,15424
TR 190,8,17984
s_add_u32 m0, s91, 49152
s_nop 0
DM 16,76,46
WL 8
MA 64,168,56
TR 192,8,15488
TR 194,8,18048
WL 8
MA 80,172,56
TR 196,8,15552
TR 198,8,18112
WL 8
MA 96,176,56
TR 200,8,15616
TR 202,8,18176
s_add_u32 m0, s91, 50176
s_nop 0
DM 17,76,46
buffer_load_dwordx4 a[56:59], v1, s[8:11], s44 offen offset:2048 sc1
WL 8
MA 32,184,60
TR 160,6,0
TR 162,6,2560
WL 8
MA 48,188,60
TR 164,6,64
TR 166,6,2624
s_add_u32 m0, s91, 51200
s_nop 0
DM 18,76,46
WL 8
MA 64,192,60
TR 168,6,128
TR 170,6,2688
WL 8
MA 80,196,60
TR 172,6,192
TR 174,6,2752
WL 8
MA 96,200,60
TR 176,6,256
TR 178,6,2816
s_add_u32 m0, s91, 52224
s_nop 0
DM 19,76,46
buffer_load_dwordx4 a[60:63], v1, s[8:11], s44 offen offset:3072 sc1
WL 8
MA 32,160,64
TR 184,6,5120
TR 186,6,7680
WL 8
MA 48,164,64
TR 188,6,5184
TR 190,6,7744
s_add_u32 m0, s91, 53248
s_nop 0
DM 20,76,46
s_add_u32 s46, s46, 81920
WL 8
MA 64,168,64
TR 192,6,5248
TR 194,6,7808
WL 8
MA 80,172,64
TR 196,6,5312
TR 198,6,7872
WL 8
MA 96,176,64
TR 200,6,5376
TR 202,6,7936
s_add_u32 s44, s44, 4096
buffer_load_dwordx4 a[64:67], v1, s[8:11], s44 offen offset:0 sc1
WL 8
MA 32,184,68
TR 160,6,10240
TR 162,6,12800
WL 8
MA 48,188,68
TR 164,6,10304
TR 166,6,12864
WL 8
MA 64,192,68
TR 168,6,10368
TR 170,6,12928
WL 8
MA 80,196,68
TR 172,6,10432
TR 174,6,12992
WL 8
MA 96,200,68
TR 176,6,10496
TR 178,6,13056
buffer_load_dwordx4 a[68:71], v1, s[8:11], s44 offen offset:1024 sc1
WV 11
s_barrier
v_add_u32 v8, 24576, v4
WL 8
MA 32,160,72
TR 184,6,15360
TR 186,6,17920
WL 8
MA 48,164,72
TR 188,6,15424
TR 190,6,17984
s_add_u32 m0, s91, 73728
s_nop 0
DM 16,76,46
WL 8
MA 64,168,72
TR 192,6,15488
TR 194,6,18048
WL 8
MA 80,172,72
TR 196,6,15552
TR 198,6,18112
WL 8
MA 96,176,72
TR 200,6,15616
TR 202,6,18176
s_add_u32 m0, s91, 74752
s_nop 0
DM 17,76,46
buffer_load_dwordx4 a[72:75], v1, s[8:11], s44 offen offset:2048 sc1
WL 8
MA 32,184,76
TR 160,8,0
TR 162,8,2560
WL 8
MA 48,188,76
TR 164,8,64
TR 166,8,2624
s_add_u32 m0, s91, 75776
s_nop 0
DM 18,76,46
WL 8
MA 64,192,76
TR 168,8,128
TR 170,8,2688
WL 8
MA 80,196,76
TR 172,8,192
TR 174,8,2752
WL 8
MA 96,200,76
TR 176,8,256
TR 178,8,2816
s_add_u32 m0, s91, 76800
s_nop 0
DM 19,76,46
buffer_load_dwordx4 a[76:79], v1, s[8:11], s44 offen offset:3072 sc1
WL 8
MA 32,160,80
TR 184,8,5120
TR 186,8,7680
WL 8
MA 48,164,80
TR 188,8,5184
TR 190,8,7744
s_add_u32 m0, s91, 77824
s_nop 0
DM 20,76,46
s_add_u32 s46, s46, 81920
WL 8
MA 64,168,80
TR 192,8,5248
TR 194,8,7808
WL 8
MA 80,172,80
TR 196,8,5312
TR 198,8,7872
WL 8
MA 96,176,80
TR 200,8,5376
TR 202,8,7936
s_add_u32 s44, s44, 4096
buffer_load_dwordx4 a[80:83], v1, s[8:11], s44 offen offset:0 sc1
WL 8
MA 32,184,84
TR 160,8,10240
TR 162,8,12800
WL 8
MA 48,188,84
TR 164,8,10304
TR 166,8,12864
WL 8
MA 64,192,84
TR 168,8,10368
TR 170,8,12928
WL 8
MA 80,196,84
TR 172,8,10432
TR 174,8,12992
WL 8
MA 96,200,84
TR 176,8,10496
TR 178,8,13056
buffer_load_dwordx4 a[84:87], v1, s[8:11], s44 offen offset:1024 sc1
WV 11
s_barrier
v_add_u32 v6, 49152, v4
WL 8
MA 32,160,88
TR 184,8,15360
TR 186,8,17920
WL 8
MA 48,164,88
TR 188,8,15424
TR 190,8,17984
s_add_u32 m0, s91, 0
s_nop 0
DM 16,76,46
WL 8
MA 64,168,88
TR 192,8,15488
TR 194,8,18048
WL 8
MA 80,172,88
TR 196,8,15552
TR 198,8,18112
WL 8
MA 96,176,88
TR 200,8,15616
TR 202,8,18176
s_add_u32 m0, s91, 1024
s_nop 0
DM 17,76,46
buffer_load_dwordx4 a[88:91], v1, s[8:11], s44 offen offset:2048 sc1
WL 8
MA 32,184,92
TR 160,6,0
TR 162,6,2560
WL 8
MA 48,188,92
TR 164,6,64
TR 166,6,2624
s_add_u32 m0, s91, 2048
s_nop 0
DM 18,76,46
WL 8
MA 64,192,92
TR 168,6,128
TR 170,6,2688
WL 8
MA 80,196,92
TR 172,6,192
TR 174,6,2752
WL 8
MA 96,200,92
TR 176,6,256
TR 178,6,2816
s_add_u32 m0, s91, 3072
s_nop 0
DM 19,76,46
buffer_load_dwordx4 a[92:95], v1, s[8:11], s44 offen offset:3072 sc1
WL 8
MA 32,160,96
TR 184,6,5120
TR 186,6,7680
WL 8
MA 48,164,96
TR 188,6,5184
TR 190,6,7744
s_add_u32 m0, s91, 4096
s_nop 0
DM 20,76,46
s_add_u32 s46, s46, 81920
WL 8
MA 64,168,96
TR 192,6,5248
TR 194,6,7808
WL 8
MA 80,172,96
TR 196,6,5312
TR 198,6,7872
WL 8
MA 96,176,96
TR 200,6,5376
TR 202,6,7936
s_add_u32 s44, s44, 4096
buffer_load_dwordx4 a[96:99], v1, s[8:11], s44 offen offset:0 sc1
WL 8
MA 32,184,100
TR 160,6,10240
TR 162,6,12800
WL 8
MA 48,188,100
TR 164,6,10304
TR 166,6,12864
WL 8
MA 64,192,100
TR 168,6,10368
TR 170,6,12928
WL 8
MA 80,196,100
TR 172,6,10432
TR 174,6,12992
WL 8
MA 96,200,100
TR 176,6,10496
TR 178,6,13056
buffer_load_dwordx4 a[100:103], v1, s[8:11], s44 offen offset:1024 sc1
WV 11
s_barrier
v_add_u32 v8, 73728, v4
WL 8
MA 32,160,104
TR 184,6,15360
TR 186,6,17920
WL 8
MA 48,164,104
TR 188,6,15424
TR 190,6,17984
s_add_u32 m0, s91, 24576
s_nop 0
DM 16,76,46
WL 8
MA 64,168,104
TR 192,6,15488
TR 194,6,18048
WL 8
MA 80,172,104
TR 196,6,15552
TR 198,6,18112
WL 8
MA 96,176,104
TR 200,6,15616
TR 202,6,18176
s_add_u32 m0, s91, 25600
s_nop 0
DM 17,76,46
buffer_load_dwordx4 a[104:107], v1, s[8:11], s44 offen offset:2048 sc1
WL 8
MA 32,184,108
TR 160,8,0
TR 162,8,2560
WL 8
MA 48,188,108
TR 164,8,64
TR 166,8,2624
s_add_u32 m0, s91, 26624
s_nop 0
DM 18,76,46
WL 8
MA 64,192,108
TR 168,8,128
TR 170,8,2688
WL 8
MA 80,196,108
TR 172,8,192
TR 174,8,2752
WL 8
MA 96,200,108
TR 176,8,256
TR 178,8,2816
s_add_u32 m0, s91, 27648
s_nop 0
DM 19,76,46
buffer_load_dwordx4 a[108:111], v1, s[8:11], s44 offen offset:3072 sc1
WL 8
MA 32,160,112
TR 184,8,5120
TR 186,8,7680
WL 8
MA 48,164,112
TR 188,8,5184
TR 190,8,7744
s_add_u32 m0, s91, 28672
s_nop 0
DM 20,76,46
s_add_u32 s46, s46, 81920
WL 8
MA 64,168,112
TR 192,8,5248
TR 194,8,7808
WL 8
MA 80,172,112
TR 196,8,5312
TR 198,8,7872
WL 8
MA 96,176,112
TR 200,8,5376
TR 202,8,7936
s_add_u32 s44, s44, 4096
buffer_load_dwordx4 a[112:115], v1, s[8:11], s44 offen offset:0 sc1
WL 8
MA 32,184,116
TR 160,8,10240
TR 162,8,12800
WL 8
MA 48,188,116
TR 164,8,10304
TR 166,8,12864
WL 8
MA 64,192,116
TR 168,8,10368
TR 170,8,12928
WL 8
MA 80,196,116
TR 172,8,10432
TR 174,8,12992
WL 8
MA 96,200,116
TR 176,8,10496
TR 178,8,13056
buffer_load_dwordx4 a[116:119], v1, s[8:11], s44 offen offset:1024 sc1
WV 11
s_barrier
v_add_u32 v6, 0, v4
WL 8
MA 32,160,120
TR 184,8,15360
TR 186,8,17920
WL 8
MA 48,164,120
TR 188,8,15424
TR 190,8,17984
s_add_u32 m0, s91, 49152
s_nop 0
DM 16,76,46
WL 8
MA 64,168,120
TR 192,8,15488
TR 194,8,18048
WL 8
MA 80,172,120
TR 196,8,15552
TR 198,8,18112
WL 8
MA 96,176,120
TR 200,8,15616
TR 202,8,18176
s_add_u32 m0, s91, 50176
s_nop 0
DM 17,76,46
buffer_load_dwordx4 a[120:123], v1, s[8:11], s44 offen offset:2048 sc1
WL 8
MA 32,184,124
TR 160,6,0
TR 162,6,2560
WL 8
MA 48,188,124
TR 164,6,64
TR 166,6,2624
s_add_u32 m0, s91, 51200
s_nop 0
DM 18,76,46
WL 8
MA 64,192,124
TR 168,6,128
TR 170,6,2688
WL 8
MA 80,196,124
TR 172,6,192
TR 174,6,2752
WL 8
MA 96,200,124
TR 176,6,256
TR 178,6,2816
s_add_u32 m0, s91, 52224
s_nop 0
DM 19,76,46
buffer_load_dwordx4 a[124:127], v1, s[8:11], s44 offen offset:3072 sc1
WL 8
MA 32,160,0
TR 184,6,5120
TR 186,6,7680
WL 8
MA 48,164,0
TR 188,6,5184
TR 190,6,7744
s_add_u32 m0, s91, 53248
s_nop 0
DM 20,76,46
s_add_u32 s46, s46, 81920
WL 8
MA 64,168,0
TR 192,6,5248
TR 194,6,7808
WL 8
MA 80,172,0
TR 196,6,5312
TR 198,6,7872
WL 8
MA 96,176,0
TR 200,6,5376
TR 202,6,7936
WL 8
MA 32,184,4
TR 160,6,10240
TR 162,6,12800
WL 8
MA 48,188,4
TR 164,6,10304
TR 166,6,12864
WL 8
MA 64,192,4
TR 168,6,10368
TR 170,6,12928
WL 8
MA 80,196,4
TR 172,6,10432
TR 174,6,12992
WL 8
MA 96,200,4
TR 176,6,10496
TR 178,6,13056
WV 9
s_barrier
v_add_u32 v8, 24576, v4
WL 8
MA 32,160,8
TR 184,6,15360
TR 186,6,17920
WL 8
MA 48,164,8
TR 188,6,15424
TR 190,6,17984
s_add_u32 m0, s91, 73728
s_nop 0
DM 16,76,46
WL 8
MA 64,168,8
TR 192,6,15488
TR 194,6,18048
WL 8
MA 80,172,8
TR 196,6,15552
TR 198,6,18112
WL 8
MA 96,176,8
TR 200,6,15616
TR 202,6,18176
s_add_u32 m0, s91, 74752
s_nop 0
DM 17,76,46
WL 8
MA 32,184,12
TR 160,8,0
TR 162,8,2560
WL 8
MA 48,188,12
TR 164,8,64
TR 166,8,2624
s_add_u32 m0, s91, 75776
s_nop 0
DM 18,76,46
WL 8
MA 64,192,12
TR 168,8,128
TR 170,8,2688
WL 8
MA 80,196,12
TR 172,8,192
TR 174,8,2752
WL 8
MA 96,200,12
TR 176,8,256
TR 178,8,2816
s_add_u32 m0, s91, 76800
s_nop 0
DM 19,76,46
WL 8
MA 32,160,16
TR 184,8,5120
TR 186,8,7680
WL 8
MA 48,164,16
TR 188,8,5184
TR 190,8,7744
s_add_u32 m0, s91, 77824
s_nop 0
DM 20,76,46
s_add_u32 s46, s46, 81920
WL 8
MA 64,168,16
TR 192,8,5248
TR 194,8,7808
WL 8
MA 80,172,16
TR 196,8,5312
TR 198,8,7872
WL 8
MA 96,176,16
TR 200,8,5376
TR 202,8,7936
WL 8
MA 32,184,20
TR 160,8,10240
TR 162,8,12800
WL 8
MA 48,188,20
TR 164,8,10304
TR 166,8,12864
WL 8
MA 64,192,20
TR 168,8,10368
TR 170,8,12928
WL 8
MA 80,196,20
TR 172,8,10432
TR 174,8,12992
WL 8
MA 96,200,20
TR 176,8,10496
TR 178,8,13056
WV 5
s_barrier
v_add_u32 v6, 49152, v4
WL 8
MA 32,160,24
TR 184,8,15360
TR 186,8,17920
WL 8
MA 48,164,24
TR 188,8,15424
TR 190,8,17984
s_add_u32 m0, s91, 0
s_nop 0
DM 16,76,46
WL 8
MA 64,168,24
TR 192,8,15488
TR 194,8,18048
WL 8
MA 80,172,24
TR 196,8,15552
TR 198,8,18112
WL 8
MA 96,176,24
TR 200,8,15616
TR 202,8,18176
s_add_u32 m0, s91, 1024
s_nop 0
DM 17,76,46
WL 8
MA 32,184,28
TR 160,6,0
TR 162,6,2560
WL 8
MA 48,188,28
TR 164,6,64
TR 166,6,2624
s_add_u32 m0, s91, 2048
s_nop 0
DM 18,76,46
WL 8
MA 64,192,28
TR 168,6,128
TR 170,6,2688
WL 8
MA 80,196,28
TR 172,6,192
TR 174,6,2752
WL 8
MA 96,200,28
TR 176,6,256
TR 178,6,2816
s_add_u32 m0, s91, 3072
s_nop 0
DM 19,76,46
WL 8
MA 32,160,32
TR 184,6,5120
TR 186,6,7680
WL 8
MA 48,164,32
TR 188,6,5184
TR 190,6,7744
s_add_u32 m0, s91, 4096
s_nop 0
DM 20,76,46
s_add_u32 s46, s46, 81920
WL 8
MA 64,168,32
TR 192,6,5248
TR 194,6,7808
WL 8
MA 80,172,32
TR 196,6,5312
TR 198,6,7872
WL 8
MA 96,176,32
TR 200,6,5376
TR 202,6,7936
WL 8
MA 32,184,36
TR 160,6,10240
TR 162,6,12800
WL 8
MA 48,188,36
TR 164,6,10304
TR 166,6,12864
WL 8
MA 64,192,36
TR 168,6,10368
TR 170,6,12928
WL 8
MA 80,196,36
TR 172,6,10432
TR 174,6,12992
WL 8
MA 96,200,36
TR 176,6,10496
TR 178,6,13056
WV 5
s_barrier
v_add_u32 v8, 73728, v4
WL 8
MA 32,160,40
TR 184,6,15360
TR 186,6,17920
WL 8
MA 48,164,40
TR 188,6,15424
TR 190,6,17984
s_add_u32 m0, s91, 24576
s_nop 0
DM 16,76,46
WL 8
MA 64,168,40
TR 192,6,15488
TR 194,6,18048
WL 8
MA 80,172,40
TR 196,6,15552
TR 198,6,18112
WL 8
MA 96,176,40
TR 200,6,15616
TR 202,6,18176
s_add_u32 m0, s91, 25600
s_nop 0
DM 17,76,46
WL 8
MA 32,184,44
TR 160,8,0
TR 162,8,2560
WL 8
MA 48,188,44
TR 164,8,64
TR 166,8,2624
s_add_u32 m0, s91, 26624
s_nop 0
DM 18,76,46
WL 8
MA 64,192,44
TR 168,8,128
TR 170,8,2688
WL 8
MA 80,196,44
TR 172,8,192
TR 174,8,2752
WL 8
MA 96,200,44
TR 176,8,256
TR 178,8,2816
s_add_u32 m0, s91, 27648
s_nop 0
DM 19,76,46
WL 8
MA 32,160,48
TR 184,8,5120
TR 186,8,7680
WL 8
MA 48,164,48
TR 188,8,5184
TR 190,8,7744
s_add_u32 m0, s91, 28672
s_nop 0
DM 20,76,46
s_add_u32 s46, s46, 81920
WL 8
MA 64,168,48
TR 192,8,5248
TR 194,8,7808
WL 8
MA 80,172,48
TR 196,8,5312
TR 198,8,7872
WL 8
MA 96,176,48
TR 200,8,5376
TR 202,8,7936
WL 8
MA 32,184,52
TR 160,8,10240
TR 162,8,12800
WL 8
MA 48,188,52
TR 164,8,10304
TR 166,8,12864
WL 8
MA 64,192,52
TR 168,8,10368
TR 170,8,12928
WL 8
MA 80,196,52
TR 172,8,10432
TR 174,8,12992
WL 8
MA 96,200,52
TR 176,8,10496
TR 178,8,13056
WV 5
s_barrier
v_add_u32 v6, 0, v4
WL 8
MA 32,160,56
TR 184,8,15360
TR 186,8,17920
WL 8
MA 48,164,56
TR 188,8,15424
TR 190,8,17984
s_add_u32 m0, s91, 49152
s_nop 0
DM 16,76,46
WL 8
MA 64,168,56
TR 192,8,15488
TR 194,8,18048
WL 8
MA 80,172,56
TR 196,8,15552
TR 198,8,18112
WL 8
MA 96,176,56
TR 200,8,15616
TR 202,8,18176
s_add_u32 m0, s91, 50176
s_nop 0
DM 17,76,46
WL 8
MA 32,184,60
TR 160,6,0
TR 162,6,2560
WL 8
MA 48,188,60
TR 164,6,64
TR 166,6,2624
s_add_u32 m0, s91, 51200
s_nop 0
DM 18,76,46
WL 8
MA 64,192,60
TR 168,6,128
TR 170,6,2688
WL 8
MA 80,196,60
TR 172,6,192
TR 174,6,2752
WL 8
MA 96,200,60
TR 176,6,256
TR 178,6,2816
s_add_u32 m0, s91, 52224
s_nop 0
DM 19,76,46
WL 8
MA 32,160,64
TR 184,6,5120
TR 186,6,7680
WL 8
MA 48,164,64
TR 188,6,5184
TR 190,6,7744
s_add_u32 m0, s91, 53248
s_nop 0
DM 20,76,46
s_add_u32 s46, s46, 81920
WL 8
MA 64,168,64
TR 192,6,5248
TR 194,6,7808
WL 8
MA 80,172,64
TR 196,6,5312
TR 198,6,7872
WL 8
MA 96,176,64
TR 200,6,5376
TR 202,6,7936
WL 8
MA 32,184,68
TR 160,6,10240
TR 162,6,12800
WL 8
MA 48,188,68
TR 164,6,10304
TR 166,6,12864
WL 8
MA 64,192,68
TR 168,6,10368
TR 170,6,12928
WL 8
MA 80,196,68
TR 172,6,10432
TR 174,6,12992
WL 8
MA 96,200,68
TR 176,6,10496
TR 178,6,13056
WV 5
s_barrier
v_add_u32 v8, 24576, v4
WL 8
MA 32,160,72
TR 184,6,15360
TR 186,6,17920
WL 8
MA 48,164,72
TR 188,6,15424
TR 190,6,17984
s_add_u32 m0, s91, 73728
s_nop 0
DM 16,76,46
WL 8
MA 64,168,72
TR 192,6,15488
TR 194,6,18048
WL 8
MA 80,172,72
TR 196,6,15552
TR 198,6,18112
WL 8
MA 96,176,72
TR 200,6,15616
TR 202,6,18176
s_add_u32 m0, s91, 74752
s_nop 0
DM 17,76,46
WL 8
MA 32,184,76
TR 160,8,0
TR 162,8,2560
WL 8
MA 48,188,76
TR 164,8,64
TR 166,8,2624
s_add_u32 m0, s91, 75776
s_nop 0
DM 18,76,46
WL 8
MA 64,192,76
TR 168,8,128
TR 170,8,2688
WL 8
MA 80,196,76
TR 172,8,192
TR 174,8,2752
WL 8
MA 96,200,76
TR 176,8,256
TR 178,8,2816
s_add_u32 m0, s91, 76800
s_nop 0
DM 19,76,46
WL 8
MA 32,160,80
TR 184,8,5120
TR 186,8,7680
WL 8
MA 48,164,80
TR 188,8,5184
TR 190,8,7744
s_add_u32 m0, s91, 77824
s_nop 0
DM 20,76,46
s_add_u32 s46, s46, 81920
WL 8
MA 64,168,80
TR 192,8,5248
TR 194,8,7808
WL 8
MA 80,172,80
TR 196,8,5312
TR 198,8,7872
WL 8
MA 96,176,80
TR 200,8,5376
TR 202,8,7936
WL 8
MA 32,184,84
TR 160,8,10240
TR 162,8,12800
WL 8
MA 48,188,84
TR 164,8,10304
TR 166,8,12864
WL 8
MA 64,192,84
TR 168,8,10368
TR 170,8,12928
WL 8
MA 80,196,84
TR 172,8,10432
TR 174,8,12992
WL 8
MA 96,200,84
TR 176,8,10496
TR 178,8,13056
WV 5
s_barrier
v_add_u32 v6, 49152, v4
WL 8
MA 32,160,88
TR 184,8,15360
TR 186,8,17920
WL 8
MA 48,164,88
TR 188,8,15424
TR 190,8,17984
WL 8
MA 64,168,88
TR 192,8,15488
TR 194,8,18048
WL 8
MA 80,172,88
TR 196,8,15552
TR 198,8,18112
WL 8
MA 96,176,88
TR 200,8,15616
TR 202,8,18176
WL 8
MA 32,184,92
TR 160,6,0
TR 162,6,2560
WL 8
MA 48,188,92
TR 164,6,64
TR 166,6,2624
WL 8
MA 64,192,92
TR 168,6,128
TR 170,6,2688
WL 8
MA 80,196,92
TR 172,6,192
TR 174,6,2752
WL 8
MA 96,200,92
TR 176,6,256
TR 178,6,2816
WL 8
MA 32,160,96
TR 184,6,5120
TR 186,6,7680
WL 8
MA 48,164,96
TR 188,6,5184
TR 190,6,7744
WL 8
MA 64,168,96
TR 192,6,5248
TR 194,6,7808
WL 8
MA 80,172,96
TR 196,6,5312
TR 198,6,7872
WL 8
MA 96,176,96
TR 200,6,5376
TR 202,6,7936
WL 8
MA 32,184,100
TR 160,6,10240
TR 162,6,12800
WL 8
MA 48,188,100
TR 164,6,10304
TR 166,6,12864
WL 8
MA 64,192,100
TR 168,6,10368
TR 170,6,12928
WL 8
MA 80,196,100
TR 172,6,10432
TR 174,6,12992
WL 8
MA 96,200,100
TR 176,6,10496
TR 178,6,13056
WV 0
s_barrier
v_add_u32 v8, 73728, v4
WL 8
MA 32,160,104
TR 184,6,15360
TR 186,6,17920
WL 8
MA 48,164,104
TR 188,6,15424
TR 190,6,17984
WL 8
MA 64,168,104
TR 192,6,15488
TR 194,6,18048
WL 8
MA 80,172,104
TR 196,6,15552
TR 198,6,18112
WL 8
MA 96,176,104
TR 200,6,15616
TR 202,6,18176
s_mul_i32 s46, s41, 160
s_lshl_b32 s47, s43, 5
s_mov_b32 s49, 13631488
v_and_b32 v22, 63, v0
v_and_b32 v23, 31, v22
v_add_u32 v23, s47, v23
v_mul_u32_u24 v23, 1280, v23
v_lshrrev_b32 v24, 5, v22
v_lshlrev_b32 v25, 3, v24
v_add_u32 v23, v23, v25
s_lshl_b32 s23, s46, 1
v_add_u32 v23, s23, v23
v_lshlrev_b32 v24, 4, v24
s_lshl_b32 s23, s46, 2
v_add_u32 v24, s23, v24
s_mov_b32 s24, 16896
buffer_load_dwordx4 v[128:131], v24, s[8:11], s24 offen offset:0
buffer_load_dwordx2 v[208:209], v23, s[8:11], s49 offen offset:0 sc1
buffer_load_dwordx4 v[132:135], v24, s[8:11], s24 offen offset:32
buffer_load_dwordx2 v[210:211], v23, s[8:11], s49 offen offset:16 sc1
buffer_load_dwordx4 v[136:139], v24, s[8:11], s24 offen offset:64
buffer_load_dwordx2 v[212:213], v23, s[8:11], s49 offen offset:32 sc1
buffer_load_dwordx4 v[140:143], v24, s[8:11], s24 offen offset:96
buffer_load_dwordx2 v[214:215], v23, s[8:11], s49 offen offset:48 sc1
buffer_load_dwordx4 v[144:147], v24, s[8:11], s24 offen offset:128
buffer_load_dwordx2 v[216:217], v23, s[8:11], s49 offen offset:64 sc1
buffer_load_dwordx4 v[148:151], v24, s[8:11], s24 offen offset:160
buffer_load_dwordx2 v[218:219], v23, s[8:11], s49 offen offset:80 sc1
buffer_load_dwordx4 v[152:155], v24, s[8:11], s24 offen offset:192
buffer_load_dwordx2 v[220:221], v23, s[8:11], s49 offen offset:96 sc1
buffer_load_dwordx4 v[156:159], v24, s[8:11], s24 offen offset:224
buffer_load_dwordx2 v[222:223], v23, s[8:11], s49 offen offset:112 sc1
buffer_load_dwordx4 v[160:163], v24, s[8:11], s24 offen offset:256
buffer_load_dwordx2 v[224:225], v23, s[8:11], s49 offen offset:128 sc1
buffer_load_dwordx4 v[164:167], v24, s[8:11], s24 offen offset:288
buffer_load_dwordx2 v[226:227], v23, s[8:11], s49 offen offset:144 sc1
buffer_load_dwordx4 v[168:171], v24, s[8:11], s24 offen offset:320
buffer_load_dwordx2 v[228:229], v23, s[8:11], s49 offen offset:160 sc1
buffer_load_dwordx4 v[172:175], v24, s[8:11], s24 offen offset:352
buffer_load_dwordx2 v[230:231], v23, s[8:11], s49 offen offset:176 sc1
buffer_load_dwordx4 v[176:179], v24, s[8:11], s24 offen offset:384
buffer_load_dwordx2 v[232:233], v23, s[8:11], s49 offen offset:192 sc1
buffer_load_dwordx4 v[180:183], v24, s[8:11], s24 offen offset:416
buffer_load_dwordx2 v[234:235], v23, s[8:11], s49 offen offset:208 sc1
buffer_load_dwordx4 v[184:187], v24, s[8:11], s24 offen offset:448
buffer_load_dwordx2 v[236:237], v23, s[8:11], s49 offen offset:224 sc1
buffer_load_dwordx4 v[188:191], v24, s[8:11], s24 offen offset:480
buffer_load_dwordx2 v[238:239], v23, s[8:11], s49 offen offset:240 sc1
buffer_load_dwordx4 v[192:195], v24, s[8:11], s24 offen offset:512
buffer_load_dwordx2 v[240:241], v23, s[8:11], s49 offen offset:256 sc1
buffer_load_dwordx4 v[196:199], v24, s[8:11], s24 offen offset:544
buffer_load_dwordx2 v[242:243], v23, s[8:11], s49 offen offset:272 sc1
buffer_load_dwordx4 v[200:203], v24, s[8:11], s24 offen offset:576
buffer_load_dwordx2 v[244:245], v23, s[8:11], s49 offen offset:288 sc1
buffer_load_dwordx4 v[204:207], v24, s[8:11], s24 offen offset:608
buffer_load_dwordx2 v[246:247], v23, s[8:11], s49 offen offset:304 sc1
WL 8
MA 32,184,108
TR 160,8,0
TR 162,8,2560
WL 8
MA 48,188,108
TR 164,8,64
TR 166,8,2624
WL 8
MA 64,192,108
TR 168,8,128
TR 170,8,2688
WL 8
MA 80,196,108
TR 172,8,192
TR 174,8,2752
WL 8
MA 96,200,108
TR 176,8,256
TR 178,8,2816
WL 8
MA 32,160,112
TR 184,8,5120
TR 186,8,7680
WL 8
MA 48,164,112
TR 188,8,5184
TR 190,8,7744
WL 8
MA 64,168,112
TR 192,8,5248
TR 194,8,7808
WL 8
MA 80,172,112
TR 196,8,5312
TR 198,8,7872
WL 8
MA 96,176,112
TR 200,8,5376
TR 202,8,7936
WL 8
MA 32,184,116
TR 160,8,10240
TR 162,8,12800
WL 8
MA 48,188,116
TR 164,8,10304
TR 166,8,12864
WL 8
MA 64,192,116
TR 168,8,10368
TR 170,8,12928
WL 8
MA 80,196,116
TR 172,8,10432
TR 174,8,12992
WL 8
MA 96,200,116
TR 176,8,10496
TR 178,8,13056
WL 8
MA 32,160,120
TR 184,8,15360
TR 186,8,17920
WL 8
MA 48,164,120
TR 188,8,15424
TR 190,8,17984
WL 8
MA 64,168,120
TR 192,8,15488
TR 194,8,18048
WL 8
MA 80,172,120
TR 196,8,15552
TR 198,8,18112
WL 8
MA 96,176,120
TR 200,8,15616
TR 202,8,18176
WL 8
MA 32,184,124
WL 6
MA 48,188,124
WL 4
MA 64,192,124
WL 2
MA 80,196,124
WL 0
MA 96,200,124
s_cmp_eq_u32 s16, 0
s_cbranch_scc0 W_f_108
s_lshl_b32 s23, s58, 2
s_add_u32 s23, s23, 128
s_mov_b64 exec, 1
v_mov_b32 v5, 1
v_mov_b32 v22, s23
buffer_atomic_add v5, v22, s[12:15], 0 offen sc0
s_mov_b64 exec, -1
W_f_108:
s_nop 7
s_nop 7
WV 0
CV 26,32,33
SH 32,26
HH 33,26
v_mul_f32 v32, v32, v128
v_mul_f32 v33, v33, v129
CV 26,32,33
SH 32,26
HH 33,26
SH 27,208
HH 28,208
v_add_f32 v32, v32, v27
v_add_f32 v33, v33, v28
CV 208,32,33
CV 26,34,35
SH 34,26
HH 35,26
v_mul_f32 v34, v34, v130
v_mul_f32 v35, v35, v131
CV 26,34,35
SH 34,26
HH 35,26
SH 27,209
HH 28,209
v_add_f32 v34, v34, v27
v_add_f32 v35, v35, v28
CV 209,34,35
buffer_store_dwordx2 v[208:209], v23, s[84:87], 0 offen offset:0
CV 26,36,37
SH 36,26
HH 37,26
v_mul_f32 v36, v36, v132
v_mul_f32 v37, v37, v133
CV 26,36,37
SH 36,26
HH 37,26
SH 27,210
HH 28,210
v_add_f32 v36, v36, v27
v_add_f32 v37, v37, v28
CV 210,36,37
CV 26,38,39
SH 38,26
HH 39,26
v_mul_f32 v38, v38, v134
v_mul_f32 v39, v39, v135
CV 26,38,39
SH 38,26
HH 39,26
SH 27,211
HH 28,211
v_add_f32 v38, v38, v27
v_add_f32 v39, v39, v28
CV 211,38,39
buffer_store_dwordx2 v[210:211], v23, s[84:87], 0 offen offset:16
CV 26,40,41
SH 40,26
HH 41,26
v_mul_f32 v40, v40, v136
v_mul_f32 v41, v41, v137
CV 26,40,41
SH 40,26
HH 41,26
SH 27,212
HH 28,212
v_add_f32 v40, v40, v27
v_add_f32 v41, v41, v28
CV 212,40,41
CV 26,42,43
SH 42,26
HH 43,26
v_mul_f32 v42, v42, v138
v_mul_f32 v43, v43, v139
CV 26,42,43
SH 42,26
HH 43,26
SH 27,213
HH 28,213
v_add_f32 v42, v42, v27
v_add_f32 v43, v43, v28
CV 213,42,43
buffer_store_dwordx2 v[212:213], v23, s[84:87], 0 offen offset:32
CV 26,44,45
SH 44,26
HH 45,26
v_mul_f32 v44, v44, v140
v_mul_f32 v45, v45, v141
CV 26,44,45
SH 44,26
HH 45,26
SH 27,214
HH 28,214
v_add_f32 v44, v44, v27
v_add_f32 v45, v45, v28
CV 214,44,45
CV 26,46,47
SH 46,26
HH 47,26
v_mul_f32 v46, v46, v142
v_mul_f32 v47, v47, v143
CV 26,46,47
SH 46,26
HH 47,26
SH 27,215
HH 28,215
v_add_f32 v46, v46, v27
v_add_f32 v47, v47, v28
CV 215,46,47
buffer_store_dwordx2 v[214:215], v23, s[84:87], 0 offen offset:48
CV 26,48,49
SH 48,26
HH 49,26
v_mul_f32 v48, v48, v144
v_mul_f32 v49, v49, v145
CV 26,48,49
SH 48,26
HH 49,26
SH 27,216
HH 28,216
v_add_f32 v48, v48, v27
v_add_f32 v49, v49, v28
CV 216,48,49
CV 26,50,51
SH 50,26
HH 51,26
v_mul_f32 v50, v50, v146
v_mul_f32 v51, v51, v147
CV 26,50,51
SH 50,26
HH 51,26
SH 27,217
HH 28,217
v_add_f32 v50, v50, v27
v_add_f32 v51, v51, v28
CV 217,50,51
buffer_store_dwordx2 v[216:217], v23, s[84:87], 0 offen offset:64
CV 26,52,53
SH 52,26
HH 53,26
v_mul_f32 v52, v52, v148
v_mul_f32 v53, v53, v149
CV 26,52,53
SH 52,26
HH 53,26
SH 27,218
HH 28,218
v_add_f32 v52, v52, v27
v_add_f32 v53, v53, v28
CV 218,52,53
CV 26,54,55
SH 54,26
HH 55,26
v_mul_f32 v54, v54, v150
v_mul_f32 v55, v55, v151
CV 26,54,55
SH 54,26
HH 55,26
SH 27,219
HH 28,219
v_add_f32 v54, v54, v27
v_add_f32 v55, v55, v28
CV 219,54,55
buffer_store_dwordx2 v[218:219], v23, s[84:87], 0 offen offset:80
CV 26,56,57
SH 56,26
HH 57,26
v_mul_f32 v56, v56, v152
v_mul_f32 v57, v57, v153
CV 26,56,57
SH 56,26
HH 57,26
SH 27,220
HH 28,220
v_add_f32 v56, v56, v27
v_add_f32 v57, v57, v28
CV 220,56,57
CV 26,58,59
SH 58,26
HH 59,26
v_mul_f32 v58, v58, v154
v_mul_f32 v59, v59, v155
CV 26,58,59
SH 58,26
HH 59,26
SH 27,221
HH 28,221
v_add_f32 v58, v58, v27
v_add_f32 v59, v59, v28
CV 221,58,59
buffer_store_dwordx2 v[220:221], v23, s[84:87], 0 offen offset:96
CV 26,60,61
SH 60,26
HH 61,26
v_mul_f32 v60, v60, v156
v_mul_f32 v61, v61, v157
CV 26,60,61
SH 60,26
HH 61,26
SH 27,222
HH 28,222
v_add_f32 v60, v60, v27
v_add_f32 v61, v61, v28
CV 222,60,61
CV 26,62,63
SH 62,26
HH 63,26
v_mul_f32 v62, v62, v158
v_mul_f32 v63, v63, v159
CV 26,62,63
SH 62,26
HH 63,26
SH 27,223
HH 28,223
v_add_f32 v62, v62, v27
v_add_f32 v63, v63, v28
CV 223,62,63
buffer_store_dwordx2 v[222:223], v23, s[84:87], 0 offen offset:112
CV 26,64,65
SH 64,26
HH 65,26
v_mul_f32 v64, v64, v160
v_mul_f32 v65, v65, v161
CV 26,64,65
SH 64,26
HH 65,26
SH 27,224
HH 28,224
v_add_f32 v64, v64, v27
v_add_f32 v65, v65, v28
CV 224,64,65
CV 26,66,67
SH 66,26
HH 67,26
v_mul_f32 v66, v66, v162
v_mul_f32 v67, v67, v163
CV 26,66,67
SH 66,26
HH 67,26
SH 27,225
HH 28,225
v_add_f32 v66, v66, v27
v_add_f32 v67, v67, v28
CV 225,66,67
buffer_store_dwordx2 v[224:225], v23, s[84:87], 0 offen offset:128
CV 26,68,69
SH 68,26
HH 69,26
v_mul_f32 v68, v68, v164
v_mul_f32 v69, v69, v165
CV 26,68,69
SH 68,26
HH 69,26
SH 27,226
HH 28,226
v_add_f32 v68, v68, v27
v_add_f32 v69, v69, v28
CV 226,68,69
CV 26,70,71
SH 70,26
HH 71,26
v_mul_f32 v70, v70, v166
v_mul_f32 v71, v71, v167
CV 26,70,71
SH 70,26
HH 71,26
SH 27,227
HH 28,227
v_add_f32 v70, v70, v27
v_add_f32 v71, v71, v28
CV 227,70,71
buffer_store_dwordx2 v[226:227], v23, s[84:87], 0 offen offset:144
CV 26,72,73
SH 72,26
HH 73,26
v_mul_f32 v72, v72, v168
v_mul_f32 v73, v73, v169
CV 26,72,73
SH 72,26
HH 73,26
SH 27,228
HH 28,228
v_add_f32 v72, v72, v27
v_add_f32 v73, v73, v28
CV 228,72,73
CV 26,74,75
SH 74,26
HH 75,26
v_mul_f32 v74, v74, v170
v_mul_f32 v75, v75, v171
CV 26,74,75
SH 74,26
HH 75,26
SH 27,229
HH 28,229
v_add_f32 v74, v74, v27
v_add_f32 v75, v75, v28
CV 229,74,75
buffer_store_dwordx2 v[228:229], v23, s[84:87], 0 offen offset:160
CV 26,76,77
SH 76,26
HH 77,26
v_mul_f32 v76, v76, v172
v_mul_f32 v77, v77, v173
CV 26,76,77
SH 76,26
HH 77,26
SH 27,230
HH 28,230
v_add_f32 v76, v76, v27
v_add_f32 v77, v77, v28
CV 230,76,77
CV 26,78,79
SH 78,26
HH 79,26
v_mul_f32 v78, v78, v174
v_mul_f32 v79, v79, v175
CV 26,78,79
SH 78,26
HH 79,26
SH 27,231
HH 28,231
v_add_f32 v78, v78, v27
v_add_f32 v79, v79, v28
CV 231,78,79
buffer_store_dwordx2 v[230:231], v23, s[84:87], 0 offen offset:176
CV 26,80,81
SH 80,26
HH 81,26
v_mul_f32 v80, v80, v176
v_mul_f32 v81, v81, v177
CV 26,80,81
SH 80,26
HH 81,26
SH 27,232
HH 28,232
v_add_f32 v80, v80, v27
v_add_f32 v81, v81, v28
CV 232,80,81
CV 26,82,83
SH 82,26
HH 83,26
v_mul_f32 v82, v82, v178
v_mul_f32 v83, v83, v179
CV 26,82,83
SH 82,26
HH 83,26
SH 27,233
HH 28,233
v_add_f32 v82, v82, v27
v_add_f32 v83, v83, v28
CV 233,82,83
buffer_store_dwordx2 v[232:233], v23, s[84:87], 0 offen offset:192
CV 26,84,85
SH 84,26
HH 85,26
v_mul_f32 v84, v84, v180
v_mul_f32 v85, v85, v181
CV 26,84,85
SH 84,26
HH 85,26
SH 27,234
HH 28,234
v_add_f32 v84, v84, v27
v_add_f32 v85, v85, v28
CV 234,84,85
CV 26,86,87
SH 86,26
HH 87,26
v_mul_f32 v86, v86, v182
v_mul_f32 v87, v87, v183
CV 26,86,87
SH 86,26
HH 87,26
SH 27,235
HH 28,235
v_add_f32 v86, v86, v27
v_add_f32 v87, v87, v28
CV 235,86,87
buffer_store_dwordx2 v[234:235], v23, s[84:87], 0 offen offset:208
CV 26,88,89
SH 88,26
HH 89,26
v_mul_f32 v88, v88, v184
v_mul_f32 v89, v89, v185
CV 26,88,89
SH 88,26
HH 89,26
SH 27,236
HH 28,236
v_add_f32 v88, v88, v27
v_add_f32 v89, v89, v28
CV 236,88,89
CV 26,90,91
SH 90,26
HH 91,26
v_mul_f32 v90, v90, v186
v_mul_f32 v91, v91, v187
CV 26,90,91
SH 90,26
HH 91,26
SH 27,237
HH 28,237
v_add_f32 v90, v90, v27
v_add_f32 v91, v91, v28
CV 237,90,91
buffer_store_dwordx2 v[236:237], v23, s[84:87], 0 offen offset:224
CV 26,92,93
SH 92,26
HH 93,26
v_mul_f32 v92, v92, v188
v_mul_f32 v93, v93, v189
CV 26,92,93
SH 92,26
HH 93,26
SH 27,238
HH 28,238
v_add_f32 v92, v92, v27
v_add_f32 v93, v93, v28
CV 238,92,93
CV 26,94,95
SH 94,26
HH 95,26
v_mul_f32 v94, v94, v190
v_mul_f32 v95, v95, v191
CV 26,94,95
SH 94,26
HH 95,26
SH 27,239
HH 28,239
v_add_f32 v94, v94, v27
v_add_f32 v95, v95, v28
CV 239,94,95
buffer_store_dwordx2 v[238:239], v23, s[84:87], 0 offen offset:240
CV 26,96,97
SH 96,26
HH 97,26
v_mul_f32 v96, v96, v192
v_mul_f32 v97, v97, v193
CV 26,96,97
SH 96,26
HH 97,26
SH 27,240
HH 28,240
v_add_f32 v96, v96, v27
v_add_f32 v97, v97, v28
CV 240,96,97
CV 26,98,99
SH 98,26
HH 99,26
v_mul_f32 v98, v98, v194
v_mul_f32 v99, v99, v195
CV 26,98,99
SH 98,26
HH 99,26
SH 27,241
HH 28,241
v_add_f32 v98, v98, v27
v_add_f32 v99, v99, v28
CV 241,98,99
buffer_store_dwordx2 v[240:241], v23, s[84:87], 0 offen offset:256
CV 26,100,101
SH 100,26
HH 101,26
v_mul_f32 v100, v100, v196
v_mul_f32 v101, v101, v197
CV 26,100,101
SH 100,26
HH 101,26
SH 27,242
HH 28,242
v_add_f32 v100, v100, v27
v_add_f32 v101, v101, v28
CV 242,100,101
CV 26,102,103
SH 102,26
HH 103,26
v_mul_f32 v102, v102, v198
v_mul_f32 v103, v103, v199
CV 26,102,103
SH 102,26
HH 103,26
SH 27,243
HH 28,243
v_add_f32 v102, v102, v27
v_add_f32 v103, v103, v28
CV 243,102,103
buffer_store_dwordx2 v[242:243], v23, s[84:87], 0 offen offset:272
CV 26,104,105
SH 104,26
HH 105,26
v_mul_f32 v104, v104, v200
v_mul_f32 v105, v105, v201
CV 26,104,105
SH 104,26
HH 105,26
SH 27,244
HH 28,244
v_add_f32 v104, v104, v27
v_add_f32 v105, v105, v28
CV 244,104,105
CV 26,106,107
SH 106,26
HH 107,26
v_mul_f32 v106, v106, v202
v_mul_f32 v107, v107, v203
CV 26,106,107
SH 106,26
HH 107,26
SH 27,245
HH 28,245
v_add_f32 v106, v106, v27
v_add_f32 v107, v107, v28
CV 245,106,107
buffer_store_dwordx2 v[244:245], v23, s[84:87], 0 offen offset:288
CV 26,108,109
SH 108,26
HH 109,26
v_mul_f32 v108, v108, v204
v_mul_f32 v109, v109, v205
CV 26,108,109
SH 108,26
HH 109,26
SH 27,246
HH 28,246
v_add_f32 v108, v108, v27
v_add_f32 v109, v109, v28
CV 246,108,109
CV 26,110,111
SH 110,26
HH 111,26
v_mul_f32 v110, v110, v206
v_mul_f32 v111, v111, v207
CV 26,110,111
SH 110,26
HH 111,26
SH 27,247
HH 28,247
v_add_f32 v110, v110, v27
v_add_f32 v111, v111, v28
CV 247,110,111
buffer_store_dwordx2 v[246:247], v23, s[84:87], 0 offen offset:304
WV 0
s_mov_b32 s48, -1
s_branch P_end
P_t2f:
s_lshr_b32 s55, s40, 2
s_cmp_eq_u32 s55, s95
s_cbranch_scc1 vvok_109
s_lshl_b32 s48, s55, 7
s_add_u32 s48, s48, 196608
s_cmp_eq_u32 s16, 0
s_cbranch_scc0 dep_111
s_mov_b32 s22, 0
v_mov_b32 v22, 0
dep_110:
buffer_load_dword v23, v22, s[8:11], s48 offen sc1
s_add_u32 s22, s22, 1
s_cmp_gt_u32 s22, 524288
s_cbranch_scc1 dep_111
WV 0
v_readfirstlane_b32 s23, v23
s_nop 3
s_cmp_ge_u32 s23, 32
s_cbranch_scc1 dep_111
s_sleep 4
s_branch dep_110
dep_111:
s_barrier
s_mov_b32 s95, s55
vvok_109:
v_and_b32 v22, 63, v0
v_lshlrev_b32 v1, 4, v22
v_and_b32 v23, 31, v22
v_lshrrev_b32 v24, 3, v23
v_and_b32 v23, 7, v23
v_lshlrev_b32 v23, 4, v23
v_lshrrev_b32 v25, 5, v22
v_lshlrev_b32 v26, 8, v25
v_add_u32 v23, v23, v26
v_lshlrev_b32 v26, 14, v24
v_add_u32 v2, v23, v26
v_add_u32 v6, 65536, v2
v_lshlrev_b32 v26, 12, v24
v_add_u32 v3, v23, v26
v_add_u32 v7, 16384, v3
v_mul_u32_u24 v26, 2560, v25
v_and_b32 v27, 31, v22
v_lshlrev_b32 v27, 4, v27
v_add_u32 v4, v26, v27
v_add_u32 v4, 2048, v4
s_mul_i32 s44, s40, 80
s_lshl_b32 s23, s41, 3
s_add_u32 s44, s44, s23
s_lshl_b32 s45, s44, 12
s_lshl_b32 s23, s16, 10
s_add_u32 s45, s45, s23
s_add_u32 s45, s45, 123731968
s_lshl_b32 s44, s44, 14
s_lshl_b32 s23, s16, 12
s_add_u32 s44, s44, s23
s_add_u32 s44, s44, 144703488
s_lshl_b32 s46, s40, 5
s_lshl_b32 s23, s16, 3
s_add_u32 s46, s46, s23
s_mul_i32 s46, s46, 2560
s_add_u32 s46, s46, 26214400
s_mov_b32 s47, s46
buffer_load_dwordx4 a[4:7], v2, s[8:11], s44 offen offset:0 sc1
buffer_load_dwordx4 a[8:11], v6, s[8:11], s44 offen offset:0 sc1
buffer_load_dwordx4 a[16:19], v2, s[8:11], s44 offen offset:512 sc1
buffer_load_dwordx4 a[20:23], v6, s[8:11], s44 offen offset:512 sc1
buffer_load_dwordx4 a[28:31], v2, s[8:11], s44 offen offset:128 sc1
buffer_load_dwordx4 a[32:35], v6, s[8:11], s44 offen offset:128 sc1
buffer_load_dwordx4 a[40:43], v2, s[8:11], s44 offen offset:640 sc1
buffer_load_dwordx4 a[44:47], v6, s[8:11], s44 offen offset:640 sc1
buffer_load_dwordx4 a[52:55], v2, s[8:11], s44 offen offset:1024 sc1
buffer_load_dwordx4 a[56:59], v6, s[8:11], s44 offen offset:1024 sc1
buffer_load_dwordx4 a[64:67], v2, s[8:11], s44 offen offset:1536 sc1
buffer_load_dwordx4 a[68:71], v6, s[8:11], s44 offen offset:1536 sc1
buffer_load_dwordx4 a[76:79], v2, s[8:11], s44 offen offset:1152 sc1
buffer_load_dwordx4 a[80:83], v6, s[8:11], s44 offen offset:1152 sc1
buffer_load_dwordx4 a[88:91], v2, s[8:11], s44 offen offset:1664 sc1
buffer_load_dwordx4 a[92:95], v6, s[8:11], s44 offen offset:1664 sc1
buffer_load_dwordx4 a[100:103], v2, s[8:11], s44 offen offset:2048 sc1
buffer_load_dwordx4 a[104:107], v6, s[8:11], s44 offen offset:2048 sc1
buffer_load_dwordx4 a[112:115], v2, s[8:11], s44 offen offset:2560 sc1
buffer_load_dwordx4 a[116:119], v6, s[8:11], s44 offen offset:2560 sc1
buffer_load_dwordx4 a[124:127], v2, s[8:11], s44 offen offset:2176 sc1
buffer_load_dwordx4 a[128:131], v6, s[8:11], s44 offen offset:2176 sc1
buffer_load_dwordx4 a[136:139], v2, s[8:11], s44 offen offset:2688 sc1
buffer_load_dwordx4 a[140:143], v6, s[8:11], s44 offen offset:2688 sc1
buffer_load_dwordx4 a[148:151], v2, s[8:11], s44 offen offset:3072 sc1
buffer_load_dwordx4 a[152:155], v6, s[8:11], s44 offen offset:3072 sc1
buffer_load_dwordx4 a[160:163], v2, s[8:11], s44 offen offset:3584 sc1
buffer_load_dwordx4 a[164:167], v6, s[8:11], s44 offen offset:3584 sc1
buffer_load_dwordx4 a[172:175], v2, s[8:11], s44 offen offset:3200 sc1
buffer_load_dwordx4 a[176:179], v6, s[8:11], s44 offen offset:3200 sc1
buffer_load_dwordx4 a[184:187], v2, s[8:11], s44 offen offset:3712 sc1
buffer_load_dwordx4 a[188:191], v6, s[8:11], s44 offen offset:3712 sc1
v_and_b32 v22, 63, v0
v_and_b32 v23, 31, v22
s_lshl_b32 s23, s40, 5
v_add_u32 v23, s23, v23
v_mul_u32_u24 v23, 1280, v23
v_lshrrev_b32 v24, 5, v22
s_mul_i32 s24, s41, 64
s_lshl_b32 s23, s16, 3
s_add_u32 s24, s24, s23
v_lshlrev_b32 v25, 2, v24
v_add_u32 v25, s24, v25
v_lshlrev_b32 v26, 1, v25
v_add_u32 v116, v23, v26
v_lshlrev_b32 v25, 2, v25
s_mov_b32 s24, 9216
buffer_load_dwordx4 v[100:103], v25, s[8:11], s24 offen offset:0
buffer_load_dwordx2 v[108:109], v116, s[80:83], 0 offen offset:0
buffer_load_dwordx4 v[104:107], v25, s[8:11], s24 offen offset:128
buffer_load_dwordx2 v[110:111], v116, s[80:83], 0 offen offset:64
s_cmp_ge_u32 s40, 62
s_cbranch_scc1 ws_112
s_add_u32 s52, s40, 1
s_lshl_b32 s52, s52, 9
s_add_u32 s52, s52, 229376
s_cmp_eq_u32 s16, 0
s_cbranch_scc0 dw_115
s_mov_b32 s22, 0
v_and_b32 v22, 63, v0
v_min_u32 v24, 31, v22
v_lshrrev_b32 v25, 3, v24
v_lshlrev_b32 v25, 7, v25
v_and_b32 v24, 7, v24
v_lshlrev_b32 v24, 2, v24
v_add_u32 v24, v24, v25
dw_114:
buffer_load_dword v23, v24, s[8:11], s52 offen sc1
s_add_u32 s22, s22, 1
s_cmp_gt_u32 s22, 524288
s_cbranch_scc1 dw_115
WV 0
v_cmp_eq_u32 vcc, 0, v23
s_cbranch_vccz dw_115
s_sleep 8
s_branch dw_114
dw_115:
s_barrier
s_branch ws_113
ws_112:
s_mov_b32 s52, 261632
s_mov_b32 s53, 200704
s_cmp_eq_u32 s16, 0
s_cbranch_scc0 dw_117
s_mov_b32 s22, 0
v_and_b32 v22, 63, v0
v_min_u32 v24, 31, v22
v_lshrrev_b32 v25, 3, v24
v_lshlrev_b32 v25, 7, v25
v_and_b32 v24, 7, v24
v_lshlrev_b32 v24, 2, v24
v_add_u32 v24, v24, v25
dw_116:
buffer_load_dword v23, v24, s[8:11], s52 offen sc1
s_add_u32 s22, s22, 1
s_cmp_gt_u32 s22, 524288
s_cbranch_scc1 dw_117
WV 0
v_cmp_eq_u32 vcc, 0, v23
s_cbranch_vccz dw_117
s_sleep 2
s_branch dw_116
dw_117:
s_barrier
s_cmp_eq_u32 s16, 0
s_cbranch_scc0 dw_119
s_mov_b32 s22, 0
v_and_b32 v22, 63, v0
v_min_u32 v24, 63, v22
v_lshlrev_b32 v24, 2, v24
v_add_u32 v25, 64, v22
v_min_u32 v25, 79, v25
v_lshlrev_b32 v25, 2, v25
dw_118:
buffer_load_dword v23, v24, s[8:11], s53 offen sc1
buffer_load_dword v26, v25, s[8:11], s53 offen sc1
s_add_u32 s22, s22, 1
s_cmp_gt_u32 s22, 524288
s_cbranch_scc1 dw_119
WV 0
v_min_u32 v23, v23, v26
v_cmp_eq_u32 vcc, 0, v23
s_cbranch_vccz dw_119
s_sleep 2
s_branch dw_118
dw_119:
s_barrier
ws_113:
buffer_load_dwordx4 a[0:3], v1, s[8:11], s46 offen offset:0 sc1
buffer_load_dwordx4 a[12:15], v1, s[8:11], s46 offen offset:1024 sc1
s_add_u32 s46, s46, 2560
buffer_load_dwordx4 a[24:27], v1, s[8:11], s46 offen offset:0 sc1
buffer_load_dwordx4 a[36:39], v1, s[8:11], s46 offen offset:1024 sc1
s_add_u32 s46, s46, 2560
buffer_load_dwordx4 a[48:51], v1, s[8:11], s46 offen offset:0 sc1
buffer_load_dwordx4 a[60:63], v1, s[8:11], s46 offen offset:1024 sc1
s_add_u32 s46, s46, 2560
buffer_load_dwordx4 a[72:75], v1, s[8:11], s46 offen offset:0 sc1
buffer_load_dwordx4 a[84:87], v1, s[8:11], s46 offen offset:1024 sc1
s_add_u32 s46, s46, 2560
buffer_load_dwordx4 a[96:99], v1, s[8:11], s46 offen offset:0 sc1
buffer_load_dwordx4 a[108:111], v1, s[8:11], s46 offen offset:1024 sc1
s_add_u32 s46, s46, 2560
buffer_load_dwordx4 a[120:123], v1, s[8:11], s46 offen offset:0 sc1
buffer_load_dwordx4 a[132:135], v1, s[8:11], s46 offen offset:1024 sc1
s_add_u32 s46, s46, 2560
buffer_load_dwordx4 a[144:147], v1, s[8:11], s46 offen offset:0 sc1
buffer_load_dwordx4 a[156:159], v1, s[8:11], s46 offen offset:1024 sc1
s_add_u32 s46, s46, 2560
buffer_load_dwordx4 a[168:171], v1, s[8:11], s46 offen offset:0 sc1
buffer_load_dwordx4 a[180:183], v1, s[8:11], s46 offen offset:1024 sc1
s_add_u32 s46, s46, 2560
buffer_load_dwordx4 a[192:195], v4, s[8:11], s47 offen sc1
buffer_load_dwordx4 a[196:199], v3, s[8:11], s45 offen offset:0 sc1
buffer_load_dwordx4 a[200:203], v7, s[8:11], s45 offen offset:0 sc1
s_add_u32 s47, s47, 5120
buffer_load_dwordx4 a[204:207], v4, s[8:11], s47 offen sc1
buffer_load_dwordx4 a[208:211], v3, s[8:11], s45 offen offset:512 sc1
buffer_load_dwordx4 a[212:215], v7, s[8:11], s45 offen offset:512 sc1
s_add_u32 s47, s47, 5120
buffer_load_dwordx4 a[216:219], v4, s[8:11], s47 offen sc1
buffer_load_dwordx4 a[220:223], v3, s[8:11], s45 offen offset:128 sc1
buffer_load_dwordx4 a[224:227], v7, s[8:11], s45 offen offset:128 sc1
s_add_u32 s47, s47, 5120
buffer_load_dwordx4 a[228:231], v4, s[8:11], s47 offen sc1
buffer_load_dwordx4 a[232:235], v3, s[8:11], s45 offen offset:640 sc1
buffer_load_dwordx4 a[236:239], v7, s[8:11], s45 offen offset:640 sc1
s_add_u32 s47, s47, 5120
WV 27
v_mfma_f32_32x32x16_bf16 v[32:47], a[4:7], a[0:3], 0
v_mfma_f32_32x32x16_bf16 v[48:63], a[8:11], a[0:3], 0
WV 26
MA 32,16,12
MA 48,20,12
WV 25
MA 32,28,24
MA 48,32,24
WV 24
MA 32,40,36
MA 48,44,36
WV 23
MA 32,52,48
MA 48,56,48
WV 22
MA 32,64,60
MA 48,68,60
WV 21
MA 32,76,72
MA 48,80,72
WV 20
MA 32,88,84
MA 48,92,84
WV 19
MA 32,100,96
MA 48,104,96
WV 18
MA 32,112,108
MA 48,116,108
WV 17
MA 32,124,120
MA 48,128,120
WV 16
MA 32,136,132
MA 48,140,132
WV 15
MA 32,148,144
MA 48,152,144
WV 14
MA 32,160,156
MA 48,164,156
WV 13
MA 32,172,168
MA 48,176,168
WV 12
MA 32,184,180
MA 48,188,180
WV 9
MA 32,196,192
MA 48,200,192
WV 6
MA 32,208,204
MA 48,212,204
WV 3
MA 32,220,216
MA 48,224,216
WV 0
MA 32,232,228
MA 48,236,228
s_cmp_eq_u32 s16, 0
s_cbranch_scc0 W_f_120
s_lshl_b32 s23, s58, 2
s_add_u32 s23, s23, 128
s_mov_b64 exec, 1
v_mov_b32 v5, 1
v_mov_b32 v22, s23
buffer_atomic_add v5, v22, s[12:15], 0 offen sc0
s_mov_b64 exec, -1
W_f_120:
s_nop 7
v_and_b32 v22, 63, v0
v_lshlrev_b32 v22, 4, v22
s_lshl_b32 s23, s16, 12
v_add_u32 v23, s23, v22
s_lshl_b32 s23, s16, 10
v_add_u32 v24, s23, v22
s_nop 7
ds_write_b128 v23, v[32:35] offset:0
ds_write_b128 v23, v[36:39] offset:1024
ds_write_b128 v23, v[40:43] offset:2048
ds_write_b128 v23, v[44:47] offset:3072
ds_write_b128 v23, v[48:51] offset:16384
ds_write_b128 v23, v[52:55] offset:17408
ds_write_b128 v23, v[56:59] offset:18432
ds_write_b128 v23, v[60:63] offset:19456
WL 0
s_barrier
ds_read_b128 v[128:131], v24 offset:0
ds_read_b128 v[132:135], v24 offset:4096
ds_read_b128 v[136:139], v24 offset:8192
ds_read_b128 v[140:143], v24 offset:12288
ds_read_b128 v[144:147], v24 offset:16384
ds_read_b128 v[148:151], v24 offset:20480
ds_read_b128 v[152:155], v24 offset:24576
ds_read_b128 v[156:159], v24 offset:28672
WL 0
v_pk_add_f32 v[128:129], v[128:129], v[132:133]
v_pk_add_f32 v[136:137], v[136:137], v[140:141]
v_pk_add_f32 v[32:33], v[128:129], v[136:137]
v_pk_add_f32 v[130:131], v[130:131], v[134:135]
v_pk_add_f32 v[138:139], v[138:139], v[142:143]
v_pk_add_f32 v[34:35], v[130:131], v[138:139]
v_pk_add_f32 v[144:145], v[144:145], v[148:149]
v_pk_add_f32 v[152:153], v[152:153], v[156:157]
v_pk_add_f32 v[36:37], v[144:145], v[152:153]
v_pk_add_f32 v[146:147], v[146:147], v[150:151]
v_pk_add_f32 v[154:155], v[154:155], v[158:159]
v_pk_add_f32 v[38:39], v[146:147], v[154:155]
s_mov_b32 s49, 13631488
CV 26,32,33
SH 32,26
HH 33,26
v_mul_f32 v32, v32, v100
v_mul_f32 v33, v33, v101
CV 26,32,33
SH 32,26
HH 33,26
SH 27,108
HH 28,108
v_add_f32 v32, v32, v27
v_add_f32 v33, v33, v28
CV 108,32,33
CV 26,34,35
SH 34,26
HH 35,26
v_mul_f32 v34, v34, v102
v_mul_f32 v35, v35, v103
CV 26,34,35
SH 34,26
HH 35,26
SH 27,109
HH 28,109
v_add_f32 v34, v34, v27
v_add_f32 v35, v35, v28
CV 109,34,35
buffer_store_dwordx2 v[108:109], v116, s[8:11], s49 offen offset:0 sc1
CV 26,36,37
SH 36,26
HH 37,26
v_mul_f32 v36, v36, v104
v_mul_f32 v37, v37, v105
CV 26,36,37
SH 36,26
HH 37,26
SH 27,110
HH 28,110
v_add_f32 v36, v36, v27
v_add_f32 v37, v37, v28
CV 110,36,37
CV 26,38,39
SH 38,26
HH 39,26
v_mul_f32 v38, v38, v106
v_mul_f32 v39, v39, v107
CV 26,38,39
SH 38,26
HH 39,26
SH 27,111
HH 28,111
v_add_f32 v38, v38, v27
v_add_f32 v39, v39, v28
CV 111,38,39
buffer_store_dwordx2 v[110:111], v116, s[8:11], s49 offen offset:64 sc1
WV 0
s_lshl_b32 s48, s40, 7
s_add_u32 s48, s48, 208896
s_branch P_end
P_lnf:
s_mov_b32 s55, s40
s_lshl_b32 s48, s40, 7
s_add_u32 s48, s48, 208896
s_lshl_b32 s40, s40, 1
s_add_u32 s40, s40, s41
s_mov_b32 s27, 13631488
v_and_b32 v2, 63, v0
v_lshrrev_b32 v3, 4, v2
v_and_b32 v4, 15, v2
s_lshl_b32 s23, s40, 4
s_lshl_b32 s24, s16, 2
s_add_u32 s23, s23, s24
v_add_u32 v5, s23, v3
v_mul_u32_u24 v6, 1280, v5
v_lshlrev_b32 v7, 4, v4
v_add_u32 v6, v6, v7
v_lshlrev_b32 v7, 5, v4
s_mov_b32 s25, 14336
s_mov_b32 s26, 11776
buffer_load_dwordx4 v[40:43], v7, s[8:11], s25 offen offset:0
buffer_load_dwordx4 v[44:47], v7, s[8:11], s25 offen offset:16
buffer_load_dwordx4 v[80:83], v7, s[8:11], s26 offen offset:0
buffer_load_dwordx4 v[84:87], v7, s[8:11], s26 offen offset:16
buffer_load_dwordx4 v[48:51], v7, s[8:11], s25 offen offset:512
buffer_load_dwordx4 v[52:55], v7, s[8:11], s25 offen offset:528
buffer_load_dwordx4 v[88:91], v7, s[8:11], s26 offen offset:512
buffer_load_dwordx4 v[92:95], v7, s[8:11], s26 offen offset:528
buffer_load_dwordx4 v[56:59], v7, s[8:11], s25 offen offset:1024
buffer_load_dwordx4 v[60:63], v7, s[8:11], s25 offen offset:1040
buffer_load_dwordx4 v[96:99], v7, s[8:11], s26 offen offset:1024
buffer_load_dwordx4 v[100:103], v7, s[8:11], s26 offen offset:1040
buffer_load_dwordx4 v[64:67], v7, s[8:11], s25 offen offset:1536
buffer_load_dwordx4 v[68:71], v7, s[8:11], s25 offen offset:1552
buffer_load_dwordx4 v[104:107], v7, s[8:11], s26 offen offset:1536
buffer_load_dwordx4 v[108:111], v7, s[8:11], s26 offen offset:1552
buffer_load_dwordx4 v[72:75], v7, s[8:11], s25 offen offset:2048
buffer_load_dwordx4 v[76:79], v7, s[8:11], s25 offen offset:2064
buffer_load_dwordx4 v[112:115], v7, s[8:11], s26 offen offset:2048
buffer_load_dwordx4 v[116:119], v7, s[8:11], s26 offen offset:2064
s_cmp_eq_u32 s16, 0
s_cbranch_scc0 dep_122
s_mov_b32 s22, 0
v_mov_b32 v22, 0
dep_121:
buffer_load_dword v23, v22, s[8:11], s48 offen sc1
s_add_u32 s22, s22, 1
s_cmp_gt_u32 s22, 524288
s_cbranch_scc1 dep_122
WV 0
v_readfirstlane_b32 s23, v23
s_nop 3
s_cmp_ge_u32 s23, 10
s_cbranch_scc1 dep_122
s_sleep 2
s_branch dep_121
dep_122:
s_barrier
buffer_load_dwordx4 v[16:19], v6, s[8:11], s27 offen offset:0 sc1
buffer_load_dwordx4 v[20:23], v6, s[8:11], s27 offen offset:256 sc1
buffer_load_dwordx4 v[24:27], v6, s[8:11], s27 offen offset:512 sc1
buffer_load_dwordx4 v[28:31], v6, s[8:11], s27 offen offset:768 sc1
buffer_load_dwordx4 v[32:35], v6, s[8:11], s27 offen offset:1024 sc1
WV 0
SH 128,16
HH 129,16
SH 130,17
HH 131,17
SH 132,18
HH 133,18
SH 134,19
HH 135,19
SH 136,20
HH 137,20
SH 138,21
HH 139,21
SH 140,22
HH 141,22
SH 142,23
HH 143,23
SH 144,24
HH 145,24
SH 146,25
HH 147,25
SH 148,26
HH 149,26
SH 150,27
HH 151,27
SH 152,28
HH 153,28
SH 154,29
HH 155,29
SH 156,30
HH 157,30
SH 158,31
HH 159,31
SH 160,32
HH 161,32
SH 162,33
HH 163,33
SH 164,34
HH 165,34
SH 166,35
HH 167,35
v_add_f32 v8, v128, v129
v_add_f32 v8, v8, v130
v_add_f32 v8, v8, v131
v_add_f32 v8, v8, v132
v_add_f32 v8, v8, v133
v_add_f32 v8, v8, v134
v_add_f32 v8, v8, v135
v_add_f32 v8, v8, v136
v_add_f32 v8, v8, v137
v_add_f32 v8, v8, v138
v_add_f32 v8, v8, v139
v_add_f32 v8, v8, v140
v_add_f32 v8, v8, v141
v_add_f32 v8, v8, v142
v_add_f32 v8, v8, v143
v_add_f32 v8, v8, v144
v_add_f32 v8, v8, v145
v_add_f32 v8, v8, v146
v_add_f32 v8, v8, v147
v_add_f32 v8, v8, v148
v_add_f32 v8, v8, v149
v_add_f32 v8, v8, v150
v_add_f32 v8, v8, v151
v_add_f32 v8, v8, v152
v_add_f32 v8, v8, v153
v_add_f32 v8, v8, v154
v_add_f32 v8, v8, v155
v_add_f32 v8, v8, v156
v_add_f32 v8, v8, v157
v_add_f32 v8, v8, v158
v_add_f32 v8, v8, v159
v_add_f32 v8, v8, v160
v_add_f32 v8, v8, v161
v_add_f32 v8, v8, v162
v_add_f32 v8, v8, v163
v_add_f32 v8, v8, v164
v_add_f32 v8, v8, v165
v_add_f32 v8, v8, v166
v_add_f32 v8, v8, v167
s_nop 1
v_add_f32_dpp v8, v8, v8 quad_perm:[1,0,3,2] row_mask:0xf bank_mask:0xf
s_nop 1
v_add_f32_dpp v8, v8, v8 quad_perm:[2,3,0,1] row_mask:0xf bank_mask:0xf
s_nop 1
v_add_f32_dpp v8, v8, v8 row_half_mirror row_mask:0xf bank_mask:0xf
s_nop 1
v_add_f32_dpp v8, v8, v8 row_mirror row_mask:0xf bank_mask:0xf
v_mul_f32 v8, 0x3acccccd, v8
v_mov_b32 v9, 0
v_sub_f32 v10, v128, v8
v_fmac_f32 v9, v10, v10
v_sub_f32 v10, v129, v8
v_fmac_f32 v9, v10, v10
v_sub_f32 v10, v130, v8
v_fmac_f32 v9, v10, v10
v_sub_f32 v10, v131, v8
v_fmac_f32 v9, v10, v10
v_sub_f32 v10, v132, v8
v_fmac_f32 v9, v10, v10
v_sub_f32 v10, v133, v8
v_fmac_f32 v9, v10, v10
v_sub_f32 v10, v134, v8
v_fmac_f32 v9, v10, v10
v_sub_f32 v10, v135, v8
v_fmac_f32 v9, v10, v10
v_sub_f32 v10, v136, v8
v_fmac_f32 v9, v10, v10
v_sub_f32 v10, v137, v8
v_fmac_f32 v9, v10, v10
v_sub_f32 v10, v138, v8
v_fmac_f32 v9, v10, v10
v_sub_f32 v10, v139, v8
v_fmac_f32 v9, v10, v10
v_sub_f32 v10, v140, v8
v_fmac_f32 v9, v10, v10
v_sub_f32 v10, v141, v8
v_fmac_f32 v9, v10, v10
v_sub_f32 v10, v142, v8
v_fmac_f32 v9, v10, v10
v_sub_f32 v10, v143, v8
v_fmac_f32 v9, v10, v10
v_sub_f32 v10, v144, v8
v_fmac_f32 v9, v10, v10
v_sub_f32 v10, v145, v8
v_fmac_f32 v9, v10, v10
v_sub_f32 v10, v146, v8
v_fmac_f32 v9, v10, v10
v_sub_f32 v10, v147, v8
v_fmac_f32 v9, v10, v10
v_sub_f32 v10, v148, v8
v_fmac_f32 v9, v10, v10
v_sub_f32 v10, v149, v8
v_fmac_f32 v9, v10, v10
v_sub_f32 v10, v150, v8
v_fmac_f32 v9, v10, v10
v_sub_f32 v10, v151, v8
v_fmac_f32 v9, v10, v10
v_sub_f32 v10, v152, v8
v_fmac_f32 v9, v10, v10
v_sub_f32 v10, v153, v8
v_fmac_f32 v9, v10, v10
v_sub_f32 v10, v154, v8
v_fmac_f32 v9, v10, v10
v_sub_f32 v10, v155, v8
v_fmac_f32 v9, v10, v10
v_sub_f32 v10, v156, v8
v_fmac_f32 v9, v10, v10
v_sub_f32 v10, v157, v8
v_fmac_f32 v9, v10, v10
v_sub_f32 v10, v158, v8
v_fmac_f32 v9, v10, v10
v_sub_f32 v10, v159, v8
v_fmac_f32 v9, v10, v10
v_sub_f32 v10, v160, v8
v_fmac_f32 v9, v10, v10
v_sub_f32 v10, v161, v8
v_fmac_f32 v9, v10, v10
v_sub_f32 v10, v162, v8
v_fmac_f32 v9, v10, v10
v_sub_f32 v10, v163, v8
v_fmac_f32 v9, v10, v10
v_sub_f32 v10, v164, v8
v_fmac_f32 v9, v10, v10
v_sub_f32 v10, v165, v8
v_fmac_f32 v9, v10, v10
v_sub_f32 v10, v166, v8
v_fmac_f32 v9, v10, v10
v_sub_f32 v10, v167, v8
v_fmac_f32 v9, v10, v10
s_nop 1
v_add_f32_dpp v9, v9, v9 quad_perm:[1,0,3,2] row_mask:0xf bank_mask:0xf
s_nop 1
v_add_f32_dpp v9, v9, v9 quad_perm:[2,3,0,1] row_mask:0xf bank_mask:0xf
s_nop 1
v_add_f32_dpp v9, v9, v9 row_half_mirror row_mask:0xf bank_mask:0xf
s_nop 1
v_add_f32_dpp v9, v9, v9 row_mirror row_mask:0xf bank_mask:0xf
v_mul_f32 v9, 0x3acccccd, v9
CV 8,8,8
SH 8,8
CV 9,9,9
SH 9,9
v_add_f32 v9, 0x3727c5ac, v9
CV 9,9,9
SH 9,9
v_sqrt_f32 v9, v9
s_nop 0
CV 9,9,9
SH 9,9
v_rcp_f32 v9, v9
s_nop 0
WV 0
v_sub_f32 v128, v128, v8
v_sub_f32 v129, v129, v8
CV 10,128,129
SH 128,10
HH 129,10
v_mul_f32 v128, v128, v9
v_mul_f32 v129, v129, v9
CV 10,128,129
SH 128,10
HH 129,10
v_add_f32 v40, 1.0, v40
v_add_f32 v41, 1.0, v41
CV 10,40,41
SH 40,10
HH 41,10
v_mul_f32 v128, v128, v40
v_mul_f32 v129, v129, v41
CV 10,128,129
SH 128,10
HH 129,10
v_add_f32 v128, v128, v80
v_add_f32 v129, v129, v81
CV 16,128,129
v_sub_f32 v130, v130, v8
v_sub_f32 v131, v131, v8
CV 10,130,131
SH 130,10
HH 131,10
v_mul_f32 v130, v130, v9
v_mul_f32 v131, v131, v9
CV 10,130,131
SH 130,10
HH 131,10
v_add_f32 v42, 1.0, v42
v_add_f32 v43, 1.0, v43
CV 10,42,43
SH 42,10
HH 43,10
v_mul_f32 v130, v130, v42
v_mul_f32 v131, v131, v43
CV 10,130,131
SH 130,10
HH 131,10
v_add_f32 v130, v130, v82
v_add_f32 v131, v131, v83
CV 17,130,131
v_sub_f32 v132, v132, v8
v_sub_f32 v133, v133, v8
CV 10,132,133
SH 132,10
HH 133,10
v_mul_f32 v132, v132, v9
v_mul_f32 v133, v133, v9
CV 10,132,133
SH 132,10
HH 133,10
v_add_f32 v44, 1.0, v44
v_add_f32 v45, 1.0, v45
CV 10,44,45
SH 44,10
HH 45,10
v_mul_f32 v132, v132, v44
v_mul_f32 v133, v133, v45
CV 10,132,133
SH 132,10
HH 133,10
v_add_f32 v132, v132, v84
v_add_f32 v133, v133, v85
CV 18,132,133
v_sub_f32 v134, v134, v8
v_sub_f32 v135, v135, v8
CV 10,134,135
SH 134,10
HH 135,10
v_mul_f32 v134, v134, v9
v_mul_f32 v135, v135, v9
CV 10,134,135
SH 134,10
HH 135,10
v_add_f32 v46, 1.0, v46
v_add_f32 v47, 1.0, v47
CV 10,46,47
SH 46,10
HH 47,10
v_mul_f32 v134, v134, v46
v_mul_f32 v135, v135, v47
CV 10,134,135
SH 134,10
HH 135,10
v_add_f32 v134, v134, v86
v_add_f32 v135, v135, v87
CV 19,134,135
v_sub_f32 v136, v136, v8
v_sub_f32 v137, v137, v8
CV 10,136,137
SH 136,10
HH 137,10
v_mul_f32 v136, v136, v9
v_mul_f32 v137, v137, v9
CV 10,136,137
SH 136,10
HH 137,10
v_add_f32 v48, 1.0, v48
v_add_f32 v49, 1.0, v49
CV 10,48,49
SH 48,10
HH 49,10
v_mul_f32 v136, v136, v48
v_mul_f32 v137, v137, v49
CV 10,136,137
SH 136,10
HH 137,10
v_add_f32 v136, v136, v88
v_add_f32 v137, v137, v89
CV 20,136,137
v_sub_f32 v138, v138, v8
v_sub_f32 v139, v139, v8
CV 10,138,139
SH 138,10
HH 139,10
v_mul_f32 v138, v138, v9
v_mul_f32 v139, v139, v9
CV 10,138,139
SH 138,10
HH 139,10
v_add_f32 v50, 1.0, v50
v_add_f32 v51, 1.0, v51
CV 10,50,51
SH 50,10
HH 51,10
v_mul_f32 v138, v138, v50
v_mul_f32 v139, v139, v51
CV 10,138,139
SH 138,10
HH 139,10
v_add_f32 v138, v138, v90
v_add_f32 v139, v139, v91
CV 21,138,139
v_sub_f32 v140, v140, v8
v_sub_f32 v141, v141, v8
CV 10,140,141
SH 140,10
HH 141,10
v_mul_f32 v140, v140, v9
v_mul_f32 v141, v141, v9
CV 10,140,141
SH 140,10
HH 141,10
v_add_f32 v52, 1.0, v52
v_add_f32 v53, 1.0, v53
CV 10,52,53
SH 52,10
HH 53,10
v_mul_f32 v140, v140, v52
v_mul_f32 v141, v141, v53
CV 10,140,141
SH 140,10
HH 141,10
v_add_f32 v140, v140, v92
v_add_f32 v141, v141, v93
CV 22,140,141
v_sub_f32 v142, v142, v8
v_sub_f32 v143, v143, v8
CV 10,142,143
SH 142,10
HH 143,10
v_mul_f32 v142, v142, v9
v_mul_f32 v143, v143, v9
CV 10,142,143
SH 142,10
HH 143,10
v_add_f32 v54, 1.0, v54
v_add_f32 v55, 1.0, v55
CV 10,54,55
SH 54,10
HH 55,10
v_mul_f32 v142, v142, v54
v_mul_f32 v143, v143, v55
CV 10,142,143
SH 142,10
HH 143,10
v_add_f32 v142, v142, v94
v_add_f32 v143, v143, v95
CV 23,142,143
v_sub_f32 v144, v144, v8
v_sub_f32 v145, v145, v8
CV 10,144,145
SH 144,10
HH 145,10
v_mul_f32 v144, v144, v9
v_mul_f32 v145, v145, v9
CV 10,144,145
SH 144,10
HH 145,10
v_add_f32 v56, 1.0, v56
v_add_f32 v57, 1.0, v57
CV 10,56,57
SH 56,10
HH 57,10
v_mul_f32 v144, v144, v56
v_mul_f32 v145, v145, v57
CV 10,144,145
SH 144,10
HH 145,10
v_add_f32 v144, v144, v96
v_add_f32 v145, v145, v97
CV 24,144,145
v_sub_f32 v146, v146, v8
v_sub_f32 v147, v147, v8
CV 10,146,147
SH 146,10
HH 147,10
v_mul_f32 v146, v146, v9
v_mul_f32 v147, v147, v9
CV 10,146,147
SH 146,10
HH 147,10
v_add_f32 v58, 1.0, v58
v_add_f32 v59, 1.0, v59
CV 10,58,59
SH 58,10
HH 59,10
v_mul_f32 v146, v146, v58
v_mul_f32 v147, v147, v59
CV 10,146,147
SH 146,10
HH 147,10
v_add_f32 v146, v146, v98
v_add_f32 v147, v147, v99
CV 25,146,147
v_sub_f32 v148, v148, v8
v_sub_f32 v149, v149, v8
CV 10,148,149
SH 148,10
HH 149,10
v_mul_f32 v148, v148, v9
v_mul_f32 v149, v149, v9
CV 10,148,149
SH 148,10
HH 149,10
v_add_f32 v60, 1.0, v60
v_add_f32 v61, 1.0, v61
CV 10,60,61
SH 60,10
HH 61,10
v_mul_f32 v148, v148, v60
v_mul_f32 v149, v149, v61
CV 10,148,149
SH 148,10
HH 149,10
v_add_f32 v148, v148, v100
v_add_f32 v149, v149, v101
CV 26,148,149
v_sub_f32 v150, v150, v8
v_sub_f32 v151, v151, v8
CV 10,150,151
SH 150,10
HH 151,10
v_mul_f32 v150, v150, v9
v_mul_f32 v151, v151, v9
CV 10,150,151
SH 150,10
HH 151,10
v_add_f32 v62, 1.0, v62
v_add_f32 v63, 1.0, v63
CV 10,62,63
SH 62,10
HH 63,10
v_mul_f32 v150, v150, v62
v_mul_f32 v151, v151, v63
CV 10,150,151
SH 150,10
HH 151,10
v_add_f32 v150, v150, v102
v_add_f32 v151, v151, v103
CV 27,150,151
v_sub_f32 v152, v152, v8
v_sub_f32 v153, v153, v8
CV 10,152,153
SH 152,10
HH 153,10
v_mul_f32 v152, v152, v9
v_mul_f32 v153, v153, v9
CV 10,152,153
SH 152,10
HH 153,10
v_add_f32 v64, 1.0, v64
v_add_f32 v65, 1.0, v65
CV 10,64,65
SH 64,10
HH 65,10
v_mul_f32 v152, v152, v64
v_mul_f32 v153, v153, v65
CV 10,152,153
SH 152,10
HH 153,10
v_add_f32 v152, v152, v104
v_add_f32 v153, v153, v105
CV 28,152,153
v_sub_f32 v154, v154, v8
v_sub_f32 v155, v155, v8
CV 10,154,155
SH 154,10
HH 155,10
v_mul_f32 v154, v154, v9
v_mul_f32 v155, v155, v9
CV 10,154,155
SH 154,10
HH 155,10
v_add_f32 v66, 1.0, v66
v_add_f32 v67, 1.0, v67
CV 10,66,67
SH 66,10
HH 67,10
v_mul_f32 v154, v154, v66
v_mul_f32 v155, v155, v67
CV 10,154,155
SH 154,10
HH 155,10
v_add_f32 v154, v154, v106
v_add_f32 v155, v155, v107
CV 29,154,155
v_sub_f32 v156, v156, v8
v_sub_f32 v157, v157, v8
CV 10,156,157
SH 156,10
HH 157,10
v_mul_f32 v156, v156, v9
v_mul_f32 v157, v157, v9
CV 10,156,157
SH 156,10
HH 157,10
v_add_f32 v68, 1.0, v68
v_add_f32 v69, 1.0, v69
CV 10,68,69
SH 68,10
HH 69,10
v_mul_f32 v156, v156, v68
v_mul_f32 v157, v157, v69
CV 10,156,157
SH 156,10
HH 157,10
v_add_f32 v156, v156, v108
v_add_f32 v157, v157, v109
CV 30,156,157
v_sub_f32 v158, v158, v8
v_sub_f32 v159, v159, v8
CV 10,158,159
SH 158,10
HH 159,10
v_mul_f32 v158, v158, v9
v_mul_f32 v159, v159, v9
CV 10,158,159
SH 158,10
HH 159,10
v_add_f32 v70, 1.0, v70
v_add_f32 v71, 1.0, v71
CV 10,70,71
SH 70,10
HH 71,10
v_mul_f32 v158, v158, v70
v_mul_f32 v159, v159, v71
CV 10,158,159
SH 158,10
HH 159,10
v_add_f32 v158, v158, v110
v_add_f32 v159, v159, v111
CV 31,158,159
v_sub_f32 v160, v160, v8
v_sub_f32 v161, v161, v8
CV 10,160,161
SH 160,10
HH 161,10
v_mul_f32 v160, v160, v9
v_mul_f32 v161, v161, v9
CV 10,160,161
SH 160,10
HH 161,10
v_add_f32 v72, 1.0, v72
v_add_f32 v73, 1.0, v73
CV 10,72,73
SH 72,10
HH 73,10
v_mul_f32 v160, v160, v72
v_mul_f32 v161, v161, v73
CV 10,160,161
SH 160,10
HH 161,10
v_add_f32 v160, v160, v112
v_add_f32 v161, v161, v113
CV 32,160,161
v_sub_f32 v162, v162, v8
v_sub_f32 v163, v163, v8
CV 10,162,163
SH 162,10
HH 163,10
v_mul_f32 v162, v162, v9
v_mul_f32 v163, v163, v9
CV 10,162,163
SH 162,10
HH 163,10
v_add_f32 v74, 1.0, v74
v_add_f32 v75, 1.0, v75
CV 10,74,75
SH 74,10
HH 75,10
v_mul_f32 v162, v162, v74
v_mul_f32 v163, v163, v75
CV 10,162,163
SH 162,10
HH 163,10
v_add_f32 v162, v162, v114
v_add_f32 v163, v163, v115
CV 33,162,163
v_sub_f32 v164, v164, v8
v_sub_f32 v165, v165, v8
CV 10,164,165
SH 164,10
HH 165,10
v_mul_f32 v164, v164, v9
v_mul_f32 v165, v165, v9
CV 10,164,165
SH 164,10
HH 165,10
v_add_f32 v76, 1.0, v76
v_add_f32 v77, 1.0, v77
CV 10,76,77
SH 76,10
HH 77,10
v_mul_f32 v164, v164, v76
v_mul_f32 v165, v165, v77
CV 10,164,165
SH 164,10
HH 165,10
v_add_f32 v164, v164, v116
v_add_f32 v165, v165, v117
CV 34,164,165
v_sub_f32 v166, v166, v8
v_sub_f32 v167, v167, v8
CV 10,166,167
SH 166,10
HH 167,10
v_mul_f32 v166, v166, v9
v_mul_f32 v167, v167, v9
CV 10,166,167
SH 166,10
HH 167,10
v_add_f32 v78, 1.0, v78
v_add_f32 v79, 1.0, v79
CV 10,78,79
SH 78,10
HH 79,10
v_mul_f32 v166, v166, v78
v_mul_f32 v167, v167, v79
CV 10,166,167
SH 166,10
HH 167,10
v_add_f32 v166, v166, v118
v_add_f32 v167, v167, v119
CV 35,166,167
v_lshrrev_b32 v8, 5, v5
v_mul_u32_u24 v8, 40960, v8
v_and_b32 v9, 31, v5
v_lshlrev_b32 v9, 4, v9
v_add_u32 v8, v8, v9
v_lshrrev_b32 v9, 1, v4
v_lshlrev_b32 v9, 10, v9
v_add_u32 v8, v8, v9
v_and_b32 v9, 1, v4
v_lshlrev_b32 v9, 3, v9
v_add_u32 v8, v8, v9
s_mov_b32 s25, 16777216
buffer_store_dwordx2 v[16:17], v8, s[8:11], s25 offen sc1
buffer_store_dwordx2 v[18:19], v8, s[8:11], s25 offen offset:512 sc1
s_add_u32 s25, s25, 8192
buffer_store_dwordx2 v[20:21], v8, s[8:11], s25 offen sc1
buffer_store_dwordx2 v[22:23], v8, s[8:11], s25 offen offset:512 sc1
s_add_u32 s25, s25, 8192
buffer_store_dwordx2 v[24:25], v8, s[8:11], s25 offen sc1
buffer_store_dwordx2 v[26:27], v8, s[8:11], s25 offen offset:512 sc1
s_add_u32 s25, s25, 8192
buffer_store_dwordx2 v[28:29], v8, s[8:11], s25 offen sc1
buffer_store_dwordx2 v[30:31], v8, s[8:11], s25 offen offset:512 sc1
s_add_u32 s25, s25, 8192
buffer_store_dwordx2 v[32:33], v8, s[8:11], s25 offen sc1
buffer_store_dwordx2 v[34:35], v8, s[8:11], s25 offen offset:512 sc1
s_add_u32 s25, s25, 8192
WV 0
s_cmp_eq_u32 s16, 0
s_cbranch_scc0 W_f_123
s_lshl_b32 s23, s58, 2
s_add_u32 s23, s23, 128
s_mov_b64 exec, 1
v_mov_b32 v5, 1
v_mov_b32 v22, s23
buffer_atomic_add v5, v22, s[12:15], 0 offen sc0
s_mov_b64 exec, -1
W_f_123:
WV 0
s_lshl_b32 s48, s55, 7
s_add_u32 s48, s48, 219136
s_branch P_end
P_wf:
s_mov_b32 s40, s41
s_mul_i32 s90, s16, 6144
s_mul_i32 s91, s16, 5120
v_and_b32 v22, 63, v0
v_lshlrev_b32 v1, 4, v22
v_lshrrev_b32 v23, 5, v22
v_lshlrev_b32 v23, 2, v23
v_and_b32 v24, 15, v22
v_lshrrev_b32 v25, 2, v24
v_add_u32 v23, v23, v25
v_lshrrev_b32 v25, 4, v22
v_and_b32 v25, 1, v25
v_lshlrev_b32 v25, 5, v25
v_and_b32 v26, 3, v24
v_lshlrev_b32 v26, 3, v26
v_add_u32 v25, v25, v26
v_mul_u32_u24 v26, 384, v23
v_add_u32 v26, v26, v25
v_lshrrev_b32 v27, 1, v23
v_and_b32 v27, 1, v27
v_lshlrev_b32 v27, 6, v27
v_add_u32 v2, v26, v27
v_sub_u32 v3, v26, v27
v_mul_u32_u24 v26, 320, v23
v_add_u32 v4, v26, v25
s_cmp_lt_u32 s40, 160
s_cbranch_scc0 wf_down_124
s_cmp_ge_u32 s40, 80
s_cselect_b32 s43, 1, 0
s_mul_i32 s23, s43, 80
s_sub_u32 s41, s40, s23
s_mul_i32 s42, s41, 6554
s_lshr_b32 s42, s42, 16
s_mul_i32 s23, s42, 10
s_sub_u32 s41, s41, s23
s_load_dwordx2 s[6:7], s[0:1], 64
s_load_dwordx2 s[18:19], s[0:1], 72
v_and_b32 v22, 63, v0
s_mul_i32 s23, s16, 384
s_add_u32 s23, s23, 0
v_add_u32 v23, s23, v22
v_mul_u32_u24 v24, 2731, v23
v_lshrrev_b32 v24, 16, v24
v_mul_u32_u24 v25, 24, v24
v_sub_u32 v25, v23, v25
v_lshrrev_b32 v26, 1, v24
v_and_b32 v26, 1, v26
v_lshlrev_b32 v26, 2, v26
v_xor_b32 v25, v25, v26
v_lshlrev_b32 v25, 4, v25
v_mul_u32_u24 v24, 3072, v24
v_add_u32 v10, v24, v25
s_mul_i32 s23, s16, 384
s_add_u32 s23, s23, 64
v_add_u32 v23, s23, v22
v_mul_u32_u24 v24, 2731, v23
v_lshrrev_b32 v24, 16, v24
v_mul_u32_u24 v25, 24, v24
v_sub_u32 v25, v23, v25
v_lshrrev_b32 v26, 1, v24
v_and_b32 v26, 1, v26
v_lshlrev_b32 v26, 2, v26
v_xor_b32 v25, v25, v26
v_lshlrev_b32 v25, 4, v25
v_mul_u32_u24 v24, 3072, v24
v_add_u32 v11, v24, v25
s_mul_i32 s23, s16, 384
s_add_u32 s23, s23, 128
v_add_u32 v23, s23, v22
v_mul_u32_u24 v24, 2731, v23
v_lshrrev_b32 v24, 16, v24
v_mul_u32_u24 v25, 24, v24
v_sub_u32 v25, v23, v25
v_lshrrev_b32 v26, 1, v24
v_and_b32 v26, 1, v26
v_lshlrev_b32 v26, 2, v26
v_xor_b32 v25, v25, v26
v_lshlrev_b32 v25, 4, v25
v_mul_u32_u24 v24, 3072, v24
v_add_u32 v12, v24, v25
s_mul_i32 s23, s16, 384
s_add_u32 s23, s23, 192
v_add_u32 v23, s23, v22
v_mul_u32_u24 v24, 2731, v23
v_lshrrev_b32 v24, 16, v24
v_mul_u32_u24 v25, 24, v24
v_sub_u32 v25, v23, v25
v_lshrrev_b32 v26, 1, v24
v_and_b32 v26, 1, v26
v_lshlrev_b32 v26, 2, v26
v_xor_b32 v25, v25, v26
v_lshlrev_b32 v25, 4, v25
v_mul_u32_u24 v24, 3072, v24
v_add_u32 v13, v24, v25
s_mul_i32 s23, s16, 384
s_add_u32 s23, s23, 256
v_add_u32 v23, s23, v22
v_mul_u32_u24 v24, 2731, v23
v_lshrrev_b32 v24, 16, v24
v_mul_u32_u24 v25, 24, v24
v_sub_u32 v25, v23, v25
v_lshrrev_b32 v26, 1, v24
v_and_b32 v26, 1, v26
v_lshlrev_b32 v26, 2, v26
v_xor_b32 v25, v25, v26
v_lshlrev_b32 v25, 4, v25
v_mul_u32_u24 v24, 3072, v24
v_add_u32 v14, v24, v25
s_mul_i32 s23, s16, 384
s_add_u32 s23, s23, 320
v_add_u32 v23, s23, v22
v_mul_u32_u24 v24, 2731, v23
v_lshrrev_b32 v24, 16, v24
v_mul_u32_u24 v25, 24, v24
v_sub_u32 v25, v23, v25
v_lshrrev_b32 v26, 1, v24
v_and_b32 v26, 1, v26
v_lshlrev_b32 v26, 2, v26
v_xor_b32 v25, v25, v26
v_lshlrev_b32 v25, 4, v25
v_mul_u32_u24 v24, 3072, v24
v_add_u32 v15, v24, v25
WL 0
s_cmp_eq_u32 s43, 0
s_cselect_b32 s6, s6, s18
s_cselect_b32 s7, s7, s19
s_mov_b32 s28, s6
s_and_b32 s29, s7, 0xffff
s_mov_b32 s30, 0x1e0000
s_mov_b32 s31, 0x20000
s_mul_i32 s44, s41, 196608
s_mul_i32 s23, s42, 384
s_add_u32 s44, s44, s23
s_mul_i32 s23, s16, 6144
s_add_u32 m0, s23, 0
s_nop 0
DM 10,28,44
s_add_u32 m0, s23, 1024
s_nop 0
DM 11,28,44
s_add_u32 m0, s23, 2048
s_nop 0
DM 12,28,44
s_add_u32 m0, s23, 3072
s_nop 0
DM 13,28,44
s_add_u32 m0, s23, 4096
s_nop 0
DM 14,28,44
s_add_u32 m0, s23, 5120
s_nop 0
DM 15,28,44
s_mul_i32 s45, s42, 12
s_add_u32 s45, s45, s43
s_mul_i32 s45, s45, 40
s_lshl_b32 s23, s41, 2
s_add_u32 s45, s45, s23
s_add_u32 s45, s45, s16
s_lshl_b32 s45, s45, 10
s_add_u32 s45, s45, 228589568
s_mul_i32 s23, s16, 6144
v_add_u32 v28, s23, v2
v_add_u32 v29, s23, v3
WV 0
s_barrier
ds_read_b64_tr_b16 v[32:33], v28 offset:0
ds_read_b64_tr_b16 v[34:35], v28 offset:3072
ds_read_b64_tr_b16 v[36:37], v29 offset:64
ds_read_b64_tr_b16 v[38:39], v29 offset:3136
ds_read_b64_tr_b16 v[40:41], v28 offset:128
ds_read_b64_tr_b16 v[42:43], v28 offset:3200
ds_read_b64_tr_b16 v[44:45], v29 offset:192
ds_read_b64_tr_b16 v[46:47], v29 offset:3264
ds_read_b64_tr_b16 v[48:49], v28 offset:256
ds_read_b64_tr_b16 v[50:51], v28 offset:3328
ds_read_b64_tr_b16 v[52:53], v29 offset:320
ds_read_b64_tr_b16 v[54:55], v29 offset:3392
WL 0
buffer_store_dwordx4 v[32:35], v1, s[8:11], s45 offen sc1
s_add_u32 s45, s45, 81920
buffer_store_dwordx4 v[36:39], v1, s[8:11], s45 offen sc1
s_add_u32 s45, s45, 81920
buffer_store_dwordx4 v[40:43], v1, s[8:11], s45 offen sc1
s_add_u32 s45, s45, 81920
buffer_store_dwordx4 v[44:47], v1, s[8:11], s45 offen sc1
s_add_u32 s45, s45, 81920
buffer_store_dwordx4 v[48:51], v1, s[8:11], s45 offen sc1
s_add_u32 s45, s45, 81920
buffer_store_dwordx4 v[52:55], v1, s[8:11], s45 offen sc1
s_add_u32 s45, s45, 81920
s_branch wf_end_125
wf_down_124:
s_sub_u32 s41, s40, 160
s_mul_i32 s42, s41, 2731
s_lshr_b32 s42, s42, 16
s_mul_i32 s23, s42, 24
s_sub_u32 s41, s41, s23
s_load_dwordx2 s[6:7], s[0:1], 80
v_and_b32 v22, 63, v0
s_mul_i32 s23, s16, 320
s_add_u32 s23, s23, 0
v_add_u32 v23, s23, v22
v_mul_u32_u24 v24, 3277, v23
v_lshrrev_b32 v24, 16, v24
v_mul_u32_u24 v25, 20, v24
v_sub_u32 v25, v23, v25
v_lshlrev_b32 v25, 4, v25
v_mul_u32_u24 v24, 1280, v24
v_add_u32 v16, v24, v25
s_mul_i32 s23, s16, 320
s_add_u32 s23, s23, 64
v_add_u32 v23, s23, v22
v_mul_u32_u24 v24, 3277, v23
v_lshrrev_b32 v24, 16, v24
v_mul_u32_u24 v25, 20, v24
v_sub_u32 v25, v23, v25
v_lshlrev_b32 v25, 4, v25
v_mul_u32_u24 v24, 1280, v24
v_add_u32 v17, v24, v25
s_mul_i32 s23, s16, 320
s_add_u32 s23, s23, 128
v_add_u32 v23, s23, v22
v_mul_u32_u24 v24, 3277, v23
v_lshrrev_b32 v24, 16, v24
v_mul_u32_u24 v25, 20, v24
v_sub_u32 v25, v23, v25
v_lshlrev_b32 v25, 4, v25
v_mul_u32_u24 v24, 1280, v24
v_add_u32 v18, v24, v25
s_mul_i32 s23, s16, 320
s_add_u32 s23, s23, 192
v_add_u32 v23, s23, v22
v_mul_u32_u24 v24, 3277, v23
v_lshrrev_b32 v24, 16, v24
v_mul_u32_u24 v25, 20, v24
v_sub_u32 v25, v23, v25
v_lshlrev_b32 v25, 4, v25
v_mul_u32_u24 v24, 1280, v24
v_add_u32 v19, v24, v25
s_mul_i32 s23, s16, 320
s_add_u32 s23, s23, 256
v_add_u32 v23, s23, v22
v_mul_u32_u24 v24, 3277, v23
v_lshrrev_b32 v24, 16, v24
v_mul_u32_u24 v25, 20, v24
v_sub_u32 v25, v23, v25
v_lshlrev_b32 v25, 4, v25
v_mul_u32_u24 v24, 1280, v24
v_add_u32 v20, v24, v25
WL 0
s_mov_b32 s28, s6
s_and_b32 s29, s7, 0xffff
s_mov_b32 s30, 0x1e0000
s_mov_b32 s31, 0x20000
s_mul_i32 s44, s41, 81920
s_mul_i32 s23, s42, 320
s_add_u32 s44, s44, s23
s_mul_i32 s23, s16, 5120
s_add_u32 m0, s23, 0
s_nop 0
DM 16,28,44
s_add_u32 m0, s23, 1024
s_nop 0
DM 17,28,44
s_add_u32 m0, s23, 2048
s_nop 0
DM 18,28,44
s_add_u32 m0, s23, 3072
s_nop 0
DM 19,28,44
s_add_u32 m0, s23, 4096
s_nop 0
DM 20,28,44
s_mul_i32 s45, s42, 480
s_lshl_b32 s23, s41, 2
s_add_u32 s45, s45, s23
s_add_u32 s45, s45, s16
s_lshl_b32 s45, s45, 10
s_add_u32 s45, s45, 232783872
s_mul_i32 s23, s16, 5120
v_add_u32 v28, s23, v4
WV 0
s_barrier
ds_read_b64_tr_b16 v[32:33], v28 offset:0
ds_read_b64_tr_b16 v[34:35], v28 offset:2560
ds_read_b64_tr_b16 v[36:37], v28 offset:64
ds_read_b64_tr_b16 v[38:39], v28 offset:2624
ds_read_b64_tr_b16 v[40:41], v28 offset:128
ds_read_b64_tr_b16 v[42:43], v28 offset:2688
ds_read_b64_tr_b16 v[44:45], v28 offset:192
ds_read_b64_tr_b16 v[46:47], v28 offset:2752
ds_read_b64_tr_b16 v[48:49], v28 offset:256
ds_read_b64_tr_b16 v[50:51], v28 offset:2816
WL 0
buffer_store_dwordx4 v[32:35], v1, s[8:11], s45 offen sc1
s_add_u32 s45, s45, 98304
buffer_store_dwordx4 v[36:39], v1, s[8:11], s45 offen sc1
s_add_u32 s45, s45, 98304
buffer_store_dwordx4 v[40:43], v1, s[8:11], s45 offen sc1
s_add_u32 s45, s45, 98304
buffer_store_dwordx4 v[44:47], v1, s[8:11], s45 offen sc1
s_add_u32 s45, s45, 98304
buffer_store_dwordx4 v[48:51], v1, s[8:11], s45 offen sc1
s_add_u32 s45, s45, 98304
wf_end_125:
WV 0
s_cmp_eq_u32 s16, 0
s_cbranch_scc0 W_f_126
s_lshl_b32 s23, s58, 2
s_add_u32 s23, s23, 128
s_mov_b64 exec, 1
v_mov_b32 v5, 1
v_mov_b32 v22, s23
buffer_atomic_add v5, v22, s[12:15], 0 offen sc0
s_mov_b64 exec, -1
W_f_126:
WV 0
s_mov_b32 s48, 225024
s_branch P_end
P_f1f:
s_cmp_eq_u32 s54, 1
s_cbranch_scc1 wfok_127
s_mov_b32 s48, 225024
s_cmp_eq_u32 s16, 0
s_cbranch_scc0 dep_129
s_mov_b32 s22, 0
v_mov_b32 v22, 0
dep_128:
buffer_load_dword v23, v22, s[8:11], s48 offen sc1
s_add_u32 s22, s22, 1
s_cmp_gt_u32 s22, 524288
s_cbranch_scc1 dep_129
WV 0
v_readfirstlane_b32 s23, v23
s_nop 3
s_cmp_ge_u32 s23, 256
s_cbranch_scc1 dep_129
s_sleep 8
s_branch dep_128
dep_129:
s_barrier
s_mov_b32 s54, 1
wfok_127:
s_lshl_b32 s55, s40, 7
s_add_u32 s55, s55, 219136
v_and_b32 v22, 63, v0
v_lshlrev_b32 v1, 4, v22
s_mul_i32 s44, s40, 40
s_mul_i32 s23, s16, 10
s_add_u32 s44, s44, s23
s_lshl_b32 s44, s44, 10
s_add_u32 s44, s44, 16777216
s_mul_i32 s45, s41, 160
s_add_u32 s45, s45, s23
s_lshl_b32 s45, s45, 10
s_add_u32 s45, s45, 228589568
s_add_u32 s46, s45, 40960
s_add_u32 s47, s45, 81920
s_add_u32 s48, s45, 122880
LA 4,1,8,45,0
LA 8,1,8,46,0
LA 12,1,8,47,0
LA 16,1,8,48,0
LA 24,1,8,45,1024
LA 28,1,8,46,1024
LA 32,1,8,47,1024
LA 36,1,8,48,1024
LA 44,1,8,45,2048
LA 48,1,8,46,2048
LA 52,1,8,47,2048
LA 56,1,8,48,2048
LA 64,1,8,45,3072
LA 68,1,8,46,3072
LA 72,1,8,47,3072
LA 76,1,8,48,3072
s_add_u32 s45, s45, 4096
s_add_u32 s46, s46, 4096
s_add_u32 s47, s47, 4096
s_add_u32 s48, s48, 4096
LA 84,1,8,45,0
LA 88,1,8,46,0
LA 92,1,8,47,0
LA 96,1,8,48,0
LA 104,1,8,45,1024
LA 108,1,8,46,1024
LA 112,1,8,47,1024
LA 116,1,8,48,1024
LA 124,1,8,45,2048
LA 128,1,8,46,2048
LA 132,1,8,47,2048
LA 136,1,8,48,2048
LA 144,1,8,45,3072
LA 148,1,8,46,3072
LA 152,1,8,47,3072
LA 156,1,8,48,3072
s_add_u32 s45, s45, 4096
s_add_u32 s46, s46, 4096
s_add_u32 s47, s47, 4096
s_add_u32 s48, s48, 4096
LA 164,1,8,45,0
LA 168,1,8,46,0
LA 172,1,8,47,0
LA 176,1,8,48,0
LA 184,1,8,45,1024
LA 188,1,8,46,1024
LA 192,1,8,47,1024
LA 196,1,8,48,1024
s_cmp_eq_u32 s16, 0
s_cbranch_scc0 dep_131
s_mov_b32 s22, 0
v_mov_b32 v22, 0
dep_130:
buffer_load_dword v23, v22, s[8:11], s55 offen sc1
s_add_u32 s22, s22, 1
s_cmp_gt_u32 s22, 524288
s_cbranch_scc1 dep_131
WV 0
v_readfirstlane_b32 s23, v23
s_nop 3
s_cmp_ge_u32 s23, 2
s_cbranch_scc1 dep_131
s_sleep 2
s_branch dep_130
dep_131:
s_barrier
buffer_load_dwordx4 a[0:3], v1, s[8:11], s44 offen offset:0 sc1
buffer_load_dwordx4 a[20:23], v1, s[8:11], s44 offen offset:1024 sc1
buffer_load_dwordx4 a[40:43], v1, s[8:11], s44 offen offset:2048 sc1
buffer_load_dwordx4 a[60:63], v1, s[8:11], s44 offen offset:3072 sc1
s_add_u32 s44, s44, 4096
buffer_load_dwordx4 a[80:83], v1, s[8:11], s44 offen offset:0 sc1
buffer_load_dwordx4 a[100:103], v1, s[8:11], s44 offen offset:1024 sc1
buffer_load_dwordx4 a[120:123], v1, s[8:11], s44 offen offset:2048 sc1
buffer_load_dwordx4 a[140:143], v1, s[8:11], s44 offen offset:3072 sc1
s_add_u32 s44, s44, 4096
buffer_load_dwordx4 a[160:163], v1, s[8:11], s44 offen offset:0 sc1
buffer_load_dwordx4 a[180:183], v1, s[8:11], s44 offen offset:1024 sc1
WV 9
v_mfma_f32_32x32x16_bf16 v[32:47], a[4:7], a[0:3], 0
v_mfma_f32_32x32x16_bf16 v[48:63], a[8:11], a[0:3], 0
v_mfma_f32_32x32x16_bf16 v[64:79], a[12:15], a[0:3], 0
v_mfma_f32_32x32x16_bf16 v[80:95], a[16:19], a[0:3], 0
WV 8
MA 32,24,20
MA 48,28,20
MA 64,32,20
MA 80,36,20
WV 7
MA 32,44,40
MA 48,48,40
MA 64,52,40
MA 80,56,40
WV 6
MA 32,64,60
MA 48,68,60
MA 64,72,60
MA 80,76,60
WV 5
MA 32,84,80
MA 48,88,80
MA 64,92,80
MA 80,96,80
WV 4
MA 32,104,100
MA 48,108,100
MA 64,112,100
MA 80,116,100
WV 3
MA 32,124,120
MA 48,128,120
MA 64,132,120
MA 80,136,120
WV 2
MA 32,144,140
MA 48,148,140
MA 64,152,140
MA 80,156,140
WV 1
MA 32,164,160
MA 48,168,160
MA 64,172,160
MA 80,176,160
WV 0
MA 32,184,180
MA 48,188,180
MA 64,192,180
MA 80,196,180
s_cmp_eq_u32 s16, 0
s_cbranch_scc0 W_f_132
s_lshl_b32 s23, s58, 2
s_add_u32 s23, s23, 128
s_mov_b64 exec, 1
v_mov_b32 v5, 1
v_mov_b32 v22, s23
buffer_atomic_add v5, v22, s[12:15], 0 offen sc0
s_mov_b64 exec, -1
W_f_132:
s_nop 7
v_and_b32 v22, 63, v0
v_lshlrev_b32 v22, 4, v22
s_lshl_b32 s23, s16, 12
v_add_u32 v23, s23, v22
s_lshl_b32 s23, s16, 10
v_add_u32 v24, s23, v22
s_nop 7
ds_write_b128 v23, v[32:35] offset:0
ds_write_b128 v23, v[36:39] offset:1024
ds_write_b128 v23, v[40:43] offset:2048
ds_write_b128 v23, v[44:47] offset:3072
ds_write_b128 v23, v[48:51] offset:16384
ds_write_b128 v23, v[52:55] offset:17408
ds_write_b128 v23, v[56:59] offset:18432
ds_write_b128 v23, v[60:63] offset:19456
ds_write_b128 v23, v[64:67] offset:32768
ds_write_b128 v23, v[68:71] offset:33792
ds_write_b128 v23, v[72:75] offset:34816
ds_write_b128 v23, v[76:79] offset:35840
ds_write_b128 v23, v[80:83] offset:49152
ds_write_b128 v23, v[84:87] offset:50176
ds_write_b128 v23, v[88:91] offset:51200
ds_write_b128 v23, v[92:95] offset:52224
WL 0
s_barrier
ds_read_b128 v[128:131], v24 offset:0
ds_read_b128 v[132:135], v24 offset:4096
ds_read_b128 v[136:139], v24 offset:8192
ds_read_b128 v[140:143], v24 offset:12288
ds_read_b128 v[144:147], v24 offset:16384
ds_read_b128 v[148:151], v24 offset:20480
ds_read_b128 v[152:155], v24 offset:24576
ds_read_b128 v[156:159], v24 offset:28672
WL 0
ds_read_b128 v[160:163], v24 offset:32768
ds_read_b128 v[164:167], v24 offset:36864
ds_read_b128 v[168:171], v24 offset:40960
ds_read_b128 v[172:175], v24 offset:45056
ds_read_b128 v[176:179], v24 offset:49152
ds_read_b128 v[180:183], v24 offset:53248
ds_read_b128 v[184:187], v24 offset:57344
ds_read_b128 v[188:191], v24 offset:61440
WL 0
v_pk_add_f32 v[128:129], v[128:129], v[132:133]
v_pk_add_f32 v[136:137], v[136:137], v[140:141]
v_pk_add_f32 v[32:33], v[128:129], v[136:137]
v_pk_add_f32 v[130:131], v[130:131], v[134:135]
v_pk_add_f32 v[138:139], v[138:139], v[142:143]
v_pk_add_f32 v[34:35], v[130:131], v[138:139]
v_pk_add_f32 v[144:145], v[144:145], v[148:149]
v_pk_add_f32 v[152:153], v[152:153], v[156:157]
v_pk_add_f32 v[36:37], v[144:145], v[152:153]
v_pk_add_f32 v[146:147], v[146:147], v[150:151]
v_pk_add_f32 v[154:155], v[154:155], v[158:159]
v_pk_add_f32 v[38:39], v[146:147], v[154:155]
v_pk_add_f32 v[160:161], v[160:161], v[164:165]
v_pk_add_f32 v[168:169], v[168:169], v[172:173]
v_pk_add_f32 v[40:41], v[160:161], v[168:169]
v_pk_add_f32 v[162:163], v[162:163], v[166:167]
v_pk_add_f32 v[170:171], v[170:171], v[174:175]
v_pk_add_f32 v[42:43], v[162:163], v[170:171]
v_pk_add_f32 v[176:177], v[176:177], v[180:181]
v_pk_add_f32 v[184:185], v[184:185], v[188:189]
v_pk_add_f32 v[44:45], v[176:177], v[184:185]
v_pk_add_f32 v[178:179], v[178:179], v[182:183]
v_pk_add_f32 v[186:187], v[186:187], v[190:191]
v_pk_add_f32 v[46:47], v[178:179], v[186:187]
s_mul_i32 s45, s40, 96
s_lshl_b32 s23, s41, 2
s_add_u32 s45, s45, s23
s_lshr_b32 s23, s16, 1
s_add_u32 s45, s45, s23
s_lshl_b32 s45, s45, 10
s_and_b32 s23, s16, 1
s_lshl_b32 s23, s23, 3
s_add_u32 s45, s45, s23
s_add_u32 s45, s45, 19922944
CV 22,32,33
SH 32,22
HH 33,22
CV 22,36,37
SH 36,22
HH 37,22
v_mul_f32 v32, v32, v36
v_mul_f32 v33, v33, v37
CV 24,32,33
CV 22,34,35
SH 34,22
HH 35,22
CV 22,38,39
SH 38,22
HH 39,22
v_mul_f32 v34, v34, v38
v_mul_f32 v35, v35, v39
CV 25,34,35
buffer_store_dwordx2 v[24:25], v1, s[8:11], s45 offen offset:0 sc1
CV 22,40,41
SH 40,22
HH 41,22
CV 22,44,45
SH 44,22
HH 45,22
v_mul_f32 v40, v40, v44
v_mul_f32 v41, v41, v45
CV 26,40,41
CV 22,42,43
SH 42,22
HH 43,22
CV 22,46,47
SH 46,22
HH 47,22
v_mul_f32 v42, v42, v46
v_mul_f32 v43, v43, v47
CV 27,42,43
buffer_store_dwordx2 v[26:27], v1, s[8:11], s45 offen offset:2048 sc1
WV 0
s_lshl_b32 s48, s40, 7
s_add_u32 s48, s48, 221184
s_branch P_end
P_f2g:
s_lshr_b32 s55, s40, 2
s_lshl_b32 s55, s55, 7
s_add_u32 s55, s55, 221184
s_mov_b32 s53, 8
s_branch P_f2c
P_f2f:
s_lshl_b32 s55, s40, 7
s_add_u32 s55, s55, 221184
s_mov_b32 s53, 24
P_f2c:
s_cmp_eq_u32 s54, 1
s_cbranch_scc1 wfok_133
s_mov_b32 s48, 225024
s_cmp_eq_u32 s16, 0
s_cbranch_scc0 dep_135
s_mov_b32 s22, 0
v_mov_b32 v22, 0
dep_134:
buffer_load_dword v23, v22, s[8:11], s48 offen sc1
s_add_u32 s22, s22, 1
s_cmp_gt_u32 s22, 524288
s_cbranch_scc1 dep_135
WV 0
v_readfirstlane_b32 s23, v23
s_nop 3
s_cmp_ge_u32 s23, 256
s_cbranch_scc1 dep_135
s_sleep 8
s_branch dep_134
dep_135:
s_barrier
s_mov_b32 s54, 1
wfok_133:
v_and_b32 v22, 63, v0
v_lshlrev_b32 v1, 4, v22
s_mul_i32 s23, s16, 24
s_mul_i32 s44, s40, 96
s_add_u32 s44, s44, s23
s_lshl_b32 s44, s44, 10
s_add_u32 s44, s44, 19922944
s_mul_i32 s45, s41, 192
s_add_u32 s45, s45, s23
s_lshl_b32 s45, s45, 10
s_add_u32 s45, s45, 232783872
s_add_u32 s46, s45, 98304
LA 0,1,8,45,0
LA 4,1,8,46,0
LA 8,1,8,45,1024
LA 12,1,8,46,1024
LA 16,1,8,45,2048
LA 20,1,8,46,2048
LA 24,1,8,45,3072
LA 28,1,8,46,3072
s_add_u32 s45, s45, 4096
s_add_u32 s46, s46, 4096
LA 32,1,8,45,0
LA 36,1,8,46,0
LA 40,1,8,45,1024
LA 44,1,8,46,1024
LA 48,1,8,45,2048
LA 52,1,8,46,2048
LA 56,1,8,45,3072
LA 60,1,8,46,3072
s_add_u32 s45, s45, 4096
s_add_u32 s46, s46, 4096
LA 64,1,8,45,0
LA 68,1,8,46,0
LA 72,1,8,45,1024
LA 76,1,8,46,1024
LA 80,1,8,45,2048
LA 84,1,8,46,2048
LA 88,1,8,45,3072
LA 92,1,8,46,3072
s_add_u32 s45, s45, 4096
s_add_u32 s46, s46, 4096
LA 96,1,8,45,0
LA 100,1,8,46,0
LA 104,1,8,45,1024
LA 108,1,8,46,1024
LA 112,1,8,45,2048
LA 116,1,8,46,2048
LA 120,1,8,45,3072
LA 124,1,8,46,3072
s_add_u32 s45, s45, 4096
s_add_u32 s46, s46, 4096
LA 128,1,8,45,0
LA 132,1,8,46,0
LA 136,1,8,45,1024
LA 140,1,8,46,1024
LA 144,1,8,45,2048
LA 148,1,8,46,2048
LA 152,1,8,45,3072
LA 156,1,8,46,3072
s_add_u32 s45, s45, 4096
s_add_u32 s46, s46, 4096
LA 160,1,8,45,0
LA 164,1,8,46,0
LA 168,1,8,45,1024
LA 172,1,8,46,1024
LA 176,1,8,45,2048
LA 180,1,8,46,2048
LA 184,1,8,45,3072
LA 188,1,8,46,3072
s_cmp_eq_u32 s16, 0
s_cbranch_scc0 dep_137
s_mov_b32 s22, 0
v_mov_b32 v22, 0
dep_136:
buffer_load_dword v23, v22, s[8:11], s55 offen sc1
s_add_u32 s22, s22, 1
s_cmp_gt_u32 s22, 524288
s_cbranch_scc1 dep_137
WV 0
v_readfirstlane_b32 s23, v23
s_nop 3
s_cmp_ge_u32 s23, s53
s_cbranch_scc1 dep_137
s_sleep 2
s_branch dep_136
dep_137:
s_barrier
buffer_load_dwordx4 v[128:131], v1, s[8:11], s44 offen offset:0 sc1
buffer_load_dwordx4 v[132:135], v1, s[8:11], s44 offen offset:1024 sc1
buffer_load_dwordx4 v[136:139], v1, s[8:11], s44 offen offset:2048 sc1
buffer_load_dwordx4 v[140:143], v1, s[8:11], s44 offen offset:3072 sc1
s_add_u32 s44, s44, 4096
buffer_load_dwordx4 v[144:147], v1, s[8:11], s44 offen offset:0 sc1
buffer_load_dwordx4 v[148:151], v1, s[8:11], s44 offen offset:1024 sc1
buffer_load_dwordx4 v[152:155], v1, s[8:11], s44 offen offset:2048 sc1
buffer_load_dwordx4 v[156:159], v1, s[8:11], s44 offen offset:3072 sc1
s_add_u32 s44, s44, 4096
buffer_load_dwordx4 v[160:163], v1, s[8:11], s44 offen offset:0 sc1
buffer_load_dwordx4 v[164:167], v1, s[8:11], s44 offen offset:1024 sc1
buffer_load_dwordx4 v[168:171], v1, s[8:11], s44 offen offset:2048 sc1
buffer_load_dwordx4 v[172:175], v1, s[8:11], s44 offen offset:3072 sc1
s_add_u32 s44, s44, 4096
buffer_load_dwordx4 v[176:179], v1, s[8:11], s44 offen offset:0 sc1
buffer_load_dwordx4 v[180:183], v1, s[8:11], s44 offen offset:1024 sc1
buffer_load_dwordx4 v[184:187], v1, s[8:11], s44 offen offset:2048 sc1
buffer_load_dwordx4 v[188:191], v1, s[8:11], s44 offen offset:3072 sc1
s_add_u32 s44, s44, 4096
buffer_load_dwordx4 v[192:195], v1, s[8:11], s44 offen offset:0 sc1
buffer_load_dwordx4 v[196:199], v1, s[8:11], s44 offen offset:1024 sc1
buffer_load_dwordx4 v[200:203], v1, s[8:11], s44 offen offset:2048 sc1
buffer_load_dwordx4 v[204:207], v1, s[8:11], s44 offen offset:3072 sc1
s_add_u32 s44, s44, 4096
buffer_load_dwordx4 v[208:211], v1, s[8:11], s44 offen offset:0 sc1
buffer_load_dwordx4 v[212:215], v1, s[8:11], s44 offen offset:1024 sc1
buffer_load_dwordx4 v[216:219], v1, s[8:11], s44 offen offset:2048 sc1
buffer_load_dwordx4 v[220:223], v1, s[8:11], s44 offen offset:3072 sc1
s_mov_b32 s49, 13631488
v_and_b32 v22, 63, v0
v_and_b32 v23, 31, v22
s_lshl_b32 s23, s40, 5
v_add_u32 v23, s23, v23
v_mul_u32_u24 v23, 1280, v23
v_lshrrev_b32 v24, 5, v22
s_mul_i32 s24, s41, 64
s_lshl_b32 s23, s16, 3
s_add_u32 s24, s24, s23
v_lshlrev_b32 v25, 2, v24
v_add_u32 v25, s24, v25
v_lshlrev_b32 v26, 1, v25
v_add_u32 v116, v23, v26
v_lshlrev_b32 v25, 2, v25
s_mov_b32 s24, 16896
buffer_load_dwordx4 v[100:103], v25, s[8:11], s24 offen offset:0
buffer_load_dwordx2 v[108:109], v116, s[8:11], s49 offen offset:0 sc1
buffer_load_dwordx4 v[104:107], v25, s[8:11], s24 offen offset:128
buffer_load_dwordx2 v[110:111], v116, s[8:11], s49 offen offset:64 sc1
WV 27
v_mfma_f32_32x32x16_bf16 v[32:47], a[0:3], v[128:131], 0
v_mfma_f32_32x32x16_bf16 v[48:63], a[4:7], v[128:131], 0
WV 26
v_mfma_f32_32x32x16_bf16 v[32:47], a[8:11], v[132:135], v[32:47]
v_mfma_f32_32x32x16_bf16 v[48:63], a[12:15], v[132:135], v[48:63]
WV 25
v_mfma_f32_32x32x16_bf16 v[32:47], a[16:19], v[136:139], v[32:47]
v_mfma_f32_32x32x16_bf16 v[48:63], a[20:23], v[136:139], v[48:63]
WV 24
v_mfma_f32_32x32x16_bf16 v[32:47], a[24:27], v[140:143], v[32:47]
v_mfma_f32_32x32x16_bf16 v[48:63], a[28:31], v[140:143], v[48:63]
WV 23
v_mfma_f32_32x32x16_bf16 v[32:47], a[32:35], v[144:147], v[32:47]
v_mfma_f32_32x32x16_bf16 v[48:63], a[36:39], v[144:147], v[48:63]
WV 22
v_mfma_f32_32x32x16_bf16 v[32:47], a[40:43], v[148:151], v[32:47]
v_mfma_f32_32x32x16_bf16 v[48:63], a[44:47], v[148:151], v[48:63]
WV 21
v_mfma_f32_32x32x16_bf16 v[32:47], a[48:51], v[152:155], v[32:47]
v_mfma_f32_32x32x16_bf16 v[48:63], a[52:55], v[152:155], v[48:63]
WV 20
v_mfma_f32_32x32x16_bf16 v[32:47], a[56:59], v[156:159], v[32:47]
v_mfma_f32_32x32x16_bf16 v[48:63], a[60:63], v[156:159], v[48:63]
WV 19
v_mfma_f32_32x32x16_bf16 v[32:47], a[64:67], v[160:163], v[32:47]
v_mfma_f32_32x32x16_bf16 v[48:63], a[68:71], v[160:163], v[48:63]
WV 18
v_mfma_f32_32x32x16_bf16 v[32:47], a[72:75], v[164:167], v[32:47]
v_mfma_f32_32x32x16_bf16 v[48:63], a[76:79], v[164:167], v[48:63]
WV 17
v_mfma_f32_32x32x16_bf16 v[32:47], a[80:83], v[168:171], v[32:47]
v_mfma_f32_32x32x16_bf16 v[48:63], a[84:87], v[168:171], v[48:63]
WV 16
v_mfma_f32_32x32x16_bf16 v[32:47], a[88:91], v[172:175], v[32:47]
v_mfma_f32_32x32x16_bf16 v[48:63], a[92:95], v[172:175], v[48:63]
WV 15
v_mfma_f32_32x32x16_bf16 v[32:47], a[96:99], v[176:179], v[32:47]
v_mfma_f32_32x32x16_bf16 v[48:63], a[100:103], v[176:179], v[48:63]
WV 14
v_mfma_f32_32x32x16_bf16 v[32:47], a[104:107], v[180:183], v[32:47]
v_mfma_f32_32x32x16_bf16 v[48:63], a[108:111], v[180:183], v[48:63]
WV 13
v_mfma_f32_32x32x16_bf16 v[32:47], a[112:115], v[184:187], v[32:47]
v_mfma_f32_32x32x16_bf16 v[48:63], a[116:119], v[184:187], v[48:63]
WV 12
v_mfma_f32_32x32x16_bf16 v[32:47], a[120:123], v[188:191], v[32:47]
v_mfma_f32_32x32x16_bf16 v[48:63], a[124:127], v[188:191], v[48:63]
WV 11
v_mfma_f32_32x32x16_bf16 v[32:47], a[128:131], v[192:195], v[32:47]
v_mfma_f32_32x32x16_bf16 v[48:63], a[132:135], v[192:195], v[48:63]
WV 10
v_mfma_f32_32x32x16_bf16 v[32:47], a[136:139], v[196:199], v[32:47]
v_mfma_f32_32x32x16_bf16 v[48:63], a[140:143], v[196:199], v[48:63]
WV 9
v_mfma_f32_32x32x16_bf16 v[32:47], a[144:147], v[200:203], v[32:47]
v_mfma_f32_32x32x16_bf16 v[48:63], a[148:151], v[200:203], v[48:63]
WV 8
v_mfma_f32_32x32x16_bf16 v[32:47], a[152:155], v[204:207], v[32:47]
v_mfma_f32_32x32x16_bf16 v[48:63], a[156:159], v[204:207], v[48:63]
WV 7
v_mfma_f32_32x32x16_bf16 v[32:47], a[160:163], v[208:211], v[32:47]
v_mfma_f32_32x32x16_bf16 v[48:63], a[164:167], v[208:211], v[48:63]
WV 6
v_mfma_f32_32x32x16_bf16 v[32:47], a[168:171], v[212:215], v[32:47]
v_mfma_f32_32x32x16_bf16 v[48:63], a[172:175], v[212:215], v[48:63]
WV 5
v_mfma_f32_32x32x16_bf16 v[32:47], a[176:179], v[216:219], v[32:47]
v_mfma_f32_32x32x16_bf16 v[48:63], a[180:183], v[216:219], v[48:63]
WV 4
v_mfma_f32_32x32x16_bf16 v[32:47], a[184:187], v[220:223], v[32:47]
v_mfma_f32_32x32x16_bf16 v[48:63], a[188:191], v[220:223], v[48:63]
s_cmp_eq_u32 s16, 0
s_cbranch_scc0 W_f_138
s_lshl_b32 s23, s58, 2
s_add_u32 s23, s23, 128
s_mov_b64 exec, 1
v_mov_b32 v5, 1
v_mov_b32 v22, s23
buffer_atomic_add v5, v22, s[12:15], 0 offen sc0
s_mov_b64 exec, -1
W_f_138:
s_nop 7
v_and_b32 v22, 63, v0
v_lshlrev_b32 v22, 4, v22
s_lshl_b32 s23, s16, 12
v_add_u32 v23, s23, v22
s_lshl_b32 s23, s16, 10
v_add_u32 v24, s23, v22
s_nop 7
ds_write_b128 v23, v[32:35] offset:0
ds_write_b128 v23, v[36:39] offset:1024
ds_write_b128 v23, v[40:43] offset:2048
ds_write_b128 v23, v[44:47] offset:3072
ds_write_b128 v23, v[48:51] offset:16384
ds_write_b128 v23, v[52:55] offset:17408
ds_write_b128 v23, v[56:59] offset:18432
ds_write_b128 v23, v[60:63] offset:19456
WL 0
s_barrier
ds_read_b128 v[128:131], v24 offset:0
ds_read_b128 v[132:135], v24 offset:4096
ds_read_b128 v[136:139], v24 offset:8192
ds_read_b128 v[140:143], v24 offset:12288
ds_read_b128 v[144:147], v24 offset:16384
ds_read_b128 v[148:151], v24 offset:20480
ds_read_b128 v[152:155], v24 offset:24576
ds_read_b128 v[156:159], v24 offset:28672
WL 0
v_pk_add_f32 v[128:129], v[128:129], v[132:133]
v_pk_add_f32 v[136:137], v[136:137], v[140:141]
v_pk_add_f32 v[32:33], v[128:129], v[136:137]
v_pk_add_f32 v[130:131], v[130:131], v[134:135]
v_pk_add_f32 v[138:139], v[138:139], v[142:143]
v_pk_add_f32 v[34:35], v[130:131], v[138:139]
v_pk_add_f32 v[144:145], v[144:145], v[148:149]
v_pk_add_f32 v[152:153], v[152:153], v[156:157]
v_pk_add_f32 v[36:37], v[144:145], v[152:153]
v_pk_add_f32 v[146:147], v[146:147], v[150:151]
v_pk_add_f32 v[154:155], v[154:155], v[158:159]
v_pk_add_f32 v[38:39], v[146:147], v[154:155]
WV 0
CV 26,32,33
SH 32,26
HH 33,26
v_mul_f32 v32, v32, v100
v_mul_f32 v33, v33, v101
CV 26,32,33
SH 32,26
HH 33,26
SH 27,108
HH 28,108
v_add_f32 v32, v32, v27
v_add_f32 v33, v33, v28
CV 108,32,33
CV 26,34,35
SH 34,26
HH 35,26
v_mul_f32 v34, v34, v102
v_mul_f32 v35, v35, v103
CV 26,34,35
SH 34,26
HH 35,26
SH 27,109
HH 28,109
v_add_f32 v34, v34, v27
v_add_f32 v35, v35, v28
CV 109,34,35
buffer_store_dwordx2 v[108:109], v116, s[84:87], 0 offen offset:0
CV 26,36,37
SH 36,26
HH 37,26
v_mul_f32 v36, v36, v104
v_mul_f32 v37, v37, v105
CV 26,36,37
SH 36,26
HH 37,26
SH 27,110
HH 28,110
v_add_f32 v36, v36, v27
v_add_f32 v37, v37, v28
CV 110,36,37
CV 26,38,39
SH 38,26
HH 39,26
v_mul_f32 v38, v38, v106
v_mul_f32 v39, v39, v107
CV 26,38,39
SH 38,26
HH 39,26
SH 27,111
HH 28,111
v_add_f32 v38, v38, v27
v_add_f32 v39, v39, v28
CV 111,38,39
buffer_store_dwordx2 v[110:111], v116, s[84:87], 0 offen offset:64
WV 0
s_mov_b32 s48, -1
P_end:
s_cmp_eq_u32 s16, 0
s_cbranch_scc0 W_p_139
s_mov_b64 exec, 1
v_mov_b32 v22, 147456
ds_write_b32 v22, v5
WL 0
s_mov_b64 exec, -1
W_p_139:
s_barrier
s_cmp_eq_u32 s48, -1
s_cbranch_scc1 P_nosig_140
s_cmp_eq_u32 s16, 0
s_cbranch_scc0 sig_141
s_mov_b64 exec, 1
v_mov_b32 v22, 1
v_mov_b32 v23, 0
buffer_atomic_add v22, v23, s[8:11], s48 offen
s_mov_b64 exec, -1
sig_141:
P_nosig_140:
s_branch P_loop
.p2align 2
.type P_table,@object
P_table:
.long 524288,524289,524290,524291,524292,524293,524294,524295,524296,524297,524298,524299,524300,524301,524302,524303
.long 524304,524305,524306,524307,524308,524309,524310,524311,524312,524313,524314,524315,524316,524317,524318,524319
.long 0,1,2,3,4,5,6,7,8,9,10,11,12,13,14,15
.long 16,17,18,19,256,257,258,259,260,261,262,263,264,265,266,267
.long 268,269,270,271,272,273,274,275,512,513,514,515,516,517,518,519
.long 520,521,522,523,524,525,526,527,528,529,530,531,768,769,770,771
.long 772,773,774,775,776,777,778,779,780,781,782,783,784,785,786,787
.long 1024,1025,1026,1027,1028,1029,1030,1031,1032,1033,1034,1035,1036,1037,1038,1039
.long 1040,1041,1042,1043,1280,1281,1282,1283,1284,1285,1286,1287,1288,1289,1290,1291
.long 1292,1293,1294,1295,1296,1297,1298,1299,1536,1537,1538,1539,1540,1541,1542,1543
.long 1544,1545,1546,1547,1548,1549,1550,1551,1552,1553,1554,1555,1792,1793,1794,1795
.long 1796,1797,1798,1799,1800,1801,1802,1803,1804,1805,1806,1807,1808,1809,1810,1811
.long 2048,2049,2050,2051,2052,2053,2054,2055,2056,2057,2058,2059,2060,2061,2062,2063
.long 2064,2065,2066,2067,2304,2305,2306,2307,2308,2309,2310,2311,2312,2313,2314,2315
.long 2316,2317,2318,2319,2320,2321,2322,2323,2560,2561,2562,2563,2564,2565,2566,2567
.long 2568,2569,2570,2571,2572,2573,2574,2575,2576,2577,2578,2579,2816,2817,2818,2819
.long 2820,2821,2822,2823,2824,2825,2826,2827,2828,2829,2830,2831,2832,2833,2834,2835
.long 3072,3073,3074,3075,3076,3077,3078,3079,3080,3081,3082,3083,3084,3085,3086,3087
.long 3088,3089,3090,3091,3328,3329,3330,3331,3332,3333,3334,3335,3336,3337,3338,3339
.long 3340,3341,3342,3343,3344,3345,3346,3347,524320,524321,524322,524323,524324,524325,524326,524327
.long 524328,524329,524330,524331,524332,524333,524334,524335,524336,524337,524338,524339,524340,524341,524342,524343
.long 524344,524345,524346,524347,524348,524349,524350,524351,524352,524353,524354,524355,524356,524357,524358,524359
.long 524360,524361,524362,524363,524364,524365,524366,524367,524368,524369,524370,524371,524372,524373,524374,524375
.long 524376,524377,524378,524379,524380,524381,524382,524383,524384,524385,524386,524387,524388,524389,524390,524391
.long 524392,524393,524394,524395,524396,524397,524398,524399,524400,524401,524402,524403,524404,524405,524406,524407
.long 524408,524409,524410,524411,524412,524413,524414,524415,524416,524417,524418,524419,524420,524421,524422,524423
.long 524424,524425,524426,524427,524428,524429,524430,524431,524432,524433,524434,524435,524436,524437,524438,524439
.long 524440,524441,524442,524443,524444,524445,524446,524447,524448,524449,524450,524451,524452,524453,524454,524455
.long 524456,524457,524458,524459,524460,524461,524462,524463,524464,524465,524466,524467,524468,524469,524470,524471
.long 524472,524473,524474,524475,524476,524477,524478,524479,524480,524481,524482,524483,524484,524485,524486,524487
.long 524488,524489,524490,524491,524492,524493,524494,524495,524496,524497,524498,524499,524500,524501,524502,524503
.long 524504,524505,524506,524507,524508,524509,524510,524511,524512,524513,524514,524515,524516,524517,524518,524519
.long 524520,524521,524522,524523,524524,524525,524526,524527,524528,524529,524530,524531,524532,524533,524534,524535
.long 524536,524537,524538,524539,524540,524541,524542,524543,65536,65537,65538,65539,65792,65793,65794,65795
.long 66048,66049,66050,66051,66304,66305,66306,66307,66560,66561,66562,66563,66816,66817,66818,66819
.long 67072,67073,67074,67075,67328,67329,67330,67331,67584,67585,67586,67587,67840,67841,67842,67843
.long 131072,131073,131074,131075,131076,131077,131078,131079,131328,131329,131330,131331,131332,131333,131334,131335
.long 131584,131585,131586,131587,131588,131589,131590,131591,131840,131841,131842,131843,131844,131845,131846,131847
.long 132096,132097,132098,132099,132100,132101,132102,132103,132352,132353,132354,132355,132356,132357,132358,132359
.long 132608,132609,132610,132611,132612,132613,132614,132615,132864,132865,132866,132867,132868,132869,132870,132871
.long 133120,133121,133122,133123,133124,133125,133126,133127,133376,133377,133378,133379,133380,133381,133382,133383
.long 196608,196609,196610,196611,196864,196865,196866,196867,197120,197121,197122,197123,197376,197377,197378,197379
.long 197632,197633,197634,197635,197888,197889,197890,197891,198144,198145,198146,198147,198400,198401,198402,198403
.long 198656,198657,198658,198659,198912,198913,198914,198915,68096,68097,68098,68099,133632,133633,133634,133635
.long 133636,133637,133638,133639,68352,68353,68354,68355,133888,133889,133890,133891,133892,133893,133894,133895
.long 68608,68609,68610,68611,199168,199169,199170,199171,276480,276481,276482,276483,276484,276485,276486,276487
.long 276488,276489,134144,134145,134146,134147,134148,134149,134150,134151,276736,276737,276738,276739,276740,276741
.long 276742,276743,276744,276745,276992,276993,276994,276995,276996,276997,276998,276999,277000,277001,68864,68865
.long 68866,68867,342016,342017,277248,277249,277250,277251,277252,277253,277254,277255,277256,277257,342272,342273
.long 601088,601089,601090,601091,601092,601093,601094,601095,601096,601097,601344,601345,601346,601347,601348,601349
.long 601350,601351,601352,601353,601600,601601,601602,601603,601604,601605,601606,601607,601608,601609,601856,601857
.long 601858,601859,601860,601861,601862,601863,601864,601865,407552,407553,407554,407555,407556,407557,407558,407559
.long 407560,407561,407562,407563,407564,407565,407566,407567,407568,407569,407570,407571,407572,407573,407574,407575
.long 277504,277505,277506,277507,277508,277509,277510,277511,277512,277513,342528,342529,134400,134401,134402,134403
.long 134404,134405,134406,134407,407808,407809,407810,407811,407812,407813,407814,407815,407816,407817,407818,407819
.long 407820,407821,407822,407823,407824,407825,407826,407827,407828,407829,407830,407831,277760,277761,277762,277763
.long 277764,277765,277766,277767,277768,277769,342784,342785,473088,473089,473090,473091,473092,473093,473094,473095
.long 473096,473097,408064,408065,408066,408067,408068,408069,408070,408071,408072,408073,408074,408075,408076,408077
.long 408078,408079,408080,408081,408082,408083,408084,408085,408086,408087,278016,278017,278018,278019,278020,278021
.long 278022,278023,278024,278025,343040,343041,473344,473345,473346,473347,473348,473349,473350,473351,473352,473353
.long 408320,408321,408322,408323,408324,408325,408326,408327,408328,408329,408330,408331,408332,408333,408334,408335
.long 408336,408337,408338,408339,408340,408341,408342,408343,278272,278273,278274,278275,278276,278277,278278,278279
.long 278280,278281,343296,343297,602112,602113,602114,602115,602116,602117,602118,602119,602120,602121,602368,602369
.long 602370,602371,602372,602373,602374,602375,602376,602377,602624,602625,602626,602627,602628,602629,602630,602631
.long 602632,602633,602880,602881,602882,602883,602884,602885,602886,602887,602888,602889,473600,473601,473602,473603
.long 473604,473605,473606,473607,473608,473609,408576,408577,408578,408579,408580,408581,408582,408583,408584,408585
.long 408586,408587,408588,408589,408590,408591,408592,408593,408594,408595,408596,408597,408598,408599,343552,343553
.long 473856,473857,473858,473859,473860,473861,473862,473863,473864,473865,408832,408833,408834,408835,408836,408837
.long 408838,408839,408840,408841,408842,408843,408844,408845,408846,408847,408848,408849,408850,408851,408852,408853
.long 408854,408855,343808,343809,474112,474113,474114,474115,474116,474117,474118,474119,474120,474121,409088,409089
.long 409090,409091,409092,409093,409094,409095,409096,409097,409098,409099,409100,409101,409102,409103,409104,409105
.long 409106,409107,409108,409109,409110,409111,474368,474369,474370,474371,474372,474373,474374,474375,474376,474377
.long 409344,409345,409346,409347,409348,409349,409350,409351,409352,409353,409354,409355,409356,409357,409358,409359
.long 409360,409361,409362,409363,409364,409365,409366,409367,603136,603137,603138,603139,603140,603141,603142,603143
.long 603144,603145,603392,603393,603394,603395,603396,603397,603398,603399,603400,603401,603648,603649,603650,603651
.long 603652,603653,603654,603655,603656,603657,603904,603905,603906,603907,603908,603909,603910,603911,603912,603913
.long 474624,474625,474626,474627,474628,474629,474630,474631,474632,474633,474880,474881,474882,474883,474884,474885
.long 474886,474887,474888,474889
.size P_table, 4944
.section .rodata,"a"
.p2align 6
.amdhsa_kernel main_kernel
  .amdhsa_next_free_vgpr 512
  .amdhsa_next_free_sgpr 100
  .amdhsa_accum_offset 256
  .amdhsa_group_segment_fixed_size 0
  .amdhsa_kernarg_size 128
  .amdhsa_user_sgpr_count 2
  .amdhsa_user_sgpr_kernarg_segment_ptr 1
  .amdhsa_system_sgpr_workgroup_id_x 1
  .amdhsa_float_denorm_mode_32 3
  .amdhsa_float_denorm_mode_16_64 3
.end_amdhsa_kernel
```
